```python
import torch

def _softmax(x, axis=-1):
    return torch.softmax(x, dim=axis)
def _gelu(x):
    return torch.nn.functional.gelu(x, approximate="tanh")
def _silu(x):
    return torch.nn.functional.silu(x)
def _sigmoid(x):
    return torch.sigmoid(x)
def _layernorm(x, axis=-1, eps=1e-5):
    m = x.mean(dim=axis, keepdim=True)
    v = x.var(dim=axis, keepdim=True, unbiased=False)
    return (x - m) / torch.sqrt(v + eps)
def _scatter_add(tgt, idx, src, axis=0):
    return tgt.clone().index_add_(axis, idx, src)
def _segment_sum(src, seg, n):
    out = torch.zeros((n,) + src.shape[1:], dtype=src.dtype)
    return out.index_add_(0, seg, src)
def _pad(x, pw):
    flat = tuple(v for pair in reversed(pw) for v in pair)
    return torch.nn.functional.pad(x, flat)

kernel_name = 'standalone__dcn_v2_cross__recsys'

def setup_inputs():

    _w = (lambda a: (lambda t: t.to(torch.bfloat16) if t.is_floating_point() else t)(torch.as_tensor(a)))
    B, F, D, L = 16384, 100, 64, 3
    Din = min(F * D, 1024)
    return {
        "x0": _w((lambda *s: torch.randn(*s, dtype=torch.bfloat16) * 0.05)(B, Din)),
        "ws": _w((lambda *s: torch.randn(*s, dtype=torch.bfloat16) * 0.05)(L, Din, Din)),
        "bs": _w((lambda *s: torch.randn(*s, dtype=torch.bfloat16) * 0.05)(L, Din)),
    }

def reference(x0, ws, bs):
    x = x0
    for l in range(ws.shape[0]):
        x = x0 * (x @ ws[l] + bs[l]) + x
    return x
```

```asm
; @launch grid=(256,1,1) block=(256,1,1) lds=163840
.amdgcn_target "amdgcn-amd-amdhsa--gfx950"
.text
.globl standalone__dcn_v2_cross__recsys_kernel
.p2align 12
.p2align 8
.type standalone__dcn_v2_cross__recsys_kernel,@function
standalone__dcn_v2_cross__recsys_kernel:
s_load_dwordx4 s[4:7], s[0:1], 0
s_load_dwordx4 s[16:19], s[0:1], 16
s_load_dwordx4 s[84:87], s[0:1], 32
s_cmp_ge_u32 s2, 256
s_cbranch_scc0 L_go
s_endpgm
L_go:
s_getpc_b64 s[40:41]
L_pcbase:
v_lshrrev_b32 v8, 6, v0
v_and_b32 v9, 63, v0
s_mov_b32 s42, L_end-L_pcbase
s_mov_b32 s43, 0x20000
s_lshr_b32 s63, s2, 3
s_lshl_b32 s63, s63, 9
v_lshlrev_b32 v3, 14, v9
v_lshl_add_u32 v3, v8, 7, v3
buffer_load_dword v3, v3, s[40:43], s63 offen
v_readfirstlane_b32 s55, v8
v_lshlrev_b32 v0, 4, v9
s_bfe_u32 s3, s2, 0x10003
s_and_b32 s71, s2, 7
s_lshr_b32 s70, s2, 4
s_lshl_b32 s54, s70, 3
s_or_b32 s71, s71, s54
s_lshl_b32 s71, s71, 18
s_and_b32 s70, s70, 0
s_lshl_b32 s66, s3, 10
s_lshl_b32 s54, s70, 8
s_or_b32 s58, s66, s54
s_xor_b32 s59, s58, 0x400
s_lshl_b32 s68, s58, 10
s_lshl_b32 s69, s59, 10
s_lshl_b32 s56, s55, 11
v_lshrrev_b32 v10, 2, v9
v_lshlrev_b32 v10, 11, v10
v_lshrrev_b32 v11, 5, v9
v_lshlrev_b32 v11, 1, v11
v_xor_b32 v11, v11, v9
v_and_b32 v11, 3, v11
v_lshl_add_u32 v10, v11, 4, v10
s_lshl_b32 s54, s55, 16
v_add_u32 v4, s54, v10
v_add_u32 v5, 31744, v4
v_lshrrev_b32 v10, 3, v9
v_lshlrev_b32 v10, 11, v10
v_lshrrev_b32 v11, 2, v9
v_and_b32 v11, 4, v11
v_xor_b32 v11, v11, v9
v_and_b32 v11, 7, v11
v_lshl_add_u32 v20, v11, 4, v10
s_lshl_b32 s67, s55, 8
s_add_u32 s66, s66, s67
v_add_u32 v23, 15360, v20
v_add_u32 v18, 30720, v20
v_add_u32 v19, 46080, v20
s_lshl_b32 s60, s55, 12
s_lshr_b32 s76, s2, 5
s_lshl_b32 s76, s76, 18
s_bfe_u32 s54, s2, 196608
s_lshl_b32 s54, s54, 8
s_add_u32 s76, s76, s54
s_bfe_u32 s54, s2, 131075
s_lshl_b32 s54, s54, 6
s_add_u32 s76, s76, s54
s_waitcnt lgkmcnt(0)
s_add_u32 s8, s4, s71
s_addc_u32 s9, s5, 0
s_add_u32 s72, s6, s66
s_addc_u32 s73, s7, 0
s_mov_b32 s4, s6
s_mov_b32 s5, s7
s_mov_b32 s6, 6291456
s_mov_b32 s7, 0x20000
s_add_u32 m0, s60, 65536
s_xor_b32 s74, s68, 0
s_add_u32 s74, s74, s72
s_addc_u32 s75, s73, 0
global_load_lds_dwordx4 v20, s[74:75] offset:0
global_load_lds_dwordx4 v23, s[74:75] offset:1024
global_load_lds_dwordx4 v18, s[74:75] offset:2048
global_load_lds_dwordx4 v19, s[74:75] offset:3072
s_add_u32 m0, s60, 81920
s_xor_b32 s74, s68, 65536
s_add_u32 s74, s74, s72
s_addc_u32 s75, s73, 0
global_load_lds_dwordx4 v20, s[74:75] offset:0
global_load_lds_dwordx4 v23, s[74:75] offset:1024
global_load_lds_dwordx4 v18, s[74:75] offset:2048
global_load_lds_dwordx4 v19, s[74:75] offset:3072
s_add_u32 m0, s56, 0
s_xor_b32 s10, s58, 0
s_add_u32 s10, s10, s8
s_addc_u32 s11, s9, 0
global_load_lds_dwordx4 v4, s[10:11]
global_load_lds_dwordx4 v5, s[10:11] offset:1024
s_add_u32 m0, s56, 8192
s_xor_b32 s10, s58, 64
s_add_u32 s10, s10, s8
s_addc_u32 s11, s9, 0
global_load_lds_dwordx4 v4, s[10:11]
global_load_lds_dwordx4 v5, s[10:11] offset:1024
s_add_u32 s20, s18, s71
s_addc_u32 s21, s19, 0
s_mov_b32 s22, 262144
s_mov_b32 s23, 0x20000
s_mov_b32 s18, 6144
s_mov_b32 s19, 0x20000
v_and_b32 v12, 48, v9
buffer_load_dwordx4 a[96:99], v12, s[16:19], s66 offen offset:0
buffer_load_dwordx4 a[100:103], v12, s[16:19], s66 offen offset:64
buffer_load_dwordx4 a[104:107], v12, s[16:19], s66 offen offset:128
buffer_load_dwordx4 a[108:111], v12, s[16:19], s66 offen offset:192
v_lshrrev_b32 v13, 1, v9
v_lshlrev_b32 v13, 11, v13
v_and_b32 v14, 1, v9
v_lshl_add_u32 v13, v14, 7, v13
buffer_load_dword v13, v13, s[16:19], s66 offen offset:2048
s_lshr_b32 s54, s2, 5
s_lshl_b32 s54, s54, 2
s_add_u32 s54, s54, s55
s_lshl_b32 s67, s2, 2
s_and_b32 s67, s67, 16
s_xor_b32 s54, s54, s67
s_bfe_u32 s67, s2, 196608
s_mul_i32 s67, s67, 96
s_add_u32 s54, s54, s67
s_lshl_b32 s54, s54, 13
s_bfe_u32 s67, s2, 131075
s_lshl_b32 s67, s67, 11
s_add_u32 s77, s54, s67
s_lshl_b32 s62, s2, 2
s_add_u32 s62, s62, s55
s_lshr_b32 s54, s62, 4
s_add_u32 s54, s54, 32
s_lshl_b32 s78, s54, 16
s_and_b32 s67, s62, 15
s_lshl_b32 s67, s67, 7
s_add_u32 s78, s78, s67
s_lshl_b32 s67, s62, 1
s_and_b32 s67, s67, 16
s_xor_b32 s54, s54, s67
s_bfe_u32 s67, s62, 0x30001
s_mul_i32 s67, s67, 96
s_add_u32 s54, s54, s67
s_lshl_b32 s54, s54, 13
s_and_b32 s67, s62, 1
s_lshl_b32 s67, s67, 12
s_add_u32 s79, s54, s67
s_mov_b32 s80, s86
s_mov_b32 s81, s87
s_mov_b32 s82, 6291456
s_mov_b32 s83, 0x20000
v_lshrrev_b32 v10, 4, v9
v_and_b32 v11, 15, v9
v_lshrrev_b32 v12, 3, v11
v_lshlrev_b32 v12, 1, v12
v_xor_b32 v12, v12, v10
v_lshl_add_u32 v12, v11, 2, v12
v_lshlrev_b32 v1, 4, v12
s_add_u32 s54, s60, 65536
v_lshlrev_b32 v10, 10, v10
v_bfe_u32 v11, v9, 2, 2
v_lshl_add_u32 v10, v11, 7, v10
v_lshrrev_b32 v11, 1, v11
v_lshl_add_u32 v10, v11, 6, v10
v_and_b32 v11, 3, v9
v_lshl_add_u32 v10, v11, 4, v10
v_add_u32 v21, s54, v10
v_xor_b32 v22, 64, v21
v_and_b32 v11, 1, v9
v_lshlrev_b32 v11, 4, v11
v_mov_b32 v10, 0x3f80
v_lshlrev_b32 v10, v11, v10
v_and_b32 v11, 2, v9
v_cmp_eq_u32 vcc, 0, v11
s_nop 1
v_cndmask_b32 v6, 0, v10, vcc
v_sub_u32 v7, v10, v6
s_lshl_b32 s64, s70, 15
s_lshl_b32 s57, s55, 13
s_xor_b32 s65, s55, s70
s_lshl_b32 s65, s65, 15
s_mov_b32 s53, 0xffff0000
s_mul_i32 s54, s66, 3072
s_add_u32 s12, s86, s54
s_addc_u32 s13, s87, 0
s_mov_b32 s14, 786432
s_mov_b32 s15, 0x20000
s_lshl_b32 s54, s2, 18
s_add_u32 s54, s54, 8388608
s_add_u32 s54, s54, s57
s_add_u32 s24, s86, s54
s_addc_u32 s25, s87, 0
s_mov_b32 s26, 237568
s_mov_b32 s27, 0x20000
s_xor_b32 s54, s2, 8
s_lshl_b32 s54, s54, 18
s_add_u32 s54, s54, 8388608
s_add_u32 s54, s54, s56
s_add_u32 s28, s86, s54
s_addc_u32 s29, s87, 0
s_lshl_b32 s54, s2, 10
s_add_u32 s54, s54, 6291456
s_add_u32 s32, s86, s54
s_addc_u32 s33, s87, 0
s_mov_b32 s34, 1024
s_mov_b32 s35, 0x20000
s_xor_b32 s54, s54, 0x2000
s_lshl_b32 s67, s55, 4
s_add_u32 s54, s54, s67
s_add_u32 s36, s86, s54
s_addc_u32 s37, s87, 0
s_mov_b32 s38, 4
s_mov_b32 s39, 0x20000
s_mov_b32 s86, 256
s_mov_b32 s87, 0x20000
v_lshrrev_b32 v11, 3, v9
v_and_b32 v11, 2, v11
v_xor_b32 v11, v11, v9
v_and_b32 v11, 3, v11
v_bfe_u32 v12, v9, 2, 2
v_lshlrev_b32 v12, 6, v12
v_lshl_add_u32 v11, v11, 4, v12
v_lshrrev_b32 v12, 4, v9
v_lshl_add_u32 v11, v12, 9, v11
s_add_u32 s54, s56, 147456
v_add_u32 v10, s54, v11
s_lshl_b32 s54, s55, 7
s_add_u32 s63, s63, s54
s_add_u32 m0, s56, 147456
s_nop 0
buffer_load_dwordx4 v4, s[4:7], s76 offen offset:0 lds
buffer_load_dwordx4 v5, s[4:7], s76 offen offset:1024 lds
s_mov_b64 exec, 0
s_cmp_eq_u32 s55, 0
s_cbranch_scc1 L_pad1
s_cmp_eq_u32 s55, 1
s_cbranch_scc1 L_pad2
s_cmp_eq_u32 s55, 2
s_cbranch_scc1 L_pad3
s_branch L_pad4
L_tret0:
s_mov_b64 exec, -1

s_waitcnt vmcnt(15)
ds_read_b64_tr_b16 a[192:193], v21 offset:0
ds_read_b64_tr_b16 a[194:195], v21 offset:512
ds_read_b64_tr_b16 a[196:197], v21 offset:8
ds_read_b64_tr_b16 a[198:199], v21 offset:520
ds_read_b64_tr_b16 a[200:201], v22 offset:0
ds_read_b64_tr_b16 a[202:203], v22 offset:512
ds_read_b64_tr_b16 a[204:205], v22 offset:8
ds_read_b64_tr_b16 a[206:207], v22 offset:520
s_add_u32 m0, s56, 131072
s_xor_b32 s10, s59, 0
s_add_u32 s10, s10, s8
s_addc_u32 s11, s9, 0
global_load_lds_dwordx4 v4, s[10:11]
global_load_lds_dwordx4 v5, s[10:11] offset:1024
s_add_u32 m0, s56, 139264
s_xor_b32 s10, s59, 64
s_add_u32 s10, s10, s8
s_addc_u32 s11, s9, 0
global_load_lds_dwordx4 v4, s[10:11]
global_load_lds_dwordx4 v5, s[10:11] offset:1024
s_waitcnt vmcnt(15)
ds_read_b64_tr_b16 a[208:209], v21 offset:16384
ds_read_b64_tr_b16 a[210:211], v21 offset:16896
ds_read_b64_tr_b16 a[212:213], v21 offset:16392
ds_read_b64_tr_b16 a[214:215], v21 offset:16904
ds_read_b64_tr_b16 a[216:217], v22 offset:16384
ds_read_b64_tr_b16 a[218:219], v22 offset:16896
ds_read_b64_tr_b16 a[220:221], v22 offset:16392
ds_read_b64_tr_b16 a[222:223], v22 offset:16904
s_add_u32 m0, s60, 98304
s_xor_b32 s74, s69, 0
s_add_u32 s74, s74, s72
s_addc_u32 s75, s73, 0
global_load_lds_dwordx4 v20, s[74:75] offset:0
global_load_lds_dwordx4 v23, s[74:75] offset:1024
global_load_lds_dwordx4 v18, s[74:75] offset:2048
global_load_lds_dwordx4 v19, s[74:75] offset:3072
s_waitcnt vmcnt(15)
s_barrier
v_add_u32 v2, 0, v1
ds_read_b128 a[128:131], v2 offset:0
ds_read_b128 a[132:135], v2 offset:8192
ds_read_b128 a[136:139], v2 offset:9216
ds_read_b128 a[140:143], v2 offset:1024
ds_read_b128 a[144:147], v2 offset:2048
ds_read_b128 a[148:151], v2 offset:10240
ds_read_b128 a[152:155], v2 offset:11264
ds_read_b128 a[156:159], v2 offset:3072
ds_read_b128 a[160:163], v2 offset:4096
ds_read_b128 a[164:167], v2 offset:12288
ds_read_b128 a[168:171], v2 offset:13312
ds_read_b128 a[172:175], v2 offset:5120
ds_read_b128 a[176:179], v2 offset:6144
ds_read_b128 a[180:183], v2 offset:14336
ds_read_b128 a[184:187], v2 offset:15360
ds_read_b128 a[188:191], v2 offset:7168
s_add_u32 m0, s60, 114688
s_xor_b32 s74, s69, 65536
s_add_u32 s74, s74, s72
s_addc_u32 s75, s73, 0
global_load_lds_dwordx4 v20, s[74:75] offset:0
global_load_lds_dwordx4 v23, s[74:75] offset:1024
global_load_lds_dwordx4 v18, s[74:75] offset:2048
global_load_lds_dwordx4 v19, s[74:75] offset:3072
s_add_u32 m0, s56, 16384
s_xor_b32 s10, s58, 128
s_add_u32 s10, s10, s8
s_addc_u32 s11, s9, 0
global_load_lds_dwordx4 v4, s[10:11]
global_load_lds_dwordx4 v5, s[10:11] offset:1024
s_add_u32 m0, s56, 24576
s_xor_b32 s10, s58, 192
s_add_u32 s10, s10, s8
s_addc_u32 s11, s9, 0
global_load_lds_dwordx4 v4, s[10:11]
global_load_lds_dwordx4 v5, s[10:11] offset:1024
s_waitcnt vmcnt(19)
v_mfma_f32_4x4x4_16b_bf16 v[248:251], v[6:7], a[96:97], 1.0
v_mfma_f32_4x4x4_16b_bf16 v[28:31], v[6:7], a[98:99], 1.0
v_mfma_f32_4x4x4_16b_bf16 a[232:235], v[6:7], a[100:101], 1.0
v_mfma_f32_4x4x4_16b_bf16 v[224:227], v[6:7], a[100:101], 1.0
v_mfma_f32_4x4x4_16b_bf16 a[236:239], v[6:7], a[102:103], 1.0
v_mfma_f32_4x4x4_16b_bf16 v[36:39], v[6:7], a[102:103], 1.0
v_mfma_f32_4x4x4_16b_bf16 a[240:243], v[6:7], a[104:105], 1.0
v_mfma_f32_4x4x4_16b_bf16 v[232:235], v[6:7], a[104:105], 1.0
v_mfma_f32_4x4x4_16b_bf16 a[244:247], v[6:7], a[106:107], 1.0
v_mfma_f32_4x4x4_16b_bf16 v[44:47], v[6:7], a[106:107], 1.0
v_mfma_f32_4x4x4_16b_bf16 a[248:251], v[6:7], a[108:109], 1.0
v_mfma_f32_4x4x4_16b_bf16 v[240:243], v[6:7], a[108:109], 1.0
v_mfma_f32_4x4x4_16b_bf16 a[252:255], v[6:7], a[110:111], 1.0
v_mfma_f32_4x4x4_16b_bf16 v[52:55], v[6:7], a[110:111], 1.0
s_waitcnt lgkmcnt(12)
v_mfma_f32_16x16x32_bf16 v[24:27], a[192:195], a[128:131], v[248:251]
v_mfma_f32_16x16x32_bf16 v[24:27], a[208:211], a[132:135], v[24:27]
s_add_u32 m0, s60, 65536
s_xor_b32 s74, s69, 128
s_add_u32 s74, s74, s72
s_addc_u32 s75, s73, 0
v_mfma_f32_16x16x32_bf16 v[56:59], a[208:211], a[136:139], v[248:251]
v_mfma_f32_16x16x32_bf16 v[56:59], a[192:195], a[140:143], v[56:59]
s_waitcnt lgkmcnt(8)
v_mfma_f32_16x16x32_bf16 v[88:91], a[192:195], a[144:147], v[248:251]
global_load_lds_dwordx4 v20, s[74:75] offset:0
v_mfma_f32_16x16x32_bf16 v[88:91], a[208:211], a[148:151], v[88:91]
s_waitcnt vmcnt(17)
v_mfma_f32_16x16x32_bf16 v[120:123], a[208:211], a[152:155], v[248:251]
ds_read_b64_tr_b16 a[112:113], v10 offset:0
v_mov_b32 v12, 0
v_mfma_f32_16x16x32_bf16 v[120:123], a[192:195], a[156:159], v[120:123]
v_mov_b32 v13, 0
s_waitcnt lgkmcnt(5)
v_mfma_f32_16x16x32_bf16 v[152:155], a[192:195], a[160:163], v[248:251]
global_load_lds_dwordx4 v23, s[74:75] offset:1024
v_mfma_f32_16x16x32_bf16 v[152:155], a[208:211], a[164:167], v[152:155]
ds_read_b64_tr_b16 a[114:115], v10 offset:256
v_mov_b32 v14, 0
v_mfma_f32_16x16x32_bf16 v[184:187], a[208:211], a[168:171], v[248:251]
ds_read_b64_tr_b16 a[116:117], v10 offset:8
v_mov_b32 v15, 0
v_mfma_f32_16x16x32_bf16 v[184:187], a[192:195], a[172:175], v[184:187]
ds_read_b64_tr_b16 a[118:119], v10 offset:264
s_waitcnt vmcnt(14) lgkmcnt(4)
v_mfma_f32_16x16x32_bf16 v[216:219], a[192:195], a[176:179], v[248:251]
s_barrier
v_mfma_f32_16x16x32_bf16 v[216:219], a[208:211], a[180:183], v[216:219]
global_load_lds_dwordx4 v18, s[74:75] offset:2048
v_mfma_f32_16x16x32_bf16 v[248:251], a[208:211], a[184:187], v[248:251]
buffer_store_dwordx4 v[12:15], v0, s[32:35], s56 offen sc1
v_mfma_f32_16x16x32_bf16 v[248:251], a[192:195], a[188:191], v[248:251]
v_mfma_f32_16x16x32_bf16 v[252:255], a[196:199], a[188:191], v[28:31]
global_load_lds_dwordx4 v19, s[74:75] offset:3072
v_mfma_f32_16x16x32_bf16 v[252:255], a[212:215], a[184:187], v[252:255]
s_waitcnt lgkmcnt(0)
v_mfma_f32_16x16x32_bf16 v[220:223], a[212:215], a[180:183], v[28:31]
s_add_u32 m0, s60, 81920
s_xor_b32 s74, s69, 65664
s_add_u32 s74, s74, s72
s_addc_u32 s75, s73, 0
v_mfma_f32_16x16x32_bf16 v[220:223], a[196:199], a[176:179], v[220:223]
buffer_store_dwordx4 a[112:115], v0, s[80:83], s77 offen offset:0 sc1
v_mfma_f32_16x16x32_bf16 v[188:191], a[196:199], a[172:175], v[28:31]
global_load_lds_dwordx4 v20, s[74:75] offset:0
v_mfma_f32_16x16x32_bf16 v[188:191], a[212:215], a[168:171], v[188:191]
v_mfma_f32_16x16x32_bf16 v[156:159], a[212:215], a[164:167], v[28:31]
buffer_store_dwordx4 a[116:119], v0, s[80:83], s77 offen offset:1024 sc1
v_mfma_f32_16x16x32_bf16 v[156:159], a[196:199], a[160:163], v[156:159]
v_mfma_f32_16x16x32_bf16 v[124:127], a[196:199], a[156:159], v[28:31]
global_load_lds_dwordx4 v23, s[74:75] offset:1024
v_mfma_f32_16x16x32_bf16 v[124:127], a[212:215], a[152:155], v[124:127]
v_mfma_f32_16x16x32_bf16 v[92:95], a[212:215], a[148:151], v[28:31]
v_mfma_f32_16x16x32_bf16 v[92:95], a[196:199], a[144:147], v[92:95]
v_mfma_f32_16x16x32_bf16 v[60:63], a[196:199], a[140:143], v[28:31]
global_load_lds_dwordx4 v18, s[74:75] offset:2048
v_mfma_f32_16x16x32_bf16 v[60:63], a[212:215], a[136:139], v[60:63]
v_mfma_f32_16x16x32_bf16 v[28:31], a[212:215], a[132:135], v[28:31]
v_mfma_f32_16x16x32_bf16 v[28:31], a[196:199], a[128:131], v[28:31]
v_mfma_f32_16x16x32_bf16 v[32:35], a[200:203], a[128:131], v[224:227]
global_load_lds_dwordx4 v19, s[74:75] offset:3072
v_mfma_f32_16x16x32_bf16 v[32:35], a[216:219], a[132:135], v[32:35]
v_mfma_f32_16x16x32_bf16 v[64:67], a[216:219], a[136:139], v[224:227]
s_waitcnt vmcnt(19)
v_mfma_f32_16x16x32_bf16 v[64:67], a[200:203], a[140:143], v[64:67]
ds_read_b64_tr_b16 a[224:225], v21 offset:32768
v_mfma_f32_16x16x32_bf16 v[96:99], a[200:203], a[144:147], v[224:227]
ds_read_b64_tr_b16 a[226:227], v21 offset:33280
v_mfma_f32_16x16x32_bf16 v[96:99], a[216:219], a[148:151], v[96:99]
ds_read_b64_tr_b16 a[228:229], v21 offset:32776
v_mfma_f32_16x16x32_bf16 v[128:131], a[216:219], a[152:155], v[224:227]
ds_read_b64_tr_b16 a[230:231], v21 offset:33288
v_mfma_f32_16x16x32_bf16 v[128:131], a[200:203], a[156:159], v[128:131]
ds_read_b64_tr_b16 a[0:1], v22 offset:32768
v_mfma_f32_16x16x32_bf16 v[160:163], a[200:203], a[160:163], v[224:227]
ds_read_b64_tr_b16 a[2:3], v22 offset:33280
v_mfma_f32_16x16x32_bf16 v[160:163], a[216:219], a[164:167], v[160:163]
ds_read_b64_tr_b16 a[4:5], v22 offset:32776
v_mfma_f32_16x16x32_bf16 v[192:195], a[216:219], a[168:171], v[224:227]
ds_read_b64_tr_b16 a[6:7], v22 offset:33288
v_mfma_f32_16x16x32_bf16 v[192:195], a[200:203], a[172:175], v[192:195]
v_mfma_f32_16x16x32_bf16 v[224:227], a[200:203], a[176:179], v[224:227]
s_waitcnt vmcnt(15)
v_mfma_f32_16x16x32_bf16 v[224:227], a[216:219], a[180:183], v[224:227]
ds_read_b64_tr_b16 a[8:9], v21 offset:49152
v_mfma_f32_16x16x32_bf16 a[232:235], a[216:219], a[184:187], a[232:235]
ds_read_b64_tr_b16 a[10:11], v21 offset:49664
v_mfma_f32_16x16x32_bf16 a[232:235], a[200:203], a[188:191], a[232:235]
v_add_u32 v2, 131072, v1
v_mfma_f32_16x16x32_bf16 a[236:239], a[204:207], a[188:191], a[236:239]
ds_read_b128 a[188:191], v2 offset:0
v_mfma_f32_16x16x32_bf16 a[236:239], a[220:223], a[184:187], a[236:239]
ds_read_b128 a[184:187], v2 offset:8192
v_mfma_f32_16x16x32_bf16 v[228:231], a[220:223], a[180:183], v[36:39]
ds_read_b128 a[180:183], v2 offset:9216
s_waitcnt lgkmcnt(5)
s_add_u32 m0, s60, 98304
v_mfma_f32_16x16x32_bf16 v[228:231], a[204:207], a[176:179], v[228:231]
ds_read_b128 a[176:179], v2 offset:1024
v_mfma_f32_16x16x32_bf16 v[196:199], a[204:207], a[172:175], v[36:39]
ds_read_b128 a[172:175], v2 offset:2048
v_mfma_f32_16x16x32_bf16 v[196:199], a[220:223], a[168:171], v[196:199]
ds_read_b128 a[168:171], v2 offset:10240
ds_read_b64_tr_b16 a[12:13], v21 offset:49160
ds_read_b64_tr_b16 a[14:15], v21 offset:49672
ds_read_b64_tr_b16 a[16:17], v22 offset:49152
ds_read_b64_tr_b16 a[18:19], v22 offset:49664
ds_read_b64_tr_b16 a[20:21], v22 offset:49160
ds_read_b64_tr_b16 a[22:23], v22 offset:49672
v_mfma_f32_16x16x32_bf16 v[164:167], a[220:223], a[164:167], v[36:39]
ds_read_b128 a[164:167], v2 offset:11264
v_mfma_f32_16x16x32_bf16 v[164:167], a[204:207], a[160:163], v[164:167]
ds_read_b128 a[160:163], v2 offset:3072
v_mfma_f32_16x16x32_bf16 v[132:135], a[204:207], a[156:159], v[36:39]
ds_read_b128 a[156:159], v2 offset:4096
v_mfma_f32_16x16x32_bf16 v[132:135], a[220:223], a[152:155], v[132:135]
ds_read_b128 a[152:155], v2 offset:12288
v_mfma_f32_16x16x32_bf16 v[100:103], a[220:223], a[148:151], v[36:39]
ds_read_b128 a[148:151], v2 offset:13312
v_mfma_f32_16x16x32_bf16 v[100:103], a[204:207], a[144:147], v[100:103]
ds_read_b128 a[144:147], v2 offset:5120
v_mfma_f32_16x16x32_bf16 v[68:71], a[204:207], a[140:143], v[36:39]
ds_read_b128 a[140:143], v2 offset:6144
v_mfma_f32_16x16x32_bf16 v[68:71], a[220:223], a[136:139], v[68:71]
ds_read_b128 a[136:139], v2 offset:14336
v_mfma_f32_16x16x32_bf16 v[36:39], a[220:223], a[132:135], v[36:39]
ds_read_b128 a[132:135], v2 offset:15360
v_mfma_f32_16x16x32_bf16 v[36:39], a[204:207], a[128:131], v[36:39]
ds_read_b128 a[128:131], v2 offset:7168
s_waitcnt lgkmcnt(15)
v_mfma_f32_16x16x32_bf16 v[24:27], a[224:227], a[188:191], v[24:27]
s_xor_b32 s74, s68, 131072
s_add_u32 s74, s74, s72
s_addc_u32 s75, s73, 0
v_mfma_f32_16x16x32_bf16 v[24:27], a[8:11], a[184:187], v[24:27]
global_load_lds_dwordx4 v20, s[74:75] offset:0
v_mfma_f32_16x16x32_bf16 v[56:59], a[8:11], a[180:183], v[56:59]
global_load_lds_dwordx4 v23, s[74:75] offset:1024
v_mfma_f32_16x16x32_bf16 v[56:59], a[224:227], a[176:179], v[56:59]
s_waitcnt lgkmcnt(8)
v_mfma_f32_16x16x32_bf16 v[88:91], a[224:227], a[172:175], v[88:91]
global_load_lds_dwordx4 v18, s[74:75] offset:2048
v_mfma_f32_16x16x32_bf16 v[88:91], a[8:11], a[168:171], v[88:91]
global_load_lds_dwordx4 v19, s[74:75] offset:3072
v_mfma_f32_16x16x32_bf16 v[120:123], a[8:11], a[164:167], v[120:123]
s_and_b32 s67, s2, 1
s_lshl_b32 s67, s67, 7
s_add_u32 s67, s67, s56
v_mfma_f32_16x16x32_bf16 v[120:123], a[224:227], a[160:163], v[120:123]
v_lshlrev_b32 v8, 4, v0
s_waitcnt lgkmcnt(4)
v_mfma_f32_16x16x32_bf16 v[152:155], a[224:227], a[156:159], v[152:155]
s_waitcnt vmcnt(10)
v_mfma_f32_16x16x32_bf16 v[152:155], a[8:11], a[152:155], v[152:155]
ds_read_b64_tr_b16 a[24:25], v21 offset:0
v_mov_b32 v9, 1
v_mfma_f32_16x16x32_bf16 v[184:187], a[8:11], a[148:151], v[184:187]
ds_read_b64_tr_b16 a[26:27], v21 offset:512
v_mfma_f32_16x16x32_bf16 v[184:187], a[224:227], a[144:147], v[184:187]
ds_read_b64_tr_b16 a[28:29], v21 offset:8
s_waitcnt vmcnt(7) lgkmcnt(3)
v_mfma_f32_16x16x32_bf16 v[216:219], a[224:227], a[140:143], v[216:219]
ds_read_b64_tr_b16 a[30:31], v21 offset:520
s_barrier
v_mfma_f32_16x16x32_bf16 v[216:219], a[8:11], a[136:139], v[216:219]
ds_read_b64_tr_b16 a[32:33], v22 offset:0
s_add_u32 m0, s56, 131072
v_mfma_f32_16x16x32_bf16 v[248:251], a[8:11], a[132:135], v[248:251]
ds_read_b64_tr_b16 a[34:35], v22 offset:512
v_mfma_f32_16x16x32_bf16 v[248:251], a[224:227], a[128:131], v[248:251]
ds_read_b64_tr_b16 a[36:37], v22 offset:8
v_mfma_f32_16x16x32_bf16 v[252:255], a[228:231], a[128:131], v[252:255]
ds_read_b64_tr_b16 a[38:39], v22 offset:520
v_mfma_f32_16x16x32_bf16 v[252:255], a[12:15], a[132:135], v[252:255]
s_xor_b32 s10, s59, 128
s_add_u32 s10, s10, s8
s_addc_u32 s11, s9, 0
v_mfma_f32_16x16x32_bf16 v[220:223], a[12:15], a[136:139], v[220:223]
global_load_lds_dwordx4 v4, s[10:11]
v_mfma_f32_16x16x32_bf16 v[220:223], a[228:231], a[140:143], v[220:223]
buffer_atomic_add v9, v8, s[84:87], s67 offen offset:0 sc1
v_mfma_f32_16x16x32_bf16 v[188:191], a[228:231], a[144:147], v[188:191]
global_load_lds_dwordx4 v5, s[10:11] offset:1024
v_mfma_f32_16x16x32_bf16 v[188:191], a[12:15], a[148:151], v[188:191]
L_pad1:
s_cbranch_execz L_pad5
v_mfma_f32_16x16x32_bf16 v[156:159], a[12:15], a[152:155], v[156:159]
v_mfma_f32_16x16x32_bf16 v[156:159], a[228:231], a[156:159], v[156:159]
s_add_u32 m0, s56, 139264
v_mfma_f32_16x16x32_bf16 v[124:127], a[228:231], a[160:163], v[124:127]
s_waitcnt vmcnt(7)
s_xor_b32 s10, s59, 192
s_add_u32 s10, s10, s8
s_addc_u32 s11, s9, 0
v_mfma_f32_16x16x32_bf16 v[124:127], a[12:15], a[164:167], v[124:127]
ds_read_b64_tr_b16 a[40:41], v21 offset:16384
v_mfma_f32_16x16x32_bf16 v[92:95], a[12:15], a[168:171], v[92:95]
ds_read_b64_tr_b16 a[42:43], v21 offset:16896
v_mfma_f32_16x16x32_bf16 v[92:95], a[228:231], a[172:175], v[92:95]
ds_read_b64_tr_b16 a[44:45], v21 offset:16392
v_mfma_f32_16x16x32_bf16 v[60:63], a[228:231], a[176:179], v[60:63]
ds_read_b64_tr_b16 a[46:47], v21 offset:16904
v_mfma_f32_16x16x32_bf16 v[60:63], a[12:15], a[180:183], v[60:63]
ds_read_b64_tr_b16 a[48:49], v22 offset:16384
v_mfma_f32_16x16x32_bf16 v[28:31], a[12:15], a[184:187], v[28:31]
ds_read_b64_tr_b16 a[50:51], v22 offset:16896
v_mfma_f32_16x16x32_bf16 v[28:31], a[228:231], a[188:191], v[28:31]
ds_read_b64_tr_b16 a[52:53], v22 offset:16392
v_mfma_f32_16x16x32_bf16 v[32:35], a[0:3], a[188:191], v[32:35]
ds_read_b64_tr_b16 a[54:55], v22 offset:16904
v_mfma_f32_16x16x32_bf16 v[32:35], a[16:19], a[184:187], v[32:35]
global_load_lds_dwordx4 v4, s[10:11]
v_mfma_f32_16x16x32_bf16 v[64:67], a[16:19], a[180:183], v[64:67]
global_load_lds_dwordx4 v5, s[10:11] offset:1024
v_mfma_f32_16x16x32_bf16 v[64:67], a[0:3], a[176:179], v[64:67]
v_mfma_f32_16x16x32_bf16 v[96:99], a[0:3], a[172:175], v[96:99]
s_add_u32 m0, s56, 32768
s_xor_b32 s10, s58, 256
s_add_u32 s10, s10, s8
s_addc_u32 s11, s9, 0
v_mfma_f32_16x16x32_bf16 v[96:99], a[16:19], a[168:171], v[96:99]
v_mfma_f32_16x16x32_bf16 v[128:131], a[16:19], a[164:167], v[128:131]
global_load_lds_dwordx4 v4, s[10:11]
v_mfma_f32_16x16x32_bf16 v[128:131], a[0:3], a[160:163], v[128:131]
v_mfma_f32_16x16x32_bf16 v[160:163], a[0:3], a[156:159], v[160:163]
v_mfma_f32_16x16x32_bf16 v[160:163], a[16:19], a[152:155], v[160:163]
global_load_lds_dwordx4 v5, s[10:11] offset:1024
v_mfma_f32_16x16x32_bf16 v[192:195], a[16:19], a[148:151], v[192:195]
v_mfma_f32_16x16x32_bf16 v[192:195], a[0:3], a[144:147], v[192:195]
v_mfma_f32_16x16x32_bf16 v[224:227], a[0:3], a[140:143], v[224:227]
s_add_u32 m0, s56, 40960
v_mfma_f32_16x16x32_bf16 v[224:227], a[16:19], a[136:139], v[224:227]
s_xor_b32 s10, s58, 320
s_add_u32 s10, s10, s8
s_addc_u32 s11, s9, 0
v_mfma_f32_16x16x32_bf16 a[232:235], a[16:19], a[132:135], a[232:235]
global_load_lds_dwordx4 v4, s[10:11]
v_mfma_f32_16x16x32_bf16 a[232:235], a[0:3], a[128:131], a[232:235]
v_mfma_f32_16x16x32_bf16 a[236:239], a[4:7], a[128:131], a[236:239]
v_mfma_f32_16x16x32_bf16 a[236:239], a[20:23], a[132:135], a[236:239]
v_mfma_f32_16x16x32_bf16 v[228:231], a[20:23], a[136:139], v[228:231]
global_load_lds_dwordx4 v5, s[10:11] offset:1024
v_mfma_f32_16x16x32_bf16 v[228:231], a[4:7], a[140:143], v[228:231]
v_mfma_f32_16x16x32_bf16 v[196:199], a[4:7], a[144:147], v[196:199]
v_mfma_f32_16x16x32_bf16 v[196:199], a[20:23], a[148:151], v[196:199]
v_mfma_f32_16x16x32_bf16 v[164:167], a[20:23], a[152:155], v[164:167]
s_add_u32 m0, s60, 114688
s_xor_b32 s74, s68, 196608
s_add_u32 s74, s74, s72
s_addc_u32 s75, s73, 0
v_mfma_f32_16x16x32_bf16 v[164:167], a[4:7], a[156:159], v[164:167]
v_mfma_f32_16x16x32_bf16 v[132:135], a[4:7], a[160:163], v[132:135]
global_load_lds_dwordx4 v20, s[74:75] offset:0
v_mfma_f32_16x16x32_bf16 v[132:135], a[20:23], a[164:167], v[132:135]
v_mfma_f32_16x16x32_bf16 v[100:103], a[20:23], a[168:171], v[100:103]
v_mfma_f32_16x16x32_bf16 v[100:103], a[4:7], a[172:175], v[100:103]
v_mfma_f32_16x16x32_bf16 v[68:71], a[4:7], a[176:179], v[68:71]
global_load_lds_dwordx4 v23, s[74:75] offset:1024
v_mfma_f32_16x16x32_bf16 v[68:71], a[20:23], a[180:183], v[68:71]
s_waitcnt vmcnt(11)
v_mfma_f32_16x16x32_bf16 v[36:39], a[20:23], a[184:187], v[36:39]
ds_read_b64_tr_b16 a[56:57], v21 offset:32768
v_mfma_f32_16x16x32_bf16 v[36:39], a[4:7], a[188:191], v[36:39]
ds_read_b64_tr_b16 a[58:59], v21 offset:33280
s_waitcnt lgkmcnt(8)
v_mfma_f32_16x16x32_bf16 v[40:43], a[24:27], a[188:191], v[232:235]
ds_read_b64_tr_b16 a[60:61], v21 offset:32776
v_mfma_f32_16x16x32_bf16 v[40:43], a[40:43], a[184:187], v[40:43]
ds_read_b64_tr_b16 a[62:63], v21 offset:33288
v_mfma_f32_16x16x32_bf16 v[72:75], a[40:43], a[180:183], v[232:235]
ds_read_b64_tr_b16 a[64:65], v22 offset:32768
v_mfma_f32_16x16x32_bf16 v[72:75], a[24:27], a[176:179], v[72:75]
ds_read_b64_tr_b16 a[66:67], v22 offset:33280
v_mfma_f32_16x16x32_bf16 v[104:107], a[24:27], a[172:175], v[232:235]
ds_read_b64_tr_b16 a[68:69], v22 offset:32776
v_mfma_f32_16x16x32_bf16 v[104:107], a[40:43], a[168:171], v[104:107]
ds_read_b64_tr_b16 a[70:71], v22 offset:33288
v_mfma_f32_16x16x32_bf16 v[136:139], a[40:43], a[164:167], v[232:235]
global_load_lds_dwordx4 v18, s[74:75] offset:2048
v_mfma_f32_16x16x32_bf16 v[136:139], a[24:27], a[160:163], v[136:139]
global_load_lds_dwordx4 v19, s[74:75] offset:3072
v_mfma_f32_16x16x32_bf16 v[168:171], a[24:27], a[156:159], v[232:235]
v_mfma_f32_16x16x32_bf16 v[168:171], a[40:43], a[152:155], v[168:171]
s_add_u32 m0, s60, 65536
s_xor_b32 s74, s69, 131072
s_add_u32 s74, s74, s72
s_addc_u32 s75, s73, 0
v_mfma_f32_16x16x32_bf16 v[200:203], a[40:43], a[148:151], v[232:235]
v_mfma_f32_16x16x32_bf16 v[200:203], a[24:27], a[144:147], v[200:203]
global_load_lds_dwordx4 v20, s[74:75] offset:0
v_mfma_f32_16x16x32_bf16 v[232:235], a[24:27], a[140:143], v[232:235]
v_mfma_f32_16x16x32_bf16 v[232:235], a[40:43], a[136:139], v[232:235]
v_mfma_f32_16x16x32_bf16 a[240:243], a[40:43], a[132:135], a[240:243]
v_mfma_f32_16x16x32_bf16 a[240:243], a[24:27], a[128:131], a[240:243]
s_waitcnt lgkmcnt(12)
v_mfma_f32_16x16x32_bf16 a[244:247], a[28:31], a[128:131], a[244:247]
global_load_lds_dwordx4 v23, s[74:75] offset:1024
v_mfma_f32_16x16x32_bf16 a[244:247], a[44:47], a[132:135], a[244:247]
v_mfma_f32_16x16x32_bf16 v[236:239], a[44:47], a[136:139], v[44:47]
v_mfma_f32_16x16x32_bf16 v[236:239], a[28:31], a[140:143], v[236:239]
global_load_lds_dwordx4 v18, s[74:75] offset:2048
v_mfma_f32_16x16x32_bf16 v[204:207], a[28:31], a[144:147], v[44:47]
v_mfma_f32_16x16x32_bf16 v[204:207], a[44:47], a[148:151], v[204:207]
v_mfma_f32_16x16x32_bf16 v[172:175], a[44:47], a[152:155], v[44:47]
v_mfma_f32_16x16x32_bf16 v[172:175], a[28:31], a[156:159], v[172:175]
global_load_lds_dwordx4 v19, s[74:75] offset:3072
v_mfma_f32_16x16x32_bf16 v[140:143], a[28:31], a[160:163], v[44:47]
v_mfma_f32_16x16x32_bf16 v[140:143], a[44:47], a[164:167], v[140:143]
s_waitcnt lgkmcnt(8)
s_add_u32 m0, s60, 81920
v_mfma_f32_16x16x32_bf16 v[108:111], a[44:47], a[168:171], v[44:47]
s_xor_b32 s74, s69, 196608
s_add_u32 s74, s74, s72
s_addc_u32 s75, s73, 0
v_mfma_f32_16x16x32_bf16 v[108:111], a[28:31], a[172:175], v[108:111]
global_load_lds_dwordx4 v20, s[74:75] offset:0
v_mfma_f32_16x16x32_bf16 v[76:79], a[28:31], a[176:179], v[44:47]
v_mfma_f32_16x16x32_bf16 v[76:79], a[44:47], a[180:183], v[76:79]
v_mfma_f32_16x16x32_bf16 v[44:47], a[44:47], a[184:187], v[44:47]
v_mfma_f32_16x16x32_bf16 v[44:47], a[28:31], a[188:191], v[44:47]
v_mfma_f32_16x16x32_bf16 v[48:51], a[32:35], a[188:191], v[240:243]
global_load_lds_dwordx4 v23, s[74:75] offset:1024
v_mfma_f32_16x16x32_bf16 v[48:51], a[48:51], a[184:187], v[48:51]
v_mfma_f32_16x16x32_bf16 v[80:83], a[48:51], a[180:183], v[240:243]
v_mfma_f32_16x16x32_bf16 v[80:83], a[32:35], a[176:179], v[80:83]
global_load_lds_dwordx4 v18, s[74:75] offset:2048
v_mfma_f32_16x16x32_bf16 v[112:115], a[32:35], a[172:175], v[240:243]
v_mfma_f32_16x16x32_bf16 v[112:115], a[48:51], a[168:171], v[112:115]
v_mfma_f32_16x16x32_bf16 v[144:147], a[48:51], a[164:167], v[240:243]
v_mfma_f32_16x16x32_bf16 v[144:147], a[32:35], a[160:163], v[144:147]
global_load_lds_dwordx4 v19, s[74:75] offset:3072
v_mfma_f32_16x16x32_bf16 v[176:179], a[32:35], a[156:159], v[240:243]
v_mfma_f32_16x16x32_bf16 v[176:179], a[48:51], a[152:155], v[176:179]
s_waitcnt lgkmcnt(0)
s_add_u32 m0, s60, 98304
v_mfma_f32_16x16x32_bf16 v[208:211], a[48:51], a[148:151], v[240:243]
s_xor_b32 s74, s69, 131200
s_add_u32 s74, s74, s72
s_addc_u32 s75, s73, 0
v_mfma_f32_16x16x32_bf16 v[208:211], a[32:35], a[144:147], v[208:211]
global_load_lds_dwordx4 v20, s[74:75] offset:0
v_mfma_f32_16x16x32_bf16 v[240:243], a[32:35], a[140:143], v[240:243]
s_waitcnt vmcnt(9)
v_mfma_f32_16x16x32_bf16 v[240:243], a[48:51], a[136:139], v[240:243]
ds_read_b64_tr_b16 a[72:73], v21 offset:49152
v_mfma_f32_16x16x32_bf16 a[248:251], a[48:51], a[132:135], a[248:251]
ds_read_b64_tr_b16 a[74:75], v21 offset:49664
v_mfma_f32_16x16x32_bf16 a[248:251], a[32:35], a[128:131], a[248:251]
v_add_u32 v2, 0, v1
v_mfma_f32_16x16x32_bf16 a[252:255], a[36:39], a[128:131], a[252:255]
ds_read_b128 a[128:131], v2 offset:16384
v_mfma_f32_16x16x32_bf16 a[252:255], a[52:55], a[132:135], a[252:255]
ds_read_b128 a[132:135], v2 offset:24576
v_mfma_f32_16x16x32_bf16 v[244:247], a[52:55], a[136:139], v[52:55]
ds_read_b128 a[136:139], v2 offset:25600
v_mfma_f32_16x16x32_bf16 v[244:247], a[36:39], a[140:143], v[244:247]
ds_read_b128 a[140:143], v2 offset:17408
v_mfma_f32_16x16x32_bf16 v[212:215], a[36:39], a[144:147], v[52:55]
ds_read_b128 a[144:147], v2 offset:18432
v_mfma_f32_16x16x32_bf16 v[212:215], a[52:55], a[148:151], v[212:215]
ds_read_b128 a[148:151], v2 offset:26624
ds_read_b64_tr_b16 a[76:77], v21 offset:49160
ds_read_b64_tr_b16 a[78:79], v21 offset:49672
ds_read_b64_tr_b16 a[80:81], v22 offset:49152
ds_read_b64_tr_b16 a[82:83], v22 offset:49664
ds_read_b64_tr_b16 a[84:85], v22 offset:49160
ds_read_b64_tr_b16 a[86:87], v22 offset:49672
v_mfma_f32_16x16x32_bf16 v[180:183], a[52:55], a[152:155], v[52:55]
ds_read_b128 a[152:155], v2 offset:27648
v_mfma_f32_16x16x32_bf16 v[180:183], a[36:39], a[156:159], v[180:183]
ds_read_b128 a[156:159], v2 offset:19456
v_mfma_f32_16x16x32_bf16 v[148:151], a[36:39], a[160:163], v[52:55]
ds_read_b128 a[160:163], v2 offset:20480
v_mfma_f32_16x16x32_bf16 v[148:151], a[52:55], a[164:167], v[148:151]
ds_read_b128 a[164:167], v2 offset:28672
v_mfma_f32_16x16x32_bf16 v[116:119], a[52:55], a[168:171], v[52:55]
ds_read_b128 a[168:171], v2 offset:29696
v_mfma_f32_16x16x32_bf16 v[116:119], a[36:39], a[172:175], v[116:119]
ds_read_b128 a[172:175], v2 offset:21504
v_mfma_f32_16x16x32_bf16 v[84:87], a[36:39], a[176:179], v[52:55]
ds_read_b128 a[176:179], v2 offset:22528
v_mfma_f32_16x16x32_bf16 v[84:87], a[52:55], a[180:183], v[84:87]
ds_read_b128 a[180:183], v2 offset:30720
v_mfma_f32_16x16x32_bf16 v[52:55], a[52:55], a[184:187], v[52:55]
ds_read_b128 a[184:187], v2 offset:31744
v_mfma_f32_16x16x32_bf16 v[52:55], a[36:39], a[188:191], v[52:55]
ds_read_b128 a[188:191], v2 offset:23552
s_waitcnt lgkmcnt(15)
v_mfma_f32_16x16x32_bf16 v[24:27], a[56:59], a[128:131], v[24:27]
global_load_lds_dwordx4 v23, s[74:75] offset:1024
v_mfma_f32_16x16x32_bf16 v[24:27], a[72:75], a[132:135], v[24:27]
global_load_lds_dwordx4 v18, s[74:75] offset:2048
v_mfma_f32_16x16x32_bf16 v[56:59], a[72:75], a[136:139], v[56:59]
global_load_lds_dwordx4 v19, s[74:75] offset:3072
v_mfma_f32_16x16x32_bf16 v[56:59], a[56:59], a[140:143], v[56:59]
s_waitcnt lgkmcnt(8)
v_mfma_f32_16x16x32_bf16 v[88:91], a[56:59], a[144:147], v[88:91]
s_add_u32 m0, s60, 114688
s_xor_b32 s74, s69, 196736
s_add_u32 s74, s74, s72
s_addc_u32 s75, s73, 0
v_mfma_f32_16x16x32_bf16 v[88:91], a[72:75], a[148:151], v[88:91]
v_mfma_f32_16x16x32_bf16 v[120:123], a[72:75], a[152:155], v[120:123]
global_load_lds_dwordx4 v20, s[74:75] offset:0
v_mfma_f32_16x16x32_bf16 v[120:123], a[56:59], a[156:159], v[120:123]
s_waitcnt lgkmcnt(4)
v_mfma_f32_16x16x32_bf16 v[152:155], a[56:59], a[160:163], v[152:155]
v_mfma_f32_16x16x32_bf16 v[152:155], a[72:75], a[164:167], v[152:155]
v_mfma_f32_16x16x32_bf16 v[184:187], a[72:75], a[168:171], v[184:187]
global_load_lds_dwordx4 v23, s[74:75] offset:1024
v_mfma_f32_16x16x32_bf16 v[184:187], a[56:59], a[172:175], v[184:187]
s_waitcnt lgkmcnt(0)
v_mfma_f32_16x16x32_bf16 v[216:219], a[56:59], a[176:179], v[216:219]
s_barrier
v_mfma_f32_16x16x32_bf16 v[216:219], a[72:75], a[180:183], v[216:219]
v_mfma_f32_16x16x32_bf16 v[248:251], a[72:75], a[184:187], v[248:251]
global_load_lds_dwordx4 v18, s[74:75] offset:2048
v_mfma_f32_16x16x32_bf16 v[248:251], a[56:59], a[188:191], v[248:251]
s_waitcnt vmcnt(11)
v_mfma_f32_16x16x32_bf16 v[252:255], a[60:63], a[188:191], v[252:255]
ds_read_b64_tr_b16 a[88:89], v21 offset:0
v_mfma_f32_16x16x32_bf16 v[252:255], a[76:79], a[184:187], v[252:255]
ds_read_b64_tr_b16 a[90:91], v21 offset:512
v_mfma_f32_16x16x32_bf16 v[220:223], a[76:79], a[180:183], v[220:223]
ds_read_b64_tr_b16 a[92:93], v21 offset:8
v_mfma_f32_16x16x32_bf16 v[220:223], a[60:63], a[176:179], v[220:223]
ds_read_b64_tr_b16 a[94:95], v21 offset:520
v_mfma_f32_16x16x32_bf16 v[188:191], a[60:63], a[172:175], v[188:191]
ds_read_b64_tr_b16 a[208:209], v22 offset:0
v_mfma_f32_16x16x32_bf16 v[188:191], a[76:79], a[168:171], v[188:191]
ds_read_b64_tr_b16 a[210:211], v22 offset:512
v_mfma_f32_16x16x32_bf16 v[156:159], a[76:79], a[164:167], v[156:159]
ds_read_b64_tr_b16 a[192:193], v22 offset:8
v_mfma_f32_16x16x32_bf16 v[156:159], a[60:63], a[160:163], v[156:159]
ds_read_b64_tr_b16 a[194:195], v22 offset:520
v_mfma_f32_16x16x32_bf16 v[124:127], a[60:63], a[156:159], v[124:127]
global_load_lds_dwordx4 v19, s[74:75] offset:3072
v_mfma_f32_16x16x32_bf16 v[124:127], a[76:79], a[152:155], v[124:127]
v_mfma_f32_16x16x32_bf16 v[92:95], a[76:79], a[148:151], v[92:95]
v_mfma_f32_16x16x32_bf16 v[92:95], a[60:63], a[144:147], v[92:95]
v_mfma_f32_16x16x32_bf16 v[60:63], a[60:63], a[140:143], v[60:63]
v_mfma_f32_16x16x32_bf16 v[60:63], a[76:79], a[136:139], v[60:63]
v_mfma_f32_16x16x32_bf16 v[28:31], a[76:79], a[132:135], v[28:31]
v_mfma_f32_16x16x32_bf16 v[28:31], a[60:63], a[128:131], v[28:31]
s_waitcnt vmcnt(8)
v_mfma_f32_16x16x32_bf16 v[32:35], a[64:67], a[128:131], v[32:35]
ds_read_b64_tr_b16 a[212:213], v21 offset:16384
v_mfma_f32_16x16x32_bf16 v[32:35], a[80:83], a[132:135], v[32:35]
ds_read_b64_tr_b16 a[214:215], v21 offset:16896
v_mfma_f32_16x16x32_bf16 v[64:67], a[80:83], a[136:139], v[64:67]
ds_read_b64_tr_b16 a[196:197], v21 offset:16392
v_mfma_f32_16x16x32_bf16 v[64:67], a[64:67], a[140:143], v[64:67]
ds_read_b64_tr_b16 a[198:199], v21 offset:16904
v_mfma_f32_16x16x32_bf16 v[96:99], a[64:67], a[144:147], v[96:99]
ds_read_b64_tr_b16 a[216:217], v22 offset:16384
v_mfma_f32_16x16x32_bf16 v[96:99], a[80:83], a[148:151], v[96:99]
ds_read_b64_tr_b16 a[218:219], v22 offset:16896
v_mfma_f32_16x16x32_bf16 v[128:131], a[80:83], a[152:155], v[128:131]
ds_read_b64_tr_b16 a[200:201], v22 offset:16392
v_mfma_f32_16x16x32_bf16 v[128:131], a[64:67], a[156:159], v[128:131]
ds_read_b64_tr_b16 a[202:203], v22 offset:16904
v_mfma_f32_16x16x32_bf16 v[160:163], a[64:67], a[160:163], v[160:163]
s_waitcnt lgkmcnt(8)
s_add_u32 m0, s60, 65536
v_mfma_f32_16x16x32_bf16 v[160:163], a[80:83], a[164:167], v[160:163]
s_xor_b32 s74, s68, 262144
s_add_u32 s74, s74, s72
s_addc_u32 s75, s73, 0
v_mfma_f32_16x16x32_bf16 v[192:195], a[80:83], a[168:171], v[192:195]
global_load_lds_dwordx4 v20, s[74:75] offset:0
v_mfma_f32_16x16x32_bf16 v[192:195], a[64:67], a[172:175], v[192:195]
global_load_lds_dwordx4 v23, s[74:75] offset:1024
v_mfma_f32_16x16x32_bf16 v[224:227], a[64:67], a[176:179], v[224:227]
global_load_lds_dwordx4 v18, s[74:75] offset:2048
v_mfma_f32_16x16x32_bf16 v[224:227], a[80:83], a[180:183], v[224:227]
global_load_lds_dwordx4 v19, s[74:75] offset:3072
v_mfma_f32_16x16x32_bf16 a[232:235], a[80:83], a[184:187], a[232:235]
v_mfma_f32_16x16x32_bf16 a[232:235], a[64:67], a[188:191], a[232:235]
v_add_u32 v2, 131072, v1
s_waitcnt lgkmcnt(0)
s_add_u32 m0, s60, 81920
v_mfma_f32_16x16x32_bf16 a[236:239], a[68:71], a[188:191], a[236:239]
ds_read_b128 a[188:191], v2 offset:0
v_mfma_f32_16x16x32_bf16 a[236:239], a[84:87], a[184:187], a[236:239]
ds_read_b128 a[184:187], v2 offset:8192
v_mfma_f32_16x16x32_bf16 v[228:231], a[84:87], a[180:183], v[228:231]
ds_read_b128 a[180:183], v2 offset:9216
v_mfma_f32_16x16x32_bf16 v[228:231], a[68:71], a[176:179], v[228:231]
ds_read_b128 a[176:179], v2 offset:1024
v_mfma_f32_16x16x32_bf16 v[196:199], a[68:71], a[172:175], v[196:199]
ds_read_b128 a[172:175], v2 offset:2048
v_mfma_f32_16x16x32_bf16 v[196:199], a[84:87], a[168:171], v[196:199]
ds_read_b128 a[168:171], v2 offset:10240
v_mfma_f32_16x16x32_bf16 v[164:167], a[84:87], a[164:167], v[164:167]
ds_read_b128 a[164:167], v2 offset:11264
v_mfma_f32_16x16x32_bf16 v[164:167], a[68:71], a[160:163], v[164:167]
ds_read_b128 a[160:163], v2 offset:3072
v_mfma_f32_16x16x32_bf16 v[132:135], a[68:71], a[156:159], v[132:135]
ds_read_b128 a[156:159], v2 offset:4096
v_mfma_f32_16x16x32_bf16 v[132:135], a[84:87], a[152:155], v[132:135]
ds_read_b128 a[152:155], v2 offset:12288
v_mfma_f32_16x16x32_bf16 v[100:103], a[84:87], a[148:151], v[100:103]
ds_read_b128 a[148:151], v2 offset:13312
s_waitcnt vmcnt(8)
v_mfma_f32_16x16x32_bf16 v[100:103], a[68:71], a[144:147], v[100:103]
ds_read_b128 a[144:147], v2 offset:5120
v_mfma_f32_16x16x32_bf16 v[68:71], a[68:71], a[140:143], v[68:71]
ds_read_b128 a[140:143], v2 offset:6144
v_mfma_f32_16x16x32_bf16 v[68:71], a[84:87], a[136:139], v[68:71]
ds_read_b128 a[136:139], v2 offset:14336
v_mfma_f32_16x16x32_bf16 v[36:39], a[84:87], a[132:135], v[36:39]
ds_read_b128 a[132:135], v2 offset:15360
v_mfma_f32_16x16x32_bf16 v[36:39], a[68:71], a[128:131], v[36:39]
ds_read_b128 a[128:131], v2 offset:7168
s_waitcnt lgkmcnt(12)
v_mfma_f32_16x16x32_bf16 v[24:27], a[88:91], a[188:191], v[24:27]
ds_read_b64_tr_b16 a[220:221], v21 offset:32768
v_mfma_f32_16x16x32_bf16 v[24:27], a[212:215], a[184:187], v[24:27]
ds_read_b64_tr_b16 a[222:223], v21 offset:33280
v_mfma_f32_16x16x32_bf16 v[56:59], a[212:215], a[180:183], v[56:59]
ds_read_b64_tr_b16 a[204:205], v21 offset:32776
v_mfma_f32_16x16x32_bf16 v[56:59], a[88:91], a[176:179], v[56:59]
ds_read_b64_tr_b16 a[206:207], v21 offset:33288
ds_read_b64_tr_b16 a[8:9], v22 offset:32768
ds_read_b64_tr_b16 a[10:11], v22 offset:33280
ds_read_b64_tr_b16 a[224:225], v22 offset:32776
ds_read_b64_tr_b16 a[226:227], v22 offset:33288
s_waitcnt lgkmcnt(15)
v_mfma_f32_16x16x32_bf16 v[88:91], a[88:91], a[172:175], v[88:91]
s_xor_b32 s74, s68, 327680
s_add_u32 s74, s74, s72
s_addc_u32 s75, s73, 0
v_mfma_f32_16x16x32_bf16 v[88:91], a[212:215], a[168:171], v[88:91]
global_load_lds_dwordx4 v20, s[74:75] offset:0
v_mfma_f32_16x16x32_bf16 v[120:123], a[212:215], a[164:167], v[120:123]
global_load_lds_dwordx4 v23, s[74:75] offset:1024
v_mfma_f32_16x16x32_bf16 v[120:123], a[88:91], a[160:163], v[120:123]
s_waitcnt lgkmcnt(12)
v_mfma_f32_16x16x32_bf16 v[152:155], a[88:91], a[156:159], v[152:155]
global_load_lds_dwordx4 v18, s[74:75] offset:2048
v_mfma_f32_16x16x32_bf16 v[152:155], a[212:215], a[152:155], v[152:155]
global_load_lds_dwordx4 v19, s[74:75] offset:3072
v_mfma_f32_16x16x32_bf16 v[184:187], a[212:215], a[148:151], v[184:187]
v_mfma_f32_16x16x32_bf16 v[184:187], a[88:91], a[144:147], v[184:187]
s_waitcnt lgkmcnt(8)
v_mfma_f32_16x16x32_bf16 v[216:219], a[88:91], a[140:143], v[216:219]
s_barrier
v_mfma_f32_16x16x32_bf16 v[216:219], a[212:215], a[136:139], v[216:219]
s_add_u32 m0, s56, 131072
s_xor_b32 s10, s59, 256
s_add_u32 s10, s10, s8
s_addc_u32 s11, s9, 0
v_mfma_f32_16x16x32_bf16 v[248:251], a[212:215], a[132:135], v[248:251]
v_mfma_f32_16x16x32_bf16 v[248:251], a[88:91], a[128:131], v[248:251]
v_mfma_f32_16x16x32_bf16 v[252:255], a[92:95], a[128:131], v[252:255]
s_waitcnt vmcnt(8)
v_mfma_f32_16x16x32_bf16 v[252:255], a[196:199], a[132:135], v[252:255]
ds_read_b64_tr_b16 a[12:13], v21 offset:49152
v_mfma_f32_16x16x32_bf16 v[220:223], a[196:199], a[136:139], v[220:223]
ds_read_b64_tr_b16 a[14:15], v21 offset:49664
v_mfma_f32_16x16x32_bf16 v[220:223], a[92:95], a[140:143], v[220:223]
ds_read_b64_tr_b16 a[228:229], v21 offset:49160
v_mfma_f32_16x16x32_bf16 v[188:191], a[92:95], a[144:147], v[188:191]
ds_read_b64_tr_b16 a[230:231], v21 offset:49672
v_mfma_f32_16x16x32_bf16 v[188:191], a[196:199], a[148:151], v[188:191]
ds_read_b64_tr_b16 a[16:17], v22 offset:49152
v_mfma_f32_16x16x32_bf16 v[156:159], a[196:199], a[152:155], v[156:159]
ds_read_b64_tr_b16 a[18:19], v22 offset:49664
v_mfma_f32_16x16x32_bf16 v[156:159], a[92:95], a[156:159], v[156:159]
ds_read_b64_tr_b16 a[0:1], v22 offset:49160
v_mfma_f32_16x16x32_bf16 v[124:127], a[92:95], a[160:163], v[124:127]
ds_read_b64_tr_b16 a[2:3], v22 offset:49672
v_mfma_f32_16x16x32_bf16 v[124:127], a[196:199], a[164:167], v[124:127]
global_load_lds_dwordx4 v4, s[10:11]
v_mfma_f32_16x16x32_bf16 v[92:95], a[196:199], a[168:171], v[92:95]
global_load_lds_dwordx4 v5, s[10:11] offset:1024
v_mfma_f32_16x16x32_bf16 v[92:95], a[92:95], a[172:175], v[92:95]
s_add_u32 m0, s56, 139264
s_xor_b32 s10, s59, 320
s_add_u32 s10, s10, s8
s_addc_u32 s11, s9, 0
v_mfma_f32_16x16x32_bf16 v[60:63], a[92:95], a[176:179], v[60:63]
global_load_lds_dwordx4 v4, s[10:11]
v_mfma_f32_16x16x32_bf16 v[60:63], a[196:199], a[180:183], v[60:63]
v_mfma_f32_16x16x32_bf16 v[28:31], a[196:199], a[184:187], v[28:31]
global_load_lds_dwordx4 v5, s[10:11] offset:1024
v_mfma_f32_16x16x32_bf16 v[28:31], a[92:95], a[188:191], v[28:31]
v_mfma_f32_16x16x32_bf16 v[32:35], a[208:211], a[188:191], v[32:35]
v_mfma_f32_16x16x32_bf16 v[32:35], a[216:219], a[184:187], v[32:35]
s_add_u32 m0, s56, 49152
s_xor_b32 s10, s58, 384
s_add_u32 s10, s10, s8
s_addc_u32 s11, s9, 0
v_mfma_f32_16x16x32_bf16 v[64:67], a[216:219], a[180:183], v[64:67]
v_mfma_f32_16x16x32_bf16 v[64:67], a[208:211], a[176:179], v[64:67]
global_load_lds_dwordx4 v4, s[10:11]
v_mfma_f32_16x16x32_bf16 v[96:99], a[208:211], a[172:175], v[96:99]
v_mfma_f32_16x16x32_bf16 v[96:99], a[216:219], a[168:171], v[96:99]
s_waitcnt vmcnt(9)
v_mfma_f32_16x16x32_bf16 v[128:131], a[216:219], a[164:167], v[128:131]
ds_read_b64_tr_b16 a[20:21], v21 offset:0
v_mfma_f32_16x16x32_bf16 v[128:131], a[208:211], a[160:163], v[128:131]
ds_read_b64_tr_b16 a[22:23], v21 offset:512
v_mfma_f32_16x16x32_bf16 v[160:163], a[208:211], a[156:159], v[160:163]
ds_read_b64_tr_b16 a[4:5], v21 offset:8
v_mfma_f32_16x16x32_bf16 v[160:163], a[216:219], a[152:155], v[160:163]
ds_read_b64_tr_b16 a[6:7], v21 offset:520
v_mfma_f32_16x16x32_bf16 v[192:195], a[216:219], a[148:151], v[192:195]
ds_read_b64_tr_b16 a[40:41], v22 offset:0
v_mfma_f32_16x16x32_bf16 v[192:195], a[208:211], a[144:147], v[192:195]
ds_read_b64_tr_b16 a[42:43], v22 offset:512
v_mfma_f32_16x16x32_bf16 v[224:227], a[208:211], a[140:143], v[224:227]
ds_read_b64_tr_b16 a[24:25], v22 offset:8
v_mfma_f32_16x16x32_bf16 v[224:227], a[216:219], a[136:139], v[224:227]
ds_read_b64_tr_b16 a[26:27], v22 offset:520
v_mfma_f32_16x16x32_bf16 a[232:235], a[216:219], a[132:135], a[232:235]
global_load_lds_dwordx4 v5, s[10:11] offset:1024
v_mfma_f32_16x16x32_bf16 a[232:235], a[208:211], a[128:131], a[232:235]
s_add_u32 m0, s56, 57344
v_mfma_f32_16x16x32_bf16 a[236:239], a[192:195], a[128:131], a[236:239]
s_xor_b32 s10, s58, 448
s_add_u32 s10, s10, s8
s_addc_u32 s11, s9, 0
v_mfma_f32_16x16x32_bf16 a[236:239], a[200:203], a[132:135], a[236:239]
global_load_lds_dwordx4 v4, s[10:11]
v_mfma_f32_16x16x32_bf16 v[228:231], a[200:203], a[136:139], v[228:231]
global_load_lds_dwordx4 v5, s[10:11] offset:1024
v_mfma_f32_16x16x32_bf16 v[228:231], a[192:195], a[140:143], v[228:231]
v_mfma_f32_16x16x32_bf16 v[196:199], a[192:195], a[144:147], v[196:199]
v_mfma_f32_16x16x32_bf16 v[196:199], a[200:203], a[148:151], v[196:199]
v_mfma_f32_16x16x32_bf16 v[164:167], a[200:203], a[152:155], v[164:167]
s_waitcnt lgkmcnt(15)
s_add_u32 m0, s60, 98304
v_mfma_f32_16x16x32_bf16 v[164:167], a[192:195], a[156:159], v[164:167]
s_xor_b32 s74, s69, 262144
s_add_u32 s74, s74, s72
s_addc_u32 s75, s73, 0
v_mfma_f32_16x16x32_bf16 v[132:135], a[192:195], a[160:163], v[132:135]
global_load_lds_dwordx4 v20, s[74:75] offset:0
v_mfma_f32_16x16x32_bf16 v[132:135], a[200:203], a[164:167], v[132:135]
v_mfma_f32_16x16x32_bf16 v[100:103], a[200:203], a[168:171], v[100:103]
v_mfma_f32_16x16x32_bf16 v[100:103], a[192:195], a[172:175], v[100:103]
v_mfma_f32_16x16x32_bf16 v[68:71], a[192:195], a[176:179], v[68:71]
global_load_lds_dwordx4 v23, s[74:75] offset:1024
v_mfma_f32_16x16x32_bf16 v[68:71], a[200:203], a[180:183], v[68:71]
v_mfma_f32_16x16x32_bf16 v[36:39], a[200:203], a[184:187], v[36:39]
v_mfma_f32_16x16x32_bf16 v[36:39], a[192:195], a[188:191], v[36:39]
s_waitcnt lgkmcnt(14)
v_mfma_f32_16x16x32_bf16 v[40:43], a[220:223], a[188:191], v[40:43]
global_load_lds_dwordx4 v18, s[74:75] offset:2048
v_mfma_f32_16x16x32_bf16 v[40:43], a[12:15], a[184:187], v[40:43]
s_waitcnt vmcnt(11)
v_mfma_f32_16x16x32_bf16 v[72:75], a[12:15], a[180:183], v[72:75]
ds_read_b64_tr_b16 a[44:45], v21 offset:16384
v_mfma_f32_16x16x32_bf16 v[72:75], a[220:223], a[176:179], v[72:75]
ds_read_b64_tr_b16 a[46:47], v21 offset:16896
v_mfma_f32_16x16x32_bf16 v[104:107], a[220:223], a[172:175], v[104:107]
ds_read_b64_tr_b16 a[28:29], v21 offset:16392
v_mfma_f32_16x16x32_bf16 v[104:107], a[12:15], a[168:171], v[104:107]
ds_read_b64_tr_b16 a[30:31], v21 offset:16904
v_mfma_f32_16x16x32_bf16 v[136:139], a[12:15], a[164:167], v[136:139]
ds_read_b64_tr_b16 a[48:49], v22 offset:16384
v_mfma_f32_16x16x32_bf16 v[136:139], a[220:223], a[160:163], v[136:139]
ds_read_b64_tr_b16 a[50:51], v22 offset:16896
v_mfma_f32_16x16x32_bf16 v[168:171], a[220:223], a[156:159], v[168:171]
ds_read_b64_tr_b16 a[32:33], v22 offset:16392
v_mfma_f32_16x16x32_bf16 v[168:171], a[12:15], a[152:155], v[168:171]
ds_read_b64_tr_b16 a[34:35], v22 offset:16904
v_mfma_f32_16x16x32_bf16 v[200:203], a[12:15], a[148:151], v[200:203]
global_load_lds_dwordx4 v19, s[74:75] offset:3072
v_mfma_f32_16x16x32_bf16 v[200:203], a[220:223], a[144:147], v[200:203]
v_mfma_f32_16x16x32_bf16 v[232:235], a[220:223], a[140:143], v[232:235]
s_waitcnt lgkmcnt(15)
s_add_u32 m0, s60, 114688
v_mfma_f32_16x16x32_bf16 v[232:235], a[12:15], a[136:139], v[232:235]
s_xor_b32 s74, s69, 327680
s_add_u32 s74, s74, s72
s_addc_u32 s75, s73, 0
v_mfma_f32_16x16x32_bf16 a[240:243], a[12:15], a[132:135], a[240:243]
global_load_lds_dwordx4 v20, s[74:75] offset:0
v_mfma_f32_16x16x32_bf16 a[240:243], a[220:223], a[128:131], a[240:243]
v_mfma_f32_16x16x32_bf16 a[244:247], a[204:207], a[128:131], a[244:247]
v_mfma_f32_16x16x32_bf16 a[244:247], a[228:231], a[132:135], a[244:247]
v_mfma_f32_16x16x32_bf16 v[236:239], a[228:231], a[136:139], v[236:239]
global_load_lds_dwordx4 v23, s[74:75] offset:1024
v_mfma_f32_16x16x32_bf16 v[236:239], a[204:207], a[140:143], v[236:239]
v_mfma_f32_16x16x32_bf16 v[204:207], a[204:207], a[144:147], v[204:207]
v_mfma_f32_16x16x32_bf16 v[204:207], a[228:231], a[148:151], v[204:207]
v_mfma_f32_16x16x32_bf16 v[172:175], a[228:231], a[152:155], v[172:175]
global_load_lds_dwordx4 v18, s[74:75] offset:2048
v_mfma_f32_16x16x32_bf16 v[172:175], a[204:207], a[156:159], v[172:175]
v_mfma_f32_16x16x32_bf16 v[140:143], a[204:207], a[160:163], v[140:143]
v_mfma_f32_16x16x32_bf16 v[140:143], a[228:231], a[164:167], v[140:143]
v_mfma_f32_16x16x32_bf16 v[108:111], a[228:231], a[168:171], v[108:111]
global_load_lds_dwordx4 v19, s[74:75] offset:3072
v_mfma_f32_16x16x32_bf16 v[108:111], a[204:207], a[172:175], v[108:111]
v_mfma_f32_16x16x32_bf16 v[76:79], a[204:207], a[176:179], v[76:79]
s_waitcnt lgkmcnt(8)
s_add_u32 m0, s60, 65536
v_mfma_f32_16x16x32_bf16 v[76:79], a[228:231], a[180:183], v[76:79]
s_xor_b32 s74, s69, 262272
s_add_u32 s74, s74, s72
s_addc_u32 s75, s73, 0
v_mfma_f32_16x16x32_bf16 v[44:47], a[228:231], a[184:187], v[44:47]
global_load_lds_dwordx4 v20, s[74:75] offset:0
v_mfma_f32_16x16x32_bf16 v[44:47], a[204:207], a[188:191], v[44:47]
v_mfma_f32_16x16x32_bf16 v[48:51], a[8:11], a[188:191], v[48:51]
v_mfma_f32_16x16x32_bf16 v[48:51], a[16:19], a[184:187], v[48:51]
v_mfma_f32_16x16x32_bf16 v[80:83], a[16:19], a[180:183], v[80:83]
global_load_lds_dwordx4 v23, s[74:75] offset:1024
v_mfma_f32_16x16x32_bf16 v[80:83], a[8:11], a[176:179], v[80:83]
v_mfma_f32_16x16x32_bf16 v[112:115], a[8:11], a[172:175], v[112:115]
v_mfma_f32_16x16x32_bf16 v[112:115], a[16:19], a[168:171], v[112:115]
v_mfma_f32_16x16x32_bf16 v[144:147], a[16:19], a[164:167], v[144:147]
global_load_lds_dwordx4 v18, s[74:75] offset:2048
v_mfma_f32_16x16x32_bf16 v[144:147], a[8:11], a[160:163], v[144:147]
v_mfma_f32_16x16x32_bf16 v[176:179], a[8:11], a[156:159], v[176:179]
v_mfma_f32_16x16x32_bf16 v[176:179], a[16:19], a[152:155], v[176:179]
v_mfma_f32_16x16x32_bf16 v[208:211], a[16:19], a[148:151], v[208:211]
global_load_lds_dwordx4 v19, s[74:75] offset:3072
v_mfma_f32_16x16x32_bf16 v[208:211], a[8:11], a[144:147], v[208:211]
v_mfma_f32_16x16x32_bf16 v[240:243], a[8:11], a[140:143], v[240:243]
s_waitcnt lgkmcnt(0)
s_add_u32 m0, s60, 81920
v_mfma_f32_16x16x32_bf16 v[240:243], a[16:19], a[136:139], v[240:243]
s_xor_b32 s74, s69, 327808
s_add_u32 s74, s74, s72
s_addc_u32 s75, s73, 0
v_mfma_f32_16x16x32_bf16 a[248:251], a[16:19], a[132:135], a[248:251]
global_load_lds_dwordx4 v20, s[74:75] offset:0
v_mfma_f32_16x16x32_bf16 a[248:251], a[8:11], a[128:131], a[248:251]
L_pad2:
s_cbranch_execz L_pad6
v_add_u32 v2, 0, v1
v_mfma_f32_16x16x32_bf16 a[252:255], a[224:227], a[128:131], a[252:255]
ds_read_b128 a[128:131], v2 offset:32768
v_mfma_f32_16x16x32_bf16 a[252:255], a[0:3], a[132:135], a[252:255]
ds_read_b128 a[132:135], v2 offset:40960
v_mfma_f32_16x16x32_bf16 v[244:247], a[0:3], a[136:139], v[244:247]
ds_read_b128 a[136:139], v2 offset:41984
v_mfma_f32_16x16x32_bf16 v[244:247], a[224:227], a[140:143], v[244:247]
ds_read_b128 a[140:143], v2 offset:33792
v_mfma_f32_16x16x32_bf16 v[212:215], a[224:227], a[144:147], v[212:215]
ds_read_b128 a[144:147], v2 offset:34816
v_mfma_f32_16x16x32_bf16 v[212:215], a[0:3], a[148:151], v[212:215]
ds_read_b128 a[148:151], v2 offset:43008
v_mfma_f32_16x16x32_bf16 v[180:183], a[0:3], a[152:155], v[180:183]
ds_read_b128 a[152:155], v2 offset:44032
v_mfma_f32_16x16x32_bf16 v[180:183], a[224:227], a[156:159], v[180:183]
ds_read_b128 a[156:159], v2 offset:35840
v_mfma_f32_16x16x32_bf16 v[148:151], a[224:227], a[160:163], v[148:151]
ds_read_b128 a[160:163], v2 offset:36864
v_mfma_f32_16x16x32_bf16 v[148:151], a[0:3], a[164:167], v[148:151]
ds_read_b128 a[164:167], v2 offset:45056
v_mfma_f32_16x16x32_bf16 v[116:119], a[0:3], a[168:171], v[116:119]
ds_read_b128 a[168:171], v2 offset:46080
v_mfma_f32_16x16x32_bf16 v[116:119], a[224:227], a[172:175], v[116:119]
ds_read_b128 a[172:175], v2 offset:37888
v_mfma_f32_16x16x32_bf16 v[84:87], a[224:227], a[176:179], v[84:87]
ds_read_b128 a[176:179], v2 offset:38912
v_mfma_f32_16x16x32_bf16 v[84:87], a[0:3], a[180:183], v[84:87]
ds_read_b128 a[180:183], v2 offset:47104
v_mfma_f32_16x16x32_bf16 v[52:55], a[0:3], a[184:187], v[52:55]
ds_read_b128 a[184:187], v2 offset:48128
v_mfma_f32_16x16x32_bf16 v[52:55], a[224:227], a[188:191], v[52:55]
ds_read_b128 a[188:191], v2 offset:39936
s_waitcnt lgkmcnt(12)
v_mfma_f32_16x16x32_bf16 v[24:27], a[20:23], a[128:131], v[24:27]
global_load_lds_dwordx4 v23, s[74:75] offset:1024
v_mfma_f32_16x16x32_bf16 v[24:27], a[44:47], a[132:135], v[24:27]
global_load_lds_dwordx4 v18, s[74:75] offset:2048
v_mfma_f32_16x16x32_bf16 v[56:59], a[44:47], a[136:139], v[56:59]
s_waitcnt vmcnt(11)
v_mfma_f32_16x16x32_bf16 v[56:59], a[20:23], a[140:143], v[56:59]
ds_read_b64_tr_b16 a[52:53], v21 offset:32768
s_waitcnt lgkmcnt(9)
v_mfma_f32_16x16x32_bf16 v[88:91], a[20:23], a[144:147], v[88:91]
ds_read_b64_tr_b16 a[54:55], v21 offset:33280
v_mfma_f32_16x16x32_bf16 v[88:91], a[44:47], a[148:151], v[88:91]
ds_read_b64_tr_b16 a[36:37], v21 offset:32776
v_mfma_f32_16x16x32_bf16 v[120:123], a[44:47], a[152:155], v[120:123]
ds_read_b64_tr_b16 a[38:39], v21 offset:33288
v_mfma_f32_16x16x32_bf16 v[120:123], a[20:23], a[156:159], v[120:123]
ds_read_b64_tr_b16 a[72:73], v22 offset:32768
s_waitcnt lgkmcnt(9)
v_mfma_f32_16x16x32_bf16 v[152:155], a[20:23], a[160:163], v[152:155]
ds_read_b64_tr_b16 a[74:75], v22 offset:33280
v_mfma_f32_16x16x32_bf16 v[152:155], a[44:47], a[164:167], v[152:155]
ds_read_b64_tr_b16 a[56:57], v22 offset:32776
v_mfma_f32_16x16x32_bf16 v[184:187], a[44:47], a[168:171], v[184:187]
ds_read_b64_tr_b16 a[58:59], v22 offset:33288
v_mfma_f32_16x16x32_bf16 v[184:187], a[20:23], a[172:175], v[184:187]
s_waitcnt lgkmcnt(8)
v_mfma_f32_16x16x32_bf16 v[216:219], a[20:23], a[176:179], v[216:219]
s_barrier
v_mfma_f32_16x16x32_bf16 v[216:219], a[44:47], a[180:183], v[216:219]
global_load_lds_dwordx4 v19, s[74:75] offset:3072
v_mfma_f32_16x16x32_bf16 v[248:251], a[44:47], a[184:187], v[248:251]
v_mfma_f32_16x16x32_bf16 v[248:251], a[20:23], a[188:191], v[248:251]
v_mfma_f32_16x16x32_bf16 v[252:255], a[4:7], a[188:191], v[252:255]
v_mfma_f32_16x16x32_bf16 v[252:255], a[28:31], a[184:187], v[252:255]
v_mfma_f32_16x16x32_bf16 v[220:223], a[28:31], a[180:183], v[220:223]
s_waitcnt vmcnt(8)
v_mfma_f32_16x16x32_bf16 v[220:223], a[4:7], a[176:179], v[220:223]
ds_read_b64_tr_b16 a[76:77], v21 offset:49152
v_mfma_f32_16x16x32_bf16 v[188:191], a[4:7], a[172:175], v[188:191]
ds_read_b64_tr_b16 a[78:79], v21 offset:49664
v_mfma_f32_16x16x32_bf16 v[188:191], a[28:31], a[168:171], v[188:191]
ds_read_b64_tr_b16 a[60:61], v21 offset:49160
v_mfma_f32_16x16x32_bf16 v[156:159], a[28:31], a[164:167], v[156:159]
ds_read_b64_tr_b16 a[62:63], v21 offset:49672
v_mfma_f32_16x16x32_bf16 v[156:159], a[4:7], a[160:163], v[156:159]
ds_read_b64_tr_b16 a[80:81], v22 offset:49152
v_mfma_f32_16x16x32_bf16 v[124:127], a[4:7], a[156:159], v[124:127]
ds_read_b64_tr_b16 a[82:83], v22 offset:49664
v_mfma_f32_16x16x32_bf16 v[124:127], a[28:31], a[152:155], v[124:127]
ds_read_b64_tr_b16 a[64:65], v22 offset:49160
v_mfma_f32_16x16x32_bf16 v[92:95], a[28:31], a[148:151], v[92:95]
ds_read_b64_tr_b16 a[66:67], v22 offset:49672
v_mfma_f32_16x16x32_bf16 v[92:95], a[4:7], a[144:147], v[92:95]
v_mfma_f32_16x16x32_bf16 v[60:63], a[4:7], a[140:143], v[60:63]
v_mfma_f32_16x16x32_bf16 v[60:63], a[28:31], a[136:139], v[60:63]
v_mfma_f32_16x16x32_bf16 v[28:31], a[28:31], a[132:135], v[28:31]
v_mfma_f32_16x16x32_bf16 v[28:31], a[4:7], a[128:131], v[28:31]
v_mfma_f32_16x16x32_bf16 v[32:35], a[40:43], a[128:131], v[32:35]
v_mfma_f32_16x16x32_bf16 v[32:35], a[48:51], a[132:135], v[32:35]
v_mfma_f32_16x16x32_bf16 v[64:67], a[48:51], a[136:139], v[64:67]
s_waitcnt vmcnt(4)
v_mfma_f32_16x16x32_bf16 v[64:67], a[40:43], a[140:143], v[64:67]
ds_read_b64_tr_b16 a[84:85], v21 offset:0
v_mfma_f32_16x16x32_bf16 v[96:99], a[40:43], a[144:147], v[96:99]
ds_read_b64_tr_b16 a[86:87], v21 offset:512
v_mfma_f32_16x16x32_bf16 v[96:99], a[48:51], a[148:151], v[96:99]
ds_read_b64_tr_b16 a[68:69], v21 offset:8
v_mfma_f32_16x16x32_bf16 v[128:131], a[48:51], a[152:155], v[128:131]
ds_read_b64_tr_b16 a[70:71], v21 offset:520
v_mfma_f32_16x16x32_bf16 v[128:131], a[40:43], a[156:159], v[128:131]
ds_read_b64_tr_b16 a[212:213], v22 offset:0
v_mfma_f32_16x16x32_bf16 v[160:163], a[40:43], a[160:163], v[160:163]
ds_read_b64_tr_b16 a[214:215], v22 offset:512
v_mfma_f32_16x16x32_bf16 v[160:163], a[48:51], a[164:167], v[160:163]
ds_read_b64_tr_b16 a[88:89], v22 offset:8
v_mfma_f32_16x16x32_bf16 v[192:195], a[48:51], a[168:171], v[192:195]
ds_read_b64_tr_b16 a[90:91], v22 offset:520
s_mov_b32 s86, 256
v_mfma_f32_16x16x32_bf16 v[192:195], a[40:43], a[172:175], v[192:195]
buffer_load_dword v8, v0, s[84:87], 0 offen offset:0 sc1
v_mfma_f32_16x16x32_bf16 v[224:227], a[40:43], a[176:179], v[224:227]
v_mfma_f32_16x16x32_bf16 v[224:227], a[48:51], a[180:183], v[224:227]
v_mfma_f32_16x16x32_bf16 a[232:235], a[48:51], a[184:187], a[232:235]
v_mfma_f32_16x16x32_bf16 a[232:235], a[40:43], a[188:191], a[232:235]
v_add_u32 v2, 131072, v1
v_mfma_f32_16x16x32_bf16 a[236:239], a[24:27], a[188:191], a[236:239]
ds_read_b128 a[188:191], v2 offset:0
v_mfma_f32_16x16x32_bf16 a[236:239], a[32:35], a[184:187], a[236:239]
ds_read_b128 a[184:187], v2 offset:8192
v_mfma_f32_16x16x32_bf16 v[228:231], a[32:35], a[180:183], v[228:231]
ds_read_b128 a[180:183], v2 offset:9216
v_mfma_f32_16x16x32_bf16 v[228:231], a[24:27], a[176:179], v[228:231]
ds_read_b128 a[176:179], v2 offset:1024
v_mfma_f32_16x16x32_bf16 v[196:199], a[24:27], a[172:175], v[196:199]
ds_read_b128 a[172:175], v2 offset:2048
v_mfma_f32_16x16x32_bf16 v[196:199], a[32:35], a[168:171], v[196:199]
ds_read_b128 a[168:171], v2 offset:10240
v_mfma_f32_16x16x32_bf16 v[164:167], a[32:35], a[164:167], v[164:167]
ds_read_b128 a[164:167], v2 offset:11264
v_mfma_f32_16x16x32_bf16 v[164:167], a[24:27], a[160:163], v[164:167]
ds_read_b128 a[160:163], v2 offset:3072
v_mfma_f32_16x16x32_bf16 v[132:135], a[24:27], a[156:159], v[132:135]
ds_read_b128 a[156:159], v2 offset:4096
v_mfma_f32_16x16x32_bf16 v[132:135], a[32:35], a[152:155], v[132:135]
ds_read_b128 a[152:155], v2 offset:12288
v_mfma_f32_16x16x32_bf16 v[100:103], a[32:35], a[148:151], v[100:103]
ds_read_b128 a[148:151], v2 offset:13312
v_mfma_f32_16x16x32_bf16 v[100:103], a[24:27], a[144:147], v[100:103]
ds_read_b128 a[144:147], v2 offset:5120
v_mfma_f32_16x16x32_bf16 v[68:71], a[24:27], a[140:143], v[68:71]
ds_read_b128 a[140:143], v2 offset:6144
v_mfma_f32_16x16x32_bf16 v[68:71], a[32:35], a[136:139], v[68:71]
ds_read_b128 a[136:139], v2 offset:14336
v_mfma_f32_16x16x32_bf16 v[36:39], a[32:35], a[132:135], v[36:39]
ds_read_b128 a[132:135], v2 offset:15360
v_mfma_f32_16x16x32_bf16 v[36:39], a[24:27], a[128:131], v[36:39]
ds_read_b128 a[128:131], v2 offset:7168
s_waitcnt lgkmcnt(12)
v_mfma_f32_16x16x32_bf16 v[24:27], a[52:55], a[188:191], v[24:27]
v_mfma_f32_16x16x32_bf16 v[24:27], a[76:79], a[184:187], v[24:27]
v_mfma_f32_16x16x32_bf16 v[56:59], a[76:79], a[180:183], v[56:59]
v_mfma_f32_16x16x32_bf16 v[56:59], a[52:55], a[176:179], v[56:59]
s_waitcnt lgkmcnt(8)
v_mfma_f32_16x16x32_bf16 v[88:91], a[52:55], a[172:175], v[88:91]
v_mfma_f32_16x16x32_bf16 v[88:91], a[76:79], a[168:171], v[88:91]
s_waitcnt vmcnt(1)
v_mfma_f32_16x16x32_bf16 v[120:123], a[76:79], a[164:167], v[120:123]
ds_read_b64_tr_b16 a[196:197], v21 offset:16384
v_mfma_f32_16x16x32_bf16 v[120:123], a[52:55], a[160:163], v[120:123]
ds_read_b64_tr_b16 a[198:199], v21 offset:16896
s_waitcnt lgkmcnt(6)
v_mfma_f32_16x16x32_bf16 v[152:155], a[52:55], a[156:159], v[152:155]
ds_read_b64_tr_b16 a[92:93], v21 offset:16392
v_mfma_f32_16x16x32_bf16 v[152:155], a[76:79], a[152:155], v[152:155]
ds_read_b64_tr_b16 a[94:95], v21 offset:16904
v_mfma_f32_16x16x32_bf16 v[184:187], a[76:79], a[148:151], v[184:187]
ds_read_b64_tr_b16 a[216:217], v22 offset:16384
v_mfma_f32_16x16x32_bf16 v[184:187], a[52:55], a[144:147], v[184:187]
ds_read_b64_tr_b16 a[218:219], v22 offset:16896
s_waitcnt lgkmcnt(6)
v_mfma_f32_16x16x32_bf16 v[216:219], a[52:55], a[140:143], v[216:219]
ds_read_b64_tr_b16 a[208:209], v22 offset:16392
s_barrier
v_mfma_f32_16x16x32_bf16 v[216:219], a[76:79], a[136:139], v[216:219]
ds_read_b64_tr_b16 a[210:211], v22 offset:16904
s_add_u32 m0, s56, 131072
v_mfma_f32_16x16x32_bf16 v[248:251], a[76:79], a[132:135], v[248:251]
s_xor_b32 s10, s59, 384
s_add_u32 s10, s10, s8
s_addc_u32 s11, s9, 0
v_mfma_f32_16x16x32_bf16 v[248:251], a[52:55], a[128:131], v[248:251]
v_mfma_f32_16x16x32_bf16 v[252:255], a[36:39], a[128:131], v[252:255]
global_load_lds_dwordx4 v4, s[10:11]
v_mfma_f32_16x16x32_bf16 v[252:255], a[60:63], a[132:135], v[252:255]
v_mfma_f32_16x16x32_bf16 v[220:223], a[60:63], a[136:139], v[220:223]
v_mfma_f32_16x16x32_bf16 v[220:223], a[36:39], a[140:143], v[220:223]
global_load_lds_dwordx4 v5, s[10:11] offset:1024
v_mfma_f32_16x16x32_bf16 v[188:191], a[36:39], a[144:147], v[188:191]
v_mfma_f32_16x16x32_bf16 v[188:191], a[60:63], a[148:151], v[188:191]
v_mfma_f32_16x16x32_bf16 v[156:159], a[60:63], a[152:155], v[156:159]
v_mfma_f32_16x16x32_bf16 v[156:159], a[36:39], a[156:159], v[156:159]
s_add_u32 m0, s56, 139264
s_xor_b32 s10, s59, 448
s_add_u32 s10, s10, s8
s_addc_u32 s11, s9, 0
v_mfma_f32_16x16x32_bf16 v[124:127], a[36:39], a[160:163], v[124:127]
v_mfma_f32_16x16x32_bf16 v[124:127], a[60:63], a[164:167], v[124:127]
global_load_lds_dwordx4 v4, s[10:11]
v_mfma_f32_16x16x32_bf16 v[92:95], a[60:63], a[168:171], v[92:95]
v_mfma_f32_16x16x32_bf16 v[92:95], a[36:39], a[172:175], v[92:95]
v_mfma_f32_16x16x32_bf16 v[60:63], a[36:39], a[176:179], v[60:63]
v_mfma_f32_16x16x32_bf16 v[60:63], a[60:63], a[180:183], v[60:63]
global_load_lds_dwordx4 v5, s[10:11] offset:1024
v_mfma_f32_16x16x32_bf16 v[28:31], a[60:63], a[184:187], v[28:31]
v_mfma_f32_16x16x32_bf16 v[28:31], a[36:39], a[188:191], v[28:31]
v_mfma_f32_16x16x32_bf16 v[32:35], a[72:75], a[188:191], v[32:35]
s_add_u32 m0, s56, 65536
v_mfma_f32_16x16x32_bf16 v[32:35], a[80:83], a[184:187], v[32:35]
s_xor_b32 s10, s58, 512
s_add_u32 s10, s10, s8
s_addc_u32 s11, s9, 0
v_mfma_f32_16x16x32_bf16 v[64:67], a[80:83], a[180:183], v[64:67]
v_mfma_f32_16x16x32_bf16 v[64:67], a[72:75], a[176:179], v[64:67]
global_load_lds_dwordx4 v4, s[10:11]
v_mfma_f32_16x16x32_bf16 v[96:99], a[72:75], a[172:175], v[96:99]
v_mfma_f32_16x16x32_bf16 v[96:99], a[80:83], a[168:171], v[96:99]
v_mfma_f32_16x16x32_bf16 v[128:131], a[80:83], a[164:167], v[128:131]
global_load_lds_dwordx4 v5, s[10:11] offset:1024
v_mfma_f32_16x16x32_bf16 v[128:131], a[72:75], a[160:163], v[128:131]
v_mfma_f32_16x16x32_bf16 v[160:163], a[72:75], a[156:159], v[160:163]
v_mfma_f32_16x16x32_bf16 v[160:163], a[80:83], a[152:155], v[160:163]
v_mfma_f32_16x16x32_bf16 v[192:195], a[80:83], a[148:151], v[192:195]
s_add_u32 m0, s56, 73728
s_xor_b32 s10, s58, 576
s_add_u32 s10, s10, s8
s_addc_u32 s11, s9, 0
v_mfma_f32_16x16x32_bf16 v[192:195], a[72:75], a[144:147], v[192:195]
s_waitcnt vmcnt(6)
v_mfma_f32_16x16x32_bf16 v[224:227], a[72:75], a[140:143], v[224:227]
v_cmp_gt_u32 vcc, 128, v8
v_mfma_f32_16x16x32_bf16 v[224:227], a[80:83], a[136:139], v[224:227]
global_load_lds_dwordx4 v4, s[10:11]
v_mfma_f32_16x16x32_bf16 a[232:235], a[80:83], a[132:135], a[232:235]
v_mfma_f32_16x16x32_bf16 a[232:235], a[72:75], a[128:131], a[232:235]
v_mfma_f32_16x16x32_bf16 a[236:239], a[56:59], a[128:131], a[236:239]
global_load_lds_dwordx4 v5, s[10:11] offset:1024
v_mfma_f32_16x16x32_bf16 a[236:239], a[64:67], a[132:135], a[236:239]
s_and_b32 s3, vcc_lo, 257
s_cbranch_scc1 L_slow0
L_back0:
v_mfma_f32_16x16x32_bf16 v[228:231], a[64:67], a[136:139], v[228:231]
v_mfma_f32_16x16x32_bf16 v[228:231], a[56:59], a[140:143], v[228:231]
v_mfma_f32_16x16x32_bf16 v[196:199], a[56:59], a[144:147], v[196:199]
s_xor_b32 s72, s64, 53248
s_add_u32 s72, s72, s12
s_addc_u32 s73, s13, 0
v_mfma_f32_16x16x32_bf16 v[196:199], a[64:67], a[148:151], v[196:199]
global_load_dwordx4 a[200:203], v0, s[72:73] offset:-4096
v_mfma_f32_16x16x32_bf16 v[164:167], a[64:67], a[152:155], v[164:167]
s_xor_b32 s74, s64, 61440
s_add_u32 s74, s74, s12
s_addc_u32 s75, s13, 0
v_mfma_f32_16x16x32_bf16 v[164:167], a[56:59], a[156:159], v[164:167]
v_mfma_f32_16x16x32_bf16 v[132:135], a[56:59], a[160:163], v[132:135]
v_mfma_f32_16x16x32_bf16 v[132:135], a[64:67], a[164:167], v[132:135]
global_load_dwordx4 a[192:195], v0, s[74:75] offset:-4096
v_mfma_f32_16x16x32_bf16 v[100:103], a[64:67], a[168:171], v[100:103]
v_mfma_f32_16x16x32_bf16 v[100:103], a[56:59], a[172:175], v[100:103]
v_mfma_f32_16x16x32_bf16 v[68:71], a[56:59], a[176:179], v[68:71]
v_mfma_f32_16x16x32_bf16 v[68:71], a[64:67], a[180:183], v[68:71]
global_load_dwordx4 a[12:15], v0, s[72:73] offset:-3072
v_mfma_f32_16x16x32_bf16 v[36:39], a[64:67], a[184:187], v[36:39]
v_mfma_f32_16x16x32_bf16 v[36:39], a[56:59], a[188:191], v[36:39]
s_waitcnt lgkmcnt(6)
v_mfma_f32_16x16x32_bf16 v[40:43], a[84:87], a[188:191], v[40:43]
v_mfma_f32_16x16x32_bf16 v[40:43], a[196:199], a[184:187], v[40:43]
global_load_dwordx4 a[220:223], v0, s[74:75] offset:-3072
v_mfma_f32_16x16x32_bf16 v[72:75], a[196:199], a[180:183], v[72:75]
v_mfma_f32_16x16x32_bf16 v[72:75], a[84:87], a[176:179], v[72:75]
v_mfma_f32_16x16x32_bf16 v[104:107], a[84:87], a[172:175], v[104:107]
v_mfma_f32_16x16x32_bf16 v[104:107], a[196:199], a[168:171], v[104:107]
global_load_dwordx4 a[228:231], v0, s[72:73] offset:-2048
v_mfma_f32_16x16x32_bf16 v[136:139], a[196:199], a[164:167], v[136:139]
v_mfma_f32_16x16x32_bf16 v[136:139], a[84:87], a[160:163], v[136:139]
v_mfma_f32_16x16x32_bf16 v[168:171], a[84:87], a[156:159], v[168:171]
v_mfma_f32_16x16x32_bf16 v[168:171], a[196:199], a[152:155], v[168:171]
global_load_dwordx4 a[204:207], v0, s[74:75] offset:-2048
v_mfma_f32_16x16x32_bf16 v[200:203], a[196:199], a[148:151], v[200:203]
v_mfma_f32_16x16x32_bf16 v[200:203], a[84:87], a[144:147], v[200:203]
v_mfma_f32_16x16x32_bf16 v[232:235], a[84:87], a[140:143], v[232:235]
v_mfma_f32_16x16x32_bf16 v[232:235], a[196:199], a[136:139], v[232:235]
global_load_dwordx4 a[16:19], v0, s[72:73] offset:-1024
v_mfma_f32_16x16x32_bf16 a[240:243], a[196:199], a[132:135], a[240:243]
s_xor_b32 s72, s64, 184320
s_add_u32 s72, s72, s12
s_addc_u32 s73, s13, 0
v_mfma_f32_16x16x32_bf16 a[240:243], a[84:87], a[128:131], a[240:243]
s_waitcnt lgkmcnt(4)
v_mfma_f32_16x16x32_bf16 a[244:247], a[68:71], a[128:131], a[244:247]
v_mfma_f32_16x16x32_bf16 a[244:247], a[92:95], a[132:135], a[244:247]
global_load_dwordx4 a[8:11], v0, s[74:75] offset:-1024
v_mfma_f32_16x16x32_bf16 v[236:239], a[92:95], a[136:139], v[236:239]
s_xor_b32 s74, s64, 192512
s_add_u32 s74, s74, s12
s_addc_u32 s75, s13, 0
v_mfma_f32_16x16x32_bf16 v[236:239], a[68:71], a[140:143], v[236:239]
v_mfma_f32_16x16x32_bf16 v[204:207], a[68:71], a[144:147], v[204:207]
v_mfma_f32_16x16x32_bf16 v[204:207], a[92:95], a[148:151], v[204:207]
global_load_dwordx4 a[0:3], v0, s[72:73] offset:-4096
v_mfma_f32_16x16x32_bf16 v[172:175], a[92:95], a[152:155], v[172:175]
v_mfma_f32_16x16x32_bf16 v[172:175], a[68:71], a[156:159], v[172:175]
v_mfma_f32_16x16x32_bf16 v[140:143], a[68:71], a[160:163], v[140:143]
v_mfma_f32_16x16x32_bf16 v[140:143], a[92:95], a[164:167], v[140:143]
global_load_dwordx4 a[224:227], v0, s[74:75] offset:-4096
v_mfma_f32_16x16x32_bf16 v[108:111], a[92:95], a[168:171], v[108:111]
v_mfma_f32_16x16x32_bf16 v[108:111], a[68:71], a[172:175], v[108:111]
v_mfma_f32_16x16x32_bf16 v[76:79], a[68:71], a[176:179], v[76:79]
v_mfma_f32_16x16x32_bf16 v[76:79], a[92:95], a[180:183], v[76:79]
global_load_dwordx4 a[44:47], v0, s[72:73] offset:-3072
v_mfma_f32_16x16x32_bf16 v[44:47], a[92:95], a[184:187], v[44:47]
v_mfma_f32_16x16x32_bf16 v[44:47], a[68:71], a[188:191], v[44:47]
s_waitcnt lgkmcnt(2)
v_mfma_f32_16x16x32_bf16 v[48:51], a[212:215], a[188:191], v[48:51]
v_mfma_f32_16x16x32_bf16 v[48:51], a[216:219], a[184:187], v[48:51]
global_load_dwordx4 a[20:23], v0, s[74:75] offset:-3072
v_mfma_f32_16x16x32_bf16 v[80:83], a[216:219], a[180:183], v[80:83]
v_mfma_f32_16x16x32_bf16 v[80:83], a[212:215], a[176:179], v[80:83]
v_mfma_f32_16x16x32_bf16 v[112:115], a[212:215], a[172:175], v[112:115]
v_mfma_f32_16x16x32_bf16 v[112:115], a[216:219], a[168:171], v[112:115]
global_load_dwordx4 a[28:31], v0, s[72:73] offset:-2048
v_mfma_f32_16x16x32_bf16 v[144:147], a[216:219], a[164:167], v[144:147]
v_mfma_f32_16x16x32_bf16 v[144:147], a[212:215], a[160:163], v[144:147]
v_mfma_f32_16x16x32_bf16 v[176:179], a[212:215], a[156:159], v[176:179]
v_mfma_f32_16x16x32_bf16 v[176:179], a[216:219], a[152:155], v[176:179]
global_load_dwordx4 a[4:7], v0, s[74:75] offset:-2048
v_mfma_f32_16x16x32_bf16 v[208:211], a[216:219], a[148:151], v[208:211]
v_mfma_f32_16x16x32_bf16 v[208:211], a[212:215], a[144:147], v[208:211]
v_mfma_f32_16x16x32_bf16 v[240:243], a[212:215], a[140:143], v[240:243]
v_mfma_f32_16x16x32_bf16 v[240:243], a[216:219], a[136:139], v[240:243]
global_load_dwordx4 a[40:43], v0, s[72:73] offset:-1024
v_mfma_f32_16x16x32_bf16 a[248:251], a[216:219], a[132:135], a[248:251]
global_load_dwordx4 a[32:35], v0, s[74:75] offset:-1024
v_mfma_f32_16x16x32_bf16 a[248:251], a[212:215], a[128:131], a[248:251]
v_add_u32 v2, 0, v1
s_waitcnt lgkmcnt(0)
v_mfma_f32_16x16x32_bf16 a[252:255], a[88:91], a[128:131], a[252:255]
ds_read_b128 a[128:131], v2 offset:49152
v_mfma_f32_16x16x32_bf16 a[252:255], a[208:211], a[132:135], a[252:255]
ds_read_b128 a[132:135], v2 offset:57344
v_mfma_f32_16x16x32_bf16 v[244:247], a[208:211], a[136:139], v[244:247]
ds_read_b128 a[136:139], v2 offset:58368
v_mfma_f32_16x16x32_bf16 v[244:247], a[88:91], a[140:143], v[244:247]
ds_read_b128 a[140:143], v2 offset:50176
v_mfma_f32_16x16x32_bf16 v[212:215], a[88:91], a[144:147], v[212:215]
ds_read_b128 a[144:147], v2 offset:51200
v_mfma_f32_16x16x32_bf16 v[212:215], a[208:211], a[148:151], v[212:215]
ds_read_b128 a[148:151], v2 offset:59392
v_mfma_f32_16x16x32_bf16 v[180:183], a[208:211], a[152:155], v[180:183]
ds_read_b128 a[152:155], v2 offset:60416
v_mfma_f32_16x16x32_bf16 v[180:183], a[88:91], a[156:159], v[180:183]
ds_read_b128 a[156:159], v2 offset:52224
v_mfma_f32_16x16x32_bf16 v[148:151], a[88:91], a[160:163], v[148:151]
ds_read_b128 a[160:163], v2 offset:53248
v_mfma_f32_16x16x32_bf16 v[148:151], a[208:211], a[164:167], v[148:151]
ds_read_b128 a[164:167], v2 offset:61440
v_mfma_f32_16x16x32_bf16 v[116:119], a[208:211], a[168:171], v[116:119]
ds_read_b128 a[168:171], v2 offset:62464
v_mfma_f32_16x16x32_bf16 v[116:119], a[88:91], a[172:175], v[116:119]
ds_read_b128 a[172:175], v2 offset:54272
v_mfma_f32_16x16x32_bf16 v[84:87], a[88:91], a[176:179], v[84:87]
ds_read_b128 a[176:179], v2 offset:55296
v_mfma_f32_16x16x32_bf16 v[84:87], a[208:211], a[180:183], v[84:87]
ds_read_b128 a[180:183], v2 offset:63488
v_mfma_f32_16x16x32_bf16 v[52:55], a[208:211], a[184:187], v[52:55]
ds_read_b128 a[184:187], v2 offset:64512
v_mfma_f32_16x16x32_bf16 v[52:55], a[88:91], a[188:191], v[52:55]
ds_read_b128 a[188:191], v2 offset:56320
s_waitcnt vmcnt(14) lgkmcnt(12)
v_mfma_f32_16x16x32_bf16 v[24:27], a[200:203], a[128:131], v[24:27]
global_load_dwordx4 a[24:27], v0, s[72:73] offset:0
v_mfma_f32_16x16x32_bf16 v[24:27], a[192:195], a[132:135], v[24:27]
v_mfma_f32_16x16x32_bf16 v[56:59], a[192:195], a[136:139], v[56:59]
v_mfma_f32_16x16x32_bf16 v[56:59], a[200:203], a[140:143], v[56:59]
s_waitcnt lgkmcnt(8)
v_mfma_f32_16x16x32_bf16 v[88:91], a[200:203], a[144:147], v[88:91]
global_load_dwordx4 a[36:39], v0, s[74:75] offset:0
v_mfma_f32_16x16x32_bf16 v[88:91], a[192:195], a[148:151], v[88:91]
v_mfma_f32_16x16x32_bf16 v[120:123], a[192:195], a[152:155], v[120:123]
v_mfma_f32_16x16x32_bf16 v[120:123], a[200:203], a[156:159], v[120:123]
s_waitcnt lgkmcnt(4)
v_mfma_f32_16x16x32_bf16 v[152:155], a[200:203], a[160:163], v[152:155]
global_load_dwordx4 a[196:199], v0, s[72:73] offset:1024
v_mfma_f32_16x16x32_bf16 v[152:155], a[192:195], a[164:167], v[152:155]
v_mfma_f32_16x16x32_bf16 v[184:187], a[192:195], a[168:171], v[184:187]
v_mfma_f32_16x16x32_bf16 v[184:187], a[200:203], a[172:175], v[184:187]
s_waitcnt lgkmcnt(0)
v_mfma_f32_16x16x32_bf16 v[216:219], a[200:203], a[176:179], v[216:219]
s_barrier
v_mfma_f32_16x16x32_bf16 v[216:219], a[192:195], a[180:183], v[216:219]
global_load_dwordx4 a[216:219], v0, s[74:75] offset:1024
v_mfma_f32_16x16x32_bf16 v[248:251], a[192:195], a[184:187], v[248:251]
v_mfma_f32_16x16x32_bf16 v[248:251], a[200:203], a[188:191], v[248:251]
s_waitcnt vmcnt(16)
v_mfma_f32_16x16x32_bf16 v[252:255], a[12:15], a[188:191], v[252:255]
v_mfma_f32_16x16x32_bf16 v[252:255], a[220:223], a[184:187], v[252:255]
global_load_dwordx4 a[212:215], v0, s[72:73] offset:2048
v_mfma_f32_16x16x32_bf16 v[220:223], a[220:223], a[180:183], v[220:223]
v_mfma_f32_16x16x32_bf16 v[220:223], a[12:15], a[176:179], v[220:223]
v_mfma_f32_16x16x32_bf16 v[188:191], a[12:15], a[172:175], v[188:191]
v_mfma_f32_16x16x32_bf16 v[188:191], a[220:223], a[168:171], v[188:191]
global_load_dwordx4 a[208:211], v0, s[74:75] offset:2048
v_mfma_f32_16x16x32_bf16 v[156:159], a[220:223], a[164:167], v[156:159]
v_mfma_f32_16x16x32_bf16 v[156:159], a[12:15], a[160:163], v[156:159]
v_mfma_f32_16x16x32_bf16 v[124:127], a[12:15], a[156:159], v[124:127]
v_mfma_f32_16x16x32_bf16 v[124:127], a[220:223], a[152:155], v[124:127]
global_load_dwordx4 a[192:195], v0, s[72:73] offset:3072
v_mfma_f32_16x16x32_bf16 v[92:95], a[220:223], a[148:151], v[92:95]
s_xor_b32 s72, s64, 69632
s_add_u32 s72, s72, s12
s_addc_u32 s73, s13, 0
v_mfma_f32_16x16x32_bf16 v[92:95], a[12:15], a[144:147], v[92:95]
v_mfma_f32_16x16x32_bf16 v[60:63], a[12:15], a[140:143], v[60:63]
v_mfma_f32_16x16x32_bf16 v[60:63], a[220:223], a[136:139], v[60:63]
global_load_dwordx4 a[200:203], v0, s[74:75] offset:3072
v_mfma_f32_16x16x32_bf16 v[28:31], a[220:223], a[132:135], v[28:31]
s_xor_b32 s74, s64, 77824
s_add_u32 s74, s74, s12
s_addc_u32 s75, s13, 0
v_mfma_f32_16x16x32_bf16 v[28:31], a[12:15], a[128:131], v[28:31]
s_waitcnt vmcnt(18)
v_mfma_f32_16x16x32_bf16 v[32:35], a[228:231], a[128:131], v[32:35]
v_mfma_f32_16x16x32_bf16 v[32:35], a[204:207], a[132:135], v[32:35]
global_load_dwordx4 a[220:223], v0, s[72:73] offset:-4096
v_mfma_f32_16x16x32_bf16 v[64:67], a[204:207], a[136:139], v[64:67]
v_mfma_f32_16x16x32_bf16 v[64:67], a[228:231], a[140:143], v[64:67]
v_mfma_f32_16x16x32_bf16 v[96:99], a[228:231], a[144:147], v[96:99]
v_mfma_f32_16x16x32_bf16 v[96:99], a[204:207], a[148:151], v[96:99]
global_load_dwordx4 a[12:15], v0, s[74:75] offset:-4096
v_mfma_f32_16x16x32_bf16 v[128:131], a[204:207], a[152:155], v[128:131]
v_mfma_f32_16x16x32_bf16 v[128:131], a[228:231], a[156:159], v[128:131]
v_mfma_f32_16x16x32_bf16 v[160:163], a[228:231], a[160:163], v[160:163]
v_mfma_f32_16x16x32_bf16 v[160:163], a[204:207], a[164:167], v[160:163]
v_mfma_f32_16x16x32_bf16 v[192:195], a[204:207], a[168:171], v[192:195]
v_mfma_f32_16x16x32_bf16 v[192:195], a[228:231], a[172:175], v[192:195]
v_mfma_f32_16x16x32_bf16 v[224:227], a[228:231], a[176:179], v[224:227]
v_mfma_f32_16x16x32_bf16 v[224:227], a[204:207], a[180:183], v[224:227]
v_mfma_f32_16x16x32_bf16 a[232:235], a[204:207], a[184:187], a[232:235]
global_load_dwordx4 a[204:207], v0, s[72:73] offset:-3072
v_mfma_f32_16x16x32_bf16 a[232:235], a[228:231], a[188:191], a[232:235]
v_add_u32 v2, 131072, v1
s_waitcnt vmcnt(19)
v_mfma_f32_16x16x32_bf16 a[236:239], a[16:19], a[188:191], a[236:239]
ds_read_b128 a[188:191], v2 offset:0
v_mfma_f32_16x16x32_bf16 a[236:239], a[8:11], a[184:187], a[236:239]
ds_read_b128 a[184:187], v2 offset:8192
v_mfma_f32_16x16x32_bf16 v[228:231], a[8:11], a[180:183], v[228:231]
ds_read_b128 a[180:183], v2 offset:9216
v_mfma_f32_16x16x32_bf16 v[228:231], a[16:19], a[176:179], v[228:231]
ds_read_b128 a[176:179], v2 offset:1024
v_mfma_f32_16x16x32_bf16 v[196:199], a[16:19], a[172:175], v[196:199]
ds_read_b128 a[172:175], v2 offset:2048
v_mfma_f32_16x16x32_bf16 v[196:199], a[8:11], a[168:171], v[196:199]
ds_read_b128 a[168:171], v2 offset:10240
v_mfma_f32_16x16x32_bf16 v[164:167], a[8:11], a[164:167], v[164:167]
ds_read_b128 a[164:167], v2 offset:11264
v_mfma_f32_16x16x32_bf16 v[164:167], a[16:19], a[160:163], v[164:167]
ds_read_b128 a[160:163], v2 offset:3072
v_mfma_f32_16x16x32_bf16 v[132:135], a[16:19], a[156:159], v[132:135]
ds_read_b128 a[156:159], v2 offset:4096
v_mfma_f32_16x16x32_bf16 v[132:135], a[8:11], a[152:155], v[132:135]
ds_read_b128 a[152:155], v2 offset:12288
v_mfma_f32_16x16x32_bf16 v[100:103], a[8:11], a[148:151], v[100:103]
ds_read_b128 a[148:151], v2 offset:13312
v_mfma_f32_16x16x32_bf16 v[100:103], a[16:19], a[144:147], v[100:103]
ds_read_b128 a[144:147], v2 offset:5120
v_mfma_f32_16x16x32_bf16 v[68:71], a[16:19], a[140:143], v[68:71]
ds_read_b128 a[140:143], v2 offset:6144
v_mfma_f32_16x16x32_bf16 v[68:71], a[8:11], a[136:139], v[68:71]
ds_read_b128 a[136:139], v2 offset:14336
v_mfma_f32_16x16x32_bf16 v[36:39], a[8:11], a[132:135], v[36:39]
ds_read_b128 a[132:135], v2 offset:15360
v_mfma_f32_16x16x32_bf16 v[36:39], a[16:19], a[128:131], v[36:39]
ds_read_b128 a[128:131], v2 offset:7168
s_waitcnt vmcnt(17) lgkmcnt(12)
v_mfma_f32_16x16x32_bf16 v[24:27], a[0:3], a[188:191], v[24:27]
global_load_dwordx4 a[228:231], v0, s[74:75] offset:-3072
v_mfma_f32_16x16x32_bf16 v[24:27], a[224:227], a[184:187], v[24:27]
v_mfma_f32_16x16x32_bf16 v[56:59], a[224:227], a[180:183], v[56:59]
v_mfma_f32_16x16x32_bf16 v[56:59], a[0:3], a[176:179], v[56:59]
s_waitcnt lgkmcnt(8)
v_mfma_f32_16x16x32_bf16 v[88:91], a[0:3], a[172:175], v[88:91]
global_load_dwordx4 a[8:11], v0, s[72:73] offset:-2048
v_mfma_f32_16x16x32_bf16 v[88:91], a[224:227], a[168:171], v[88:91]
v_mfma_f32_16x16x32_bf16 v[120:123], a[224:227], a[164:167], v[120:123]
v_mfma_f32_16x16x32_bf16 v[120:123], a[0:3], a[160:163], v[120:123]
s_waitcnt lgkmcnt(4)
v_mfma_f32_16x16x32_bf16 v[152:155], a[0:3], a[156:159], v[152:155]
global_load_dwordx4 a[16:19], v0, s[74:75] offset:-2048
v_mfma_f32_16x16x32_bf16 v[152:155], a[224:227], a[152:155], v[152:155]
v_mfma_f32_16x16x32_bf16 v[184:187], a[224:227], a[148:151], v[184:187]
v_mfma_f32_16x16x32_bf16 v[184:187], a[0:3], a[144:147], v[184:187]
s_waitcnt lgkmcnt(0)
v_mfma_f32_16x16x32_bf16 v[216:219], a[0:3], a[140:143], v[216:219]
s_barrier
v_mfma_f32_16x16x32_bf16 v[216:219], a[224:227], a[136:139], v[216:219]
s_add_u32 m0, s56, 131072
v_mfma_f32_16x16x32_bf16 v[248:251], a[224:227], a[132:135], v[248:251]
global_load_dwordx4 a[224:227], v0, s[72:73] offset:-1024
v_mfma_f32_16x16x32_bf16 v[248:251], a[0:3], a[128:131], v[248:251]
s_xor_b32 s10, s59, 512
s_add_u32 s10, s10, s8
s_addc_u32 s11, s9, 0
s_waitcnt vmcnt(19)
v_mfma_f32_16x16x32_bf16 v[252:255], a[44:47], a[128:131], v[252:255]
v_mfma_f32_16x16x32_bf16 v[252:255], a[20:23], a[132:135], v[252:255]
global_load_lds_dwordx4 v4, s[10:11]
v_mfma_f32_16x16x32_bf16 v[220:223], a[20:23], a[136:139], v[220:223]
global_load_dwordx4 a[0:3], v0, s[74:75] offset:-1024
v_mfma_f32_16x16x32_bf16 v[220:223], a[44:47], a[140:143], v[220:223]
v_mfma_f32_16x16x32_bf16 v[188:191], a[44:47], a[144:147], v[188:191]
v_mfma_f32_16x16x32_bf16 v[188:191], a[20:23], a[148:151], v[188:191]
v_mfma_f32_16x16x32_bf16 v[156:159], a[20:23], a[152:155], v[156:159]
global_load_lds_dwordx4 v5, s[10:11] offset:1024
v_mfma_f32_16x16x32_bf16 v[156:159], a[44:47], a[156:159], v[156:159]
v_mfma_f32_16x16x32_bf16 v[124:127], a[44:47], a[160:163], v[124:127]
v_mfma_f32_16x16x32_bf16 v[124:127], a[20:23], a[164:167], v[124:127]
s_add_u32 m0, s56, 139264
s_xor_b32 s10, s59, 576
s_add_u32 s10, s10, s8
s_addc_u32 s11, s9, 0
v_mfma_f32_16x16x32_bf16 v[92:95], a[20:23], a[168:171], v[92:95]
v_mfma_f32_16x16x32_bf16 v[92:95], a[44:47], a[172:175], v[92:95]
global_load_lds_dwordx4 v4, s[10:11]
v_mfma_f32_16x16x32_bf16 v[60:63], a[44:47], a[176:179], v[60:63]
v_mfma_f32_16x16x32_bf16 v[60:63], a[20:23], a[180:183], v[60:63]
v_mfma_f32_16x16x32_bf16 v[28:31], a[20:23], a[184:187], v[28:31]
v_mfma_f32_16x16x32_bf16 v[28:31], a[44:47], a[188:191], v[28:31]
s_waitcnt vmcnt(21)
v_mfma_f32_16x16x32_bf16 v[32:35], a[28:31], a[188:191], v[32:35]
global_load_lds_dwordx4 v5, s[10:11] offset:1024
v_mfma_f32_16x16x32_bf16 v[32:35], a[4:7], a[184:187], v[32:35]
v_mfma_f32_16x16x32_bf16 v[64:67], a[4:7], a[180:183], v[64:67]
s_add_u32 m0, s56, 81920
v_mfma_f32_16x16x32_bf16 v[64:67], a[28:31], a[176:179], v[64:67]
s_xor_b32 s10, s58, 640
s_add_u32 s10, s10, s8
s_addc_u32 s11, s9, 0
v_mfma_f32_16x16x32_bf16 v[96:99], a[28:31], a[172:175], v[96:99]
v_mfma_f32_16x16x32_bf16 v[96:99], a[4:7], a[168:171], v[96:99]
global_load_lds_dwordx4 v4, s[10:11]
L_pad3:
s_cbranch_execz L_pad7
v_mfma_f32_16x16x32_bf16 v[128:131], a[4:7], a[164:167], v[128:131]
v_mfma_f32_16x16x32_bf16 v[128:131], a[28:31], a[160:163], v[128:131]
v_mfma_f32_16x16x32_bf16 v[160:163], a[28:31], a[156:159], v[160:163]
global_load_lds_dwordx4 v5, s[10:11] offset:1024
v_mfma_f32_16x16x32_bf16 v[160:163], a[4:7], a[152:155], v[160:163]
v_mfma_f32_16x16x32_bf16 v[192:195], a[4:7], a[148:151], v[192:195]
v_mfma_f32_16x16x32_bf16 v[192:195], a[28:31], a[144:147], v[192:195]
s_add_u32 m0, s56, 90112
v_mfma_f32_16x16x32_bf16 v[224:227], a[28:31], a[140:143], v[224:227]
s_xor_b32 s10, s58, 704
s_add_u32 s10, s10, s8
s_addc_u32 s11, s9, 0
v_mfma_f32_16x16x32_bf16 v[224:227], a[4:7], a[136:139], v[224:227]
v_mfma_f32_16x16x32_bf16 a[232:235], a[4:7], a[132:135], a[232:235]
global_load_lds_dwordx4 v4, s[10:11]
v_mfma_f32_16x16x32_bf16 a[232:235], a[28:31], a[128:131], a[232:235]
s_waitcnt vmcnt(23)
v_mfma_f32_16x16x32_bf16 a[236:239], a[40:43], a[128:131], a[236:239]
v_mfma_f32_16x16x32_bf16 a[236:239], a[32:35], a[132:135], a[236:239]
global_load_lds_dwordx4 v5, s[10:11] offset:1024
v_mfma_f32_16x16x32_bf16 v[228:231], a[32:35], a[136:139], v[228:231]
v_mfma_f32_16x16x32_bf16 v[228:231], a[40:43], a[140:143], v[228:231]
v_mfma_f32_16x16x32_bf16 v[196:199], a[40:43], a[144:147], v[196:199]
v_mfma_f32_16x16x32_bf16 v[196:199], a[32:35], a[148:151], v[196:199]
v_mfma_f32_16x16x32_bf16 v[164:167], a[32:35], a[152:155], v[164:167]
v_mfma_f32_16x16x32_bf16 v[164:167], a[40:43], a[156:159], v[164:167]
v_mfma_f32_16x16x32_bf16 v[132:135], a[40:43], a[160:163], v[132:135]
v_mfma_f32_16x16x32_bf16 v[132:135], a[32:35], a[164:167], v[132:135]
v_mfma_f32_16x16x32_bf16 v[100:103], a[32:35], a[168:171], v[100:103]
v_mfma_f32_16x16x32_bf16 v[100:103], a[40:43], a[172:175], v[100:103]
v_mfma_f32_16x16x32_bf16 v[68:71], a[40:43], a[176:179], v[68:71]
v_lshlrev_b32 v3, 10, v0
v_mfma_f32_16x16x32_bf16 v[68:71], a[32:35], a[180:183], v[68:71]
v_mfma_f32_16x16x32_bf16 v[36:39], a[32:35], a[184:187], v[36:39]
buffer_load_dword v3, v3, s[40:43], s63 offen
v_mfma_f32_16x16x32_bf16 v[36:39], a[40:43], a[188:191], v[36:39]
s_waitcnt vmcnt(23)
v_mfma_f32_16x16x32_bf16 v[40:43], a[24:27], a[188:191], v[40:43]
v_mfma_f32_16x16x32_bf16 v[40:43], a[36:39], a[184:187], v[40:43]
v_mfma_f32_16x16x32_bf16 v[72:75], a[36:39], a[180:183], v[72:75]
v_mfma_f32_16x16x32_bf16 v[72:75], a[24:27], a[176:179], v[72:75]
v_mfma_f32_16x16x32_bf16 v[104:107], a[24:27], a[172:175], v[104:107]
v_mfma_f32_16x16x32_bf16 v[104:107], a[36:39], a[168:171], v[104:107]
v_mfma_f32_16x16x32_bf16 v[136:139], a[36:39], a[164:167], v[136:139]
v_mfma_f32_16x16x32_bf16 v[136:139], a[24:27], a[160:163], v[136:139]
v_mfma_f32_16x16x32_bf16 v[168:171], a[24:27], a[156:159], v[168:171]
v_mfma_f32_16x16x32_bf16 v[168:171], a[36:39], a[152:155], v[168:171]
v_mfma_f32_16x16x32_bf16 v[200:203], a[36:39], a[148:151], v[200:203]
v_mfma_f32_16x16x32_bf16 v[200:203], a[24:27], a[144:147], v[200:203]
v_mfma_f32_16x16x32_bf16 v[232:235], a[24:27], a[140:143], v[232:235]
v_mfma_f32_16x16x32_bf16 v[232:235], a[36:39], a[136:139], v[232:235]
v_mfma_f32_16x16x32_bf16 a[240:243], a[36:39], a[132:135], a[240:243]
v_mfma_f32_16x16x32_bf16 a[240:243], a[24:27], a[128:131], a[240:243]
s_waitcnt vmcnt(21)
v_mfma_f32_16x16x32_bf16 a[244:247], a[196:199], a[128:131], a[244:247]
v_mfma_f32_16x16x32_bf16 a[244:247], a[216:219], a[132:135], a[244:247]
v_mfma_f32_16x16x32_bf16 v[236:239], a[216:219], a[136:139], v[236:239]
v_mfma_f32_16x16x32_bf16 v[236:239], a[196:199], a[140:143], v[236:239]
v_mfma_f32_16x16x32_bf16 v[204:207], a[196:199], a[144:147], v[204:207]
v_mfma_f32_16x16x32_bf16 v[204:207], a[216:219], a[148:151], v[204:207]
v_mfma_f32_16x16x32_bf16 v[172:175], a[216:219], a[152:155], v[172:175]
v_mfma_f32_16x16x32_bf16 v[172:175], a[196:199], a[156:159], v[172:175]
v_mfma_f32_16x16x32_bf16 v[140:143], a[196:199], a[160:163], v[140:143]
v_mfma_f32_16x16x32_bf16 v[140:143], a[216:219], a[164:167], v[140:143]
v_mfma_f32_16x16x32_bf16 v[108:111], a[216:219], a[168:171], v[108:111]
v_mfma_f32_16x16x32_bf16 v[108:111], a[196:199], a[172:175], v[108:111]
v_mfma_f32_16x16x32_bf16 v[76:79], a[196:199], a[176:179], v[76:79]
v_mfma_f32_16x16x32_bf16 v[76:79], a[216:219], a[180:183], v[76:79]
v_mfma_f32_16x16x32_bf16 v[44:47], a[216:219], a[184:187], v[44:47]
v_mfma_f32_16x16x32_bf16 v[44:47], a[196:199], a[188:191], v[44:47]
s_waitcnt vmcnt(19)
v_mfma_f32_16x16x32_bf16 v[48:51], a[212:215], a[188:191], v[48:51]
v_mfma_f32_16x16x32_bf16 v[48:51], a[208:211], a[184:187], v[48:51]
v_mfma_f32_16x16x32_bf16 v[80:83], a[208:211], a[180:183], v[80:83]
v_mfma_f32_16x16x32_bf16 v[80:83], a[212:215], a[176:179], v[80:83]
v_mfma_f32_16x16x32_bf16 v[112:115], a[212:215], a[172:175], v[112:115]
v_mfma_f32_16x16x32_bf16 v[112:115], a[208:211], a[168:171], v[112:115]
v_mfma_f32_16x16x32_bf16 v[144:147], a[208:211], a[164:167], v[144:147]
v_mfma_f32_16x16x32_bf16 v[144:147], a[212:215], a[160:163], v[144:147]
global_load_dwordx4 a[20:23], v0, s[72:73] offset:0
v_mfma_f32_16x16x32_bf16 v[176:179], a[212:215], a[156:159], v[176:179]
v_mfma_f32_16x16x32_bf16 v[176:179], a[208:211], a[152:155], v[176:179]
v_mfma_f32_16x16x32_bf16 v[208:211], a[208:211], a[148:151], v[208:211]
v_mfma_f32_16x16x32_bf16 v[208:211], a[212:215], a[144:147], v[208:211]
global_load_dwordx4 a[44:47], v0, s[74:75] offset:0
v_mfma_f32_16x16x32_bf16 v[240:243], a[212:215], a[140:143], v[240:243]
v_mfma_f32_16x16x32_bf16 v[240:243], a[208:211], a[136:139], v[240:243]
v_mfma_f32_16x16x32_bf16 a[248:251], a[208:211], a[132:135], a[248:251]
global_load_dwordx4 a[4:7], v0, s[72:73] offset:1024
v_mfma_f32_16x16x32_bf16 a[248:251], a[212:215], a[128:131], a[248:251]
v_add_u32 v2, 65536, v1
s_waitcnt vmcnt(20)
v_mfma_f32_16x16x32_bf16 a[252:255], a[192:195], a[128:131], a[252:255]
ds_read_b128 a[128:131], v2 offset:0
v_mfma_f32_16x16x32_bf16 a[252:255], a[200:203], a[132:135], a[252:255]
ds_read_b128 a[132:135], v2 offset:8192
v_mfma_f32_16x16x32_bf16 v[244:247], a[200:203], a[136:139], v[244:247]
ds_read_b128 a[136:139], v2 offset:9216
v_mfma_f32_16x16x32_bf16 v[244:247], a[192:195], a[140:143], v[244:247]
ds_read_b128 a[140:143], v2 offset:1024
v_mfma_f32_16x16x32_bf16 v[212:215], a[192:195], a[144:147], v[212:215]
ds_read_b128 a[144:147], v2 offset:2048
v_mfma_f32_16x16x32_bf16 v[212:215], a[200:203], a[148:151], v[212:215]
ds_read_b128 a[148:151], v2 offset:10240
v_mfma_f32_16x16x32_bf16 v[180:183], a[200:203], a[152:155], v[180:183]
ds_read_b128 a[152:155], v2 offset:11264
v_mfma_f32_16x16x32_bf16 v[180:183], a[192:195], a[156:159], v[180:183]
ds_read_b128 a[156:159], v2 offset:3072
v_mfma_f32_16x16x32_bf16 v[148:151], a[192:195], a[160:163], v[148:151]
ds_read_b128 a[160:163], v2 offset:4096
v_mfma_f32_16x16x32_bf16 v[148:151], a[200:203], a[164:167], v[148:151]
ds_read_b128 a[164:167], v2 offset:12288
v_mfma_f32_16x16x32_bf16 v[116:119], a[200:203], a[168:171], v[116:119]
ds_read_b128 a[168:171], v2 offset:13312
v_mfma_f32_16x16x32_bf16 v[116:119], a[192:195], a[172:175], v[116:119]
ds_read_b128 a[172:175], v2 offset:5120
v_mfma_f32_16x16x32_bf16 v[84:87], a[192:195], a[176:179], v[84:87]
ds_read_b128 a[176:179], v2 offset:6144
v_mfma_f32_16x16x32_bf16 v[84:87], a[200:203], a[180:183], v[84:87]
ds_read_b128 a[180:183], v2 offset:14336
v_mfma_f32_16x16x32_bf16 v[52:55], a[200:203], a[184:187], v[52:55]
ds_read_b128 a[184:187], v2 offset:15360
v_mfma_f32_16x16x32_bf16 v[52:55], a[192:195], a[188:191], v[52:55]
ds_read_b128 a[188:191], v2 offset:7168
s_waitcnt vmcnt(18) lgkmcnt(12)
v_mfma_f32_16x16x32_bf16 v[24:27], a[220:223], a[128:131], v[24:27]
global_load_dwordx4 a[28:31], v0, s[74:75] offset:1024
v_mfma_f32_16x16x32_bf16 v[24:27], a[12:15], a[132:135], v[24:27]
v_mfma_f32_16x16x32_bf16 v[56:59], a[12:15], a[136:139], v[56:59]
v_mfma_f32_16x16x32_bf16 v[56:59], a[220:223], a[140:143], v[56:59]
s_waitcnt lgkmcnt(8)
v_mfma_f32_16x16x32_bf16 v[88:91], a[220:223], a[144:147], v[88:91]
global_load_dwordx4 a[32:35], v0, s[72:73] offset:2048
v_mfma_f32_16x16x32_bf16 v[88:91], a[12:15], a[148:151], v[88:91]
v_mfma_f32_16x16x32_bf16 v[120:123], a[12:15], a[152:155], v[120:123]
v_mfma_f32_16x16x32_bf16 v[120:123], a[220:223], a[156:159], v[120:123]
s_waitcnt lgkmcnt(4)
v_mfma_f32_16x16x32_bf16 v[152:155], a[220:223], a[160:163], v[152:155]
global_load_dwordx4 a[40:43], v0, s[74:75] offset:2048
v_mfma_f32_16x16x32_bf16 v[152:155], a[12:15], a[164:167], v[152:155]
v_mfma_f32_16x16x32_bf16 v[184:187], a[12:15], a[168:171], v[184:187]
v_mfma_f32_16x16x32_bf16 v[184:187], a[220:223], a[172:175], v[184:187]
s_waitcnt vmcnt(11) lgkmcnt(0)
v_mfma_f32_16x16x32_bf16 v[216:219], a[220:223], a[176:179], v[216:219]
s_barrier
v_mfma_f32_16x16x32_bf16 v[216:219], a[12:15], a[180:183], v[216:219]
global_load_dwordx4 a[36:39], v0, s[72:73] offset:3072
v_mfma_f32_16x16x32_bf16 v[248:251], a[12:15], a[184:187], v[248:251]
s_xor_b32 s72, s64, 200704
s_add_u32 s72, s72, s12
s_addc_u32 s73, s13, 0
v_mfma_f32_16x16x32_bf16 v[248:251], a[220:223], a[188:191], v[248:251]
v_mfma_f32_16x16x32_bf16 v[252:255], a[204:207], a[188:191], v[252:255]
v_mfma_f32_16x16x32_bf16 v[252:255], a[228:231], a[184:187], v[252:255]
global_load_dwordx4 a[24:27], v0, s[74:75] offset:3072
v_mfma_f32_16x16x32_bf16 v[220:223], a[228:231], a[180:183], v[220:223]
s_xor_b32 s74, s64, 208896
s_add_u32 s74, s74, s12
s_addc_u32 s75, s13, 0
v_mfma_f32_16x16x32_bf16 v[220:223], a[204:207], a[176:179], v[220:223]
v_mfma_f32_16x16x32_bf16 v[188:191], a[204:207], a[172:175], v[188:191]
v_mfma_f32_16x16x32_bf16 v[188:191], a[228:231], a[168:171], v[188:191]
global_load_dwordx4 a[216:219], v0, s[72:73] offset:-4096
v_mfma_f32_16x16x32_bf16 v[156:159], a[228:231], a[164:167], v[156:159]
v_mfma_f32_16x16x32_bf16 v[156:159], a[204:207], a[160:163], v[156:159]
v_mfma_f32_16x16x32_bf16 v[124:127], a[204:207], a[156:159], v[124:127]
v_mfma_f32_16x16x32_bf16 v[124:127], a[228:231], a[152:155], v[124:127]
global_load_dwordx4 a[196:199], v0, s[74:75] offset:-4096
v_mfma_f32_16x16x32_bf16 v[92:95], a[228:231], a[148:151], v[92:95]
v_mfma_f32_16x16x32_bf16 v[92:95], a[204:207], a[144:147], v[92:95]
v_mfma_f32_16x16x32_bf16 v[60:63], a[204:207], a[140:143], v[60:63]
v_mfma_f32_16x16x32_bf16 v[60:63], a[228:231], a[136:139], v[60:63]
global_load_dwordx4 a[208:211], v0, s[72:73] offset:-3072
v_mfma_f32_16x16x32_bf16 v[28:31], a[228:231], a[132:135], v[28:31]
v_mfma_f32_16x16x32_bf16 v[28:31], a[204:207], a[128:131], v[28:31]
v_mfma_f32_16x16x32_bf16 v[32:35], a[8:11], a[128:131], v[32:35]
v_mfma_f32_16x16x32_bf16 v[32:35], a[16:19], a[132:135], v[32:35]
global_load_dwordx4 a[212:215], v0, s[74:75] offset:-3072
v_mfma_f32_16x16x32_bf16 v[64:67], a[16:19], a[136:139], v[64:67]
v_mfma_f32_16x16x32_bf16 v[64:67], a[8:11], a[140:143], v[64:67]
v_mfma_f32_16x16x32_bf16 v[96:99], a[8:11], a[144:147], v[96:99]
v_mfma_f32_16x16x32_bf16 v[96:99], a[16:19], a[148:151], v[96:99]
global_load_dwordx4 a[200:203], v0, s[72:73] offset:-2048
v_mfma_f32_16x16x32_bf16 v[128:131], a[16:19], a[152:155], v[128:131]
v_mfma_f32_16x16x32_bf16 v[128:131], a[8:11], a[156:159], v[128:131]
v_mfma_f32_16x16x32_bf16 v[160:163], a[8:11], a[160:163], v[160:163]
v_mfma_f32_16x16x32_bf16 v[160:163], a[16:19], a[164:167], v[160:163]
global_load_dwordx4 a[192:195], v0, s[74:75] offset:-2048
v_mfma_f32_16x16x32_bf16 v[192:195], a[16:19], a[168:171], v[192:195]
v_mfma_f32_16x16x32_bf16 v[192:195], a[8:11], a[172:175], v[192:195]
v_mfma_f32_16x16x32_bf16 v[224:227], a[8:11], a[176:179], v[224:227]
v_mfma_f32_16x16x32_bf16 v[224:227], a[16:19], a[180:183], v[224:227]
global_load_dwordx4 a[12:15], v0, s[72:73] offset:-1024
v_mfma_f32_16x16x32_bf16 a[232:235], a[16:19], a[184:187], a[232:235]
v_mfma_f32_16x16x32_bf16 a[232:235], a[8:11], a[188:191], a[232:235]
v_mfma_f32_16x16x32_bf16 a[236:239], a[224:227], a[188:191], a[236:239]
v_mfma_f32_16x16x32_bf16 a[236:239], a[0:3], a[184:187], a[236:239]
global_load_dwordx4 a[220:223], v0, s[74:75] offset:-1024
v_mfma_f32_16x16x32_bf16 v[228:231], a[0:3], a[180:183], v[228:231]
v_mfma_f32_16x16x32_bf16 v[228:231], a[224:227], a[176:179], v[228:231]
v_mfma_f32_16x16x32_bf16 v[196:199], a[224:227], a[172:175], v[196:199]
v_mfma_f32_16x16x32_bf16 v[196:199], a[0:3], a[168:171], v[196:199]
global_load_dwordx4 a[228:231], v0, s[72:73] offset:0
v_mfma_f32_16x16x32_bf16 v[164:167], a[0:3], a[164:167], v[164:167]
v_mfma_f32_16x16x32_bf16 v[164:167], a[224:227], a[160:163], v[164:167]
v_mfma_f32_16x16x32_bf16 v[132:135], a[224:227], a[156:159], v[132:135]
v_mfma_f32_16x16x32_bf16 v[132:135], a[0:3], a[152:155], v[132:135]
global_load_dwordx4 a[204:207], v0, s[74:75] offset:0
v_mfma_f32_16x16x32_bf16 v[100:103], a[0:3], a[148:151], v[100:103]
v_mfma_f32_16x16x32_bf16 v[100:103], a[224:227], a[144:147], v[100:103]
v_mfma_f32_16x16x32_bf16 v[68:71], a[224:227], a[140:143], v[68:71]
v_mfma_f32_16x16x32_bf16 v[68:71], a[0:3], a[136:139], v[68:71]
global_load_dwordx4 a[16:19], v0, s[72:73] offset:1024
v_mfma_f32_16x16x32_bf16 v[36:39], a[0:3], a[132:135], v[36:39]
v_mfma_f32_16x16x32_bf16 v[36:39], a[224:227], a[128:131], v[36:39]
s_waitcnt vmcnt(17)
v_mfma_f32_16x16x32_bf16 v[40:43], a[20:23], a[128:131], v[40:43]
v_mfma_f32_16x16x32_bf16 v[40:43], a[44:47], a[132:135], v[40:43]
global_load_dwordx4 a[8:11], v0, s[74:75] offset:1024
v_mfma_f32_16x16x32_bf16 v[72:75], a[44:47], a[136:139], v[72:75]
v_mfma_f32_16x16x32_bf16 v[72:75], a[20:23], a[140:143], v[72:75]
v_mfma_f32_16x16x32_bf16 v[104:107], a[20:23], a[144:147], v[104:107]
v_mfma_f32_16x16x32_bf16 v[104:107], a[44:47], a[148:151], v[104:107]
global_load_dwordx4 a[0:3], v0, s[72:73] offset:2048
v_mfma_f32_16x16x32_bf16 v[136:139], a[44:47], a[152:155], v[136:139]
v_mfma_f32_16x16x32_bf16 v[136:139], a[20:23], a[156:159], v[136:139]
v_mfma_f32_16x16x32_bf16 v[168:171], a[20:23], a[160:163], v[168:171]
v_mfma_f32_16x16x32_bf16 v[168:171], a[44:47], a[164:167], v[168:171]
global_load_dwordx4 a[224:227], v0, s[74:75] offset:2048
v_mfma_f32_16x16x32_bf16 v[200:203], a[44:47], a[168:171], v[200:203]
v_mfma_f32_16x16x32_bf16 v[200:203], a[20:23], a[172:175], v[200:203]
v_mfma_f32_16x16x32_bf16 v[232:235], a[20:23], a[176:179], v[232:235]
v_mfma_f32_16x16x32_bf16 v[232:235], a[44:47], a[180:183], v[232:235]
v_mfma_f32_16x16x32_bf16 a[240:243], a[44:47], a[184:187], a[240:243]
global_load_dwordx4 a[44:47], v0, s[72:73] offset:3072
v_mfma_f32_16x16x32_bf16 a[240:243], a[20:23], a[188:191], a[240:243]
s_waitcnt vmcnt(19)
v_mfma_f32_16x16x32_bf16 a[244:247], a[4:7], a[188:191], a[244:247]
v_mfma_f32_16x16x32_bf16 a[244:247], a[28:31], a[184:187], a[244:247]
v_mfma_f32_16x16x32_bf16 v[236:239], a[28:31], a[180:183], v[236:239]
global_load_dwordx4 a[20:23], v0, s[74:75] offset:3072
v_mfma_f32_16x16x32_bf16 v[236:239], a[4:7], a[176:179], v[236:239]
s_xor_b32 s72, s64, 86016
s_add_u32 s72, s72, s12
s_addc_u32 s73, s13, 0
v_mfma_f32_16x16x32_bf16 v[204:207], a[4:7], a[172:175], v[204:207]
v_mfma_f32_16x16x32_bf16 v[204:207], a[28:31], a[168:171], v[204:207]
v_mfma_f32_16x16x32_bf16 v[172:175], a[28:31], a[164:167], v[172:175]
s_xor_b32 s74, s64, 94208
s_add_u32 s74, s74, s12
s_addc_u32 s75, s13, 0
v_mfma_f32_16x16x32_bf16 v[172:175], a[4:7], a[160:163], v[172:175]
v_mfma_f32_16x16x32_bf16 v[140:143], a[4:7], a[156:159], v[140:143]
v_mfma_f32_16x16x32_bf16 v[140:143], a[28:31], a[152:155], v[140:143]
v_mfma_f32_16x16x32_bf16 v[108:111], a[28:31], a[148:151], v[108:111]
v_mfma_f32_16x16x32_bf16 v[108:111], a[4:7], a[144:147], v[108:111]
v_mfma_f32_16x16x32_bf16 v[76:79], a[4:7], a[140:143], v[76:79]
v_mfma_f32_16x16x32_bf16 v[76:79], a[28:31], a[136:139], v[76:79]
v_mfma_f32_16x16x32_bf16 v[44:47], a[28:31], a[132:135], v[44:47]
global_load_dwordx4 a[28:31], v0, s[72:73] offset:-4096
v_mfma_f32_16x16x32_bf16 v[44:47], a[4:7], a[128:131], v[44:47]
s_waitcnt vmcnt(19)
v_mfma_f32_16x16x32_bf16 v[48:51], a[32:35], a[128:131], v[48:51]
v_mfma_f32_16x16x32_bf16 v[48:51], a[40:43], a[132:135], v[48:51]
v_mfma_f32_16x16x32_bf16 v[80:83], a[40:43], a[136:139], v[80:83]
global_load_dwordx4 a[4:7], v0, s[74:75] offset:-4096
v_mfma_f32_16x16x32_bf16 v[80:83], a[32:35], a[140:143], v[80:83]
v_mfma_f32_16x16x32_bf16 v[112:115], a[32:35], a[144:147], v[112:115]
v_mfma_f32_16x16x32_bf16 v[112:115], a[40:43], a[148:151], v[112:115]
v_mfma_f32_16x16x32_bf16 v[144:147], a[40:43], a[152:155], v[144:147]
v_mfma_f32_16x16x32_bf16 v[144:147], a[32:35], a[156:159], v[144:147]
v_mfma_f32_16x16x32_bf16 v[176:179], a[32:35], a[160:163], v[176:179]
v_mfma_f32_16x16x32_bf16 v[176:179], a[40:43], a[164:167], v[176:179]
v_mfma_f32_16x16x32_bf16 v[208:211], a[40:43], a[168:171], v[208:211]
v_mfma_f32_16x16x32_bf16 v[208:211], a[32:35], a[172:175], v[208:211]
v_mfma_f32_16x16x32_bf16 v[240:243], a[32:35], a[176:179], v[240:243]
v_mfma_f32_16x16x32_bf16 v[240:243], a[40:43], a[180:183], v[240:243]
v_mfma_f32_16x16x32_bf16 a[248:251], a[40:43], a[184:187], a[248:251]
global_load_dwordx4 a[40:43], v0, s[72:73] offset:-3072
v_mfma_f32_16x16x32_bf16 a[248:251], a[32:35], a[188:191], a[248:251]
v_add_u32 v2, 131072, v1
s_waitcnt vmcnt(19)
v_mfma_f32_16x16x32_bf16 a[252:255], a[36:39], a[188:191], a[252:255]
ds_read_b128 a[188:191], v2 offset:0
v_mfma_f32_16x16x32_bf16 a[252:255], a[24:27], a[184:187], a[252:255]
ds_read_b128 a[184:187], v2 offset:8192
v_mfma_f32_16x16x32_bf16 v[244:247], a[24:27], a[180:183], v[244:247]
ds_read_b128 a[180:183], v2 offset:9216
v_mfma_f32_16x16x32_bf16 v[244:247], a[36:39], a[176:179], v[244:247]
ds_read_b128 a[176:179], v2 offset:1024
v_mfma_f32_16x16x32_bf16 v[212:215], a[36:39], a[172:175], v[212:215]
ds_read_b128 a[172:175], v2 offset:2048
v_mfma_f32_16x16x32_bf16 v[212:215], a[24:27], a[168:171], v[212:215]
ds_read_b128 a[168:171], v2 offset:10240
v_mfma_f32_16x16x32_bf16 v[180:183], a[24:27], a[164:167], v[180:183]
ds_read_b128 a[164:167], v2 offset:11264
v_mfma_f32_16x16x32_bf16 v[180:183], a[36:39], a[160:163], v[180:183]
ds_read_b128 a[160:163], v2 offset:3072
v_mfma_f32_16x16x32_bf16 v[148:151], a[36:39], a[156:159], v[148:151]
ds_read_b128 a[156:159], v2 offset:4096
v_mfma_f32_16x16x32_bf16 v[148:151], a[24:27], a[152:155], v[148:151]
ds_read_b128 a[152:155], v2 offset:12288
v_mfma_f32_16x16x32_bf16 v[116:119], a[24:27], a[148:151], v[116:119]
ds_read_b128 a[148:151], v2 offset:13312
v_mfma_f32_16x16x32_bf16 v[116:119], a[36:39], a[144:147], v[116:119]
ds_read_b128 a[144:147], v2 offset:5120
v_mfma_f32_16x16x32_bf16 v[84:87], a[36:39], a[140:143], v[84:87]
ds_read_b128 a[140:143], v2 offset:6144
v_mfma_f32_16x16x32_bf16 v[84:87], a[24:27], a[136:139], v[84:87]
ds_read_b128 a[136:139], v2 offset:14336
v_mfma_f32_16x16x32_bf16 v[52:55], a[24:27], a[132:135], v[52:55]
ds_read_b128 a[132:135], v2 offset:15360
v_mfma_f32_16x16x32_bf16 v[52:55], a[36:39], a[128:131], v[52:55]
ds_read_b128 a[128:131], v2 offset:7168
s_waitcnt vmcnt(17) lgkmcnt(12)
v_mfma_f32_16x16x32_bf16 v[24:27], a[216:219], a[188:191], v[24:27]
global_load_dwordx4 a[32:35], v0, s[74:75] offset:-3072
v_mfma_f32_16x16x32_bf16 v[24:27], a[196:199], a[184:187], v[24:27]
v_mfma_f32_16x16x32_bf16 v[56:59], a[196:199], a[180:183], v[56:59]
v_mfma_f32_16x16x32_bf16 v[56:59], a[216:219], a[176:179], v[56:59]
s_waitcnt lgkmcnt(8)
v_mfma_f32_16x16x32_bf16 v[88:91], a[216:219], a[172:175], v[88:91]
global_load_dwordx4 a[24:27], v0, s[72:73] offset:-2048
v_mfma_f32_16x16x32_bf16 v[88:91], a[196:199], a[168:171], v[88:91]
v_mfma_f32_16x16x32_bf16 v[120:123], a[196:199], a[164:167], v[120:123]
v_mfma_f32_16x16x32_bf16 v[120:123], a[216:219], a[160:163], v[120:123]
s_waitcnt lgkmcnt(4)
v_mfma_f32_16x16x32_bf16 v[152:155], a[216:219], a[156:159], v[152:155]
global_load_dwordx4 a[36:39], v0, s[74:75] offset:-2048
v_mfma_f32_16x16x32_bf16 v[152:155], a[196:199], a[152:155], v[152:155]
v_mfma_f32_16x16x32_bf16 v[184:187], a[196:199], a[148:151], v[184:187]
v_mfma_f32_16x16x32_bf16 v[184:187], a[216:219], a[144:147], v[184:187]
s_waitcnt lgkmcnt(0)
v_mfma_f32_16x16x32_bf16 v[216:219], a[216:219], a[140:143], v[216:219]
s_barrier
v_mfma_f32_16x16x32_bf16 v[216:219], a[196:199], a[136:139], v[216:219]
s_add_u32 m0, s56, 131072
v_mfma_f32_16x16x32_bf16 v[248:251], a[196:199], a[132:135], v[248:251]
global_load_dwordx4 a[196:199], v0, s[72:73] offset:-1024
v_mfma_f32_16x16x32_bf16 v[248:251], a[216:219], a[128:131], v[248:251]
s_xor_b32 s10, s59, 640
s_add_u32 s10, s10, s8
s_addc_u32 s11, s9, 0
s_waitcnt vmcnt(19)
v_mfma_f32_16x16x32_bf16 v[252:255], a[208:211], a[128:131], v[252:255]
v_mfma_f32_16x16x32_bf16 v[252:255], a[212:215], a[132:135], v[252:255]
global_load_lds_dwordx4 v4, s[10:11]
v_mfma_f32_16x16x32_bf16 v[220:223], a[212:215], a[136:139], v[220:223]
global_load_dwordx4 a[216:219], v0, s[74:75] offset:-1024
v_mfma_f32_16x16x32_bf16 v[220:223], a[208:211], a[140:143], v[220:223]
v_mfma_f32_16x16x32_bf16 v[188:191], a[208:211], a[144:147], v[188:191]
v_mfma_f32_16x16x32_bf16 v[188:191], a[212:215], a[148:151], v[188:191]
v_mfma_f32_16x16x32_bf16 v[156:159], a[212:215], a[152:155], v[156:159]
global_load_lds_dwordx4 v5, s[10:11] offset:1024
v_mfma_f32_16x16x32_bf16 v[156:159], a[208:211], a[156:159], v[156:159]
v_mfma_f32_16x16x32_bf16 v[124:127], a[208:211], a[160:163], v[124:127]
v_mfma_f32_16x16x32_bf16 v[124:127], a[212:215], a[164:167], v[124:127]
s_add_u32 m0, s56, 139264
v_mfma_f32_16x16x32_bf16 v[92:95], a[212:215], a[168:171], v[92:95]
s_xor_b32 s10, s59, 704
s_add_u32 s10, s10, s8
s_addc_u32 s11, s9, 0
v_mfma_f32_16x16x32_bf16 v[92:95], a[208:211], a[172:175], v[92:95]
v_mfma_f32_16x16x32_bf16 v[60:63], a[208:211], a[176:179], v[60:63]
global_load_lds_dwordx4 v4, s[10:11]
v_mfma_f32_16x16x32_bf16 v[60:63], a[212:215], a[180:183], v[60:63]
v_mfma_f32_16x16x32_bf16 v[28:31], a[212:215], a[184:187], v[28:31]
v_mfma_f32_16x16x32_bf16 v[28:31], a[208:211], a[188:191], v[28:31]
s_waitcnt vmcnt(21)
v_mfma_f32_16x16x32_bf16 v[32:35], a[200:203], a[188:191], v[32:35]
global_load_lds_dwordx4 v5, s[10:11] offset:1024
v_mfma_f32_16x16x32_bf16 v[32:35], a[192:195], a[184:187], v[32:35]
v_mfma_f32_16x16x32_bf16 v[64:67], a[192:195], a[180:183], v[64:67]
s_add_u32 m0, s56, 98304
v_mfma_f32_16x16x32_bf16 v[64:67], a[200:203], a[176:179], v[64:67]
s_xor_b32 s10, s58, 768
s_add_u32 s10, s10, s8
s_addc_u32 s11, s9, 0
v_mfma_f32_16x16x32_bf16 v[96:99], a[200:203], a[172:175], v[96:99]
v_mfma_f32_16x16x32_bf16 v[96:99], a[192:195], a[168:171], v[96:99]
global_load_lds_dwordx4 v4, s[10:11]
v_mfma_f32_16x16x32_bf16 v[128:131], a[192:195], a[164:167], v[128:131]
v_mfma_f32_16x16x32_bf16 v[128:131], a[200:203], a[160:163], v[128:131]
v_mfma_f32_16x16x32_bf16 v[160:163], a[200:203], a[156:159], v[160:163]
global_load_lds_dwordx4 v5, s[10:11] offset:1024
v_mfma_f32_16x16x32_bf16 v[160:163], a[192:195], a[152:155], v[160:163]
v_mfma_f32_16x16x32_bf16 v[192:195], a[192:195], a[148:151], v[192:195]
v_mfma_f32_16x16x32_bf16 v[192:195], a[200:203], a[144:147], v[192:195]
s_add_u32 m0, s56, 106496
v_mfma_f32_16x16x32_bf16 v[224:227], a[200:203], a[140:143], v[224:227]
s_xor_b32 s10, s58, 832
s_add_u32 s10, s10, s8
s_addc_u32 s11, s9, 0
v_mfma_f32_16x16x32_bf16 v[224:227], a[192:195], a[136:139], v[224:227]
v_mfma_f32_16x16x32_bf16 a[232:235], a[192:195], a[132:135], a[232:235]
global_load_lds_dwordx4 v4, s[10:11]
v_mfma_f32_16x16x32_bf16 a[232:235], a[200:203], a[128:131], a[232:235]
s_waitcnt vmcnt(23)
v_mfma_f32_16x16x32_bf16 a[236:239], a[12:15], a[128:131], a[236:239]
v_mfma_f32_16x16x32_bf16 a[236:239], a[220:223], a[132:135], a[236:239]
v_mfma_f32_16x16x32_bf16 v[228:231], a[220:223], a[136:139], v[228:231]
global_load_lds_dwordx4 v5, s[10:11] offset:1024
v_mfma_f32_16x16x32_bf16 v[228:231], a[12:15], a[140:143], v[228:231]
v_mfma_f32_16x16x32_bf16 v[196:199], a[12:15], a[144:147], v[196:199]
v_mfma_f32_16x16x32_bf16 v[196:199], a[220:223], a[148:151], v[196:199]
s_add_u32 m0, s60, 147456
v_mfma_f32_16x16x32_bf16 v[164:167], a[220:223], a[152:155], v[164:167]
v_add_u32 v21, 81920, v21
v_mfma_f32_16x16x32_bf16 v[164:167], a[12:15], a[156:159], v[164:167]
v_add_u32 v22, 81920, v22
v_mfma_f32_16x16x32_bf16 v[132:135], a[12:15], a[160:163], v[132:135]
buffer_load_dwordx4 v20, s[4:7], s78 offen offset:0 lds
v_mfma_f32_16x16x32_bf16 v[132:135], a[220:223], a[164:167], v[132:135]
v_mfma_f32_16x16x32_bf16 v[100:103], a[220:223], a[168:171], v[100:103]
v_mfma_f32_16x16x32_bf16 v[100:103], a[12:15], a[172:175], v[100:103]
buffer_load_dwordx4 v23, s[4:7], s78 offen offset:1024 lds
v_mfma_f32_16x16x32_bf16 v[68:71], a[12:15], a[176:179], v[68:71]
v_mfma_f32_16x16x32_bf16 v[68:71], a[220:223], a[180:183], v[68:71]
v_mfma_f32_16x16x32_bf16 v[36:39], a[220:223], a[184:187], v[36:39]
v_mfma_f32_16x16x32_bf16 v[36:39], a[12:15], a[188:191], v[36:39]
s_waitcnt vmcnt(24)
v_mfma_f32_16x16x32_bf16 v[40:43], a[228:231], a[188:191], v[40:43]
buffer_load_dwordx4 v18, s[4:7], s78 offen offset:2048 lds
v_mfma_f32_16x16x32_bf16 v[40:43], a[204:207], a[184:187], v[40:43]
v_mfma_f32_16x16x32_bf16 v[72:75], a[204:207], a[180:183], v[72:75]
buffer_load_dwordx4 v19, s[4:7], s78 offen offset:3072 lds
v_mfma_f32_16x16x32_bf16 v[72:75], a[228:231], a[176:179], v[72:75]
v_mfma_f32_16x16x32_bf16 v[104:107], a[228:231], a[172:175], v[104:107]
v_mfma_f32_16x16x32_bf16 v[104:107], a[204:207], a[168:171], v[104:107]
v_mfma_f32_16x16x32_bf16 v[136:139], a[204:207], a[164:167], v[136:139]
v_mfma_f32_16x16x32_bf16 v[136:139], a[228:231], a[160:163], v[136:139]
v_mfma_f32_16x16x32_bf16 v[168:171], a[228:231], a[156:159], v[168:171]
v_mfma_f32_16x16x32_bf16 v[168:171], a[204:207], a[152:155], v[168:171]
v_mfma_f32_16x16x32_bf16 v[200:203], a[204:207], a[148:151], v[200:203]
v_mfma_f32_16x16x32_bf16 v[200:203], a[228:231], a[144:147], v[200:203]
v_mfma_f32_16x16x32_bf16 v[232:235], a[228:231], a[140:143], v[232:235]
v_mfma_f32_16x16x32_bf16 v[232:235], a[204:207], a[136:139], v[232:235]
v_mfma_f32_16x16x32_bf16 a[240:243], a[204:207], a[132:135], a[240:243]
v_mfma_f32_16x16x32_bf16 a[240:243], a[228:231], a[128:131], a[240:243]
s_waitcnt vmcnt(24)
v_mfma_f32_16x16x32_bf16 a[244:247], a[16:19], a[128:131], a[244:247]
v_mfma_f32_16x16x32_bf16 a[244:247], a[8:11], a[132:135], a[244:247]
v_mfma_f32_16x16x32_bf16 v[236:239], a[8:11], a[136:139], v[236:239]
v_mfma_f32_16x16x32_bf16 v[236:239], a[16:19], a[140:143], v[236:239]
v_mfma_f32_16x16x32_bf16 v[204:207], a[16:19], a[144:147], v[204:207]
v_mfma_f32_16x16x32_bf16 v[204:207], a[8:11], a[148:151], v[204:207]
v_mfma_f32_16x16x32_bf16 v[172:175], a[8:11], a[152:155], v[172:175]
v_mfma_f32_16x16x32_bf16 v[172:175], a[16:19], a[156:159], v[172:175]
v_mfma_f32_16x16x32_bf16 v[140:143], a[16:19], a[160:163], v[140:143]
v_mfma_f32_16x16x32_bf16 v[140:143], a[8:11], a[164:167], v[140:143]
v_mfma_f32_16x16x32_bf16 v[108:111], a[8:11], a[168:171], v[108:111]
v_mfma_f32_16x16x32_bf16 v[108:111], a[16:19], a[172:175], v[108:111]
v_mfma_f32_16x16x32_bf16 v[76:79], a[16:19], a[176:179], v[76:79]
v_mfma_f32_16x16x32_bf16 v[76:79], a[8:11], a[180:183], v[76:79]
v_mfma_f32_16x16x32_bf16 v[44:47], a[8:11], a[184:187], v[44:47]
v_mfma_f32_16x16x32_bf16 v[44:47], a[16:19], a[188:191], v[44:47]
s_waitcnt vmcnt(22)
v_mfma_f32_16x16x32_bf16 v[48:51], a[0:3], a[188:191], v[48:51]
v_mfma_f32_16x16x32_bf16 v[48:51], a[224:227], a[184:187], v[48:51]
v_mfma_f32_16x16x32_bf16 v[80:83], a[224:227], a[180:183], v[80:83]
v_mfma_f32_16x16x32_bf16 v[80:83], a[0:3], a[176:179], v[80:83]
v_mfma_f32_16x16x32_bf16 v[112:115], a[0:3], a[172:175], v[112:115]
v_mfma_f32_16x16x32_bf16 v[112:115], a[224:227], a[168:171], v[112:115]
v_mfma_f32_16x16x32_bf16 v[144:147], a[224:227], a[164:167], v[144:147]
v_mfma_f32_16x16x32_bf16 v[144:147], a[0:3], a[160:163], v[144:147]
global_load_dwordx4 a[212:215], v0, s[72:73] offset:0
v_mfma_f32_16x16x32_bf16 v[176:179], a[0:3], a[156:159], v[176:179]
v_mfma_f32_16x16x32_bf16 v[176:179], a[224:227], a[152:155], v[176:179]
v_mfma_f32_16x16x32_bf16 v[208:211], a[224:227], a[148:151], v[208:211]
v_mfma_f32_16x16x32_bf16 v[208:211], a[0:3], a[144:147], v[208:211]
global_load_dwordx4 a[208:211], v0, s[74:75] offset:0
v_mfma_f32_16x16x32_bf16 v[240:243], a[0:3], a[140:143], v[240:243]
v_mfma_f32_16x16x32_bf16 v[240:243], a[224:227], a[136:139], v[240:243]
v_mfma_f32_16x16x32_bf16 a[248:251], a[224:227], a[132:135], a[248:251]
global_load_dwordx4 a[192:195], v0, s[72:73] offset:1024
v_mfma_f32_16x16x32_bf16 a[248:251], a[0:3], a[128:131], a[248:251]
v_add_u32 v2, 65536, v1
s_waitcnt vmcnt(23)
v_mfma_f32_16x16x32_bf16 a[252:255], a[44:47], a[128:131], a[252:255]
ds_read_b128 a[128:131], v2 offset:16384
v_mfma_f32_16x16x32_bf16 a[252:255], a[20:23], a[132:135], a[252:255]
ds_read_b128 a[132:135], v2 offset:24576
v_mfma_f32_16x16x32_bf16 v[244:247], a[20:23], a[136:139], v[244:247]
ds_read_b128 a[136:139], v2 offset:25600
v_mfma_f32_16x16x32_bf16 v[244:247], a[44:47], a[140:143], v[244:247]
ds_read_b128 a[140:143], v2 offset:17408
v_mfma_f32_16x16x32_bf16 v[212:215], a[44:47], a[144:147], v[212:215]
ds_read_b128 a[144:147], v2 offset:18432
v_mfma_f32_16x16x32_bf16 v[212:215], a[20:23], a[148:151], v[212:215]
ds_read_b128 a[148:151], v2 offset:26624
v_mfma_f32_16x16x32_bf16 v[180:183], a[20:23], a[152:155], v[180:183]
ds_read_b128 a[152:155], v2 offset:27648
v_mfma_f32_16x16x32_bf16 v[180:183], a[44:47], a[156:159], v[180:183]
ds_read_b128 a[156:159], v2 offset:19456
v_mfma_f32_16x16x32_bf16 v[148:151], a[44:47], a[160:163], v[148:151]
ds_read_b128 a[160:163], v2 offset:20480
v_mfma_f32_16x16x32_bf16 v[148:151], a[20:23], a[164:167], v[148:151]
ds_read_b128 a[164:167], v2 offset:28672
v_mfma_f32_16x16x32_bf16 v[116:119], a[20:23], a[168:171], v[116:119]
ds_read_b128 a[168:171], v2 offset:29696
v_mfma_f32_16x16x32_bf16 v[116:119], a[44:47], a[172:175], v[116:119]
ds_read_b128 a[172:175], v2 offset:21504
v_mfma_f32_16x16x32_bf16 v[84:87], a[44:47], a[176:179], v[84:87]
ds_read_b128 a[176:179], v2 offset:22528
v_mfma_f32_16x16x32_bf16 v[84:87], a[20:23], a[180:183], v[84:87]
ds_read_b128 a[180:183], v2 offset:30720
v_mfma_f32_16x16x32_bf16 v[52:55], a[20:23], a[184:187], v[52:55]
ds_read_b128 a[184:187], v2 offset:31744
v_mfma_f32_16x16x32_bf16 v[52:55], a[44:47], a[188:191], v[52:55]
ds_read_b128 a[188:191], v2 offset:23552
s_waitcnt vmcnt(21) lgkmcnt(12)
v_mfma_f32_16x16x32_bf16 v[24:27], a[28:31], a[128:131], v[24:27]
global_load_dwordx4 a[200:203], v0, s[74:75] offset:1024
v_mfma_f32_16x16x32_bf16 v[24:27], a[4:7], a[132:135], v[24:27]
v_mfma_f32_16x16x32_bf16 v[56:59], a[4:7], a[136:139], v[56:59]
v_mfma_f32_16x16x32_bf16 v[56:59], a[28:31], a[140:143], v[56:59]
s_waitcnt lgkmcnt(8)
v_mfma_f32_16x16x32_bf16 v[88:91], a[28:31], a[144:147], v[88:91]
global_load_dwordx4 a[220:223], v0, s[72:73] offset:2048
v_mfma_f32_16x16x32_bf16 v[88:91], a[4:7], a[148:151], v[88:91]
v_mfma_f32_16x16x32_bf16 v[120:123], a[4:7], a[152:155], v[120:123]
v_mfma_f32_16x16x32_bf16 v[120:123], a[28:31], a[156:159], v[120:123]
s_waitcnt lgkmcnt(4)
v_mfma_f32_16x16x32_bf16 v[152:155], a[28:31], a[160:163], v[152:155]
global_load_dwordx4 a[12:15], v0, s[74:75] offset:2048
v_mfma_f32_16x16x32_bf16 v[152:155], a[4:7], a[164:167], v[152:155]
v_mfma_f32_16x16x32_bf16 v[184:187], a[4:7], a[168:171], v[184:187]
v_mfma_f32_16x16x32_bf16 v[184:187], a[28:31], a[172:175], v[184:187]
s_waitcnt vmcnt(14) lgkmcnt(0)
v_mfma_f32_16x16x32_bf16 v[216:219], a[28:31], a[176:179], v[216:219]
s_barrier
v_mfma_f32_16x16x32_bf16 v[216:219], a[4:7], a[180:183], v[216:219]
global_load_dwordx4 a[204:207], v0, s[72:73] offset:3072
v_mfma_f32_16x16x32_bf16 v[248:251], a[4:7], a[184:187], v[248:251]
s_xor_b32 s72, s64, 217088
s_add_u32 s72, s72, s12
s_addc_u32 s73, s13, 0
L_pad4:
s_cbranch_execz L_pad8
v_mfma_f32_16x16x32_bf16 v[248:251], a[28:31], a[188:191], v[248:251]
v_mfma_f32_16x16x32_bf16 v[252:255], a[40:43], a[188:191], v[252:255]
v_mfma_f32_16x16x32_bf16 v[252:255], a[32:35], a[184:187], v[252:255]
global_load_dwordx4 a[228:231], v0, s[74:75] offset:3072
v_mfma_f32_16x16x32_bf16 v[220:223], a[32:35], a[180:183], v[220:223]
s_xor_b32 s74, s64, 225280
s_add_u32 s74, s74, s12
s_addc_u32 s75, s13, 0
v_mfma_f32_16x16x32_bf16 v[220:223], a[40:43], a[176:179], v[220:223]
v_mfma_f32_16x16x32_bf16 v[188:191], a[40:43], a[172:175], v[188:191]
v_mfma_f32_16x16x32_bf16 v[188:191], a[32:35], a[168:171], v[188:191]
global_load_dwordx4 a[8:11], v0, s[72:73] offset:-4096
v_mfma_f32_16x16x32_bf16 v[156:159], a[32:35], a[164:167], v[156:159]
v_mfma_f32_16x16x32_bf16 v[156:159], a[40:43], a[160:163], v[156:159]
v_mfma_f32_16x16x32_bf16 v[124:127], a[40:43], a[156:159], v[124:127]
v_mfma_f32_16x16x32_bf16 v[124:127], a[32:35], a[152:155], v[124:127]
global_load_dwordx4 a[16:19], v0, s[74:75] offset:-4096
v_mfma_f32_16x16x32_bf16 v[92:95], a[32:35], a[148:151], v[92:95]
v_mfma_f32_16x16x32_bf16 v[92:95], a[40:43], a[144:147], v[92:95]
v_mfma_f32_16x16x32_bf16 v[60:63], a[40:43], a[140:143], v[60:63]
v_mfma_f32_16x16x32_bf16 v[60:63], a[32:35], a[136:139], v[60:63]
global_load_dwordx4 a[224:227], v0, s[72:73] offset:-3072
v_mfma_f32_16x16x32_bf16 v[28:31], a[32:35], a[132:135], v[28:31]
v_mfma_f32_16x16x32_bf16 v[28:31], a[40:43], a[128:131], v[28:31]
v_mfma_f32_16x16x32_bf16 v[32:35], a[24:27], a[128:131], v[32:35]
v_mfma_f32_16x16x32_bf16 v[32:35], a[36:39], a[132:135], v[32:35]
global_load_dwordx4 a[0:3], v0, s[74:75] offset:-3072
v_mfma_f32_16x16x32_bf16 v[64:67], a[36:39], a[136:139], v[64:67]
v_mfma_f32_16x16x32_bf16 v[64:67], a[24:27], a[140:143], v[64:67]
v_mfma_f32_16x16x32_bf16 v[96:99], a[24:27], a[144:147], v[96:99]
v_mfma_f32_16x16x32_bf16 v[96:99], a[36:39], a[148:151], v[96:99]
global_load_dwordx4 a[20:23], v0, s[72:73] offset:-2048
v_mfma_f32_16x16x32_bf16 v[128:131], a[36:39], a[152:155], v[128:131]
v_mfma_f32_16x16x32_bf16 v[128:131], a[24:27], a[156:159], v[128:131]
v_mfma_f32_16x16x32_bf16 v[160:163], a[24:27], a[160:163], v[160:163]
v_mfma_f32_16x16x32_bf16 v[160:163], a[36:39], a[164:167], v[160:163]
global_load_dwordx4 a[44:47], v0, s[74:75] offset:-2048
v_mfma_f32_16x16x32_bf16 v[192:195], a[36:39], a[168:171], v[192:195]
s_waitcnt vmcnt(14)
v_mfma_f32_16x16x32_bf16 v[192:195], a[24:27], a[172:175], v[192:195]
ds_read_b64_tr_b16 a[112:113], v21 offset:0
v_mfma_f32_16x16x32_bf16 v[224:227], a[24:27], a[176:179], v[224:227]
ds_read_b64_tr_b16 a[114:115], v21 offset:512
v_mfma_f32_16x16x32_bf16 v[224:227], a[36:39], a[180:183], v[224:227]
global_load_dwordx4 a[4:7], v0, s[72:73] offset:-1024
v_mfma_f32_16x16x32_bf16 a[232:235], a[36:39], a[184:187], a[232:235]
ds_read_b64_tr_b16 a[116:117], v21 offset:8
v_mfma_f32_16x16x32_bf16 a[232:235], a[24:27], a[188:191], a[232:235]
ds_read_b64_tr_b16 a[118:119], v21 offset:520
v_mfma_f32_16x16x32_bf16 a[236:239], a[196:199], a[188:191], a[236:239]
v_mfma_f32_16x16x32_bf16 a[236:239], a[216:219], a[184:187], a[236:239]
global_load_dwordx4 a[28:31], v0, s[74:75] offset:-1024
v_mfma_f32_16x16x32_bf16 v[228:231], a[216:219], a[180:183], v[228:231]
ds_read_b64_tr_b16 a[120:121], v22 offset:0
v_mfma_f32_16x16x32_bf16 v[228:231], a[196:199], a[176:179], v[228:231]
ds_read_b64_tr_b16 a[122:123], v22 offset:512
v_mfma_f32_16x16x32_bf16 v[196:199], a[196:199], a[172:175], v[196:199]
v_mfma_f32_16x16x32_bf16 v[196:199], a[216:219], a[168:171], v[196:199]
global_load_dwordx4 a[32:35], v0, s[72:73] offset:0
v_mfma_f32_16x16x32_bf16 v[164:167], a[216:219], a[164:167], v[164:167]
ds_read_b64_tr_b16 a[124:125], v22 offset:8
v_mfma_f32_16x16x32_bf16 v[164:167], a[196:199], a[160:163], v[164:167]
ds_read_b64_tr_b16 a[126:127], v22 offset:520
v_mfma_f32_16x16x32_bf16 v[132:135], a[196:199], a[156:159], v[132:135]
v_mfma_f32_16x16x32_bf16 v[132:135], a[216:219], a[152:155], v[132:135]
global_load_dwordx4 a[40:43], v0, s[74:75] offset:0
v_mfma_f32_16x16x32_bf16 v[100:103], a[216:219], a[148:151], v[100:103]
v_mfma_f32_16x16x32_bf16 v[100:103], a[196:199], a[144:147], v[100:103]
v_mfma_f32_16x16x32_bf16 v[68:71], a[196:199], a[140:143], v[68:71]
v_mfma_f32_16x16x32_bf16 v[68:71], a[216:219], a[136:139], v[68:71]
global_load_dwordx4 a[36:39], v0, s[72:73] offset:1024
v_mfma_f32_16x16x32_bf16 v[36:39], a[216:219], a[132:135], v[36:39]
v_mfma_f32_16x16x32_bf16 v[36:39], a[196:199], a[128:131], v[36:39]
s_waitcnt vmcnt(17)
v_mfma_f32_16x16x32_bf16 v[40:43], a[212:215], a[128:131], v[40:43]
v_mfma_f32_16x16x32_bf16 v[40:43], a[208:211], a[132:135], v[40:43]
global_load_dwordx4 a[24:27], v0, s[74:75] offset:1024
v_mfma_f32_16x16x32_bf16 v[72:75], a[208:211], a[136:139], v[72:75]
s_waitcnt lgkmcnt(0)
v_mfma_f32_16x16x32_bf16 v[72:75], a[212:215], a[140:143], v[72:75]
v_mfma_f32_16x16x32_bf16 v[104:107], a[212:215], a[144:147], v[104:107]
v_mfma_f32_16x16x32_bf16 v[104:107], a[208:211], a[148:151], v[104:107]
global_load_dwordx4 a[216:219], v0, s[72:73] offset:2048
v_mfma_f32_16x16x32_bf16 v[136:139], a[208:211], a[152:155], v[136:139]
buffer_store_dwordx4 a[112:115], v0, s[80:83], s79 offen offset:0 sc1
v_mfma_f32_16x16x32_bf16 v[136:139], a[212:215], a[156:159], v[136:139]
v_mfma_f32_16x16x32_bf16 v[168:171], a[212:215], a[160:163], v[168:171]
v_mfma_f32_16x16x32_bf16 v[168:171], a[208:211], a[164:167], v[168:171]
global_load_dwordx4 a[196:199], v0, s[74:75] offset:2048
v_mfma_f32_16x16x32_bf16 v[200:203], a[208:211], a[168:171], v[200:203]
v_mfma_f32_16x16x32_bf16 v[200:203], a[212:215], a[172:175], v[200:203]
v_mfma_f32_16x16x32_bf16 v[232:235], a[212:215], a[176:179], v[232:235]
v_mfma_f32_16x16x32_bf16 v[232:235], a[208:211], a[180:183], v[232:235]
v_mfma_f32_16x16x32_bf16 a[240:243], a[208:211], a[184:187], a[240:243]
global_load_dwordx4 a[208:211], v0, s[72:73] offset:3072
v_mfma_f32_16x16x32_bf16 a[240:243], a[212:215], a[188:191], a[240:243]
s_waitcnt vmcnt(20)
v_mfma_f32_16x16x32_bf16 a[244:247], a[192:195], a[188:191], a[244:247]
v_mfma_f32_16x16x32_bf16 a[244:247], a[200:203], a[184:187], a[244:247]
v_mfma_f32_16x16x32_bf16 v[236:239], a[200:203], a[180:183], v[236:239]
global_load_dwordx4 a[212:215], v0, s[74:75] offset:3072
v_mfma_f32_16x16x32_bf16 v[236:239], a[192:195], a[176:179], v[236:239]
s_xor_b32 s72, s64, 102400
s_add_u32 s72, s72, s12
s_addc_u32 s73, s13, 0
v_mfma_f32_16x16x32_bf16 v[204:207], a[192:195], a[172:175], v[204:207]
v_mfma_f32_16x16x32_bf16 v[204:207], a[200:203], a[168:171], v[204:207]
v_mfma_f32_16x16x32_bf16 v[172:175], a[200:203], a[164:167], v[172:175]
s_xor_b32 s74, s64, 110592
s_add_u32 s74, s74, s12
s_addc_u32 s75, s13, 0
v_mfma_f32_16x16x32_bf16 v[172:175], a[192:195], a[160:163], v[172:175]
v_mfma_f32_16x16x32_bf16 v[140:143], a[192:195], a[156:159], v[140:143]
v_mfma_f32_16x16x32_bf16 v[140:143], a[200:203], a[152:155], v[140:143]
v_mfma_f32_16x16x32_bf16 v[108:111], a[200:203], a[148:151], v[108:111]
v_mfma_f32_16x16x32_bf16 v[108:111], a[192:195], a[144:147], v[108:111]
v_mfma_f32_16x16x32_bf16 v[76:79], a[192:195], a[140:143], v[76:79]
buffer_store_dwordx4 a[116:119], v0, s[80:83], s79 offen offset:1024 sc1
v_mfma_f32_16x16x32_bf16 v[76:79], a[200:203], a[136:139], v[76:79]
v_mfma_f32_16x16x32_bf16 v[44:47], a[200:203], a[132:135], v[44:47]
global_load_dwordx4 a[200:203], v0, s[72:73] offset:-4096
v_mfma_f32_16x16x32_bf16 v[44:47], a[192:195], a[128:131], v[44:47]
s_waitcnt vmcnt(21)
v_mfma_f32_16x16x32_bf16 v[48:51], a[220:223], a[128:131], v[48:51]
v_mfma_f32_16x16x32_bf16 v[48:51], a[12:15], a[132:135], v[48:51]
v_mfma_f32_16x16x32_bf16 v[80:83], a[12:15], a[136:139], v[80:83]
global_load_dwordx4 a[192:195], v0, s[74:75] offset:-4096
v_mfma_f32_16x16x32_bf16 v[80:83], a[220:223], a[140:143], v[80:83]
v_mfma_f32_16x16x32_bf16 v[112:115], a[220:223], a[144:147], v[112:115]
v_mfma_f32_16x16x32_bf16 v[112:115], a[12:15], a[148:151], v[112:115]
v_mfma_f32_16x16x32_bf16 v[144:147], a[12:15], a[152:155], v[144:147]
v_mfma_f32_16x16x32_bf16 v[144:147], a[220:223], a[156:159], v[144:147]
v_mfma_f32_16x16x32_bf16 v[176:179], a[220:223], a[160:163], v[176:179]
v_mfma_f32_16x16x32_bf16 v[176:179], a[12:15], a[164:167], v[176:179]
v_mfma_f32_16x16x32_bf16 v[208:211], a[12:15], a[168:171], v[208:211]
v_mfma_f32_16x16x32_bf16 v[208:211], a[220:223], a[172:175], v[208:211]
v_mfma_f32_16x16x32_bf16 v[240:243], a[220:223], a[176:179], v[240:243]
v_mfma_f32_16x16x32_bf16 v[240:243], a[12:15], a[180:183], v[240:243]
v_mfma_f32_16x16x32_bf16 a[248:251], a[12:15], a[184:187], a[248:251]
global_load_dwordx4 a[12:15], v0, s[72:73] offset:-3072
v_mfma_f32_16x16x32_bf16 a[248:251], a[220:223], a[188:191], a[248:251]
v_add_u32 v2, 131072, v1
s_waitcnt vmcnt(21)
v_mfma_f32_16x16x32_bf16 a[252:255], a[204:207], a[188:191], a[252:255]
ds_read_b128 a[188:191], v2 offset:0
v_mfma_f32_16x16x32_bf16 a[252:255], a[228:231], a[184:187], a[252:255]
ds_read_b128 a[184:187], v2 offset:8192
v_mfma_f32_16x16x32_bf16 v[244:247], a[228:231], a[180:183], v[244:247]
ds_read_b128 a[180:183], v2 offset:9216
v_mfma_f32_16x16x32_bf16 v[244:247], a[204:207], a[176:179], v[244:247]
ds_read_b128 a[176:179], v2 offset:1024
v_mfma_f32_16x16x32_bf16 v[212:215], a[204:207], a[172:175], v[212:215]
ds_read_b128 a[172:175], v2 offset:2048
v_mfma_f32_16x16x32_bf16 v[212:215], a[228:231], a[168:171], v[212:215]
ds_read_b128 a[168:171], v2 offset:10240
v_mfma_f32_16x16x32_bf16 v[180:183], a[228:231], a[164:167], v[180:183]
ds_read_b128 a[164:167], v2 offset:11264
v_mfma_f32_16x16x32_bf16 v[180:183], a[204:207], a[160:163], v[180:183]
ds_read_b128 a[160:163], v2 offset:3072
v_mfma_f32_16x16x32_bf16 v[148:151], a[204:207], a[156:159], v[148:151]
ds_read_b128 a[156:159], v2 offset:4096
v_mfma_f32_16x16x32_bf16 v[148:151], a[228:231], a[152:155], v[148:151]
ds_read_b128 a[152:155], v2 offset:12288
v_mfma_f32_16x16x32_bf16 v[116:119], a[228:231], a[148:151], v[116:119]
ds_read_b128 a[148:151], v2 offset:13312
v_mfma_f32_16x16x32_bf16 v[116:119], a[204:207], a[144:147], v[116:119]
ds_read_b128 a[144:147], v2 offset:5120
v_mfma_f32_16x16x32_bf16 v[84:87], a[204:207], a[140:143], v[84:87]
ds_read_b128 a[140:143], v2 offset:6144
v_mfma_f32_16x16x32_bf16 v[84:87], a[228:231], a[136:139], v[84:87]
ds_read_b128 a[136:139], v2 offset:14336
v_mfma_f32_16x16x32_bf16 v[52:55], a[228:231], a[132:135], v[52:55]
ds_read_b128 a[132:135], v2 offset:15360
v_mfma_f32_16x16x32_bf16 v[52:55], a[204:207], a[128:131], v[52:55]
ds_read_b128 a[128:131], v2 offset:7168
s_waitcnt vmcnt(19) lgkmcnt(12)
v_mfma_f32_16x16x32_bf16 v[24:27], a[8:11], a[188:191], v[24:27]
global_load_dwordx4 a[220:223], v0, s[74:75] offset:-3072
v_mfma_f32_16x16x32_bf16 v[24:27], a[16:19], a[184:187], v[24:27]
buffer_store_dwordx4 a[120:123], v0, s[80:83], s79 offen offset:2048 sc1
v_mfma_f32_16x16x32_bf16 v[56:59], a[16:19], a[180:183], v[56:59]
v_mfma_f32_16x16x32_bf16 v[56:59], a[8:11], a[176:179], v[56:59]
s_waitcnt lgkmcnt(8)
v_mfma_f32_16x16x32_bf16 v[88:91], a[8:11], a[172:175], v[88:91]
global_load_dwordx4 a[228:231], v0, s[72:73] offset:-2048
v_mfma_f32_16x16x32_bf16 v[88:91], a[16:19], a[168:171], v[88:91]
v_mfma_f32_16x16x32_bf16 v[120:123], a[16:19], a[164:167], v[120:123]
v_mfma_f32_16x16x32_bf16 v[120:123], a[8:11], a[160:163], v[120:123]
s_waitcnt lgkmcnt(4)
v_mfma_f32_16x16x32_bf16 v[152:155], a[8:11], a[156:159], v[152:155]
global_load_dwordx4 a[204:207], v0, s[74:75] offset:-2048
v_mfma_f32_16x16x32_bf16 v[152:155], a[16:19], a[152:155], v[152:155]
v_mfma_f32_16x16x32_bf16 v[184:187], a[16:19], a[148:151], v[184:187]
v_mfma_f32_16x16x32_bf16 v[184:187], a[8:11], a[144:147], v[184:187]
s_waitcnt lgkmcnt(0)
v_mfma_f32_16x16x32_bf16 v[216:219], a[8:11], a[140:143], v[216:219]
s_barrier
v_mfma_f32_16x16x32_bf16 v[216:219], a[16:19], a[136:139], v[216:219]
buffer_store_dwordx4 a[124:127], v0, s[80:83], s79 offen offset:3072 sc1
v_mfma_f32_16x16x32_bf16 v[248:251], a[16:19], a[132:135], v[248:251]
s_add_u32 m0, s56, 131072
s_xor_b32 s10, s59, 768
s_add_u32 s10, s10, s8
s_addc_u32 s11, s9, 0
v_mfma_f32_16x16x32_bf16 v[248:251], a[8:11], a[128:131], v[248:251]
s_waitcnt vmcnt(22)
v_mfma_f32_16x16x32_bf16 v[252:255], a[224:227], a[128:131], v[252:255]
global_load_lds_dwordx4 v4, s[10:11]
v_mfma_f32_16x16x32_bf16 v[252:255], a[0:3], a[132:135], v[252:255]
v_mfma_f32_16x16x32_bf16 v[220:223], a[0:3], a[136:139], v[220:223]
v_mfma_f32_16x16x32_bf16 v[220:223], a[224:227], a[140:143], v[220:223]
v_mfma_f32_16x16x32_bf16 v[188:191], a[224:227], a[144:147], v[188:191]
global_load_lds_dwordx4 v5, s[10:11] offset:1024
v_mfma_f32_16x16x32_bf16 v[188:191], a[0:3], a[148:151], v[188:191]
v_mfma_f32_16x16x32_bf16 v[156:159], a[0:3], a[152:155], v[156:159]
v_mfma_f32_16x16x32_bf16 v[156:159], a[224:227], a[156:159], v[156:159]
s_add_u32 m0, s56, 139264
v_mfma_f32_16x16x32_bf16 v[124:127], a[224:227], a[160:163], v[124:127]
s_xor_b32 s10, s59, 832
s_add_u32 s10, s10, s8
s_addc_u32 s11, s9, 0
v_mfma_f32_16x16x32_bf16 v[124:127], a[0:3], a[164:167], v[124:127]
v_mfma_f32_16x16x32_bf16 v[92:95], a[0:3], a[168:171], v[92:95]
global_load_lds_dwordx4 v4, s[10:11]
v_mfma_f32_16x16x32_bf16 v[92:95], a[224:227], a[172:175], v[92:95]
v_mfma_f32_16x16x32_bf16 v[60:63], a[224:227], a[176:179], v[60:63]
v_mfma_f32_16x16x32_bf16 v[60:63], a[0:3], a[180:183], v[60:63]
global_load_lds_dwordx4 v5, s[10:11] offset:1024
v_mfma_f32_16x16x32_bf16 v[28:31], a[0:3], a[184:187], v[28:31]
v_mfma_f32_16x16x32_bf16 v[28:31], a[224:227], a[188:191], v[28:31]
s_waitcnt vmcnt(24)
v_mfma_f32_16x16x32_bf16 v[32:35], a[20:23], a[188:191], v[32:35]
global_load_dwordx4 a[224:227], v0, s[72:73] offset:-1024
v_mfma_f32_16x16x32_bf16 v[32:35], a[44:47], a[184:187], v[32:35]
v_mfma_f32_16x16x32_bf16 v[64:67], a[44:47], a[180:183], v[64:67]
s_add_u32 m0, s56, 114688
v_mfma_f32_16x16x32_bf16 v[64:67], a[20:23], a[176:179], v[64:67]
s_xor_b32 s10, s58, 896
s_add_u32 s10, s10, s8
s_addc_u32 s11, s9, 0
v_mfma_f32_16x16x32_bf16 v[96:99], a[20:23], a[172:175], v[96:99]
v_mfma_f32_16x16x32_bf16 v[96:99], a[44:47], a[168:171], v[96:99]
global_load_lds_dwordx4 v4, s[10:11]
v_mfma_f32_16x16x32_bf16 v[128:131], a[44:47], a[164:167], v[128:131]
v_mfma_f32_16x16x32_bf16 v[128:131], a[20:23], a[160:163], v[128:131]
v_mfma_f32_16x16x32_bf16 v[160:163], a[20:23], a[156:159], v[160:163]
global_load_lds_dwordx4 v5, s[10:11] offset:1024
v_mfma_f32_16x16x32_bf16 v[160:163], a[44:47], a[152:155], v[160:163]
v_mfma_f32_16x16x32_bf16 v[192:195], a[44:47], a[148:151], v[192:195]
v_mfma_f32_16x16x32_bf16 v[192:195], a[20:23], a[144:147], v[192:195]
s_add_u32 m0, s56, 122880
v_mfma_f32_16x16x32_bf16 v[224:227], a[20:23], a[140:143], v[224:227]
s_xor_b32 s10, s58, 960
s_add_u32 s10, s10, s8
s_addc_u32 s11, s9, 0
v_mfma_f32_16x16x32_bf16 v[224:227], a[44:47], a[136:139], v[224:227]
v_mfma_f32_16x16x32_bf16 a[232:235], a[44:47], a[132:135], a[232:235]
global_load_lds_dwordx4 v4, s[10:11]
v_mfma_f32_16x16x32_bf16 a[232:235], a[20:23], a[128:131], a[232:235]
s_waitcnt vmcnt(26)
v_mfma_f32_16x16x32_bf16 a[236:239], a[4:7], a[128:131], a[236:239]
v_mfma_f32_16x16x32_bf16 a[236:239], a[28:31], a[132:135], a[236:239]
global_load_lds_dwordx4 v5, s[10:11] offset:1024
v_mfma_f32_16x16x32_bf16 v[228:231], a[28:31], a[136:139], v[228:231]
v_mfma_f32_16x16x32_bf16 v[228:231], a[4:7], a[140:143], v[228:231]
v_mfma_f32_16x16x32_bf16 v[196:199], a[4:7], a[144:147], v[196:199]
v_mfma_f32_16x16x32_bf16 v[196:199], a[28:31], a[148:151], v[196:199]
v_mfma_f32_16x16x32_bf16 v[164:167], a[28:31], a[152:155], v[164:167]
v_mfma_f32_16x16x32_bf16 v[164:167], a[4:7], a[156:159], v[164:167]
v_mfma_f32_16x16x32_bf16 v[132:135], a[4:7], a[160:163], v[132:135]
v_mfma_f32_16x16x32_bf16 v[132:135], a[28:31], a[164:167], v[132:135]
v_mfma_f32_16x16x32_bf16 v[100:103], a[28:31], a[168:171], v[100:103]
v_mfma_f32_16x16x32_bf16 v[100:103], a[4:7], a[172:175], v[100:103]
v_mfma_f32_16x16x32_bf16 v[68:71], a[4:7], a[176:179], v[68:71]
v_mfma_f32_16x16x32_bf16 v[68:71], a[28:31], a[180:183], v[68:71]
v_mfma_f32_16x16x32_bf16 v[36:39], a[28:31], a[184:187], v[36:39]
v_mfma_f32_16x16x32_bf16 v[36:39], a[4:7], a[188:191], v[36:39]
s_waitcnt vmcnt(25)
v_mfma_f32_16x16x32_bf16 v[40:43], a[32:35], a[188:191], v[40:43]
v_mfma_f32_16x16x32_bf16 v[40:43], a[40:43], a[184:187], v[40:43]
v_mfma_f32_16x16x32_bf16 v[72:75], a[40:43], a[180:183], v[72:75]
v_mfma_f32_16x16x32_bf16 v[72:75], a[32:35], a[176:179], v[72:75]
v_mfma_f32_16x16x32_bf16 v[104:107], a[32:35], a[172:175], v[104:107]
v_mfma_f32_16x16x32_bf16 v[104:107], a[40:43], a[168:171], v[104:107]
v_mfma_f32_16x16x32_bf16 v[136:139], a[40:43], a[164:167], v[136:139]
v_mfma_f32_16x16x32_bf16 v[136:139], a[32:35], a[160:163], v[136:139]
v_mfma_f32_16x16x32_bf16 v[168:171], a[32:35], a[156:159], v[168:171]
v_mfma_f32_16x16x32_bf16 v[168:171], a[40:43], a[152:155], v[168:171]
v_mfma_f32_16x16x32_bf16 v[200:203], a[40:43], a[148:151], v[200:203]
v_mfma_f32_16x16x32_bf16 v[200:203], a[32:35], a[144:147], v[200:203]
v_mfma_f32_16x16x32_bf16 v[232:235], a[32:35], a[140:143], v[232:235]
v_mfma_f32_16x16x32_bf16 v[232:235], a[40:43], a[136:139], v[232:235]
v_mfma_f32_16x16x32_bf16 a[240:243], a[40:43], a[132:135], a[240:243]
v_mfma_f32_16x16x32_bf16 a[240:243], a[32:35], a[128:131], a[240:243]
s_waitcnt vmcnt(23)
v_mfma_f32_16x16x32_bf16 a[244:247], a[36:39], a[128:131], a[244:247]
v_mfma_f32_16x16x32_bf16 a[244:247], a[24:27], a[132:135], a[244:247]
v_mfma_f32_16x16x32_bf16 v[236:239], a[24:27], a[136:139], v[236:239]
v_mfma_f32_16x16x32_bf16 v[236:239], a[36:39], a[140:143], v[236:239]
v_mfma_f32_16x16x32_bf16 v[204:207], a[36:39], a[144:147], v[204:207]
v_mfma_f32_16x16x32_bf16 v[204:207], a[24:27], a[148:151], v[204:207]
v_mfma_f32_16x16x32_bf16 v[172:175], a[24:27], a[152:155], v[172:175]
v_mfma_f32_16x16x32_bf16 v[172:175], a[36:39], a[156:159], v[172:175]
v_mfma_f32_16x16x32_bf16 v[140:143], a[36:39], a[160:163], v[140:143]
v_mfma_f32_16x16x32_bf16 v[140:143], a[24:27], a[164:167], v[140:143]
v_mfma_f32_16x16x32_bf16 v[108:111], a[24:27], a[168:171], v[108:111]
v_mfma_f32_16x16x32_bf16 v[108:111], a[36:39], a[172:175], v[108:111]
v_mfma_f32_16x16x32_bf16 v[76:79], a[36:39], a[176:179], v[76:79]
v_mfma_f32_16x16x32_bf16 v[76:79], a[24:27], a[180:183], v[76:79]
v_mfma_f32_16x16x32_bf16 v[44:47], a[24:27], a[184:187], v[44:47]
v_mfma_f32_16x16x32_bf16 v[44:47], a[36:39], a[188:191], v[44:47]
s_waitcnt vmcnt(20)
v_mfma_f32_16x16x32_bf16 v[48:51], a[216:219], a[188:191], v[48:51]
v_mfma_f32_16x16x32_bf16 v[48:51], a[196:199], a[184:187], v[48:51]
v_mfma_f32_16x16x32_bf16 v[80:83], a[196:199], a[180:183], v[80:83]
v_mfma_f32_16x16x32_bf16 v[80:83], a[216:219], a[176:179], v[80:83]
v_mfma_f32_16x16x32_bf16 v[112:115], a[216:219], a[172:175], v[112:115]
v_mfma_f32_16x16x32_bf16 v[112:115], a[196:199], a[168:171], v[112:115]
v_mfma_f32_16x16x32_bf16 v[144:147], a[196:199], a[164:167], v[144:147]
s_xor_b32 s72, s64, 233472
s_add_u32 s72, s72, s12
s_addc_u32 s73, s13, 0
v_mfma_f32_16x16x32_bf16 v[144:147], a[216:219], a[160:163], v[144:147]
v_mfma_f32_16x16x32_bf16 v[176:179], a[216:219], a[156:159], v[176:179]
v_mfma_f32_16x16x32_bf16 v[176:179], a[196:199], a[152:155], v[176:179]
v_mfma_f32_16x16x32_bf16 v[208:211], a[196:199], a[148:151], v[208:211]
v_mfma_f32_16x16x32_bf16 v[208:211], a[216:219], a[144:147], v[208:211]
v_mfma_f32_16x16x32_bf16 v[240:243], a[216:219], a[140:143], v[240:243]
v_mfma_f32_16x16x32_bf16 v[240:243], a[196:199], a[136:139], v[240:243]
v_mfma_f32_16x16x32_bf16 a[248:251], a[196:199], a[132:135], a[248:251]
global_load_dwordx4 a[196:199], v0, s[74:75] offset:-1024
v_mfma_f32_16x16x32_bf16 a[248:251], a[216:219], a[128:131], a[248:251]
v_add_u32 v2, 65536, v1
s_waitcnt vmcnt(19)
v_mfma_f32_16x16x32_bf16 a[252:255], a[208:211], a[128:131], a[252:255]
ds_read_b128 a[128:131], v2 offset:32768
v_mfma_f32_16x16x32_bf16 a[252:255], a[212:215], a[132:135], a[252:255]
ds_read_b128 a[132:135], v2 offset:40960
v_mfma_f32_16x16x32_bf16 v[244:247], a[212:215], a[136:139], v[244:247]
ds_read_b128 a[136:139], v2 offset:41984
v_mfma_f32_16x16x32_bf16 v[244:247], a[208:211], a[140:143], v[244:247]
ds_read_b128 a[140:143], v2 offset:33792
v_mfma_f32_16x16x32_bf16 v[212:215], a[208:211], a[144:147], v[212:215]
ds_read_b128 a[144:147], v2 offset:34816
v_mfma_f32_16x16x32_bf16 v[212:215], a[212:215], a[148:151], v[212:215]
ds_read_b128 a[148:151], v2 offset:43008
v_mfma_f32_16x16x32_bf16 v[180:183], a[212:215], a[152:155], v[180:183]
ds_read_b128 a[152:155], v2 offset:44032
v_mfma_f32_16x16x32_bf16 v[180:183], a[208:211], a[156:159], v[180:183]
ds_read_b128 a[156:159], v2 offset:35840
v_mfma_f32_16x16x32_bf16 v[148:151], a[208:211], a[160:163], v[148:151]
ds_read_b128 a[160:163], v2 offset:36864
v_mfma_f32_16x16x32_bf16 v[148:151], a[212:215], a[164:167], v[148:151]
ds_read_b128 a[164:167], v2 offset:45056
v_mfma_f32_16x16x32_bf16 v[116:119], a[212:215], a[168:171], v[116:119]
ds_read_b128 a[168:171], v2 offset:46080
v_mfma_f32_16x16x32_bf16 v[116:119], a[208:211], a[172:175], v[116:119]
ds_read_b128 a[172:175], v2 offset:37888
v_mfma_f32_16x16x32_bf16 v[84:87], a[208:211], a[176:179], v[84:87]
ds_read_b128 a[176:179], v2 offset:38912
v_mfma_f32_16x16x32_bf16 v[84:87], a[212:215], a[180:183], v[84:87]
ds_read_b128 a[180:183], v2 offset:47104
v_mfma_f32_16x16x32_bf16 v[52:55], a[212:215], a[184:187], v[52:55]
ds_read_b128 a[184:187], v2 offset:48128
v_mfma_f32_16x16x32_bf16 v[52:55], a[208:211], a[188:191], v[52:55]
ds_read_b128 a[188:191], v2 offset:39936
s_waitcnt vmcnt(16) lgkmcnt(12)
v_mfma_f32_16x16x32_bf16 v[24:27], a[200:203], a[128:131], v[24:27]
global_load_dwordx4 a[216:219], v0, s[72:73] offset:-4096
v_mfma_f32_16x16x32_bf16 v[24:27], a[192:195], a[132:135], v[24:27]
s_xor_b32 s74, s64, 241664
s_add_u32 s74, s74, s12
s_addc_u32 s75, s13, 0
v_mfma_f32_16x16x32_bf16 v[56:59], a[192:195], a[136:139], v[56:59]
v_mfma_f32_16x16x32_bf16 v[56:59], a[200:203], a[140:143], v[56:59]
s_waitcnt lgkmcnt(8)
v_mfma_f32_16x16x32_bf16 v[88:91], a[200:203], a[144:147], v[88:91]
global_load_dwordx4 a[212:215], v0, s[74:75] offset:-4096
v_mfma_f32_16x16x32_bf16 v[88:91], a[192:195], a[148:151], v[88:91]
s_and_b32 s67, s2, 1
s_lshl_b32 s67, s67, 7
s_add_u32 s67, s67, s56
v_mfma_f32_16x16x32_bf16 v[120:123], a[192:195], a[152:155], v[120:123]
v_mfma_f32_16x16x32_bf16 v[120:123], a[200:203], a[156:159], v[120:123]
v_lshlrev_b32 v8, 4, v0
s_waitcnt lgkmcnt(4)
v_mfma_f32_16x16x32_bf16 v[152:155], a[200:203], a[160:163], v[152:155]
global_load_dwordx4 a[208:211], v0, s[72:73] offset:-3072
v_mfma_f32_16x16x32_bf16 v[152:155], a[192:195], a[164:167], v[152:155]
v_mfma_f32_16x16x32_bf16 v[184:187], a[192:195], a[168:171], v[184:187]
v_mov_b32 v9, 1
v_mfma_f32_16x16x32_bf16 v[184:187], a[200:203], a[172:175], v[184:187]
s_waitcnt vmcnt(9) lgkmcnt(0)
v_mfma_f32_16x16x32_bf16 v[216:219], a[200:203], a[176:179], v[216:219]
s_barrier
v_mfma_f32_16x16x32_bf16 v[216:219], a[192:195], a[180:183], v[216:219]
buffer_atomic_add v9, v8, s[84:87], s67 offen offset:16 sc1
v_mfma_f32_16x16x32_bf16 v[248:251], a[192:195], a[184:187], v[248:251]
global_load_dwordx4 a[192:195], v0, s[74:75] offset:-3072
v_mfma_f32_16x16x32_bf16 v[248:251], a[200:203], a[188:191], v[248:251]
v_mfma_f32_16x16x32_bf16 v[252:255], a[12:15], a[188:191], v[252:255]
v_mfma_f32_16x16x32_bf16 v[252:255], a[220:223], a[184:187], v[252:255]
v_mfma_f32_16x16x32_bf16 v[220:223], a[220:223], a[180:183], v[220:223]
global_load_dwordx4 a[200:203], v0, s[72:73] offset:-2048
v_mfma_f32_16x16x32_bf16 v[220:223], a[12:15], a[176:179], v[220:223]
v_mfma_f32_16x16x32_bf16 v[188:191], a[12:15], a[172:175], v[188:191]
v_mfma_f32_16x16x32_bf16 v[188:191], a[220:223], a[168:171], v[188:191]
v_mfma_f32_16x16x32_bf16 v[156:159], a[220:223], a[164:167], v[156:159]
v_mfma_f32_16x16x32_bf16 v[156:159], a[12:15], a[160:163], v[156:159]
v_mfma_f32_16x16x32_bf16 v[124:127], a[12:15], a[156:159], v[124:127]
v_mfma_f32_16x16x32_bf16 v[124:127], a[220:223], a[152:155], v[124:127]
v_mfma_f32_16x16x32_bf16 v[92:95], a[220:223], a[148:151], v[92:95]
v_mfma_f32_16x16x32_bf16 v[92:95], a[12:15], a[144:147], v[92:95]
v_mfma_f32_16x16x32_bf16 v[60:63], a[12:15], a[140:143], v[60:63]
v_mfma_f32_16x16x32_bf16 v[60:63], a[220:223], a[136:139], v[60:63]
v_mfma_f32_16x16x32_bf16 v[28:31], a[220:223], a[132:135], v[28:31]
global_load_dwordx4 a[220:223], v0, s[74:75] offset:-2048
v_mfma_f32_16x16x32_bf16 v[28:31], a[12:15], a[128:131], v[28:31]
v_mfma_f32_16x16x32_bf16 v[32:35], a[228:231], a[128:131], v[32:35]
v_add_u32 v3, s65, v1
v_mfma_f32_16x16x32_bf16 v[32:35], a[204:207], a[132:135], v[32:35]
ds_read_b128 a[0:3], v3 offset:0
v_mfma_f32_16x16x32_bf16 v[64:67], a[204:207], a[136:139], v[64:67]
v_mfma_f32_16x16x32_bf16 v[64:67], a[228:231], a[140:143], v[64:67]
ds_read_b128 a[4:7], v3 offset:1024
v_mfma_f32_16x16x32_bf16 v[96:99], a[228:231], a[144:147], v[96:99]
v_mfma_f32_16x16x32_bf16 v[96:99], a[204:207], a[148:151], v[96:99]
ds_read_b128 a[8:11], v3 offset:2048
v_mfma_f32_16x16x32_bf16 v[128:131], a[204:207], a[152:155], v[128:131]
ds_read_b128 a[12:15], v3 offset:3072
v_mfma_f32_16x16x32_bf16 v[128:131], a[228:231], a[156:159], v[128:131]
v_mfma_f32_16x16x32_bf16 v[160:163], a[228:231], a[160:163], v[160:163]
ds_read_b128 a[16:19], v3 offset:4096
v_mfma_f32_16x16x32_bf16 v[160:163], a[204:207], a[164:167], v[160:163]
v_mfma_f32_16x16x32_bf16 v[192:195], a[204:207], a[168:171], v[192:195]
ds_read_b128 a[20:23], v3 offset:5120
v_mfma_f32_16x16x32_bf16 v[192:195], a[228:231], a[172:175], v[192:195]
ds_read_b128 a[24:27], v3 offset:6144
v_mfma_f32_16x16x32_bf16 v[224:227], a[228:231], a[176:179], v[224:227]
v_mfma_f32_16x16x32_bf16 v[224:227], a[204:207], a[180:183], v[224:227]
ds_read_b128 a[28:31], v3 offset:7168
v_mfma_f32_16x16x32_bf16 a[232:235], a[204:207], a[184:187], a[232:235]
global_load_dwordx4 a[204:207], v0, s[72:73] offset:-1024
v_mfma_f32_16x16x32_bf16 a[232:235], a[228:231], a[188:191], a[232:235]
v_add_u32 v2, 131072, v1
s_waitcnt vmcnt(8)
v_mfma_f32_16x16x32_bf16 a[236:239], a[224:227], a[188:191], a[236:239]
ds_read_b128 a[188:191], v2 offset:0
v_mfma_f32_16x16x32_bf16 a[236:239], a[196:199], a[184:187], a[236:239]
ds_read_b128 a[184:187], v2 offset:8192
v_mfma_f32_16x16x32_bf16 v[228:231], a[196:199], a[180:183], v[228:231]
ds_read_b128 a[180:183], v2 offset:9216
v_mfma_f32_16x16x32_bf16 v[228:231], a[224:227], a[176:179], v[228:231]
ds_read_b128 a[176:179], v2 offset:1024
v_mfma_f32_16x16x32_bf16 v[196:199], a[224:227], a[172:175], v[196:199]
ds_read_b128 a[172:175], v2 offset:2048
v_mfma_f32_16x16x32_bf16 v[196:199], a[196:199], a[168:171], v[196:199]
ds_read_b128 a[168:171], v2 offset:10240
v_mfma_f32_16x16x32_bf16 v[164:167], a[196:199], a[164:167], v[164:167]
ds_read_b128 a[164:167], v2 offset:11264
v_mfma_f32_16x16x32_bf16 v[164:167], a[224:227], a[160:163], v[164:167]
ds_read_b128 a[160:163], v2 offset:3072
v_mfma_f32_16x16x32_bf16 v[132:135], a[224:227], a[156:159], v[132:135]
ds_read_b128 a[156:159], v2 offset:4096
v_mfma_f32_16x16x32_bf16 v[132:135], a[196:199], a[152:155], v[132:135]
ds_read_b128 a[152:155], v2 offset:12288
v_mfma_f32_16x16x32_bf16 v[100:103], a[196:199], a[148:151], v[100:103]
ds_read_b128 a[148:151], v2 offset:13312
v_mfma_f32_16x16x32_bf16 v[100:103], a[224:227], a[144:147], v[100:103]
ds_read_b128 a[144:147], v2 offset:5120
v_mfma_f32_16x16x32_bf16 v[68:71], a[224:227], a[140:143], v[68:71]
ds_read_b128 a[140:143], v2 offset:6144
v_mfma_f32_16x16x32_bf16 v[68:71], a[196:199], a[136:139], v[68:71]
ds_read_b128 a[136:139], v2 offset:14336
v_mfma_f32_16x16x32_bf16 v[36:39], a[196:199], a[132:135], v[36:39]
ds_read_b128 a[132:135], v2 offset:15360
v_mfma_f32_16x16x32_bf16 v[36:39], a[224:227], a[128:131], v[36:39]
ds_read_b128 a[128:131], v2 offset:7168
s_waitcnt vmcnt(6) lgkmcnt(12)
v_mfma_f32_16x16x32_bf16 v[24:27], a[216:219], a[188:191], v[24:27]
global_load_dwordx4 a[228:231], v0, s[74:75] offset:-1024
v_mfma_f32_16x16x32_bf16 v[24:27], a[212:215], a[184:187], v[24:27]
ds_read_b128 a[32:35], v3 offset:8192
v_mfma_f32_16x16x32_bf16 v[56:59], a[212:215], a[180:183], v[56:59]
ds_read_b128 a[36:39], v3 offset:9216
v_mfma_f32_16x16x32_bf16 v[56:59], a[216:219], a[176:179], v[56:59]
s_waitcnt lgkmcnt(10)
v_mfma_f32_16x16x32_bf16 v[88:91], a[216:219], a[172:175], v[88:91]
global_load_dwordx4 a[196:199], v0, s[72:73] offset:0
v_mfma_f32_16x16x32_bf16 v[88:91], a[212:215], a[168:171], v[88:91]
ds_read_b128 a[40:43], v3 offset:10240
v_mfma_f32_16x16x32_bf16 v[120:123], a[212:215], a[164:167], v[120:123]
ds_read_b128 a[44:47], v3 offset:11264
v_mfma_f32_16x16x32_bf16 v[120:123], a[216:219], a[160:163], v[120:123]
s_waitcnt lgkmcnt(8)
v_mfma_f32_16x16x32_bf16 v[152:155], a[216:219], a[156:159], v[152:155]
global_load_dwordx4 a[224:227], v0, s[74:75] offset:0
v_mfma_f32_16x16x32_bf16 v[152:155], a[212:215], a[152:155], v[152:155]
ds_read_b128 a[48:51], v3 offset:12288
v_mfma_f32_16x16x32_bf16 v[184:187], a[212:215], a[148:151], v[184:187]
ds_read_b128 a[52:55], v3 offset:13312
v_mfma_f32_16x16x32_bf16 v[184:187], a[216:219], a[144:147], v[184:187]
ds_read_b128 a[56:59], v3 offset:14336
ds_read_b128 a[60:63], v3 offset:15360
s_waitcnt lgkmcnt(0)
v_mfma_f32_16x16x32_bf16 v[216:219], a[216:219], a[140:143], v[216:219]
s_barrier
v_mfma_f32_16x16x32_bf16 v[216:219], a[212:215], a[136:139], v[216:219]
s_add_u32 m0, s56, 131072
v_mfma_f32_16x16x32_bf16 v[248:251], a[212:215], a[132:135], v[248:251]
global_load_dwordx4 a[212:215], v0, s[72:73] offset:1024
v_mfma_f32_16x16x32_bf16 v[248:251], a[216:219], a[128:131], v[248:251]
s_xor_b32 s10, s59, 896
s_add_u32 s10, s10, s8
s_addc_u32 s11, s9, 0
s_waitcnt vmcnt(7)
v_mfma_f32_16x16x32_bf16 v[252:255], a[208:211], a[128:131], v[252:255]
global_load_lds_dwordx4 v4, s[10:11]
v_mfma_f32_16x16x32_bf16 v[252:255], a[192:195], a[132:135], v[252:255]
v_mfma_f32_16x16x32_bf16 v[220:223], a[192:195], a[136:139], v[220:223]
global_load_dwordx4 a[216:219], v0, s[74:75] offset:1024
v_mfma_f32_16x16x32_bf16 v[220:223], a[208:211], a[140:143], v[220:223]
v_mfma_f32_16x16x32_bf16 v[188:191], a[208:211], a[144:147], v[188:191]
v_mfma_f32_16x16x32_bf16 v[188:191], a[192:195], a[148:151], v[188:191]
global_load_lds_dwordx4 v5, s[10:11] offset:1024
v_mfma_f32_16x16x32_bf16 v[156:159], a[192:195], a[152:155], v[156:159]
v_mfma_f32_16x16x32_bf16 v[156:159], a[208:211], a[156:159], v[156:159]
s_add_u32 m0, s56, 139264
v_mfma_f32_16x16x32_bf16 v[124:127], a[208:211], a[160:163], v[124:127]
s_xor_b32 s10, s59, 960
s_add_u32 s10, s10, s8
s_addc_u32 s11, s9, 0
v_mfma_f32_16x16x32_bf16 v[124:127], a[192:195], a[164:167], v[124:127]
global_load_lds_dwordx4 v4, s[10:11]
v_mfma_f32_16x16x32_bf16 v[92:95], a[192:195], a[168:171], v[92:95]
v_mfma_f32_16x16x32_bf16 v[92:95], a[208:211], a[172:175], v[92:95]
v_mfma_f32_16x16x32_bf16 v[60:63], a[208:211], a[176:179], v[60:63]
global_load_lds_dwordx4 v5, s[10:11] offset:1024
v_mfma_f32_16x16x32_bf16 v[60:63], a[192:195], a[180:183], v[60:63]
v_mfma_f32_16x16x32_bf16 v[28:31], a[192:195], a[184:187], v[28:31]
global_load_dwordx4 a[192:195], v0, s[72:73] offset:2048
L_pad5:
s_cbranch_execz L_pad9
v_mfma_f32_16x16x32_bf16 v[28:31], a[208:211], a[188:191], v[28:31]
s_waitcnt vmcnt(11)
v_mfma_f32_16x16x32_bf16 v[32:35], a[200:203], a[188:191], v[32:35]
v_mfma_f32_16x16x32_bf16 v[32:35], a[220:223], a[184:187], v[32:35]
v_mfma_f32_16x16x32_bf16 v[64:67], a[220:223], a[180:183], v[64:67]
global_load_dwordx4 a[208:211], v0, s[74:75] offset:2048
v_mfma_f32_16x16x32_bf16 v[64:67], a[200:203], a[176:179], v[64:67]
v_mfma_f32_16x16x32_bf16 v[96:99], a[200:203], a[172:175], v[96:99]
v_mfma_f32_16x16x32_bf16 v[96:99], a[220:223], a[168:171], v[96:99]
v_mfma_f32_16x16x32_bf16 v[128:131], a[220:223], a[164:167], v[128:131]
v_mfma_f32_16x16x32_bf16 v[128:131], a[200:203], a[160:163], v[128:131]
v_mfma_f32_16x16x32_bf16 v[160:163], a[200:203], a[156:159], v[160:163]
v_mfma_f32_16x16x32_bf16 v[160:163], a[220:223], a[152:155], v[160:163]
v_mfma_f32_16x16x32_bf16 v[192:195], a[220:223], a[148:151], v[192:195]
v_mfma_f32_16x16x32_bf16 v[192:195], a[200:203], a[144:147], v[192:195]
ds_read_b128 a[64:67], v3 offset:16384
v_mfma_f32_16x16x32_bf16 v[224:227], a[200:203], a[140:143], v[224:227]
v_mfma_f32_16x16x32_bf16 v[224:227], a[220:223], a[136:139], v[224:227]
ds_read_b128 a[68:71], v3 offset:17408
v_mfma_f32_16x16x32_bf16 a[232:235], a[220:223], a[132:135], a[232:235]
global_load_dwordx4 a[220:223], v0, s[72:73] offset:3072
v_mfma_f32_16x16x32_bf16 a[232:235], a[200:203], a[128:131], a[232:235]
s_waitcnt vmcnt(11)
v_mfma_f32_16x16x32_bf16 a[236:239], a[204:207], a[128:131], a[236:239]
ds_read_b128 a[72:75], v3 offset:18432
v_mfma_f32_16x16x32_bf16 a[236:239], a[228:231], a[132:135], a[236:239]
v_mfma_f32_16x16x32_bf16 v[228:231], a[228:231], a[136:139], v[228:231]
global_load_dwordx4 a[200:203], v0, s[74:75] offset:3072
v_mfma_f32_16x16x32_bf16 v[228:231], a[204:207], a[140:143], v[228:231]
s_xor_b32 s72, s64, 118784
s_add_u32 s72, s72, s12
s_addc_u32 s73, s13, 0
v_mfma_f32_16x16x32_bf16 v[196:199], a[204:207], a[144:147], v[196:199]
v_mfma_f32_16x16x32_bf16 v[196:199], a[228:231], a[148:151], v[196:199]
ds_read_b128 a[76:79], v3 offset:19456
v_mfma_f32_16x16x32_bf16 v[164:167], a[228:231], a[152:155], v[164:167]
s_xor_b32 s74, s64, 126976
s_add_u32 s74, s74, s12
s_addc_u32 s75, s13, 0
v_mfma_f32_16x16x32_bf16 v[164:167], a[204:207], a[156:159], v[164:167]
v_mfma_f32_16x16x32_bf16 v[132:135], a[204:207], a[160:163], v[132:135]
ds_read_b128 a[80:83], v3 offset:20480
v_mfma_f32_16x16x32_bf16 v[132:135], a[228:231], a[164:167], v[132:135]
v_mfma_f32_16x16x32_bf16 v[100:103], a[228:231], a[168:171], v[100:103]
ds_read_b128 a[84:87], v3 offset:21504
v_mfma_f32_16x16x32_bf16 v[100:103], a[204:207], a[172:175], v[100:103]
v_mfma_f32_16x16x32_bf16 v[68:71], a[204:207], a[176:179], v[68:71]
ds_read_b128 a[88:91], v3 offset:22528
v_mfma_f32_16x16x32_bf16 v[68:71], a[228:231], a[180:183], v[68:71]
v_mfma_f32_16x16x32_bf16 v[36:39], a[228:231], a[184:187], v[36:39]
global_load_dwordx4 a[228:231], v0, s[72:73] offset:-4096
v_mfma_f32_16x16x32_bf16 v[36:39], a[204:207], a[188:191], v[36:39]
s_waitcnt vmcnt(11)
v_mfma_f32_16x16x32_bf16 v[40:43], a[196:199], a[188:191], v[40:43]
ds_read_b128 a[92:95], v3 offset:23552
v_mfma_f32_16x16x32_bf16 v[40:43], a[224:227], a[184:187], v[40:43]
v_mfma_f32_16x16x32_bf16 v[72:75], a[224:227], a[180:183], v[72:75]
global_load_dwordx4 a[204:207], v0, s[74:75] offset:-4096
v_mfma_f32_16x16x32_bf16 v[72:75], a[196:199], a[176:179], v[72:75]
ds_read_b128 a[96:99], v3 offset:24576
v_mfma_f32_16x16x32_bf16 v[104:107], a[196:199], a[172:175], v[104:107]
v_mfma_f32_16x16x32_bf16 v[104:107], a[224:227], a[168:171], v[104:107]
ds_read_b128 a[100:103], v3 offset:25600
v_mfma_f32_16x16x32_bf16 v[136:139], a[224:227], a[164:167], v[136:139]
v_mfma_f32_16x16x32_bf16 v[136:139], a[196:199], a[160:163], v[136:139]
ds_read_b128 a[104:107], v3 offset:26624
v_mfma_f32_16x16x32_bf16 v[168:171], a[196:199], a[156:159], v[168:171]
v_mfma_f32_16x16x32_bf16 v[168:171], a[224:227], a[152:155], v[168:171]
ds_read_b128 a[108:111], v3 offset:27648
v_mfma_f32_16x16x32_bf16 v[200:203], a[224:227], a[148:151], v[200:203]
v_mfma_f32_16x16x32_bf16 v[200:203], a[196:199], a[144:147], v[200:203]
ds_read_b128 a[112:115], v3 offset:28672
v_mfma_f32_16x16x32_bf16 v[232:235], a[196:199], a[140:143], v[232:235]
v_mfma_f32_16x16x32_bf16 v[232:235], a[224:227], a[136:139], v[232:235]
v_mfma_f32_16x16x32_bf16 a[240:243], a[224:227], a[132:135], a[240:243]
global_load_dwordx4 a[224:227], v0, s[72:73] offset:-3072
v_mfma_f32_16x16x32_bf16 a[240:243], a[196:199], a[128:131], a[240:243]
ds_read_b128 a[116:119], v3 offset:29696
s_waitcnt vmcnt(10)
v_mfma_f32_16x16x32_bf16 a[244:247], a[212:215], a[128:131], a[244:247]
v_mfma_f32_16x16x32_bf16 a[244:247], a[216:219], a[132:135], a[244:247]
ds_read_b128 a[120:123], v3 offset:30720
v_mfma_f32_16x16x32_bf16 v[236:239], a[216:219], a[136:139], v[236:239]
global_load_dwordx4 a[196:199], v0, s[74:75] offset:-3072
v_mfma_f32_16x16x32_bf16 v[236:239], a[212:215], a[140:143], v[236:239]
v_mfma_f32_16x16x32_bf16 v[204:207], a[212:215], a[144:147], v[204:207]
ds_read_b128 a[124:127], v3 offset:31744
v_mfma_f32_16x16x32_bf16 v[204:207], a[216:219], a[148:151], v[204:207]
v_mfma_f32_16x16x32_bf16 v[172:175], a[216:219], a[152:155], v[172:175]
v_mfma_f32_16x16x32_bf16 v[172:175], a[212:215], a[156:159], v[172:175]
v_mfma_f32_16x16x32_bf16 v[140:143], a[212:215], a[160:163], v[140:143]
v_mfma_f32_16x16x32_bf16 v[140:143], a[216:219], a[164:167], v[140:143]
v_mfma_f32_16x16x32_bf16 v[108:111], a[216:219], a[168:171], v[108:111]
v_mfma_f32_16x16x32_bf16 v[108:111], a[212:215], a[172:175], v[108:111]
v_mfma_f32_16x16x32_bf16 v[76:79], a[212:215], a[176:179], v[76:79]
v_mfma_f32_16x16x32_bf16 v[76:79], a[216:219], a[180:183], v[76:79]
v_mfma_f32_16x16x32_bf16 v[44:47], a[216:219], a[184:187], v[44:47]
global_load_dwordx4 a[216:219], v0, s[72:73] offset:-2048
v_mfma_f32_16x16x32_bf16 v[44:47], a[212:215], a[188:191], v[44:47]
s_waitcnt vmcnt(7)
v_mfma_f32_16x16x32_bf16 v[48:51], a[192:195], a[188:191], v[48:51]
v_mfma_f32_16x16x32_bf16 v[48:51], a[208:211], a[184:187], v[48:51]
v_mfma_f32_16x16x32_bf16 v[80:83], a[208:211], a[180:183], v[80:83]
global_load_dwordx4 a[212:215], v0, s[74:75] offset:-2048
v_mfma_f32_16x16x32_bf16 v[80:83], a[192:195], a[176:179], v[80:83]
v_mfma_f32_16x16x32_bf16 v[112:115], a[192:195], a[172:175], v[112:115]
v_mfma_f32_16x16x32_bf16 v[112:115], a[208:211], a[168:171], v[112:115]
v_mfma_f32_16x16x32_bf16 v[144:147], a[208:211], a[164:167], v[144:147]
v_mfma_f32_16x16x32_bf16 v[144:147], a[192:195], a[160:163], v[144:147]
v_mfma_f32_16x16x32_bf16 v[176:179], a[192:195], a[156:159], v[176:179]
v_mfma_f32_16x16x32_bf16 v[176:179], a[208:211], a[152:155], v[176:179]
v_mfma_f32_16x16x32_bf16 v[208:211], a[208:211], a[148:151], v[208:211]
v_mfma_f32_16x16x32_bf16 v[208:211], a[192:195], a[144:147], v[208:211]
v_mfma_f32_16x16x32_bf16 v[240:243], a[192:195], a[140:143], v[240:243]
v_mfma_f32_16x16x32_bf16 v[240:243], a[208:211], a[136:139], v[240:243]
v_mfma_f32_16x16x32_bf16 a[248:251], a[208:211], a[132:135], a[248:251]
global_load_dwordx4 a[208:211], v0, s[72:73] offset:-1024
v_mfma_f32_16x16x32_bf16 a[248:251], a[192:195], a[128:131], a[248:251]
v_add_u32 v2, 65536, v1
s_waitcnt vmcnt(7)
v_mfma_f32_16x16x32_bf16 a[252:255], a[220:223], a[128:131], a[252:255]
ds_read_b128 a[128:131], v2 offset:49152
v_mfma_f32_16x16x32_bf16 a[252:255], a[200:203], a[132:135], a[252:255]
ds_read_b128 a[132:135], v2 offset:57344
v_mfma_f32_16x16x32_bf16 v[244:247], a[200:203], a[136:139], v[244:247]
ds_read_b128 a[136:139], v2 offset:58368
v_mfma_f32_16x16x32_bf16 v[244:247], a[220:223], a[140:143], v[244:247]
ds_read_b128 a[140:143], v2 offset:50176
v_mfma_f32_16x16x32_bf16 v[212:215], a[220:223], a[144:147], v[212:215]
ds_read_b128 a[144:147], v2 offset:51200
v_mfma_f32_16x16x32_bf16 v[212:215], a[200:203], a[148:151], v[212:215]
ds_read_b128 a[148:151], v2 offset:59392
v_mfma_f32_16x16x32_bf16 v[180:183], a[200:203], a[152:155], v[180:183]
ds_read_b128 a[152:155], v2 offset:60416
v_mfma_f32_16x16x32_bf16 v[180:183], a[220:223], a[156:159], v[180:183]
ds_read_b128 a[156:159], v2 offset:52224
v_mfma_f32_16x16x32_bf16 v[148:151], a[220:223], a[160:163], v[148:151]
ds_read_b128 a[160:163], v2 offset:53248
v_mfma_f32_16x16x32_bf16 v[148:151], a[200:203], a[164:167], v[148:151]
ds_read_b128 a[164:167], v2 offset:61440
v_mfma_f32_16x16x32_bf16 v[116:119], a[200:203], a[168:171], v[116:119]
ds_read_b128 a[168:171], v2 offset:62464
v_mfma_f32_16x16x32_bf16 v[116:119], a[220:223], a[172:175], v[116:119]
ds_read_b128 a[172:175], v2 offset:54272
v_mfma_f32_16x16x32_bf16 v[84:87], a[220:223], a[176:179], v[84:87]
ds_read_b128 a[176:179], v2 offset:55296
v_mfma_f32_16x16x32_bf16 v[84:87], a[200:203], a[180:183], v[84:87]
ds_read_b128 a[180:183], v2 offset:63488
v_mfma_f32_16x16x32_bf16 v[52:55], a[200:203], a[184:187], v[52:55]
ds_read_b128 a[184:187], v2 offset:64512
v_mfma_f32_16x16x32_bf16 v[52:55], a[220:223], a[188:191], v[52:55]
ds_read_b128 a[188:191], v2 offset:56320
s_waitcnt vmcnt(5) lgkmcnt(12)
v_mfma_f32_16x16x32_bf16 v[24:27], a[228:231], a[128:131], v[24:27]
global_load_dwordx4 a[192:195], v0, s[74:75] offset:-1024
v_mfma_f32_16x16x32_bf16 v[24:27], a[204:207], a[132:135], v[24:27]
s_xor_b32 s72, s64, 249856
s_add_u32 s72, s72, s12
s_addc_u32 s73, s13, 0
v_mfma_f32_16x16x32_bf16 v[56:59], a[204:207], a[136:139], v[56:59]
s_xor_b32 s74, s64, 258048
s_add_u32 s74, s74, s12
s_addc_u32 s75, s13, 0
v_mfma_f32_16x16x32_bf16 v[56:59], a[228:231], a[140:143], v[56:59]
s_waitcnt lgkmcnt(8)
v_mfma_f32_16x16x32_bf16 v[88:91], a[228:231], a[144:147], v[88:91]
global_load_dwordx4 a[200:203], v0, s[72:73] offset:-4096
v_mfma_f32_16x16x32_bf16 v[88:91], a[204:207], a[148:151], v[88:91]
v_mfma_f32_16x16x32_bf16 v[120:123], a[204:207], a[152:155], v[120:123]
v_mfma_f32_16x16x32_bf16 v[120:123], a[228:231], a[156:159], v[120:123]
s_waitcnt lgkmcnt(4)
v_mfma_f32_16x16x32_bf16 v[152:155], a[228:231], a[160:163], v[152:155]
global_load_dwordx4 a[220:223], v0, s[74:75] offset:-4096
v_mfma_f32_16x16x32_bf16 v[152:155], a[204:207], a[164:167], v[152:155]
v_mfma_f32_16x16x32_bf16 v[184:187], a[204:207], a[168:171], v[184:187]
v_mfma_f32_16x16x32_bf16 v[184:187], a[228:231], a[172:175], v[184:187]
s_waitcnt lgkmcnt(0)
v_mfma_f32_16x16x32_bf16 v[216:219], a[228:231], a[176:179], v[216:219]
s_barrier
v_mfma_f32_16x16x32_bf16 v[216:219], a[204:207], a[180:183], v[216:219]
v_mfma_f32_16x16x32_bf16 v[248:251], a[204:207], a[184:187], v[248:251]
global_load_dwordx4 a[204:207], v0, s[72:73] offset:-3072
v_mfma_f32_16x16x32_bf16 v[248:251], a[228:231], a[188:191], v[248:251]
s_waitcnt vmcnt(7)
v_mfma_f32_16x16x32_bf16 v[252:255], a[224:227], a[188:191], v[252:255]
v_mfma_f32_16x16x32_bf16 v[252:255], a[196:199], a[184:187], v[252:255]
v_mfma_f32_16x16x32_bf16 v[220:223], a[196:199], a[180:183], v[220:223]
global_load_dwordx4 a[228:231], v0, s[74:75] offset:-3072
v_mfma_f32_16x16x32_bf16 v[220:223], a[224:227], a[176:179], v[220:223]
v_mfma_f32_16x16x32_bf16 v[188:191], a[224:227], a[172:175], v[188:191]
v_mfma_f32_16x16x32_bf16 v[188:191], a[196:199], a[168:171], v[188:191]
v_mfma_f32_16x16x32_bf16 v[156:159], a[196:199], a[164:167], v[156:159]
v_mfma_f32_16x16x32_bf16 v[156:159], a[224:227], a[160:163], v[156:159]
v_mfma_f32_16x16x32_bf16 v[124:127], a[224:227], a[156:159], v[124:127]
v_mfma_f32_16x16x32_bf16 v[124:127], a[196:199], a[152:155], v[124:127]
v_mfma_f32_16x16x32_bf16 v[92:95], a[196:199], a[148:151], v[92:95]
v_mfma_f32_16x16x32_bf16 v[92:95], a[224:227], a[144:147], v[92:95]
v_mfma_f32_16x16x32_bf16 v[60:63], a[224:227], a[140:143], v[60:63]
v_mfma_f32_16x16x32_bf16 v[60:63], a[196:199], a[136:139], v[60:63]
v_mfma_f32_16x16x32_bf16 v[28:31], a[196:199], a[132:135], v[28:31]
global_load_dwordx4 a[196:199], v0, s[72:73] offset:-2048
v_mfma_f32_16x16x32_bf16 v[28:31], a[224:227], a[128:131], v[28:31]
s_waitcnt vmcnt(7)
v_mfma_f32_16x16x32_bf16 v[32:35], a[216:219], a[128:131], v[32:35]
v_mfma_f32_16x16x32_bf16 v[32:35], a[212:215], a[132:135], v[32:35]
v_mfma_f32_16x16x32_bf16 v[64:67], a[212:215], a[136:139], v[64:67]
global_load_dwordx4 a[224:227], v0, s[74:75] offset:-2048
v_mfma_f32_16x16x32_bf16 v[64:67], a[216:219], a[140:143], v[64:67]
v_mfma_f32_16x16x32_bf16 v[96:99], a[216:219], a[144:147], v[96:99]
v_mfma_f32_16x16x32_bf16 v[96:99], a[212:215], a[148:151], v[96:99]
v_mfma_f32_16x16x32_bf16 v[128:131], a[212:215], a[152:155], v[128:131]
v_mfma_f32_16x16x32_bf16 v[128:131], a[216:219], a[156:159], v[128:131]
v_mfma_f32_16x16x32_bf16 v[160:163], a[216:219], a[160:163], v[160:163]
v_mfma_f32_16x16x32_bf16 v[160:163], a[212:215], a[164:167], v[160:163]
v_mfma_f32_16x16x32_bf16 v[192:195], a[212:215], a[168:171], v[192:195]
v_mfma_f32_16x16x32_bf16 v[192:195], a[216:219], a[172:175], v[192:195]
v_mfma_f32_16x16x32_bf16 v[224:227], a[216:219], a[176:179], v[224:227]
v_mfma_f32_16x16x32_bf16 v[224:227], a[212:215], a[180:183], v[224:227]
v_mfma_f32_16x16x32_bf16 a[232:235], a[212:215], a[184:187], a[232:235]
global_load_dwordx4 a[212:215], v0, s[72:73] offset:-1024
v_mfma_f32_16x16x32_bf16 a[232:235], a[216:219], a[188:191], a[232:235]
v_add_u32 v2, 131072, v1
s_waitcnt vmcnt(7)
v_mfma_f32_16x16x32_bf16 a[236:239], a[208:211], a[188:191], a[236:239]
ds_read_b128 a[188:191], v2 offset:0
v_mfma_f32_16x16x32_bf16 a[236:239], a[192:195], a[184:187], a[236:239]
ds_read_b128 a[184:187], v2 offset:8192
v_mfma_f32_16x16x32_bf16 v[228:231], a[192:195], a[180:183], v[228:231]
ds_read_b128 a[180:183], v2 offset:9216
v_mfma_f32_16x16x32_bf16 v[228:231], a[208:211], a[176:179], v[228:231]
ds_read_b128 a[176:179], v2 offset:1024
v_mfma_f32_16x16x32_bf16 v[196:199], a[208:211], a[172:175], v[196:199]
ds_read_b128 a[172:175], v2 offset:2048
v_mfma_f32_16x16x32_bf16 v[196:199], a[192:195], a[168:171], v[196:199]
ds_read_b128 a[168:171], v2 offset:10240
v_mfma_f32_16x16x32_bf16 v[164:167], a[192:195], a[164:167], v[164:167]
ds_read_b128 a[164:167], v2 offset:11264
v_mfma_f32_16x16x32_bf16 v[164:167], a[208:211], a[160:163], v[164:167]
ds_read_b128 a[160:163], v2 offset:3072
v_mfma_f32_16x16x32_bf16 v[132:135], a[208:211], a[156:159], v[132:135]
ds_read_b128 a[156:159], v2 offset:4096
v_mfma_f32_16x16x32_bf16 v[132:135], a[192:195], a[152:155], v[132:135]
ds_read_b128 a[152:155], v2 offset:12288
v_mfma_f32_16x16x32_bf16 v[100:103], a[192:195], a[148:151], v[100:103]
ds_read_b128 a[148:151], v2 offset:13312
v_mfma_f32_16x16x32_bf16 v[100:103], a[208:211], a[144:147], v[100:103]
ds_read_b128 a[144:147], v2 offset:5120
v_mfma_f32_16x16x32_bf16 v[68:71], a[208:211], a[140:143], v[68:71]
ds_read_b128 a[140:143], v2 offset:6144
v_mfma_f32_16x16x32_bf16 v[68:71], a[192:195], a[136:139], v[68:71]
ds_read_b128 a[136:139], v2 offset:14336
v_mfma_f32_16x16x32_bf16 v[36:39], a[192:195], a[132:135], v[36:39]
ds_read_b128 a[132:135], v2 offset:15360
v_mfma_f32_16x16x32_bf16 v[36:39], a[208:211], a[128:131], v[36:39]
ds_read_b128 a[128:131], v2 offset:7168
s_waitcnt vmcnt(5) lgkmcnt(12)
v_mfma_f32_16x16x32_bf16 v[24:27], a[200:203], a[188:191], v[24:27]
global_load_dwordx4 a[216:219], v0, s[74:75] offset:-1024
v_mfma_f32_16x16x32_bf16 v[24:27], a[220:223], a[184:187], v[24:27]
v_mfma_f32_16x16x32_bf16 v[56:59], a[220:223], a[180:183], v[56:59]
v_mfma_f32_16x16x32_bf16 v[56:59], a[200:203], a[176:179], v[56:59]
s_waitcnt lgkmcnt(8)
v_mfma_f32_16x16x32_bf16 v[88:91], a[200:203], a[172:175], v[88:91]
global_load_dwordx4 a[192:195], v0, s[72:73] offset:0
v_mfma_f32_16x16x32_bf16 v[88:91], a[220:223], a[168:171], v[88:91]
v_mfma_f32_16x16x32_bf16 v[120:123], a[220:223], a[164:167], v[120:123]
v_mfma_f32_16x16x32_bf16 v[120:123], a[200:203], a[160:163], v[120:123]
s_waitcnt lgkmcnt(4)
v_mfma_f32_16x16x32_bf16 v[152:155], a[200:203], a[156:159], v[152:155]
global_load_dwordx4 a[208:211], v0, s[74:75] offset:0
v_mfma_f32_16x16x32_bf16 v[152:155], a[220:223], a[152:155], v[152:155]
v_mfma_f32_16x16x32_bf16 v[184:187], a[220:223], a[148:151], v[184:187]
v_mfma_f32_16x16x32_bf16 v[184:187], a[200:203], a[144:147], v[184:187]
s_waitcnt lgkmcnt(0)
v_mfma_f32_16x16x32_bf16 v[216:219], a[200:203], a[140:143], v[216:219]
s_barrier
v_mfma_f32_16x16x32_bf16 v[216:219], a[220:223], a[136:139], v[216:219]
v_mfma_f32_16x16x32_bf16 v[248:251], a[220:223], a[132:135], v[248:251]
global_load_dwordx4 a[220:223], v0, s[72:73] offset:1024
v_mfma_f32_16x16x32_bf16 v[248:251], a[200:203], a[128:131], v[248:251]
s_waitcnt vmcnt(7)
v_mfma_f32_16x16x32_bf16 v[252:255], a[204:207], a[128:131], v[252:255]
v_mfma_f32_16x16x32_bf16 v[252:255], a[228:231], a[132:135], v[252:255]
v_mfma_f32_16x16x32_bf16 v[220:223], a[228:231], a[136:139], v[220:223]
global_load_dwordx4 a[200:203], v0, s[74:75] offset:1024
v_mfma_f32_16x16x32_bf16 v[220:223], a[204:207], a[140:143], v[220:223]
v_mfma_f32_16x16x32_bf16 v[188:191], a[204:207], a[144:147], v[188:191]
v_mfma_f32_16x16x32_bf16 v[188:191], a[228:231], a[148:151], v[188:191]
v_mfma_f32_16x16x32_bf16 v[156:159], a[228:231], a[152:155], v[156:159]
v_mfma_f32_16x16x32_bf16 v[156:159], a[204:207], a[156:159], v[156:159]
v_mfma_f32_16x16x32_bf16 v[124:127], a[204:207], a[160:163], v[124:127]
v_mfma_f32_16x16x32_bf16 v[124:127], a[228:231], a[164:167], v[124:127]
v_mfma_f32_16x16x32_bf16 v[92:95], a[228:231], a[168:171], v[92:95]
v_mfma_f32_16x16x32_bf16 v[92:95], a[204:207], a[172:175], v[92:95]
v_mfma_f32_16x16x32_bf16 v[60:63], a[204:207], a[176:179], v[60:63]
v_mfma_f32_16x16x32_bf16 v[60:63], a[228:231], a[180:183], v[60:63]
v_mfma_f32_16x16x32_bf16 v[28:31], a[228:231], a[184:187], v[28:31]
global_load_dwordx4 a[228:231], v0, s[72:73] offset:2048
v_mfma_f32_16x16x32_bf16 v[28:31], a[204:207], a[188:191], v[28:31]
s_waitcnt vmcnt(7)
v_mfma_f32_16x16x32_bf16 v[32:35], a[196:199], a[188:191], v[32:35]
v_mfma_f32_16x16x32_bf16 v[32:35], a[224:227], a[184:187], v[32:35]
v_mfma_f32_16x16x32_bf16 v[64:67], a[224:227], a[180:183], v[64:67]
global_load_dwordx4 a[204:207], v0, s[74:75] offset:2048
v_mfma_f32_16x16x32_bf16 v[64:67], a[196:199], a[176:179], v[64:67]
v_mfma_f32_16x16x32_bf16 v[96:99], a[196:199], a[172:175], v[96:99]
v_mfma_f32_16x16x32_bf16 v[96:99], a[224:227], a[168:171], v[96:99]
v_mfma_f32_16x16x32_bf16 v[128:131], a[224:227], a[164:167], v[128:131]
v_mfma_f32_16x16x32_bf16 v[128:131], a[196:199], a[160:163], v[128:131]
v_mfma_f32_16x16x32_bf16 v[160:163], a[196:199], a[156:159], v[160:163]
v_mfma_f32_16x16x32_bf16 v[160:163], a[224:227], a[152:155], v[160:163]
v_mfma_f32_16x16x32_bf16 v[192:195], a[224:227], a[148:151], v[192:195]
v_mfma_f32_16x16x32_bf16 v[192:195], a[196:199], a[144:147], v[192:195]
v_mfma_f32_16x16x32_bf16 v[224:227], a[196:199], a[140:143], v[224:227]
v_accvgpr_read_b32 v9, a0
v_accvgpr_read_b32 v11, a1
v_mfma_f32_16x16x32_bf16 v[224:227], a[224:227], a[136:139], v[224:227]
v_lshlrev_b32 v8, 16, v9
v_mfma_f32_16x16x32_bf16 a[232:235], a[224:227], a[132:135], a[232:235]
global_load_dwordx4 a[224:227], v0, s[72:73] offset:3072
v_mfma_f32_16x16x32_bf16 a[232:235], a[196:199], a[128:131], a[232:235]
v_lshlrev_b32 v10, 16, v11
s_waitcnt vmcnt(7)
v_mfma_f32_16x16x32_bf16 a[236:239], a[212:215], a[128:131], a[236:239]
v_and_b32 v9, s53, v9
v_and_b32 v11, s53, v11
v_mfma_f32_16x16x32_bf16 a[236:239], a[216:219], a[132:135], a[236:239]
v_accvgpr_read_b32 v13, a2
v_mfma_f32_16x16x32_bf16 v[228:231], a[216:219], a[136:139], v[228:231]
global_load_dwordx4 a[196:199], v0, s[74:75] offset:3072
v_mfma_f32_16x16x32_bf16 v[228:231], a[212:215], a[140:143], v[228:231]
s_xor_b32 s72, s64, 4096
s_add_u32 s72, s72, s12
s_addc_u32 s73, s13, 0
v_mfma_f32_16x16x32_bf16 v[196:199], a[212:215], a[144:147], v[196:199]
v_accvgpr_read_b32 v15, a3
v_lshlrev_b32 v12, 16, v13
v_mfma_f32_16x16x32_bf16 v[196:199], a[216:219], a[148:151], v[196:199]
v_lshlrev_b32 v14, 16, v15
v_mfma_f32_16x16x32_bf16 v[164:167], a[216:219], a[152:155], v[164:167]
s_xor_b32 s74, s64, 12288
s_add_u32 s74, s74, s12
s_addc_u32 s75, s13, 0
v_mfma_f32_16x16x32_bf16 v[164:167], a[212:215], a[156:159], v[164:167]
v_and_b32 v13, s53, v13
v_and_b32 v15, s53, v15
v_mfma_f32_16x16x32_bf16 v[132:135], a[212:215], a[160:163], v[132:135]
s_add_u32 s54, s57, 65536
v_add_u32 v3, s54, v0
v_mfma_f32_16x16x32_bf16 v[132:135], a[216:219], a[164:167], v[132:135]
v_mul_f32 v8, v8, v24
v_mul_f32 v9, v9, v25
v_mfma_f32_16x16x32_bf16 v[100:103], a[216:219], a[168:171], v[100:103]
v_mul_f32 v10, v10, v26
v_mfma_f32_16x16x32_bf16 v[100:103], a[212:215], a[172:175], v[100:103]
v_mul_f32 v11, v11, v27
v_cvt_pk_bf16_f32 v16, v8, v9
v_mfma_f32_16x16x32_bf16 v[68:71], a[212:215], a[176:179], v[68:71]
v_cvt_pk_bf16_f32 v17, v10, v11
v_accvgpr_read_b32 v9, a4
v_mfma_f32_16x16x32_bf16 v[68:71], a[216:219], a[180:183], v[68:71]
v_accvgpr_read_b32 v11, a5
v_mfma_f32_16x16x32_bf16 v[36:39], a[216:219], a[184:187], v[36:39]
global_load_dwordx4 a[216:219], v0, s[72:73] offset:0
v_mfma_f32_16x16x32_bf16 v[36:39], a[212:215], a[188:191], v[36:39]
v_lshlrev_b32 v8, 16, v9
s_waitcnt vmcnt(7)
v_mfma_f32_16x16x32_bf16 v[40:43], a[192:195], a[188:191], v[40:43]
v_lshlrev_b32 v10, 16, v11
v_and_b32 v9, s53, v9
v_mfma_f32_16x16x32_bf16 v[40:43], a[208:211], a[184:187], v[40:43]
v_and_b32 v11, s53, v11
v_mfma_f32_16x16x32_bf16 v[72:75], a[208:211], a[180:183], v[72:75]
global_load_dwordx4 a[212:215], v0, s[74:75] offset:0
v_mfma_f32_16x16x32_bf16 v[72:75], a[192:195], a[176:179], v[72:75]
v_mul_f32 v12, v12, v28
v_mfma_f32_16x16x32_bf16 v[104:107], a[192:195], a[172:175], v[104:107]
v_mul_f32 v13, v13, v29
v_mul_f32 v14, v14, v30
v_mfma_f32_16x16x32_bf16 v[104:107], a[208:211], a[168:171], v[104:107]
v_mul_f32 v15, v15, v31
v_cvt_pk_bf16_f32 v18, v12, v13
v_mfma_f32_16x16x32_bf16 v[136:139], a[208:211], a[164:167], v[136:139]
v_cvt_pk_bf16_f32 v19, v14, v15
v_mfma_f32_16x16x32_bf16 v[136:139], a[192:195], a[160:163], v[136:139]
v_accvgpr_read_b32 v13, a6
v_accvgpr_read_b32 v15, a7
v_mfma_f32_16x16x32_bf16 v[168:171], a[192:195], a[156:159], v[168:171]
v_lshlrev_b32 v12, 16, v13
v_lshlrev_b32 v14, 16, v15
v_mfma_f32_16x16x32_bf16 v[168:171], a[208:211], a[152:155], v[168:171]
v_and_b32 v13, s53, v13
v_mfma_f32_16x16x32_bf16 v[200:203], a[208:211], a[148:151], v[200:203]
v_and_b32 v15, s53, v15
v_mfma_f32_16x16x32_bf16 v[200:203], a[192:195], a[144:147], v[200:203]
ds_write_b128 v3, v[16:19] offset:0
v_mfma_f32_16x16x32_bf16 v[232:235], a[192:195], a[140:143], v[232:235]
v_mul_f32 v8, v8, v56
v_mul_f32 v9, v9, v57
v_mfma_f32_16x16x32_bf16 v[232:235], a[208:211], a[136:139], v[232:235]
v_mul_f32 v10, v10, v58
v_mfma_f32_16x16x32_bf16 a[240:243], a[208:211], a[132:135], a[240:243]
global_load_dwordx4 a[208:211], v0, s[72:73] offset:1024
v_mfma_f32_16x16x32_bf16 a[240:243], a[192:195], a[128:131], a[240:243]
v_mul_f32 v11, v11, v59
v_cvt_pk_bf16_f32 v20, v8, v9
s_waitcnt vmcnt(7)
v_mfma_f32_16x16x32_bf16 a[244:247], a[220:223], a[128:131], a[244:247]
v_cvt_pk_bf16_f32 v21, v10, v11
v_mfma_f32_16x16x32_bf16 a[244:247], a[200:203], a[132:135], a[244:247]
v_accvgpr_read_b32 v9, a8
v_mfma_f32_16x16x32_bf16 v[236:239], a[200:203], a[136:139], v[236:239]
global_load_dwordx4 a[192:195], v0, s[74:75] offset:1024
v_mfma_f32_16x16x32_bf16 v[236:239], a[220:223], a[140:143], v[236:239]
v_accvgpr_read_b32 v11, a9
v_lshlrev_b32 v8, 16, v9
v_mfma_f32_16x16x32_bf16 v[204:207], a[220:223], a[144:147], v[204:207]
v_lshlrev_b32 v10, 16, v11
v_mfma_f32_16x16x32_bf16 v[204:207], a[200:203], a[148:151], v[204:207]
v_and_b32 v9, s53, v9
v_and_b32 v11, s53, v11
v_mfma_f32_16x16x32_bf16 v[172:175], a[200:203], a[152:155], v[172:175]
s_mov_b32 s60, 0
v_mfma_f32_16x16x32_bf16 v[172:175], a[220:223], a[156:159], v[172:175]
buffer_store_dwordx4 v[16:19], v0, s[24:27], s60 offen offset:0 sc1
v_mfma_f32_16x16x32_bf16 v[140:143], a[220:223], a[160:163], v[140:143]
v_mul_f32 v12, v12, v60
v_mul_f32 v13, v13, v61
v_mfma_f32_16x16x32_bf16 v[140:143], a[200:203], a[164:167], v[140:143]
v_mul_f32 v14, v14, v62
v_mul_f32 v15, v15, v63
v_mfma_f32_16x16x32_bf16 v[108:111], a[200:203], a[168:171], v[108:111]
v_cvt_pk_bf16_f32 v22, v12, v13
v_cvt_pk_bf16_f32 v23, v14, v15
v_mfma_f32_16x16x32_bf16 v[108:111], a[220:223], a[172:175], v[108:111]
v_accvgpr_read_b32 v13, a10
v_mfma_f32_16x16x32_bf16 v[76:79], a[220:223], a[176:179], v[76:79]
v_accvgpr_read_b32 v15, a11
v_lshlrev_b32 v12, 16, v13
v_mfma_f32_16x16x32_bf16 v[76:79], a[200:203], a[180:183], v[76:79]
v_lshlrev_b32 v14, 16, v15
v_mfma_f32_16x16x32_bf16 v[44:47], a[200:203], a[184:187], v[44:47]
global_load_dwordx4 a[200:203], v0, s[72:73] offset:2048
v_mfma_f32_16x16x32_bf16 v[44:47], a[220:223], a[188:191], v[44:47]
v_and_b32 v13, s53, v13
s_waitcnt vmcnt(8)
v_mfma_f32_16x16x32_bf16 v[48:51], a[228:231], a[188:191], v[48:51]
v_and_b32 v15, s53, v15
v_mfma_f32_16x16x32_bf16 v[48:51], a[204:207], a[184:187], v[48:51]
ds_write_b128 v3, v[20:23] offset:1024
v_mfma_f32_16x16x32_bf16 v[80:83], a[204:207], a[180:183], v[80:83]
global_load_dwordx4 a[220:223], v0, s[74:75] offset:2048
v_mfma_f32_16x16x32_bf16 v[80:83], a[228:231], a[176:179], v[80:83]
v_mul_f32 v8, v8, v88
v_mfma_f32_16x16x32_bf16 v[112:115], a[228:231], a[172:175], v[112:115]
v_mul_f32 v9, v9, v89
v_mul_f32 v10, v10, v90
v_mfma_f32_16x16x32_bf16 v[112:115], a[204:207], a[168:171], v[112:115]
v_mul_f32 v11, v11, v91
v_cvt_pk_bf16_f32 v16, v8, v9
v_mfma_f32_16x16x32_bf16 v[144:147], a[204:207], a[164:167], v[144:147]
v_cvt_pk_bf16_f32 v17, v10, v11
v_mfma_f32_16x16x32_bf16 v[144:147], a[228:231], a[160:163], v[144:147]
v_accvgpr_read_b32 v9, a12
v_accvgpr_read_b32 v11, a13
v_mfma_f32_16x16x32_bf16 v[176:179], a[228:231], a[156:159], v[176:179]
v_lshlrev_b32 v8, 16, v9
v_lshlrev_b32 v10, 16, v11
v_mfma_f32_16x16x32_bf16 v[176:179], a[204:207], a[152:155], v[176:179]
v_and_b32 v9, s53, v9
v_and_b32 v11, s53, v11
v_mfma_f32_16x16x32_bf16 v[208:211], a[204:207], a[148:151], v[208:211]
buffer_store_dwordx4 v[20:23], v0, s[24:27], s60 offen offset:1024 sc1
v_mfma_f32_16x16x32_bf16 v[208:211], a[228:231], a[144:147], v[208:211]
v_mfma_f32_16x16x32_bf16 v[240:243], a[228:231], a[140:143], v[240:243]
v_mul_f32 v12, v12, v92
v_mul_f32 v13, v13, v93
v_mfma_f32_16x16x32_bf16 v[240:243], a[204:207], a[136:139], v[240:243]
v_mul_f32 v14, v14, v94
v_mfma_f32_16x16x32_bf16 a[248:251], a[204:207], a[132:135], a[248:251]
global_load_dwordx4 a[204:207], v0, s[72:73] offset:3072
v_mfma_f32_16x16x32_bf16 a[248:251], a[228:231], a[128:131], a[248:251]
v_add_u32 v2, 0, v1
s_waitcnt vmcnt(9)
v_mfma_f32_16x16x32_bf16 a[252:255], a[224:227], a[128:131], a[252:255]
ds_read_b128 a[128:131], v2 offset:0
v_mul_f32 v15, v15, v95
v_mfma_f32_16x16x32_bf16 a[252:255], a[196:199], a[132:135], a[252:255]
ds_read_b128 a[132:135], v2 offset:8192
v_cvt_pk_bf16_f32 v18, v12, v13
v_mfma_f32_16x16x32_bf16 v[244:247], a[196:199], a[136:139], v[244:247]
ds_read_b128 a[136:139], v2 offset:9216
v_cvt_pk_bf16_f32 v19, v14, v15
v_mfma_f32_16x16x32_bf16 v[244:247], a[224:227], a[140:143], v[244:247]
ds_read_b128 a[140:143], v2 offset:1024
v_accvgpr_read_b32 v13, a14
v_mfma_f32_16x16x32_bf16 v[212:215], a[224:227], a[144:147], v[212:215]
ds_read_b128 a[144:147], v2 offset:2048
v_accvgpr_read_b32 v15, a15
v_mfma_f32_16x16x32_bf16 v[212:215], a[196:199], a[148:151], v[212:215]
ds_read_b128 a[148:151], v2 offset:10240
v_mfma_f32_16x16x32_bf16 v[180:183], a[196:199], a[152:155], v[180:183]
ds_read_b128 a[152:155], v2 offset:11264
v_lshlrev_b32 v12, 16, v13
v_mfma_f32_16x16x32_bf16 v[180:183], a[224:227], a[156:159], v[180:183]
ds_read_b128 a[156:159], v2 offset:3072
v_lshlrev_b32 v14, 16, v15
v_mfma_f32_16x16x32_bf16 v[148:151], a[224:227], a[160:163], v[148:151]
ds_read_b128 a[160:163], v2 offset:4096
v_and_b32 v13, s53, v13
v_mfma_f32_16x16x32_bf16 v[148:151], a[196:199], a[164:167], v[148:151]
ds_read_b128 a[164:167], v2 offset:12288
v_and_b32 v15, s53, v15
v_mfma_f32_16x16x32_bf16 v[116:119], a[196:199], a[168:171], v[116:119]
ds_read_b128 a[168:171], v2 offset:13312
v_mfma_f32_16x16x32_bf16 v[116:119], a[224:227], a[172:175], v[116:119]
ds_read_b128 a[172:175], v2 offset:5120
v_mfma_f32_16x16x32_bf16 v[84:87], a[224:227], a[176:179], v[84:87]
ds_read_b128 a[176:179], v2 offset:6144
v_mfma_f32_16x16x32_bf16 v[84:87], a[196:199], a[180:183], v[84:87]
ds_read_b128 a[180:183], v2 offset:14336
v_mul_f32 v8, v8, v120
v_mfma_f32_16x16x32_bf16 v[52:55], a[196:199], a[184:187], v[52:55]
ds_read_b128 a[184:187], v2 offset:15360
v_mul_f32 v9, v9, v121
v_mfma_f32_16x16x32_bf16 v[52:55], a[224:227], a[188:191], v[52:55]
ds_read_b128 a[188:191], v2 offset:7168
s_waitcnt vmcnt(7) lgkmcnt(12)
v_mfma_f32_16x16x32_bf16 v[40:43], a[216:219], a[128:131], v[40:43]
global_load_dwordx4 a[228:231], v0, s[74:75] offset:3072
v_mfma_f32_16x16x32_bf16 v[40:43], a[212:215], a[132:135], v[40:43]
s_xor_b32 s72, s64, 20480
s_add_u32 s72, s72, s12
s_addc_u32 s73, s13, 0
v_mfma_f32_16x16x32_bf16 v[72:75], a[212:215], a[136:139], v[72:75]
s_xor_b32 s74, s64, 28672
s_add_u32 s74, s74, s12
s_addc_u32 s75, s13, 0
v_mfma_f32_16x16x32_bf16 v[72:75], a[216:219], a[140:143], v[72:75]
s_waitcnt lgkmcnt(8)
v_mfma_f32_16x16x32_bf16 v[104:107], a[216:219], a[144:147], v[104:107]
global_load_dwordx4 a[196:199], v0, s[72:73] offset:0
v_mfma_f32_16x16x32_bf16 v[104:107], a[212:215], a[148:151], v[104:107]
ds_write_b128 v3, v[16:19] offset:2048
v_mfma_f32_16x16x32_bf16 v[136:139], a[212:215], a[152:155], v[136:139]
v_mul_f32 v10, v10, v122
v_mul_f32 v11, v11, v123
v_mfma_f32_16x16x32_bf16 v[136:139], a[216:219], a[156:159], v[136:139]
v_cvt_pk_bf16_f32 v20, v8, v9
s_waitcnt lgkmcnt(5)
v_mfma_f32_16x16x32_bf16 v[168:171], a[216:219], a[160:163], v[168:171]
global_load_dwordx4 a[224:227], v0, s[74:75] offset:0
v_mfma_f32_16x16x32_bf16 v[168:171], a[212:215], a[164:167], v[168:171]
v_cvt_pk_bf16_f32 v21, v10, v11
v_accvgpr_read_b32 v9, a16
v_mfma_f32_16x16x32_bf16 v[200:203], a[212:215], a[168:171], v[200:203]
v_accvgpr_read_b32 v11, a17
v_lshlrev_b32 v8, 16, v9
v_mfma_f32_16x16x32_bf16 v[200:203], a[216:219], a[172:175], v[200:203]
v_lshlrev_b32 v10, 16, v11
v_and_b32 v9, s53, v9
s_waitcnt lgkmcnt(1)
v_mfma_f32_16x16x32_bf16 v[232:235], a[216:219], a[176:179], v[232:235]
v_and_b32 v11, s53, v11
v_mfma_f32_16x16x32_bf16 v[232:235], a[212:215], a[180:183], v[232:235]
buffer_store_dwordx4 v[16:19], v0, s[24:27], s60 offen offset:2048 sc1
v_mfma_f32_16x16x32_bf16 a[240:243], a[212:215], a[184:187], a[240:243]
global_load_dwordx4 a[212:215], v0, s[72:73] offset:1024
L_pad6:
s_cbranch_execz L_pad10
v_mfma_f32_16x16x32_bf16 a[240:243], a[216:219], a[188:191], a[240:243]
s_waitcnt vmcnt(10)
v_mfma_f32_16x16x32_bf16 a[244:247], a[208:211], a[188:191], a[244:247]
v_mul_f32 v12, v12, v124
v_mul_f32 v13, v13, v125
v_mfma_f32_16x16x32_bf16 a[244:247], a[192:195], a[184:187], a[244:247]
v_mfma_f32_16x16x32_bf16 v[236:239], a[192:195], a[180:183], v[236:239]
global_load_dwordx4 a[216:219], v0, s[74:75] offset:1024
v_mfma_f32_16x16x32_bf16 v[236:239], a[208:211], a[176:179], v[236:239]
v_mul_f32 v14, v14, v126
v_mul_f32 v15, v15, v127
v_mfma_f32_16x16x32_bf16 v[204:207], a[208:211], a[172:175], v[204:207]
v_cvt_pk_bf16_f32 v22, v12, v13
v_cvt_pk_bf16_f32 v23, v14, v15
v_mfma_f32_16x16x32_bf16 v[204:207], a[192:195], a[168:171], v[204:207]
v_accvgpr_read_b32 v13, a18
v_mfma_f32_16x16x32_bf16 v[172:175], a[192:195], a[164:167], v[172:175]
v_accvgpr_read_b32 v15, a19
v_lshlrev_b32 v12, 16, v13
v_mfma_f32_16x16x32_bf16 v[172:175], a[208:211], a[160:163], v[172:175]
v_lshlrev_b32 v14, 16, v15
v_and_b32 v13, s53, v13
v_mfma_f32_16x16x32_bf16 v[140:143], a[208:211], a[156:159], v[140:143]
v_and_b32 v15, s53, v15
v_mfma_f32_16x16x32_bf16 v[140:143], a[192:195], a[152:155], v[140:143]
ds_write_b128 v3, v[20:23] offset:3072
v_mfma_f32_16x16x32_bf16 v[108:111], a[192:195], a[148:151], v[108:111]
v_mul_f32 v8, v8, v152
v_mul_f32 v9, v9, v153
v_mfma_f32_16x16x32_bf16 v[108:111], a[208:211], a[144:147], v[108:111]
v_mul_f32 v10, v10, v154
v_mul_f32 v11, v11, v155
v_mfma_f32_16x16x32_bf16 v[76:79], a[208:211], a[140:143], v[76:79]
v_cvt_pk_bf16_f32 v16, v8, v9
v_mfma_f32_16x16x32_bf16 v[76:79], a[192:195], a[136:139], v[76:79]
v_cvt_pk_bf16_f32 v17, v10, v11
v_mfma_f32_16x16x32_bf16 v[44:47], a[192:195], a[132:135], v[44:47]
global_load_dwordx4 a[192:195], v0, s[72:73] offset:2048
v_mfma_f32_16x16x32_bf16 v[44:47], a[208:211], a[128:131], v[44:47]
v_accvgpr_read_b32 v9, a20
s_waitcnt vmcnt(9)
v_mfma_f32_16x16x32_bf16 v[48:51], a[200:203], a[128:131], v[48:51]
v_accvgpr_read_b32 v11, a21
v_lshlrev_b32 v8, 16, v9
v_mfma_f32_16x16x32_bf16 v[48:51], a[220:223], a[132:135], v[48:51]
v_lshlrev_b32 v10, 16, v11
v_mfma_f32_16x16x32_bf16 v[80:83], a[220:223], a[136:139], v[80:83]
global_load_dwordx4 a[208:211], v0, s[74:75] offset:2048
v_mfma_f32_16x16x32_bf16 v[80:83], a[200:203], a[140:143], v[80:83]
v_and_b32 v9, s53, v9
v_and_b32 v11, s53, v11
v_mfma_f32_16x16x32_bf16 v[112:115], a[200:203], a[144:147], v[112:115]
buffer_store_dwordx4 v[20:23], v0, s[24:27], s60 offen offset:3072 sc1
v_mfma_f32_16x16x32_bf16 v[112:115], a[220:223], a[148:151], v[112:115]
v_mfma_f32_16x16x32_bf16 v[144:147], a[220:223], a[152:155], v[144:147]
v_mul_f32 v12, v12, v156
v_mul_f32 v13, v13, v157
v_mfma_f32_16x16x32_bf16 v[144:147], a[200:203], a[156:159], v[144:147]
v_mul_f32 v14, v14, v158
v_mul_f32 v15, v15, v159
v_mfma_f32_16x16x32_bf16 v[176:179], a[200:203], a[160:163], v[176:179]
v_cvt_pk_bf16_f32 v18, v12, v13
v_cvt_pk_bf16_f32 v19, v14, v15
v_mfma_f32_16x16x32_bf16 v[176:179], a[220:223], a[164:167], v[176:179]
v_accvgpr_read_b32 v13, a22
v_mfma_f32_16x16x32_bf16 v[208:211], a[220:223], a[168:171], v[208:211]
v_accvgpr_read_b32 v15, a23
v_lshlrev_b32 v12, 16, v13
v_mfma_f32_16x16x32_bf16 v[208:211], a[200:203], a[172:175], v[208:211]
v_lshlrev_b32 v14, 16, v15
v_and_b32 v13, s53, v13
v_mfma_f32_16x16x32_bf16 v[240:243], a[200:203], a[176:179], v[240:243]
v_and_b32 v15, s53, v15
v_mfma_f32_16x16x32_bf16 v[240:243], a[220:223], a[180:183], v[240:243]
ds_write_b128 v3, v[16:19] offset:4096
v_mfma_f32_16x16x32_bf16 a[248:251], a[220:223], a[184:187], a[248:251]
global_load_dwordx4 a[220:223], v0, s[72:73] offset:3072
v_mfma_f32_16x16x32_bf16 a[248:251], a[200:203], a[188:191], a[248:251]
s_waitcnt vmcnt(9)
v_mfma_f32_16x16x32_bf16 a[252:255], a[204:207], a[188:191], a[252:255]
ds_read_b128 a[188:191], v2 offset:16384
v_mul_f32 v8, v8, v184
v_mfma_f32_16x16x32_bf16 a[252:255], a[228:231], a[184:187], a[252:255]
ds_read_b128 a[184:187], v2 offset:24576
v_mul_f32 v9, v9, v185
v_mfma_f32_16x16x32_bf16 v[244:247], a[228:231], a[180:183], v[244:247]
ds_read_b128 a[180:183], v2 offset:25600
v_mul_f32 v10, v10, v186
v_mfma_f32_16x16x32_bf16 v[244:247], a[204:207], a[176:179], v[244:247]
ds_read_b128 a[176:179], v2 offset:17408
v_mul_f32 v11, v11, v187
v_mfma_f32_16x16x32_bf16 v[212:215], a[204:207], a[172:175], v[212:215]
ds_read_b128 a[172:175], v2 offset:18432
v_cvt_pk_bf16_f32 v20, v8, v9
v_mfma_f32_16x16x32_bf16 v[212:215], a[228:231], a[168:171], v[212:215]
ds_read_b128 a[168:171], v2 offset:26624
v_cvt_pk_bf16_f32 v21, v10, v11
v_mfma_f32_16x16x32_bf16 v[180:183], a[228:231], a[164:167], v[180:183]
ds_read_b128 a[164:167], v2 offset:27648
v_mfma_f32_16x16x32_bf16 v[180:183], a[204:207], a[160:163], v[180:183]
ds_read_b128 a[160:163], v2 offset:19456
v_accvgpr_read_b32 v9, a24
v_mfma_f32_16x16x32_bf16 v[148:151], a[204:207], a[156:159], v[148:151]
ds_read_b128 a[156:159], v2 offset:20480
v_accvgpr_read_b32 v11, a25
v_mfma_f32_16x16x32_bf16 v[148:151], a[228:231], a[152:155], v[148:151]
ds_read_b128 a[152:155], v2 offset:28672
v_lshlrev_b32 v8, 16, v9
v_mfma_f32_16x16x32_bf16 v[116:119], a[228:231], a[148:151], v[116:119]
ds_read_b128 a[148:151], v2 offset:29696
v_lshlrev_b32 v10, 16, v11
v_mfma_f32_16x16x32_bf16 v[116:119], a[204:207], a[144:147], v[116:119]
ds_read_b128 a[144:147], v2 offset:21504
v_and_b32 v9, s53, v9
v_mfma_f32_16x16x32_bf16 v[84:87], a[204:207], a[140:143], v[84:87]
ds_read_b128 a[140:143], v2 offset:22528
v_mfma_f32_16x16x32_bf16 v[84:87], a[228:231], a[136:139], v[84:87]
ds_read_b128 a[136:139], v2 offset:30720
v_and_b32 v11, s53, v11
v_mfma_f32_16x16x32_bf16 v[52:55], a[228:231], a[132:135], v[52:55]
ds_read_b128 a[132:135], v2 offset:31744
s_mov_b32 s60, 4096
v_mfma_f32_16x16x32_bf16 v[52:55], a[204:207], a[128:131], v[52:55]
ds_read_b128 a[128:131], v2 offset:23552
s_waitcnt vmcnt(7) lgkmcnt(12)
v_mfma_f32_16x16x32_bf16 v[40:43], a[196:199], a[188:191], v[40:43]
global_load_dwordx4 a[200:203], v0, s[74:75] offset:3072
v_mfma_f32_16x16x32_bf16 v[40:43], a[224:227], a[184:187], v[40:43]
s_xor_b32 s72, s64, 36864
s_add_u32 s72, s72, s12
s_addc_u32 s73, s13, 0
v_mfma_f32_16x16x32_bf16 v[72:75], a[224:227], a[180:183], v[72:75]
s_xor_b32 s74, s64, 45056
s_add_u32 s74, s74, s12
s_addc_u32 s75, s13, 0
v_mfma_f32_16x16x32_bf16 v[72:75], a[196:199], a[176:179], v[72:75]
s_waitcnt lgkmcnt(8)
v_mfma_f32_16x16x32_bf16 v[104:107], a[196:199], a[172:175], v[104:107]
global_load_dwordx4 a[228:231], v0, s[72:73] offset:0
v_mfma_f32_16x16x32_bf16 v[104:107], a[224:227], a[168:171], v[104:107]
buffer_store_dwordx4 v[16:19], v0, s[24:27], s60 offen offset:0 sc1
v_mfma_f32_16x16x32_bf16 v[136:139], a[224:227], a[164:167], v[136:139]
v_mul_f32 v12, v12, v188
v_mul_f32 v13, v13, v189
v_mfma_f32_16x16x32_bf16 v[136:139], a[196:199], a[160:163], v[136:139]
s_waitcnt lgkmcnt(4)
v_mfma_f32_16x16x32_bf16 v[168:171], a[196:199], a[156:159], v[168:171]
global_load_dwordx4 a[204:207], v0, s[74:75] offset:0
v_mfma_f32_16x16x32_bf16 v[168:171], a[224:227], a[152:155], v[168:171]
v_mul_f32 v14, v14, v190
v_mul_f32 v15, v15, v191
v_mfma_f32_16x16x32_bf16 v[200:203], a[224:227], a[148:151], v[200:203]
v_cvt_pk_bf16_f32 v22, v12, v13
v_cvt_pk_bf16_f32 v23, v14, v15
v_mfma_f32_16x16x32_bf16 v[200:203], a[196:199], a[144:147], v[200:203]
v_accvgpr_read_b32 v13, a26
s_waitcnt lgkmcnt(0)
v_mfma_f32_16x16x32_bf16 v[232:235], a[196:199], a[140:143], v[232:235]
v_accvgpr_read_b32 v15, a27
v_mfma_f32_16x16x32_bf16 v[232:235], a[224:227], a[136:139], v[232:235]
v_lshlrev_b32 v12, 16, v13
v_mfma_f32_16x16x32_bf16 a[240:243], a[224:227], a[132:135], a[240:243]
global_load_dwordx4 a[224:227], v0, s[72:73] offset:1024
v_mfma_f32_16x16x32_bf16 a[240:243], a[196:199], a[128:131], a[240:243]
v_lshlrev_b32 v14, 16, v15
s_waitcnt vmcnt(9)
v_mfma_f32_16x16x32_bf16 a[244:247], a[212:215], a[128:131], a[244:247]
v_and_b32 v13, s53, v13
v_and_b32 v15, s53, v15
v_mfma_f32_16x16x32_bf16 a[244:247], a[216:219], a[132:135], a[244:247]
ds_write_b128 v3, v[20:23] offset:5120
v_mfma_f32_16x16x32_bf16 v[236:239], a[216:219], a[136:139], v[236:239]
global_load_dwordx4 a[196:199], v0, s[74:75] offset:1024
v_mfma_f32_16x16x32_bf16 v[236:239], a[212:215], a[140:143], v[236:239]
v_mul_f32 v8, v8, v216
v_mfma_f32_16x16x32_bf16 v[204:207], a[212:215], a[144:147], v[204:207]
v_mul_f32 v9, v9, v217
v_mfma_f32_16x16x32_bf16 v[204:207], a[216:219], a[148:151], v[204:207]
v_mul_f32 v10, v10, v218
v_mul_f32 v11, v11, v219
v_mfma_f32_16x16x32_bf16 v[172:175], a[216:219], a[152:155], v[172:175]
v_cvt_pk_bf16_f32 v16, v8, v9
v_cvt_pk_bf16_f32 v17, v10, v11
v_mfma_f32_16x16x32_bf16 v[172:175], a[212:215], a[156:159], v[172:175]
v_accvgpr_read_b32 v9, a28
v_mfma_f32_16x16x32_bf16 v[140:143], a[212:215], a[160:163], v[140:143]
v_accvgpr_read_b32 v11, a29
v_lshlrev_b32 v8, 16, v9
v_mfma_f32_16x16x32_bf16 v[140:143], a[216:219], a[164:167], v[140:143]
v_lshlrev_b32 v10, 16, v11
v_and_b32 v9, s53, v9
v_mfma_f32_16x16x32_bf16 v[108:111], a[216:219], a[168:171], v[108:111]
v_and_b32 v11, s53, v11
v_mfma_f32_16x16x32_bf16 v[108:111], a[212:215], a[172:175], v[108:111]
buffer_store_dwordx4 v[20:23], v0, s[24:27], s60 offen offset:1024 sc1
v_mfma_f32_16x16x32_bf16 v[76:79], a[212:215], a[176:179], v[76:79]
v_mul_f32 v12, v12, v220
v_mfma_f32_16x16x32_bf16 v[76:79], a[216:219], a[180:183], v[76:79]
v_mul_f32 v13, v13, v221
v_mfma_f32_16x16x32_bf16 v[44:47], a[216:219], a[184:187], v[44:47]
global_load_dwordx4 a[216:219], v0, s[72:73] offset:2048
v_mfma_f32_16x16x32_bf16 v[44:47], a[212:215], a[188:191], v[44:47]
v_mul_f32 v14, v14, v222
s_waitcnt vmcnt(10)
v_mfma_f32_16x16x32_bf16 v[48:51], a[192:195], a[188:191], v[48:51]
v_mul_f32 v15, v15, v223
v_cvt_pk_bf16_f32 v18, v12, v13
v_mfma_f32_16x16x32_bf16 v[48:51], a[208:211], a[184:187], v[48:51]
v_cvt_pk_bf16_f32 v19, v14, v15
v_mfma_f32_16x16x32_bf16 v[80:83], a[208:211], a[180:183], v[80:83]
global_load_dwordx4 a[212:215], v0, s[74:75] offset:2048
v_mfma_f32_16x16x32_bf16 v[80:83], a[192:195], a[176:179], v[80:83]
v_accvgpr_read_b32 v13, a30
v_accvgpr_read_b32 v15, a31
v_mfma_f32_16x16x32_bf16 v[112:115], a[192:195], a[172:175], v[112:115]
v_lshlrev_b32 v12, 16, v13
v_mfma_f32_16x16x32_bf16 v[112:115], a[208:211], a[168:171], v[112:115]
v_lshlrev_b32 v14, 16, v15
v_and_b32 v13, s53, v13
v_mfma_f32_16x16x32_bf16 v[144:147], a[208:211], a[164:167], v[144:147]
v_and_b32 v15, s53, v15
v_mfma_f32_16x16x32_bf16 v[144:147], a[192:195], a[160:163], v[144:147]
ds_write_b128 v3, v[16:19] offset:6144
v_mfma_f32_16x16x32_bf16 v[176:179], a[192:195], a[156:159], v[176:179]
v_mul_f32 v8, v8, v248
v_mul_f32 v9, v9, v249
v_mfma_f32_16x16x32_bf16 v[176:179], a[208:211], a[152:155], v[176:179]
v_mul_f32 v10, v10, v250
v_mul_f32 v11, v11, v251
v_mfma_f32_16x16x32_bf16 v[208:211], a[208:211], a[148:151], v[208:211]
v_cvt_pk_bf16_f32 v20, v8, v9
v_cvt_pk_bf16_f32 v21, v10, v11
v_mfma_f32_16x16x32_bf16 v[208:211], a[192:195], a[144:147], v[208:211]
buffer_store_dwordx4 v[16:19], v0, s[24:27], s60 offen offset:2048 sc1
v_mfma_f32_16x16x32_bf16 v[240:243], a[192:195], a[140:143], v[240:243]
v_mfma_f32_16x16x32_bf16 v[240:243], a[208:211], a[136:139], v[240:243]
v_mul_f32 v12, v12, v252
v_mfma_f32_16x16x32_bf16 a[248:251], a[208:211], a[132:135], a[248:251]
global_load_dwordx4 a[208:211], v0, s[72:73] offset:3072
v_mfma_f32_16x16x32_bf16 a[248:251], a[192:195], a[128:131], a[248:251]
v_mul_f32 v13, v13, v253
v_mul_f32 v14, v14, v254
s_waitcnt vmcnt(10)
v_mfma_f32_16x16x32_bf16 a[252:255], a[220:223], a[128:131], a[252:255]
ds_read_b128 a[128:131], v2 offset:32768
v_mfma_f32_16x16x32_bf16 a[252:255], a[200:203], a[132:135], a[252:255]
ds_read_b128 a[132:135], v2 offset:40960
v_mul_f32 v15, v15, v255
v_mfma_f32_16x16x32_bf16 v[244:247], a[200:203], a[136:139], v[244:247]
ds_read_b128 a[136:139], v2 offset:41984
v_cvt_pk_bf16_f32 v22, v12, v13
v_mfma_f32_16x16x32_bf16 v[244:247], a[220:223], a[140:143], v[244:247]
ds_read_b128 a[140:143], v2 offset:33792
v_cvt_pk_bf16_f32 v23, v14, v15
v_mfma_f32_16x16x32_bf16 v[212:215], a[220:223], a[144:147], v[212:215]
ds_read_b128 a[144:147], v2 offset:34816
v_mfma_f32_16x16x32_bf16 v[212:215], a[200:203], a[148:151], v[212:215]
ds_read_b128 a[148:151], v2 offset:43008
v_mfma_f32_16x16x32_bf16 v[180:183], a[200:203], a[152:155], v[180:183]
ds_read_b128 a[152:155], v2 offset:44032
v_mfma_f32_16x16x32_bf16 v[180:183], a[220:223], a[156:159], v[180:183]
ds_read_b128 a[156:159], v2 offset:35840
v_mfma_f32_16x16x32_bf16 v[148:151], a[220:223], a[160:163], v[148:151]
ds_read_b128 a[160:163], v2 offset:36864
v_mfma_f32_16x16x32_bf16 v[148:151], a[200:203], a[164:167], v[148:151]
ds_read_b128 a[164:167], v2 offset:45056
v_mfma_f32_16x16x32_bf16 v[116:119], a[200:203], a[168:171], v[116:119]
ds_read_b128 a[168:171], v2 offset:46080
v_accvgpr_read_b32 v9, a32
v_mfma_f32_16x16x32_bf16 v[116:119], a[220:223], a[172:175], v[116:119]
ds_read_b128 a[172:175], v2 offset:37888
v_accvgpr_read_b32 v11, a33
v_mfma_f32_16x16x32_bf16 v[84:87], a[220:223], a[176:179], v[84:87]
ds_read_b128 a[176:179], v2 offset:38912
v_lshlrev_b32 v8, 16, v9
v_mfma_f32_16x16x32_bf16 v[84:87], a[200:203], a[180:183], v[84:87]
ds_read_b128 a[180:183], v2 offset:47104
v_lshlrev_b32 v10, 16, v11
v_mfma_f32_16x16x32_bf16 v[52:55], a[200:203], a[184:187], v[52:55]
ds_read_b128 a[184:187], v2 offset:48128
v_and_b32 v9, s53, v9
v_mfma_f32_16x16x32_bf16 v[52:55], a[220:223], a[188:191], v[52:55]
ds_read_b128 a[188:191], v2 offset:39936
s_waitcnt vmcnt(7) lgkmcnt(12)
v_mfma_f32_16x16x32_bf16 v[40:43], a[228:231], a[128:131], v[40:43]
global_load_dwordx4 a[192:195], v0, s[74:75] offset:3072
v_mfma_f32_16x16x32_bf16 v[40:43], a[204:207], a[132:135], v[40:43]
s_xor_b32 s72, s64, 53248
s_add_u32 s72, s72, s12
s_addc_u32 s73, s13, 0
v_mfma_f32_16x16x32_bf16 v[72:75], a[204:207], a[136:139], v[72:75]
s_xor_b32 s74, s64, 61440
s_add_u32 s74, s74, s12
s_addc_u32 s75, s13, 0
v_mfma_f32_16x16x32_bf16 v[72:75], a[228:231], a[140:143], v[72:75]
v_and_b32 v11, s53, v11
s_waitcnt lgkmcnt(8)
v_mfma_f32_16x16x32_bf16 v[104:107], a[228:231], a[144:147], v[104:107]
global_load_dwordx4 a[200:203], v0, s[72:73] offset:0
v_mfma_f32_16x16x32_bf16 v[104:107], a[204:207], a[148:151], v[104:107]
ds_write_b128 v3, v[20:23] offset:7168
v_mfma_f32_16x16x32_bf16 v[136:139], a[204:207], a[152:155], v[136:139]
buffer_store_dwordx4 v[20:23], v0, s[24:27], s60 offen offset:3072 sc1
v_mfma_f32_16x16x32_bf16 v[136:139], a[228:231], a[156:159], v[136:139]
v_accvgpr_read_b32 v13, a34
s_waitcnt lgkmcnt(5)
v_mfma_f32_16x16x32_bf16 v[168:171], a[228:231], a[160:163], v[168:171]
global_load_dwordx4 a[220:223], v0, s[74:75] offset:0
v_mfma_f32_16x16x32_bf16 v[168:171], a[204:207], a[164:167], v[168:171]
v_accvgpr_read_b32 v15, a35
v_lshlrev_b32 v12, 16, v13
v_mfma_f32_16x16x32_bf16 v[200:203], a[204:207], a[168:171], v[200:203]
v_lshlrev_b32 v14, 16, v15
v_and_b32 v13, s53, v13
v_mfma_f32_16x16x32_bf16 v[200:203], a[228:231], a[172:175], v[200:203]
v_and_b32 v15, s53, v15
s_waitcnt lgkmcnt(1)
v_mfma_f32_16x16x32_bf16 v[232:235], a[228:231], a[176:179], v[232:235]
s_add_u32 s54, s57, 131072
v_add_u32 v3, s54, v0
v_mfma_f32_16x16x32_bf16 v[232:235], a[204:207], a[180:183], v[232:235]
v_mul_f32 v8, v8, v32
v_mfma_f32_16x16x32_bf16 a[240:243], a[204:207], a[184:187], a[240:243]
global_load_dwordx4 a[204:207], v0, s[72:73] offset:1024
v_mfma_f32_16x16x32_bf16 a[240:243], a[228:231], a[188:191], a[240:243]
v_mul_f32 v9, v9, v33
v_mul_f32 v10, v10, v34
s_waitcnt vmcnt(10)
v_mfma_f32_16x16x32_bf16 a[244:247], a[224:227], a[188:191], a[244:247]
v_mul_f32 v11, v11, v35
v_cvt_pk_bf16_f32 v16, v8, v9
v_mfma_f32_16x16x32_bf16 a[244:247], a[196:199], a[184:187], a[244:247]
v_cvt_pk_bf16_f32 v17, v10, v11
v_mfma_f32_16x16x32_bf16 v[236:239], a[196:199], a[180:183], v[236:239]
global_load_dwordx4 a[228:231], v0, s[74:75] offset:1024
v_mfma_f32_16x16x32_bf16 v[236:239], a[224:227], a[176:179], v[236:239]
v_accvgpr_read_b32 v9, a36
v_accvgpr_read_b32 v11, a37
v_mfma_f32_16x16x32_bf16 v[204:207], a[224:227], a[172:175], v[204:207]
v_lshlrev_b32 v8, 16, v9
v_lshlrev_b32 v10, 16, v11
v_mfma_f32_16x16x32_bf16 v[204:207], a[196:199], a[168:171], v[204:207]
v_and_b32 v9, s53, v9
v_and_b32 v11, s53, v11
v_mfma_f32_16x16x32_bf16 v[172:175], a[196:199], a[164:167], v[172:175]
v_mul_f32 v12, v12, v36
v_mul_f32 v13, v13, v37
v_mfma_f32_16x16x32_bf16 v[172:175], a[224:227], a[160:163], v[172:175]
v_mul_f32 v14, v14, v38
v_mul_f32 v15, v15, v39
v_mfma_f32_16x16x32_bf16 v[140:143], a[224:227], a[156:159], v[140:143]
v_cvt_pk_bf16_f32 v18, v12, v13
v_cvt_pk_bf16_f32 v19, v14, v15
v_mfma_f32_16x16x32_bf16 v[140:143], a[196:199], a[152:155], v[140:143]
v_accvgpr_read_b32 v13, a38
v_accvgpr_read_b32 v15, a39
v_mfma_f32_16x16x32_bf16 v[108:111], a[196:199], a[148:151], v[108:111]
v_lshlrev_b32 v12, 16, v13
v_lshlrev_b32 v14, 16, v15
v_mfma_f32_16x16x32_bf16 v[108:111], a[224:227], a[144:147], v[108:111]
v_and_b32 v13, s53, v13
v_and_b32 v15, s53, v15
v_mfma_f32_16x16x32_bf16 v[76:79], a[224:227], a[140:143], v[76:79]
ds_write_b128 v3, v[16:19] offset:0
v_mfma_f32_16x16x32_bf16 v[76:79], a[196:199], a[136:139], v[76:79]
v_mul_f32 v8, v8, v64
v_mfma_f32_16x16x32_bf16 v[44:47], a[196:199], a[132:135], v[44:47]
global_load_dwordx4 a[196:199], v0, s[72:73] offset:2048
v_mfma_f32_16x16x32_bf16 v[44:47], a[224:227], a[128:131], v[44:47]
v_mul_f32 v9, v9, v65
v_mul_f32 v10, v10, v66
s_waitcnt vmcnt(9)
v_mfma_f32_16x16x32_bf16 v[48:51], a[216:219], a[128:131], v[48:51]
v_mul_f32 v11, v11, v67
v_cvt_pk_bf16_f32 v20, v8, v9
v_mfma_f32_16x16x32_bf16 v[48:51], a[212:215], a[132:135], v[48:51]
v_cvt_pk_bf16_f32 v21, v10, v11
v_mfma_f32_16x16x32_bf16 v[80:83], a[212:215], a[136:139], v[80:83]
global_load_dwordx4 a[224:227], v0, s[74:75] offset:2048
v_mfma_f32_16x16x32_bf16 v[80:83], a[216:219], a[140:143], v[80:83]
v_accvgpr_read_b32 v9, a40
v_accvgpr_read_b32 v11, a41
v_mfma_f32_16x16x32_bf16 v[112:115], a[216:219], a[144:147], v[112:115]
v_lshlrev_b32 v8, 16, v9
v_lshlrev_b32 v10, 16, v11
v_mfma_f32_16x16x32_bf16 v[112:115], a[212:215], a[148:151], v[112:115]
v_and_b32 v9, s53, v9
v_and_b32 v11, s53, v11
v_mfma_f32_16x16x32_bf16 v[144:147], a[212:215], a[152:155], v[144:147]
s_mov_b32 s60, 32768
v_mfma_f32_16x16x32_bf16 v[144:147], a[216:219], a[156:159], v[144:147]
buffer_store_dwordx4 v[16:19], v0, s[24:27], s60 offen offset:0 sc1
v_mfma_f32_16x16x32_bf16 v[176:179], a[216:219], a[160:163], v[176:179]
v_mul_f32 v12, v12, v68
v_mul_f32 v13, v13, v69
v_mfma_f32_16x16x32_bf16 v[176:179], a[212:215], a[164:167], v[176:179]
v_mul_f32 v14, v14, v70
v_mul_f32 v15, v15, v71
v_mfma_f32_16x16x32_bf16 v[208:211], a[212:215], a[168:171], v[208:211]
v_cvt_pk_bf16_f32 v22, v12, v13
v_cvt_pk_bf16_f32 v23, v14, v15
v_mfma_f32_16x16x32_bf16 v[208:211], a[216:219], a[172:175], v[208:211]
v_accvgpr_read_b32 v13, a42
v_accvgpr_read_b32 v15, a43
v_mfma_f32_16x16x32_bf16 v[240:243], a[216:219], a[176:179], v[240:243]
v_lshlrev_b32 v12, 16, v13
v_lshlrev_b32 v14, 16, v15
v_mfma_f32_16x16x32_bf16 v[240:243], a[212:215], a[180:183], v[240:243]
v_and_b32 v13, s53, v13
v_mfma_f32_16x16x32_bf16 a[248:251], a[212:215], a[184:187], a[248:251]
global_load_dwordx4 a[212:215], v0, s[72:73] offset:3072
v_mfma_f32_16x16x32_bf16 a[248:251], a[216:219], a[188:191], a[248:251]
v_and_b32 v15, s53, v15
s_waitcnt vmcnt(9)
v_mfma_f32_16x16x32_bf16 a[252:255], a[208:211], a[188:191], a[252:255]
ds_read_b128 a[188:191], v2 offset:49152
v_mfma_f32_16x16x32_bf16 a[252:255], a[192:195], a[184:187], a[252:255]
ds_read_b128 a[184:187], v2 offset:57344
v_mul_f32 v8, v8, v96
v_mfma_f32_16x16x32_bf16 v[244:247], a[192:195], a[180:183], v[244:247]
ds_read_b128 a[180:183], v2 offset:58368
v_mul_f32 v9, v9, v97
v_mfma_f32_16x16x32_bf16 v[244:247], a[208:211], a[176:179], v[244:247]
ds_read_b128 a[176:179], v2 offset:50176
v_mul_f32 v10, v10, v98
v_mfma_f32_16x16x32_bf16 v[212:215], a[208:211], a[172:175], v[212:215]
ds_read_b128 a[172:175], v2 offset:51200
v_mul_f32 v11, v11, v99
v_mfma_f32_16x16x32_bf16 v[212:215], a[192:195], a[168:171], v[212:215]
ds_read_b128 a[168:171], v2 offset:59392
v_cvt_pk_bf16_f32 v16, v8, v9
v_mfma_f32_16x16x32_bf16 v[180:183], a[192:195], a[164:167], v[180:183]
ds_read_b128 a[164:167], v2 offset:60416
v_cvt_pk_bf16_f32 v17, v10, v11
v_mfma_f32_16x16x32_bf16 v[180:183], a[208:211], a[160:163], v[180:183]
ds_read_b128 a[160:163], v2 offset:52224
v_accvgpr_read_b32 v9, a44
v_mfma_f32_16x16x32_bf16 v[148:151], a[208:211], a[156:159], v[148:151]
ds_read_b128 a[156:159], v2 offset:53248
v_accvgpr_read_b32 v11, a45
v_mfma_f32_16x16x32_bf16 v[148:151], a[192:195], a[152:155], v[148:151]
ds_read_b128 a[152:155], v2 offset:61440
v_lshlrev_b32 v8, 16, v9
v_mfma_f32_16x16x32_bf16 v[116:119], a[192:195], a[148:151], v[116:119]
ds_read_b128 a[148:151], v2 offset:62464
s_mov_b32 s38, 4
v_mfma_f32_16x16x32_bf16 v[116:119], a[208:211], a[144:147], v[116:119]
ds_read_b128 a[144:147], v2 offset:54272
s_waitcnt vmcnt(7)
v_mfma_f32_16x16x32_bf16 v[84:87], a[208:211], a[140:143], v[84:87]
ds_read_b128 a[140:143], v2 offset:55296
v_lshlrev_b32 v10, 16, v11
v_mfma_f32_16x16x32_bf16 v[84:87], a[192:195], a[136:139], v[84:87]
ds_read_b128 a[136:139], v2 offset:63488
v_and_b32 v9, s53, v9
v_mfma_f32_16x16x32_bf16 v[52:55], a[192:195], a[132:135], v[52:55]
ds_read_b128 a[132:135], v2 offset:64512
v_and_b32 v11, s53, v11
v_mfma_f32_16x16x32_bf16 v[52:55], a[208:211], a[128:131], v[52:55]
ds_read_b128 a[128:131], v2 offset:56320
s_waitcnt vmcnt(6) lgkmcnt(12)
v_mfma_f32_16x16x32_bf16 v[40:43], a[200:203], a[188:191], v[40:43]
global_load_dwordx4 a[216:219], v0, s[74:75] offset:3072
v_mfma_f32_16x16x32_bf16 v[40:43], a[220:223], a[184:187], v[40:43]
s_xor_b32 s72, s64, 102400
s_add_u32 s72, s72, s12
s_addc_u32 s73, s13, 0
buffer_store_dword v6, v0, s[36:39], 0 offen offset:0 sc1
v_mfma_f32_16x16x32_bf16 v[72:75], a[220:223], a[180:183], v[72:75]
s_xor_b32 s74, s64, 110592
s_add_u32 s74, s74, s12
s_addc_u32 s75, s13, 0
v_mfma_f32_16x16x32_bf16 v[72:75], a[200:203], a[176:179], v[72:75]
s_waitcnt lgkmcnt(8)
v_mfma_f32_16x16x32_bf16 v[104:107], a[200:203], a[172:175], v[104:107]
global_load_dwordx4 a[192:195], v0, s[72:73] offset:0
v_mfma_f32_16x16x32_bf16 v[104:107], a[220:223], a[168:171], v[104:107]
ds_write_b128 v3, v[20:23] offset:1024
v_mfma_f32_16x16x32_bf16 v[136:139], a[220:223], a[164:167], v[136:139]
buffer_store_dwordx4 v[20:23], v0, s[24:27], s60 offen offset:1024 sc1
v_mfma_f32_16x16x32_bf16 v[136:139], a[200:203], a[160:163], v[136:139]
v_mul_f32 v12, v12, v100
s_waitcnt lgkmcnt(5)
v_mfma_f32_16x16x32_bf16 v[168:171], a[200:203], a[156:159], v[168:171]
global_load_dwordx4 a[208:211], v0, s[74:75] offset:0
v_mfma_f32_16x16x32_bf16 v[168:171], a[220:223], a[152:155], v[168:171]
v_mul_f32 v13, v13, v101
v_mul_f32 v14, v14, v102
v_mfma_f32_16x16x32_bf16 v[200:203], a[220:223], a[148:151], v[200:203]
v_mul_f32 v15, v15, v103
v_cvt_pk_bf16_f32 v18, v12, v13
v_mfma_f32_16x16x32_bf16 v[200:203], a[200:203], a[144:147], v[200:203]
v_cvt_pk_bf16_f32 v19, v14, v15
v_accvgpr_read_b32 v13, a46
s_waitcnt lgkmcnt(1)
v_mfma_f32_16x16x32_bf16 v[232:235], a[200:203], a[140:143], v[232:235]
v_accvgpr_read_b32 v15, a47
v_lshlrev_b32 v12, 16, v13
v_mfma_f32_16x16x32_bf16 v[232:235], a[220:223], a[136:139], v[232:235]
v_lshlrev_b32 v14, 16, v15
v_mfma_f32_16x16x32_bf16 a[240:243], a[220:223], a[132:135], a[240:243]
global_load_dwordx4 a[220:223], v0, s[72:73] offset:1024
v_mfma_f32_16x16x32_bf16 a[240:243], a[200:203], a[128:131], a[240:243]
v_and_b32 v13, s53, v13
v_and_b32 v15, s53, v15
s_waitcnt vmcnt(10)
v_mfma_f32_16x16x32_bf16 a[244:247], a[204:207], a[128:131], a[244:247]
ds_write_b128 v3, v[16:19] offset:2048
v_mfma_f32_16x16x32_bf16 a[244:247], a[228:231], a[132:135], a[244:247]
v_mul_f32 v8, v8, v128
v_mfma_f32_16x16x32_bf16 v[236:239], a[228:231], a[136:139], v[236:239]
global_load_dwordx4 a[200:203], v0, s[74:75] offset:1024
v_mfma_f32_16x16x32_bf16 v[236:239], a[204:207], a[140:143], v[236:239]
v_mul_f32 v9, v9, v129
v_mul_f32 v10, v10, v130
v_mfma_f32_16x16x32_bf16 v[204:207], a[204:207], a[144:147], v[204:207]
v_mul_f32 v11, v11, v131
v_cvt_pk_bf16_f32 v20, v8, v9
v_mfma_f32_16x16x32_bf16 v[204:207], a[228:231], a[148:151], v[204:207]
v_cvt_pk_bf16_f32 v21, v10, v11
v_accvgpr_read_b32 v9, a48
v_mfma_f32_16x16x32_bf16 v[172:175], a[228:231], a[152:155], v[172:175]
v_accvgpr_read_b32 v11, a49
v_lshlrev_b32 v8, 16, v9
v_mfma_f32_16x16x32_bf16 v[172:175], a[204:207], a[156:159], v[172:175]
v_lshlrev_b32 v10, 16, v11
v_and_b32 v9, s53, v9
v_mfma_f32_16x16x32_bf16 v[140:143], a[204:207], a[160:163], v[140:143]
v_and_b32 v11, s53, v11
v_mfma_f32_16x16x32_bf16 v[140:143], a[228:231], a[164:167], v[140:143]
buffer_store_dwordx4 v[16:19], v0, s[24:27], s60 offen offset:2048 sc1
v_mfma_f32_16x16x32_bf16 v[108:111], a[228:231], a[168:171], v[108:111]
v_mul_f32 v12, v12, v132
v_mul_f32 v13, v13, v133
v_mfma_f32_16x16x32_bf16 v[108:111], a[204:207], a[172:175], v[108:111]
v_mul_f32 v14, v14, v134
v_mul_f32 v15, v15, v135
v_mfma_f32_16x16x32_bf16 v[76:79], a[204:207], a[176:179], v[76:79]
v_cvt_pk_bf16_f32 v22, v12, v13
v_cvt_pk_bf16_f32 v23, v14, v15
v_mfma_f32_16x16x32_bf16 v[76:79], a[228:231], a[180:183], v[76:79]
v_accvgpr_read_b32 v13, a50
v_mfma_f32_16x16x32_bf16 v[44:47], a[228:231], a[184:187], v[44:47]
global_load_dwordx4 a[228:231], v0, s[72:73] offset:2048
v_mfma_f32_16x16x32_bf16 v[44:47], a[204:207], a[188:191], v[44:47]
v_accvgpr_read_b32 v15, a51
v_lshlrev_b32 v12, 16, v13
s_waitcnt vmcnt(11)
v_mfma_f32_16x16x32_bf16 v[48:51], a[196:199], a[188:191], v[48:51]
v_lshlrev_b32 v14, 16, v15
v_and_b32 v13, s53, v13
v_mfma_f32_16x16x32_bf16 v[48:51], a[224:227], a[184:187], v[48:51]
v_and_b32 v15, s53, v15
v_mfma_f32_16x16x32_bf16 v[80:83], a[224:227], a[180:183], v[80:83]
global_load_dwordx4 a[204:207], v0, s[74:75] offset:2048
v_mfma_f32_16x16x32_bf16 v[80:83], a[196:199], a[176:179], v[80:83]
ds_write_b128 v3, v[20:23] offset:3072
v_mfma_f32_16x16x32_bf16 v[112:115], a[196:199], a[172:175], v[112:115]
v_mul_f32 v8, v8, v160
v_mul_f32 v9, v9, v161
v_mfma_f32_16x16x32_bf16 v[112:115], a[224:227], a[168:171], v[112:115]
v_mul_f32 v10, v10, v162
v_mul_f32 v11, v11, v163
v_mfma_f32_16x16x32_bf16 v[144:147], a[224:227], a[164:167], v[144:147]
v_cvt_pk_bf16_f32 v16, v8, v9
v_cvt_pk_bf16_f32 v17, v10, v11
v_mfma_f32_16x16x32_bf16 v[144:147], a[196:199], a[160:163], v[144:147]
v_accvgpr_read_b32 v9, a52
v_accvgpr_read_b32 v11, a53
v_mfma_f32_16x16x32_bf16 v[176:179], a[196:199], a[156:159], v[176:179]
v_lshlrev_b32 v8, 16, v9
v_lshlrev_b32 v10, 16, v11
v_mfma_f32_16x16x32_bf16 v[176:179], a[224:227], a[152:155], v[176:179]
v_and_b32 v9, s53, v9
v_and_b32 v11, s53, v11
v_mfma_f32_16x16x32_bf16 v[208:211], a[224:227], a[148:151], v[208:211]
buffer_store_dwordx4 v[20:23], v0, s[24:27], s60 offen offset:3072 sc1
v_mfma_f32_16x16x32_bf16 v[208:211], a[196:199], a[144:147], v[208:211]
v_mul_f32 v12, v12, v164
v_mul_f32 v13, v13, v165
v_mfma_f32_16x16x32_bf16 v[240:243], a[196:199], a[140:143], v[240:243]
s_mov_b32 s86, 256
v_mul_f32 v14, v14, v166
v_mfma_f32_16x16x32_bf16 v[240:243], a[224:227], a[136:139], v[240:243]
buffer_load_dword v5, v0, s[84:87], 0 offen offset:0 sc1
v_mfma_f32_16x16x32_bf16 a[248:251], a[224:227], a[132:135], a[248:251]
global_load_dwordx4 a[224:227], v0, s[72:73] offset:3072
v_mfma_f32_16x16x32_bf16 a[248:251], a[196:199], a[128:131], a[248:251]
v_add_u32 v2, 65536, v1
v_mul_f32 v15, v15, v167
s_waitcnt vmcnt(12)
v_mfma_f32_16x16x32_bf16 a[252:255], a[212:215], a[128:131], a[252:255]
ds_read_b128 a[128:131], v2 offset:32768
v_cvt_pk_bf16_f32 v18, v12, v13
v_mfma_f32_16x16x32_bf16 a[252:255], a[216:219], a[132:135], a[252:255]
ds_read_b128 a[132:135], v2 offset:40960
v_cvt_pk_bf16_f32 v19, v14, v15
v_mfma_f32_16x16x32_bf16 v[244:247], a[216:219], a[136:139], v[244:247]
ds_read_b128 a[136:139], v2 offset:41984
v_accvgpr_read_b32 v13, a54
v_mfma_f32_16x16x32_bf16 v[244:247], a[212:215], a[140:143], v[244:247]
ds_read_b128 a[140:143], v2 offset:33792
v_accvgpr_read_b32 v15, a55
v_mfma_f32_16x16x32_bf16 v[212:215], a[212:215], a[144:147], v[212:215]
ds_read_b128 a[144:147], v2 offset:34816
L_pad7:
s_cbranch_execz L_pad11
v_lshlrev_b32 v12, 16, v13
v_mfma_f32_16x16x32_bf16 v[212:215], a[216:219], a[148:151], v[212:215]
ds_read_b128 a[148:151], v2 offset:43008
v_lshlrev_b32 v14, 16, v15
v_mfma_f32_16x16x32_bf16 v[180:183], a[216:219], a[152:155], v[180:183]
ds_read_b128 a[152:155], v2 offset:44032
v_and_b32 v13, s53, v13
v_mfma_f32_16x16x32_bf16 v[180:183], a[212:215], a[156:159], v[180:183]
ds_read_b128 a[156:159], v2 offset:35840
v_and_b32 v15, s53, v15
v_mfma_f32_16x16x32_bf16 v[148:151], a[212:215], a[160:163], v[148:151]
ds_read_b128 a[160:163], v2 offset:36864
v_mfma_f32_16x16x32_bf16 v[148:151], a[216:219], a[164:167], v[148:151]
ds_read_b128 a[164:167], v2 offset:45056
v_mfma_f32_16x16x32_bf16 v[116:119], a[216:219], a[168:171], v[116:119]
ds_read_b128 a[168:171], v2 offset:46080
v_mul_f32 v8, v8, v192
v_mfma_f32_16x16x32_bf16 v[116:119], a[212:215], a[172:175], v[116:119]
ds_read_b128 a[172:175], v2 offset:37888
v_mul_f32 v9, v9, v193
v_mfma_f32_16x16x32_bf16 v[84:87], a[212:215], a[176:179], v[84:87]
ds_read_b128 a[176:179], v2 offset:38912
v_mul_f32 v10, v10, v194
v_mfma_f32_16x16x32_bf16 v[84:87], a[216:219], a[180:183], v[84:87]
ds_read_b128 a[180:183], v2 offset:47104
v_mul_f32 v11, v11, v195
v_mfma_f32_16x16x32_bf16 v[52:55], a[216:219], a[184:187], v[52:55]
ds_read_b128 a[184:187], v2 offset:48128
v_cvt_pk_bf16_f32 v20, v8, v9
v_mfma_f32_16x16x32_bf16 v[52:55], a[212:215], a[188:191], v[52:55]
ds_read_b128 a[188:191], v2 offset:39936
s_waitcnt vmcnt(8) lgkmcnt(12)
v_mfma_f32_16x16x32_bf16 v[40:43], a[192:195], a[128:131], v[40:43]
global_load_dwordx4 a[196:199], v0, s[74:75] offset:3072
v_mfma_f32_16x16x32_bf16 v[40:43], a[208:211], a[132:135], v[40:43]
s_xor_b32 s72, s64, 118784
s_add_u32 s72, s72, s12
s_addc_u32 s73, s13, 0
v_mfma_f32_16x16x32_bf16 v[72:75], a[208:211], a[136:139], v[72:75]
s_xor_b32 s74, s64, 126976
s_add_u32 s74, s74, s12
s_addc_u32 s75, s13, 0
v_mfma_f32_16x16x32_bf16 v[72:75], a[192:195], a[140:143], v[72:75]
v_cvt_pk_bf16_f32 v21, v10, v11
s_waitcnt lgkmcnt(8)
v_mfma_f32_16x16x32_bf16 v[104:107], a[192:195], a[144:147], v[104:107]
global_load_dwordx4 a[216:219], v0, s[72:73] offset:0
v_mfma_f32_16x16x32_bf16 v[104:107], a[208:211], a[148:151], v[104:107]
ds_write_b128 v3, v[16:19] offset:4096
v_mfma_f32_16x16x32_bf16 v[136:139], a[208:211], a[152:155], v[136:139]
v_accvgpr_read_b32 v9, a56
v_accvgpr_read_b32 v11, a57
v_mfma_f32_16x16x32_bf16 v[136:139], a[192:195], a[156:159], v[136:139]
v_lshlrev_b32 v8, 16, v9
s_waitcnt lgkmcnt(5)
v_mfma_f32_16x16x32_bf16 v[168:171], a[192:195], a[160:163], v[168:171]
global_load_dwordx4 a[212:215], v0, s[74:75] offset:0
v_mfma_f32_16x16x32_bf16 v[168:171], a[208:211], a[164:167], v[168:171]
v_lshlrev_b32 v10, 16, v11
v_and_b32 v9, s53, v9
v_mfma_f32_16x16x32_bf16 v[200:203], a[208:211], a[168:171], v[200:203]
v_and_b32 v11, s53, v11
s_mov_b32 s60, 36864
v_mfma_f32_16x16x32_bf16 v[200:203], a[192:195], a[172:175], v[200:203]
v_mul_f32 v12, v12, v196
s_waitcnt lgkmcnt(1)
v_mfma_f32_16x16x32_bf16 v[232:235], a[192:195], a[176:179], v[232:235]
v_mul_f32 v13, v13, v197
v_mfma_f32_16x16x32_bf16 v[232:235], a[208:211], a[180:183], v[232:235]
buffer_store_dwordx4 v[16:19], v0, s[24:27], s60 offen offset:0 sc1
v_mfma_f32_16x16x32_bf16 a[240:243], a[208:211], a[184:187], a[240:243]
global_load_dwordx4 a[208:211], v0, s[72:73] offset:1024
v_mfma_f32_16x16x32_bf16 a[240:243], a[192:195], a[188:191], a[240:243]
v_mul_f32 v14, v14, v198
v_mul_f32 v15, v15, v199
s_waitcnt vmcnt(11)
v_mfma_f32_16x16x32_bf16 a[244:247], a[220:223], a[188:191], a[244:247]
v_cvt_pk_bf16_f32 v22, v12, v13
v_cvt_pk_bf16_f32 v23, v14, v15
v_mfma_f32_16x16x32_bf16 a[244:247], a[200:203], a[184:187], a[244:247]
v_accvgpr_read_b32 v13, a58
v_mfma_f32_16x16x32_bf16 v[236:239], a[200:203], a[180:183], v[236:239]
global_load_dwordx4 a[192:195], v0, s[74:75] offset:1024
v_mfma_f32_16x16x32_bf16 v[236:239], a[220:223], a[176:179], v[236:239]
v_accvgpr_read_b32 v15, a59
v_lshlrev_b32 v12, 16, v13
v_mfma_f32_16x16x32_bf16 v[204:207], a[220:223], a[172:175], v[204:207]
v_lshlrev_b32 v14, 16, v15
v_and_b32 v13, s53, v13
v_mfma_f32_16x16x32_bf16 v[204:207], a[200:203], a[168:171], v[204:207]
v_and_b32 v15, s53, v15
v_mfma_f32_16x16x32_bf16 v[172:175], a[200:203], a[164:167], v[172:175]
ds_write_b128 v3, v[20:23] offset:5120
v_mfma_f32_16x16x32_bf16 v[172:175], a[220:223], a[160:163], v[172:175]
v_mul_f32 v8, v8, v224
v_mul_f32 v9, v9, v225
v_mfma_f32_16x16x32_bf16 v[140:143], a[220:223], a[156:159], v[140:143]
v_mul_f32 v10, v10, v226
v_mul_f32 v11, v11, v227
v_mfma_f32_16x16x32_bf16 v[140:143], a[200:203], a[152:155], v[140:143]
v_cvt_pk_bf16_f32 v16, v8, v9
v_cvt_pk_bf16_f32 v17, v10, v11
v_mfma_f32_16x16x32_bf16 v[108:111], a[200:203], a[148:151], v[108:111]
v_accvgpr_read_b32 v9, a60
v_accvgpr_read_b32 v11, a61
v_mfma_f32_16x16x32_bf16 v[108:111], a[220:223], a[144:147], v[108:111]
v_lshlrev_b32 v8, 16, v9
v_lshlrev_b32 v10, 16, v11
v_mfma_f32_16x16x32_bf16 v[76:79], a[220:223], a[140:143], v[76:79]
v_and_b32 v9, s53, v9
v_and_b32 v11, s53, v11
v_mfma_f32_16x16x32_bf16 v[76:79], a[200:203], a[136:139], v[76:79]
buffer_store_dwordx4 v[20:23], v0, s[24:27], s60 offen offset:1024 sc1
v_mfma_f32_16x16x32_bf16 v[44:47], a[200:203], a[132:135], v[44:47]
global_load_dwordx4 a[200:203], v0, s[72:73] offset:2048
v_mfma_f32_16x16x32_bf16 v[44:47], a[220:223], a[128:131], v[44:47]
v_mul_f32 v12, v12, v228
v_mul_f32 v13, v13, v229
s_waitcnt vmcnt(11)
v_mfma_f32_16x16x32_bf16 v[48:51], a[228:231], a[128:131], v[48:51]
v_mul_f32 v14, v14, v230
v_mul_f32 v15, v15, v231
v_mfma_f32_16x16x32_bf16 v[48:51], a[204:207], a[132:135], v[48:51]
v_cvt_pk_bf16_f32 v18, v12, v13
v_mfma_f32_16x16x32_bf16 v[80:83], a[204:207], a[136:139], v[80:83]
global_load_dwordx4 a[220:223], v0, s[74:75] offset:2048
v_mfma_f32_16x16x32_bf16 v[80:83], a[228:231], a[140:143], v[80:83]
v_cvt_pk_bf16_f32 v19, v14, v15
v_accvgpr_read_b32 v13, a62
v_mfma_f32_16x16x32_bf16 v[112:115], a[228:231], a[144:147], v[112:115]
v_accvgpr_read_b32 v15, a63
v_lshlrev_b32 v12, 16, v13
v_mfma_f32_16x16x32_bf16 v[112:115], a[204:207], a[148:151], v[112:115]
v_lshlrev_b32 v14, 16, v15
v_and_b32 v13, s53, v13
v_mfma_f32_16x16x32_bf16 v[144:147], a[204:207], a[152:155], v[144:147]
v_and_b32 v15, s53, v15
v_mfma_f32_16x16x32_bf16 v[144:147], a[228:231], a[156:159], v[144:147]
ds_write_b128 v3, v[16:19] offset:6144
v_mfma_f32_16x16x32_bf16 v[176:179], a[228:231], a[160:163], v[176:179]
v_accvgpr_read_b32 v20, a232
v_accvgpr_read_b32 v21, a233
v_mfma_f32_16x16x32_bf16 v[176:179], a[204:207], a[164:167], v[176:179]
v_mul_f32 v8, v8, v20
v_mul_f32 v9, v9, v21
v_mfma_f32_16x16x32_bf16 v[208:211], a[204:207], a[168:171], v[208:211]
v_accvgpr_read_b32 v20, a234
v_accvgpr_read_b32 v21, a235
v_mfma_f32_16x16x32_bf16 v[208:211], a[228:231], a[172:175], v[208:211]
v_mul_f32 v10, v10, v20
v_mul_f32 v11, v11, v21
v_mfma_f32_16x16x32_bf16 v[240:243], a[228:231], a[176:179], v[240:243]
s_waitcnt vmcnt(10)
v_cmp_gt_u32 vcc, 128, v5
v_cvt_pk_bf16_f32 v20, v8, v9
v_mfma_f32_16x16x32_bf16 v[240:243], a[204:207], a[180:183], v[240:243]
v_cvt_pk_bf16_f32 v21, v10, v11
v_mfma_f32_16x16x32_bf16 a[248:251], a[204:207], a[184:187], a[248:251]
global_load_dwordx4 a[204:207], v0, s[72:73] offset:3072
v_mfma_f32_16x16x32_bf16 a[248:251], a[228:231], a[188:191], a[248:251]
v_accvgpr_read_b32 v22, a236
s_waitcnt vmcnt(9)
v_mfma_f32_16x16x32_bf16 a[252:255], a[224:227], a[188:191], a[252:255]
ds_read_b128 a[188:191], v2 offset:49152
v_accvgpr_read_b32 v23, a237
v_mfma_f32_16x16x32_bf16 a[252:255], a[196:199], a[184:187], a[252:255]
ds_read_b128 a[184:187], v2 offset:57344
v_mul_f32 v12, v12, v22
v_mfma_f32_16x16x32_bf16 v[244:247], a[196:199], a[180:183], v[244:247]
ds_read_b128 a[180:183], v2 offset:58368
v_mul_f32 v13, v13, v23
v_mfma_f32_16x16x32_bf16 v[244:247], a[224:227], a[176:179], v[244:247]
ds_read_b128 a[176:179], v2 offset:50176
s_and_b32 s3, vcc_lo, 514
s_cbranch_scc1 L_slow1
L_back1:
v_mfma_f32_16x16x32_bf16 v[212:215], a[224:227], a[172:175], v[212:215]
ds_read_b128 a[172:175], v2 offset:51200
v_accvgpr_read_b32 v22, a238
v_mfma_f32_16x16x32_bf16 v[212:215], a[196:199], a[168:171], v[212:215]
ds_read_b128 a[168:171], v2 offset:59392
v_accvgpr_read_b32 v23, a239
v_mfma_f32_16x16x32_bf16 v[180:183], a[196:199], a[164:167], v[180:183]
ds_read_b128 a[164:167], v2 offset:60416
v_mul_f32 v14, v14, v22
v_mfma_f32_16x16x32_bf16 v[180:183], a[224:227], a[160:163], v[180:183]
ds_read_b128 a[160:163], v2 offset:52224
v_mul_f32 v15, v15, v23
v_mfma_f32_16x16x32_bf16 v[148:151], a[224:227], a[156:159], v[148:151]
ds_read_b128 a[156:159], v2 offset:53248
v_cvt_pk_bf16_f32 v22, v12, v13
v_mfma_f32_16x16x32_bf16 v[148:151], a[196:199], a[152:155], v[148:151]
ds_read_b128 a[152:155], v2 offset:61440
v_cvt_pk_bf16_f32 v23, v14, v15
v_mfma_f32_16x16x32_bf16 v[116:119], a[196:199], a[148:151], v[116:119]
ds_read_b128 a[148:151], v2 offset:62464
v_mfma_f32_16x16x32_bf16 v[116:119], a[224:227], a[144:147], v[116:119]
ds_read_b128 a[144:147], v2 offset:54272
v_mfma_f32_16x16x32_bf16 v[84:87], a[224:227], a[140:143], v[84:87]
ds_read_b128 a[140:143], v2 offset:55296
v_mfma_f32_16x16x32_bf16 v[84:87], a[196:199], a[136:139], v[84:87]
ds_read_b128 a[136:139], v2 offset:63488
v_mfma_f32_16x16x32_bf16 v[52:55], a[196:199], a[132:135], v[52:55]
ds_read_b128 a[132:135], v2 offset:64512
v_mfma_f32_16x16x32_bf16 v[52:55], a[224:227], a[128:131], v[52:55]
ds_read_b128 a[128:131], v2 offset:56320
s_waitcnt vmcnt(7) lgkmcnt(12)
v_mfma_f32_16x16x32_bf16 v[40:43], a[216:219], a[188:191], v[40:43]
global_load_dwordx4 a[228:231], v0, s[74:75] offset:3072
v_mfma_f32_16x16x32_bf16 v[40:43], a[212:215], a[184:187], v[40:43]
s_add_u32 s72, s12, 266240
s_addc_u32 s73, s13, 0
v_mfma_f32_16x16x32_bf16 v[72:75], a[212:215], a[180:183], v[72:75]
s_add_u32 s74, s12, 299008
s_addc_u32 s75, s13, 0
v_mfma_f32_16x16x32_bf16 v[72:75], a[216:219], a[176:179], v[72:75]
s_waitcnt lgkmcnt(8)
v_mfma_f32_16x16x32_bf16 v[104:107], a[216:219], a[172:175], v[104:107]
global_load_dwordx4 a[196:199], v0, s[72:73] offset:-4096
v_mfma_f32_16x16x32_bf16 v[104:107], a[212:215], a[168:171], v[104:107]
buffer_store_dwordx4 v[16:19], v0, s[24:27], s60 offen offset:2048 sc1
v_mfma_f32_16x16x32_bf16 v[136:139], a[212:215], a[164:167], v[136:139]
ds_write_b128 v3, v[20:23] offset:7168
v_mfma_f32_16x16x32_bf16 v[136:139], a[216:219], a[160:163], v[136:139]
s_waitcnt lgkmcnt(5)
v_mfma_f32_16x16x32_bf16 v[168:171], a[216:219], a[156:159], v[168:171]
global_load_dwordx4 a[224:227], v0, s[74:75] offset:-4096
buffer_store_dwordx4 v[20:23], v0, s[24:27], s60 offen offset:3072 sc1
v_mfma_f32_16x16x32_bf16 v[168:171], a[212:215], a[152:155], v[168:171]
v_mfma_f32_16x16x32_bf16 v[200:203], a[212:215], a[148:151], v[200:203]
v_mfma_f32_16x16x32_bf16 v[200:203], a[216:219], a[144:147], v[200:203]
s_waitcnt lgkmcnt(0)
v_mfma_f32_16x16x32_bf16 v[232:235], a[216:219], a[140:143], v[232:235]
s_barrier
v_mfma_f32_16x16x32_bf16 v[232:235], a[212:215], a[136:139], v[232:235]
v_mfma_f32_16x16x32_bf16 a[240:243], a[212:215], a[132:135], a[240:243]
global_load_dwordx4 a[212:215], v0, s[72:73] offset:-3072
v_mfma_f32_16x16x32_bf16 a[240:243], a[216:219], a[128:131], a[240:243]
s_waitcnt vmcnt(10)
v_mfma_f32_16x16x32_bf16 a[244:247], a[208:211], a[128:131], a[244:247]
v_mfma_f32_16x16x32_bf16 a[244:247], a[192:195], a[132:135], a[244:247]
v_mfma_f32_16x16x32_bf16 v[236:239], a[192:195], a[136:139], v[236:239]
global_load_dwordx4 a[216:219], v0, s[74:75] offset:-3072
v_mfma_f32_16x16x32_bf16 v[236:239], a[208:211], a[140:143], v[236:239]
v_mfma_f32_16x16x32_bf16 v[204:207], a[208:211], a[144:147], v[204:207]
v_mfma_f32_16x16x32_bf16 v[204:207], a[192:195], a[148:151], v[204:207]
v_mfma_f32_16x16x32_bf16 v[172:175], a[192:195], a[152:155], v[172:175]
v_mfma_f32_16x16x32_bf16 v[172:175], a[208:211], a[156:159], v[172:175]
v_mfma_f32_16x16x32_bf16 v[140:143], a[208:211], a[160:163], v[140:143]
v_mfma_f32_16x16x32_bf16 v[140:143], a[192:195], a[164:167], v[140:143]
v_mfma_f32_16x16x32_bf16 v[108:111], a[192:195], a[168:171], v[108:111]
v_mfma_f32_16x16x32_bf16 v[108:111], a[208:211], a[172:175], v[108:111]
v_mfma_f32_16x16x32_bf16 v[76:79], a[208:211], a[176:179], v[76:79]
v_mfma_f32_16x16x32_bf16 v[76:79], a[192:195], a[180:183], v[76:79]
v_mfma_f32_16x16x32_bf16 v[44:47], a[192:195], a[184:187], v[44:47]
global_load_dwordx4 a[192:195], v0, s[72:73] offset:-2048
v_mfma_f32_16x16x32_bf16 v[44:47], a[208:211], a[188:191], v[44:47]
s_waitcnt vmcnt(9)
v_mfma_f32_16x16x32_bf16 v[48:51], a[200:203], a[188:191], v[48:51]
v_mfma_f32_16x16x32_bf16 v[48:51], a[220:223], a[184:187], v[48:51]
v_mfma_f32_16x16x32_bf16 v[80:83], a[220:223], a[180:183], v[80:83]
global_load_dwordx4 a[208:211], v0, s[74:75] offset:-2048
v_mfma_f32_16x16x32_bf16 v[80:83], a[200:203], a[176:179], v[80:83]
v_mfma_f32_16x16x32_bf16 v[112:115], a[200:203], a[172:175], v[112:115]
v_mfma_f32_16x16x32_bf16 v[112:115], a[220:223], a[168:171], v[112:115]
v_mfma_f32_16x16x32_bf16 v[144:147], a[220:223], a[164:167], v[144:147]
v_mfma_f32_16x16x32_bf16 v[144:147], a[200:203], a[160:163], v[144:147]
v_mfma_f32_16x16x32_bf16 v[176:179], a[200:203], a[156:159], v[176:179]
v_mfma_f32_16x16x32_bf16 v[176:179], a[220:223], a[152:155], v[176:179]
v_mfma_f32_16x16x32_bf16 v[208:211], a[220:223], a[148:151], v[208:211]
v_mfma_f32_16x16x32_bf16 v[208:211], a[200:203], a[144:147], v[208:211]
v_mfma_f32_16x16x32_bf16 v[240:243], a[200:203], a[140:143], v[240:243]
v_accvgpr_read_b32 v9, a64
v_accvgpr_read_b32 v11, a65
v_mfma_f32_16x16x32_bf16 v[240:243], a[220:223], a[136:139], v[240:243]
v_lshlrev_b32 v8, 16, v9
v_mfma_f32_16x16x32_bf16 a[248:251], a[220:223], a[132:135], a[248:251]
global_load_dwordx4 a[220:223], v0, s[72:73] offset:-1024
v_mfma_f32_16x16x32_bf16 a[248:251], a[200:203], a[128:131], a[248:251]
v_add_u32 v2, 65536, v0
v_lshlrev_b32 v10, 16, v11
s_waitcnt vmcnt(9)
v_mfma_f32_16x16x32_bf16 a[252:255], a[204:207], a[128:131], a[252:255]
ds_read_b128 a[128:131], v2 offset:0
v_and_b32 v9, s53, v9
v_mfma_f32_16x16x32_bf16 a[252:255], a[228:231], a[132:135], a[252:255]
ds_read_b128 a[132:135], v2 offset:8192
v_and_b32 v11, s53, v11
v_mfma_f32_16x16x32_bf16 v[244:247], a[228:231], a[136:139], v[244:247]
ds_read_b128 a[136:139], v2 offset:9216
v_accvgpr_read_b32 v13, a66
v_mfma_f32_16x16x32_bf16 v[244:247], a[204:207], a[140:143], v[244:247]
ds_read_b128 a[140:143], v2 offset:1024
v_accvgpr_read_b32 v15, a67
v_mfma_f32_16x16x32_bf16 v[212:215], a[204:207], a[144:147], v[212:215]
ds_read_b128 a[144:147], v2 offset:2048
v_lshlrev_b32 v12, 16, v13
v_mfma_f32_16x16x32_bf16 v[212:215], a[228:231], a[148:151], v[212:215]
ds_read_b128 a[148:151], v2 offset:10240
v_lshlrev_b32 v14, 16, v15
v_mfma_f32_16x16x32_bf16 v[180:183], a[228:231], a[152:155], v[180:183]
ds_read_b128 a[152:155], v2 offset:11264
v_and_b32 v13, s53, v13
v_mfma_f32_16x16x32_bf16 v[180:183], a[204:207], a[156:159], v[180:183]
ds_read_b128 a[156:159], v2 offset:3072
v_and_b32 v15, s53, v15
v_mfma_f32_16x16x32_bf16 v[148:151], a[204:207], a[160:163], v[148:151]
ds_read_b128 a[160:163], v2 offset:4096
s_add_u32 s54, s57, 0
v_mfma_f32_16x16x32_bf16 v[148:151], a[228:231], a[164:167], v[148:151]
ds_read_b128 a[164:167], v2 offset:12288
v_add_u32 v3, s54, v0
v_mfma_f32_16x16x32_bf16 v[116:119], a[228:231], a[168:171], v[116:119]
ds_read_b128 a[168:171], v2 offset:13312
v_mul_f32 v8, v8, v40
v_mfma_f32_16x16x32_bf16 v[116:119], a[204:207], a[172:175], v[116:119]
ds_read_b128 a[172:175], v2 offset:5120
v_mul_f32 v9, v9, v41
v_mfma_f32_16x16x32_bf16 v[84:87], a[204:207], a[176:179], v[84:87]
ds_read_b128 a[176:179], v2 offset:6144
v_mul_f32 v10, v10, v42
v_mfma_f32_16x16x32_bf16 v[84:87], a[228:231], a[180:183], v[84:87]
ds_read_b128 a[180:183], v2 offset:14336
v_mul_f32 v11, v11, v43
v_mfma_f32_16x16x32_bf16 v[52:55], a[228:231], a[184:187], v[52:55]
ds_read_b128 a[184:187], v2 offset:15360
v_cvt_pk_bf16_f32 v16, v8, v9
v_mfma_f32_16x16x32_bf16 v[52:55], a[204:207], a[188:191], v[52:55]
ds_read_b128 a[188:191], v2 offset:7168
s_waitcnt vmcnt(6) lgkmcnt(12)
v_mfma_f32_16x16x32_bf16 v[24:27], a[196:199], a[128:131], v[24:27]
global_load_dwordx4 a[200:203], v0, s[74:75] offset:-1024
v_mfma_f32_16x16x32_bf16 v[24:27], a[224:227], a[132:135], v[24:27]
s_add_u32 s72, s12, 331776
s_addc_u32 s73, s13, 0
v_mfma_f32_16x16x32_bf16 v[56:59], a[224:227], a[136:139], v[56:59]
s_add_u32 s74, s12, 364544
s_addc_u32 s75, s13, 0
v_mfma_f32_16x16x32_bf16 v[56:59], a[196:199], a[140:143], v[56:59]
v_cvt_pk_bf16_f32 v17, v10, v11
s_waitcnt lgkmcnt(8)
v_mfma_f32_16x16x32_bf16 v[88:91], a[196:199], a[144:147], v[88:91]
global_load_dwordx4 a[228:231], v0, s[72:73] offset:-4096
v_mfma_f32_16x16x32_bf16 v[88:91], a[224:227], a[148:151], v[88:91]
v_accvgpr_read_b32 v9, a68
v_accvgpr_read_b32 v11, a69
v_mfma_f32_16x16x32_bf16 v[120:123], a[224:227], a[152:155], v[120:123]
v_lshlrev_b32 v8, 16, v9
v_lshlrev_b32 v10, 16, v11
v_mfma_f32_16x16x32_bf16 v[120:123], a[196:199], a[156:159], v[120:123]
s_waitcnt lgkmcnt(4)
v_mfma_f32_16x16x32_bf16 v[152:155], a[196:199], a[160:163], v[152:155]
global_load_dwordx4 a[204:207], v0, s[74:75] offset:-4096
v_mfma_f32_16x16x32_bf16 v[152:155], a[224:227], a[164:167], v[152:155]
s_mov_b32 s38, 132
s_waitcnt vmcnt(8)
v_mfma_f32_16x16x32_bf16 v[184:187], a[224:227], a[168:171], v[184:187]
buffer_store_dword v6, v0, s[36:39], 0 offen offset:128 sc1
v_mfma_f32_16x16x32_bf16 v[184:187], a[196:199], a[172:175], v[184:187]
v_and_b32 v9, s53, v9
v_and_b32 v11, s53, v11
s_waitcnt lgkmcnt(0)
v_mfma_f32_16x16x32_bf16 v[216:219], a[196:199], a[176:179], v[216:219]
v_mul_f32 v12, v12, v44
v_mfma_f32_16x16x32_bf16 v[216:219], a[224:227], a[180:183], v[216:219]
v_mul_f32 v13, v13, v45
v_mfma_f32_16x16x32_bf16 v[248:251], a[224:227], a[184:187], v[248:251]
global_load_dwordx4 a[224:227], v0, s[72:73] offset:-3072
v_mfma_f32_16x16x32_bf16 v[248:251], a[196:199], a[188:191], v[248:251]
v_mul_f32 v14, v14, v46
v_mul_f32 v15, v15, v47
s_waitcnt vmcnt(8)
v_mfma_f32_16x16x32_bf16 v[252:255], a[212:215], a[188:191], v[252:255]
v_cvt_pk_bf16_f32 v18, v12, v13
v_cvt_pk_bf16_f32 v19, v14, v15
v_mfma_f32_16x16x32_bf16 v[252:255], a[216:219], a[184:187], v[252:255]
v_accvgpr_read_b32 v13, a70
v_mfma_f32_16x16x32_bf16 v[220:223], a[216:219], a[180:183], v[220:223]
global_load_dwordx4 a[196:199], v0, s[74:75] offset:-3072
v_mfma_f32_16x16x32_bf16 v[220:223], a[212:215], a[176:179], v[220:223]
v_accvgpr_read_b32 v15, a71
v_lshlrev_b32 v12, 16, v13
v_mfma_f32_16x16x32_bf16 v[188:191], a[212:215], a[172:175], v[188:191]
v_lshlrev_b32 v14, 16, v15
v_and_b32 v13, s53, v13
v_mfma_f32_16x16x32_bf16 v[188:191], a[216:219], a[168:171], v[188:191]
v_and_b32 v15, s53, v15
v_mfma_f32_16x16x32_bf16 v[156:159], a[216:219], a[164:167], v[156:159]
ds_write_b128 v3, v[16:19] offset:0
v_mfma_f32_16x16x32_bf16 v[156:159], a[212:215], a[160:163], v[156:159]
v_mul_f32 v8, v8, v72
v_mul_f32 v9, v9, v73
v_mfma_f32_16x16x32_bf16 v[124:127], a[212:215], a[156:159], v[124:127]
v_mul_f32 v10, v10, v74
v_mul_f32 v11, v11, v75
v_mfma_f32_16x16x32_bf16 v[124:127], a[216:219], a[152:155], v[124:127]
v_cvt_pk_bf16_f32 v20, v8, v9
v_cvt_pk_bf16_f32 v21, v10, v11
v_mfma_f32_16x16x32_bf16 v[92:95], a[216:219], a[148:151], v[92:95]
v_accvgpr_read_b32 v9, a72
v_accvgpr_read_b32 v11, a73
v_mfma_f32_16x16x32_bf16 v[92:95], a[212:215], a[144:147], v[92:95]
v_lshlrev_b32 v8, 16, v9
v_lshlrev_b32 v10, 16, v11
v_mfma_f32_16x16x32_bf16 v[60:63], a[212:215], a[140:143], v[60:63]
v_and_b32 v9, s53, v9
v_and_b32 v11, s53, v11
s_mov_b32 s60, 65536
v_mfma_f32_16x16x32_bf16 v[60:63], a[216:219], a[136:139], v[60:63]
buffer_store_dwordx4 v[16:19], v0, s[24:27], s60 offen offset:0 sc1
v_mfma_f32_16x16x32_bf16 v[28:31], a[216:219], a[132:135], v[28:31]
global_load_dwordx4 a[216:219], v0, s[72:73] offset:-2048
v_mfma_f32_16x16x32_bf16 v[28:31], a[212:215], a[128:131], v[28:31]
s_waitcnt vmcnt(9)
v_mfma_f32_16x16x32_bf16 v[32:35], a[192:195], a[128:131], v[32:35]
v_mul_f32 v12, v12, v76
v_mul_f32 v13, v13, v77
v_mfma_f32_16x16x32_bf16 v[32:35], a[208:211], a[132:135], v[32:35]
v_mul_f32 v14, v14, v78
v_mfma_f32_16x16x32_bf16 v[64:67], a[208:211], a[136:139], v[64:67]
global_load_dwordx4 a[212:215], v0, s[74:75] offset:-2048
v_mfma_f32_16x16x32_bf16 v[64:67], a[192:195], a[140:143], v[64:67]
v_mul_f32 v15, v15, v79
v_cvt_pk_bf16_f32 v22, v12, v13
v_mfma_f32_16x16x32_bf16 v[96:99], a[192:195], a[144:147], v[96:99]
v_cvt_pk_bf16_f32 v23, v14, v15
v_accvgpr_read_b32 v13, a74
v_mfma_f32_16x16x32_bf16 v[96:99], a[208:211], a[148:151], v[96:99]
v_accvgpr_read_b32 v15, a75
v_lshlrev_b32 v12, 16, v13
v_mfma_f32_16x16x32_bf16 v[128:131], a[208:211], a[152:155], v[128:131]
v_lshlrev_b32 v14, 16, v15
v_and_b32 v13, s53, v13
v_mfma_f32_16x16x32_bf16 v[128:131], a[192:195], a[156:159], v[128:131]
v_and_b32 v15, s53, v15
v_mfma_f32_16x16x32_bf16 v[160:163], a[192:195], a[160:163], v[160:163]
ds_write_b128 v3, v[20:23] offset:1024
v_mfma_f32_16x16x32_bf16 v[160:163], a[208:211], a[164:167], v[160:163]
v_mul_f32 v8, v8, v104
v_mul_f32 v9, v9, v105
v_mfma_f32_16x16x32_bf16 v[192:195], a[208:211], a[168:171], v[192:195]
v_mul_f32 v10, v10, v106
v_mul_f32 v11, v11, v107
v_mfma_f32_16x16x32_bf16 v[192:195], a[192:195], a[172:175], v[192:195]
v_cvt_pk_bf16_f32 v16, v8, v9
v_cvt_pk_bf16_f32 v17, v10, v11
v_mfma_f32_16x16x32_bf16 v[224:227], a[192:195], a[176:179], v[224:227]
v_accvgpr_read_b32 v9, a76
v_accvgpr_read_b32 v11, a77
v_mfma_f32_16x16x32_bf16 v[224:227], a[208:211], a[180:183], v[224:227]
v_lshlrev_b32 v8, 16, v9
v_mfma_f32_16x16x32_bf16 a[232:235], a[208:211], a[184:187], a[232:235]
global_load_dwordx4 a[208:211], v0, s[72:73] offset:-1024
v_mfma_f32_16x16x32_bf16 a[232:235], a[192:195], a[188:191], a[232:235]
v_lshlrev_b32 v10, 16, v11
v_and_b32 v9, s53, v9
s_waitcnt vmcnt(9)
v_mfma_f32_16x16x32_bf16 a[236:239], a[220:223], a[188:191], a[236:239]
ds_read_b128 a[188:191], v2 offset:16384
v_and_b32 v11, s53, v11
v_mfma_f32_16x16x32_bf16 a[236:239], a[200:203], a[184:187], a[236:239]
ds_read_b128 a[184:187], v2 offset:24576
v_mfma_f32_16x16x32_bf16 v[228:231], a[200:203], a[180:183], v[228:231]
ds_read_b128 a[180:183], v2 offset:25600
v_mfma_f32_16x16x32_bf16 v[228:231], a[220:223], a[176:179], v[228:231]
ds_read_b128 a[176:179], v2 offset:17408
v_mul_f32 v12, v12, v108
v_mfma_f32_16x16x32_bf16 v[196:199], a[220:223], a[172:175], v[196:199]
ds_read_b128 a[172:175], v2 offset:18432
v_mul_f32 v13, v13, v109
v_mfma_f32_16x16x32_bf16 v[196:199], a[200:203], a[168:171], v[196:199]
ds_read_b128 a[168:171], v2 offset:26624
v_mul_f32 v14, v14, v110
v_mfma_f32_16x16x32_bf16 v[164:167], a[200:203], a[164:167], v[164:167]
ds_read_b128 a[164:167], v2 offset:27648
v_mul_f32 v15, v15, v111
v_mfma_f32_16x16x32_bf16 v[164:167], a[220:223], a[160:163], v[164:167]
ds_read_b128 a[160:163], v2 offset:19456
v_cvt_pk_bf16_f32 v18, v12, v13
v_mfma_f32_16x16x32_bf16 v[132:135], a[220:223], a[156:159], v[132:135]
ds_read_b128 a[156:159], v2 offset:20480
v_cvt_pk_bf16_f32 v19, v14, v15
v_mfma_f32_16x16x32_bf16 v[132:135], a[200:203], a[152:155], v[132:135]
ds_read_b128 a[152:155], v2 offset:28672
v_accvgpr_read_b32 v13, a78
v_mfma_f32_16x16x32_bf16 v[100:103], a[200:203], a[148:151], v[100:103]
ds_read_b128 a[148:151], v2 offset:29696
v_accvgpr_read_b32 v15, a79
v_mfma_f32_16x16x32_bf16 v[100:103], a[220:223], a[144:147], v[100:103]
ds_read_b128 a[144:147], v2 offset:21504
v_lshlrev_b32 v12, 16, v13
v_mfma_f32_16x16x32_bf16 v[68:71], a[220:223], a[140:143], v[68:71]
ds_read_b128 a[140:143], v2 offset:22528
v_lshlrev_b32 v14, 16, v15
v_mfma_f32_16x16x32_bf16 v[68:71], a[200:203], a[136:139], v[68:71]
ds_read_b128 a[136:139], v2 offset:30720
v_and_b32 v13, s53, v13
v_mfma_f32_16x16x32_bf16 v[36:39], a[200:203], a[132:135], v[36:39]
ds_read_b128 a[132:135], v2 offset:31744
v_and_b32 v15, s53, v15
v_mfma_f32_16x16x32_bf16 v[36:39], a[220:223], a[128:131], v[36:39]
ds_read_b128 a[128:131], v2 offset:23552
s_waitcnt vmcnt(7) lgkmcnt(12)
v_mfma_f32_16x16x32_bf16 v[24:27], a[228:231], a[188:191], v[24:27]
global_load_dwordx4 a[192:195], v0, s[74:75] offset:-1024
v_mfma_f32_16x16x32_bf16 v[24:27], a[204:207], a[184:187], v[24:27]
s_add_u32 s72, s12, 274432
s_addc_u32 s73, s13, 0
v_mfma_f32_16x16x32_bf16 v[56:59], a[204:207], a[180:183], v[56:59]
s_add_u32 s74, s12, 307200
s_addc_u32 s75, s13, 0
v_mfma_f32_16x16x32_bf16 v[56:59], a[228:231], a[176:179], v[56:59]
s_waitcnt lgkmcnt(8)
v_mfma_f32_16x16x32_bf16 v[88:91], a[228:231], a[172:175], v[88:91]
global_load_dwordx4 a[200:203], v0, s[72:73] offset:-4096
v_mfma_f32_16x16x32_bf16 v[88:91], a[204:207], a[168:171], v[88:91]
s_mov_b32 s34, 64
v_mfma_f32_16x16x32_bf16 v[120:123], a[204:207], a[164:167], v[120:123]
buffer_load_dword v5, v0, s[32:35], 0 offen offset:0 sc1
v_mfma_f32_16x16x32_bf16 v[120:123], a[228:231], a[160:163], v[120:123]
s_waitcnt lgkmcnt(4)
v_mfma_f32_16x16x32_bf16 v[152:155], a[228:231], a[156:159], v[152:155]
global_load_dwordx4 a[220:223], v0, s[74:75] offset:-4096
v_mfma_f32_16x16x32_bf16 v[152:155], a[204:207], a[152:155], v[152:155]
buffer_store_dwordx4 v[20:23], v0, s[24:27], s60 offen offset:1024 sc1
v_mfma_f32_16x16x32_bf16 v[184:187], a[204:207], a[148:151], v[184:187]
ds_write_b128 v3, v[16:19] offset:2048
v_mfma_f32_16x16x32_bf16 v[184:187], a[228:231], a[144:147], v[184:187]
v_mul_f32 v8, v8, v136
v_mul_f32 v9, v9, v137
s_waitcnt lgkmcnt(1)
v_mfma_f32_16x16x32_bf16 v[216:219], a[228:231], a[140:143], v[216:219]
v_mul_f32 v10, v10, v138
v_mul_f32 v11, v11, v139
v_mfma_f32_16x16x32_bf16 v[216:219], a[204:207], a[136:139], v[216:219]
v_cvt_pk_bf16_f32 v20, v8, v9
v_mfma_f32_16x16x32_bf16 v[248:251], a[204:207], a[132:135], v[248:251]
global_load_dwordx4 a[204:207], v0, s[72:73] offset:-3072
v_mfma_f32_16x16x32_bf16 v[248:251], a[228:231], a[128:131], v[248:251]
v_cvt_pk_bf16_f32 v21, v10, v11
v_accvgpr_read_b32 v9, a80
s_waitcnt vmcnt(10)
v_mfma_f32_16x16x32_bf16 v[252:255], a[224:227], a[128:131], v[252:255]
v_accvgpr_read_b32 v11, a81
v_lshlrev_b32 v8, 16, v9
v_mfma_f32_16x16x32_bf16 v[252:255], a[196:199], a[132:135], v[252:255]
v_lshlrev_b32 v10, 16, v11
v_mfma_f32_16x16x32_bf16 v[220:223], a[196:199], a[136:139], v[220:223]
global_load_dwordx4 a[228:231], v0, s[74:75] offset:-3072
v_mfma_f32_16x16x32_bf16 v[220:223], a[224:227], a[140:143], v[220:223]
v_and_b32 v9, s53, v9
v_and_b32 v11, s53, v11
v_mfma_f32_16x16x32_bf16 v[188:191], a[224:227], a[144:147], v[188:191]
buffer_store_dwordx4 v[16:19], v0, s[24:27], s60 offen offset:2048 sc1
v_mfma_f32_16x16x32_bf16 v[188:191], a[196:199], a[148:151], v[188:191]
v_mul_f32 v12, v12, v140
v_mul_f32 v13, v13, v141
v_mfma_f32_16x16x32_bf16 v[156:159], a[196:199], a[152:155], v[156:159]
v_mul_f32 v14, v14, v142
v_mul_f32 v15, v15, v143
v_mfma_f32_16x16x32_bf16 v[156:159], a[224:227], a[156:159], v[156:159]
v_cvt_pk_bf16_f32 v22, v12, v13
v_cvt_pk_bf16_f32 v23, v14, v15
v_mfma_f32_16x16x32_bf16 v[124:127], a[224:227], a[160:163], v[124:127]
v_accvgpr_read_b32 v13, a82
v_accvgpr_read_b32 v15, a83
v_mfma_f32_16x16x32_bf16 v[124:127], a[196:199], a[164:167], v[124:127]
v_lshlrev_b32 v12, 16, v13
v_lshlrev_b32 v14, 16, v15
v_mfma_f32_16x16x32_bf16 v[92:95], a[196:199], a[168:171], v[92:95]
v_and_b32 v13, s53, v13
v_and_b32 v15, s53, v15
v_mfma_f32_16x16x32_bf16 v[92:95], a[224:227], a[172:175], v[92:95]
ds_write_b128 v3, v[20:23] offset:3072
v_mfma_f32_16x16x32_bf16 v[60:63], a[224:227], a[176:179], v[60:63]
v_mul_f32 v8, v8, v168
v_mul_f32 v9, v9, v169
v_mfma_f32_16x16x32_bf16 v[60:63], a[196:199], a[180:183], v[60:63]
v_mul_f32 v10, v10, v170
v_mfma_f32_16x16x32_bf16 v[28:31], a[196:199], a[184:187], v[28:31]
global_load_dwordx4 a[196:199], v0, s[72:73] offset:-2048
v_mfma_f32_16x16x32_bf16 v[28:31], a[224:227], a[188:191], v[28:31]
v_mul_f32 v11, v11, v171
v_cvt_pk_bf16_f32 v16, v8, v9
s_waitcnt vmcnt(10)
v_mfma_f32_16x16x32_bf16 v[32:35], a[216:219], a[188:191], v[32:35]
v_cvt_pk_bf16_f32 v17, v10, v11
v_accvgpr_read_b32 v9, a84
v_mfma_f32_16x16x32_bf16 v[32:35], a[212:215], a[184:187], v[32:35]
v_accvgpr_read_b32 v11, a85
v_mfma_f32_16x16x32_bf16 v[64:67], a[212:215], a[180:183], v[64:67]
global_load_dwordx4 a[224:227], v0, s[74:75] offset:-2048
v_mfma_f32_16x16x32_bf16 v[64:67], a[216:219], a[176:179], v[64:67]
v_lshlrev_b32 v8, 16, v9
v_lshlrev_b32 v10, 16, v11
L_pad8:
s_cbranch_execz L_pad12
v_mfma_f32_16x16x32_bf16 v[96:99], a[216:219], a[172:175], v[96:99]
v_and_b32 v9, s53, v9
v_and_b32 v11, s53, v11
v_mfma_f32_16x16x32_bf16 v[96:99], a[212:215], a[168:171], v[96:99]
buffer_store_dwordx4 v[20:23], v0, s[24:27], s60 offen offset:3072 sc1
v_mfma_f32_16x16x32_bf16 v[128:131], a[212:215], a[164:167], v[128:131]
v_mul_f32 v12, v12, v172
v_mul_f32 v13, v13, v173
v_mfma_f32_16x16x32_bf16 v[128:131], a[216:219], a[160:163], v[128:131]
v_mul_f32 v14, v14, v174
v_mul_f32 v15, v15, v175
v_mfma_f32_16x16x32_bf16 v[160:163], a[216:219], a[156:159], v[160:163]
v_cvt_pk_bf16_f32 v18, v12, v13
v_cvt_pk_bf16_f32 v19, v14, v15
v_mfma_f32_16x16x32_bf16 v[160:163], a[212:215], a[152:155], v[160:163]
v_accvgpr_read_b32 v13, a86
v_accvgpr_read_b32 v15, a87
v_mfma_f32_16x16x32_bf16 v[192:195], a[212:215], a[148:151], v[192:195]
v_lshlrev_b32 v12, 16, v13
v_lshlrev_b32 v14, 16, v15
v_mfma_f32_16x16x32_bf16 v[192:195], a[216:219], a[144:147], v[192:195]
v_and_b32 v13, s53, v13
v_and_b32 v15, s53, v15
v_mfma_f32_16x16x32_bf16 v[224:227], a[216:219], a[140:143], v[224:227]
ds_write_b128 v3, v[16:19] offset:4096
v_mfma_f32_16x16x32_bf16 v[224:227], a[212:215], a[136:139], v[224:227]
v_mul_f32 v8, v8, v200
v_mfma_f32_16x16x32_bf16 a[232:235], a[212:215], a[132:135], a[232:235]
global_load_dwordx4 a[212:215], v0, s[72:73] offset:-1024
v_mfma_f32_16x16x32_bf16 a[232:235], a[216:219], a[128:131], a[232:235]
v_add_u32 v2, 131072, v0
v_mul_f32 v9, v9, v201
s_waitcnt vmcnt(11)
v_mfma_f32_16x16x32_bf16 a[236:239], a[208:211], a[128:131], a[236:239]
ds_read_b128 a[128:131], v2 offset:0
v_mul_f32 v10, v10, v202
v_mfma_f32_16x16x32_bf16 a[236:239], a[192:195], a[132:135], a[236:239]
ds_read_b128 a[132:135], v2 offset:8192
v_mul_f32 v11, v11, v203
v_mfma_f32_16x16x32_bf16 v[228:231], a[192:195], a[136:139], v[228:231]
ds_read_b128 a[136:139], v2 offset:9216
v_cvt_pk_bf16_f32 v20, v8, v9
v_mfma_f32_16x16x32_bf16 v[228:231], a[208:211], a[140:143], v[228:231]
ds_read_b128 a[140:143], v2 offset:1024
v_cvt_pk_bf16_f32 v21, v10, v11
v_mfma_f32_16x16x32_bf16 v[196:199], a[208:211], a[144:147], v[196:199]
ds_read_b128 a[144:147], v2 offset:2048
v_accvgpr_read_b32 v9, a88
v_mfma_f32_16x16x32_bf16 v[196:199], a[192:195], a[148:151], v[196:199]
ds_read_b128 a[148:151], v2 offset:10240
v_accvgpr_read_b32 v11, a89
v_mfma_f32_16x16x32_bf16 v[164:167], a[192:195], a[152:155], v[164:167]
ds_read_b128 a[152:155], v2 offset:11264
v_lshlrev_b32 v8, 16, v9
v_mfma_f32_16x16x32_bf16 v[164:167], a[208:211], a[156:159], v[164:167]
ds_read_b128 a[156:159], v2 offset:3072
v_lshlrev_b32 v10, 16, v11
v_mfma_f32_16x16x32_bf16 v[132:135], a[208:211], a[160:163], v[132:135]
ds_read_b128 a[160:163], v2 offset:4096
v_and_b32 v9, s53, v9
v_mfma_f32_16x16x32_bf16 v[132:135], a[192:195], a[164:167], v[132:135]
ds_read_b128 a[164:167], v2 offset:12288
v_and_b32 v11, s53, v11
v_mfma_f32_16x16x32_bf16 v[100:103], a[192:195], a[168:171], v[100:103]
ds_read_b128 a[168:171], v2 offset:13312
s_mov_b32 s60, 69632
v_mfma_f32_16x16x32_bf16 v[100:103], a[208:211], a[172:175], v[100:103]
ds_read_b128 a[172:175], v2 offset:5120
v_mfma_f32_16x16x32_bf16 v[68:71], a[208:211], a[176:179], v[68:71]
ds_read_b128 a[176:179], v2 offset:6144
v_mfma_f32_16x16x32_bf16 v[68:71], a[192:195], a[180:183], v[68:71]
ds_read_b128 a[180:183], v2 offset:14336
v_mul_f32 v12, v12, v204
v_mfma_f32_16x16x32_bf16 v[36:39], a[192:195], a[184:187], v[36:39]
ds_read_b128 a[184:187], v2 offset:15360
v_mul_f32 v13, v13, v205
v_mfma_f32_16x16x32_bf16 v[36:39], a[208:211], a[188:191], v[36:39]
ds_read_b128 a[188:191], v2 offset:7168
s_waitcnt vmcnt(8) lgkmcnt(12)
v_mfma_f32_16x16x32_bf16 v[24:27], a[200:203], a[128:131], v[24:27]
global_load_dwordx4 a[216:219], v0, s[74:75] offset:-1024
v_mfma_f32_16x16x32_bf16 v[24:27], a[220:223], a[132:135], v[24:27]
s_add_u32 s72, s12, 339968
s_addc_u32 s73, s13, 0
v_mfma_f32_16x16x32_bf16 v[56:59], a[220:223], a[136:139], v[56:59]
s_add_u32 s74, s12, 372736
s_addc_u32 s75, s13, 0
v_mfma_f32_16x16x32_bf16 v[56:59], a[200:203], a[140:143], v[56:59]
s_waitcnt lgkmcnt(8)
v_mfma_f32_16x16x32_bf16 v[88:91], a[200:203], a[144:147], v[88:91]
global_load_dwordx4 a[192:195], v0, s[72:73] offset:-4096
v_mfma_f32_16x16x32_bf16 v[88:91], a[220:223], a[148:151], v[88:91]
v_cmp_ne_u32 vcc, 16256, v5
v_mfma_f32_16x16x32_bf16 v[120:123], a[220:223], a[152:155], v[120:123]
buffer_store_dwordx4 v[16:19], v0, s[24:27], s60 offen offset:0 sc1
v_mfma_f32_16x16x32_bf16 v[120:123], a[200:203], a[156:159], v[120:123]
v_mul_f32 v14, v14, v206
s_waitcnt lgkmcnt(4)
v_mfma_f32_16x16x32_bf16 v[152:155], a[200:203], a[160:163], v[152:155]
global_load_dwordx4 a[208:211], v0, s[74:75] offset:-4096
v_mfma_f32_16x16x32_bf16 v[152:155], a[220:223], a[164:167], v[152:155]
v_mul_f32 v15, v15, v207
v_cvt_pk_bf16_f32 v22, v12, v13
v_mfma_f32_16x16x32_bf16 v[184:187], a[220:223], a[168:171], v[184:187]
v_cvt_pk_bf16_f32 v23, v14, v15
v_accvgpr_read_b32 v13, a90
v_mfma_f32_16x16x32_bf16 v[184:187], a[200:203], a[172:175], v[184:187]
s_and_b32 s3, vcc_lo, 15
s_cbranch_scc1 L_slow2
L_back2:
s_waitcnt lgkmcnt(0)
v_mfma_f32_16x16x32_bf16 v[216:219], a[200:203], a[176:179], v[216:219]
v_accvgpr_read_b32 v15, a91
v_lshlrev_b32 v12, 16, v13
v_mfma_f32_16x16x32_bf16 v[216:219], a[220:223], a[180:183], v[216:219]
v_lshlrev_b32 v14, 16, v15
v_mfma_f32_16x16x32_bf16 v[248:251], a[220:223], a[184:187], v[248:251]
global_load_dwordx4 a[220:223], v0, s[72:73] offset:-3072
v_mfma_f32_16x16x32_bf16 v[248:251], a[200:203], a[188:191], v[248:251]
v_and_b32 v13, s53, v13
v_and_b32 v15, s53, v15
s_waitcnt vmcnt(10)
v_mfma_f32_16x16x32_bf16 v[252:255], a[204:207], a[188:191], v[252:255]
ds_write_b128 v3, v[20:23] offset:5120
v_mfma_f32_16x16x32_bf16 v[252:255], a[228:231], a[184:187], v[252:255]
s_add_u32 m0, s56, 98304
v_mul_f32 v8, v8, v232
v_mfma_f32_16x16x32_bf16 v[220:223], a[228:231], a[180:183], v[220:223]
global_load_dwordx4 a[200:203], v0, s[74:75] offset:-3072
v_mfma_f32_16x16x32_bf16 v[220:223], a[204:207], a[176:179], v[220:223]
v_mul_f32 v9, v9, v233
v_mul_f32 v10, v10, v234
v_mfma_f32_16x16x32_bf16 v[188:191], a[204:207], a[172:175], v[188:191]
s_add_u32 s30, s28, 0
s_addc_u32 s31, s29, 0
v_mfma_f32_16x16x32_bf16 v[188:191], a[228:231], a[168:171], v[188:191]
v_mul_f32 v11, v11, v235
v_cvt_pk_bf16_f32 v16, v8, v9
v_mfma_f32_16x16x32_bf16 v[156:159], a[228:231], a[164:167], v[156:159]
v_cvt_pk_bf16_f32 v17, v10, v11
v_accvgpr_read_b32 v9, a92
v_mfma_f32_16x16x32_bf16 v[156:159], a[204:207], a[160:163], v[156:159]
v_accvgpr_read_b32 v11, a93
v_mfma_f32_16x16x32_bf16 v[124:127], a[204:207], a[156:159], v[124:127]
global_load_lds_dwordx4 v0, s[30:31] nt
v_mfma_f32_16x16x32_bf16 v[124:127], a[228:231], a[152:155], v[124:127]
v_lshlrev_b32 v8, 16, v9
v_lshlrev_b32 v10, 16, v11
v_mfma_f32_16x16x32_bf16 v[92:95], a[228:231], a[148:151], v[92:95]
v_and_b32 v9, s53, v9
v_and_b32 v11, s53, v11
v_mfma_f32_16x16x32_bf16 v[92:95], a[204:207], a[144:147], v[92:95]
buffer_store_dwordx4 v[20:23], v0, s[24:27], s60 offen offset:1024 sc1
v_mfma_f32_16x16x32_bf16 v[60:63], a[204:207], a[140:143], v[60:63]
v_mul_f32 v12, v12, v236
v_mul_f32 v13, v13, v237
v_mfma_f32_16x16x32_bf16 v[60:63], a[228:231], a[136:139], v[60:63]
v_mul_f32 v14, v14, v238
v_mfma_f32_16x16x32_bf16 v[28:31], a[228:231], a[132:135], v[28:31]
global_load_dwordx4 a[228:231], v0, s[72:73] offset:-2048
v_mfma_f32_16x16x32_bf16 v[28:31], a[204:207], a[128:131], v[28:31]
v_mul_f32 v15, v15, v239
v_cvt_pk_bf16_f32 v18, v12, v13
s_waitcnt vmcnt(11)
v_mfma_f32_16x16x32_bf16 v[32:35], a[196:199], a[128:131], v[32:35]
v_cvt_pk_bf16_f32 v19, v14, v15
v_accvgpr_read_b32 v13, a94
v_mfma_f32_16x16x32_bf16 v[32:35], a[224:227], a[132:135], v[32:35]
v_accvgpr_read_b32 v15, a95
v_mfma_f32_16x16x32_bf16 v[64:67], a[224:227], a[136:139], v[64:67]
global_load_dwordx4 a[204:207], v0, s[74:75] offset:-2048
v_mfma_f32_16x16x32_bf16 v[64:67], a[196:199], a[140:143], v[64:67]
v_lshlrev_b32 v12, 16, v13
v_lshlrev_b32 v14, 16, v15
v_mfma_f32_16x16x32_bf16 v[96:99], a[196:199], a[144:147], v[96:99]
v_and_b32 v13, s53, v13
v_mfma_f32_16x16x32_bf16 v[96:99], a[224:227], a[148:151], v[96:99]
global_load_lds_dwordx4 v0, s[30:31] offset:1024 nt
v_mfma_f32_16x16x32_bf16 v[128:131], a[224:227], a[152:155], v[128:131]
v_and_b32 v15, s53, v15
v_mfma_f32_16x16x32_bf16 v[128:131], a[196:199], a[156:159], v[128:131]
ds_write_b128 v3, v[16:19] offset:6144
v_mfma_f32_16x16x32_bf16 v[160:163], a[196:199], a[160:163], v[160:163]
v_accvgpr_read_b32 v20, a240
v_accvgpr_read_b32 v21, a241
v_mfma_f32_16x16x32_bf16 v[160:163], a[224:227], a[164:167], v[160:163]
v_mul_f32 v8, v8, v20
v_mul_f32 v9, v9, v21
v_mfma_f32_16x16x32_bf16 v[192:195], a[224:227], a[168:171], v[192:195]
v_accvgpr_read_b32 v20, a242
v_accvgpr_read_b32 v21, a243
v_mfma_f32_16x16x32_bf16 v[192:195], a[196:199], a[172:175], v[192:195]
v_mul_f32 v10, v10, v20
v_mul_f32 v11, v11, v21
v_mfma_f32_16x16x32_bf16 v[224:227], a[196:199], a[176:179], v[224:227]
v_cvt_pk_bf16_f32 v20, v8, v9
v_cvt_pk_bf16_f32 v21, v10, v11
v_mfma_f32_16x16x32_bf16 v[224:227], a[224:227], a[180:183], v[224:227]
buffer_store_dwordx4 v[16:19], v0, s[24:27], s60 offen offset:2048 sc1
v_mfma_f32_16x16x32_bf16 a[232:235], a[224:227], a[184:187], a[232:235]
global_load_dwordx4 a[224:227], v0, s[72:73] offset:-1024
v_mfma_f32_16x16x32_bf16 a[232:235], a[196:199], a[188:191], a[232:235]
v_accvgpr_read_b32 v22, a244
s_waitcnt vmcnt(12)
v_mfma_f32_16x16x32_bf16 a[236:239], a[212:215], a[188:191], a[236:239]
ds_read_b128 a[188:191], v2 offset:16384
v_accvgpr_read_b32 v23, a245
v_mfma_f32_16x16x32_bf16 a[236:239], a[216:219], a[184:187], a[236:239]
ds_read_b128 a[184:187], v2 offset:24576
v_mul_f32 v12, v12, v22
v_mfma_f32_16x16x32_bf16 v[228:231], a[216:219], a[180:183], v[228:231]
ds_read_b128 a[180:183], v2 offset:25600
s_add_u32 m0, s56, 106496
v_mfma_f32_16x16x32_bf16 v[228:231], a[212:215], a[176:179], v[228:231]
ds_read_b128 a[176:179], v2 offset:17408
v_mul_f32 v13, v13, v23
v_mfma_f32_16x16x32_bf16 v[196:199], a[212:215], a[172:175], v[196:199]
ds_read_b128 a[172:175], v2 offset:18432
v_accvgpr_read_b32 v22, a246
v_mfma_f32_16x16x32_bf16 v[196:199], a[216:219], a[168:171], v[196:199]
ds_read_b128 a[168:171], v2 offset:26624
v_accvgpr_read_b32 v23, a247
v_mfma_f32_16x16x32_bf16 v[164:167], a[216:219], a[164:167], v[164:167]
ds_read_b128 a[164:167], v2 offset:27648
v_mul_f32 v14, v14, v22
v_mfma_f32_16x16x32_bf16 v[164:167], a[212:215], a[160:163], v[164:167]
ds_read_b128 a[160:163], v2 offset:19456
v_mul_f32 v15, v15, v23
v_mfma_f32_16x16x32_bf16 v[132:135], a[212:215], a[156:159], v[132:135]
ds_read_b128 a[156:159], v2 offset:20480
v_cvt_pk_bf16_f32 v22, v12, v13
v_mfma_f32_16x16x32_bf16 v[132:135], a[216:219], a[152:155], v[132:135]
ds_read_b128 a[152:155], v2 offset:28672
v_cvt_pk_bf16_f32 v23, v14, v15
v_mfma_f32_16x16x32_bf16 v[100:103], a[216:219], a[148:151], v[100:103]
ds_read_b128 a[148:151], v2 offset:29696
v_mfma_f32_16x16x32_bf16 v[100:103], a[212:215], a[144:147], v[100:103]
ds_read_b128 a[144:147], v2 offset:21504
v_mfma_f32_16x16x32_bf16 v[68:71], a[212:215], a[140:143], v[68:71]
ds_read_b128 a[140:143], v2 offset:22528
v_mfma_f32_16x16x32_bf16 v[68:71], a[216:219], a[136:139], v[68:71]
ds_read_b128 a[136:139], v2 offset:30720
v_mfma_f32_16x16x32_bf16 v[36:39], a[216:219], a[132:135], v[36:39]
ds_read_b128 a[132:135], v2 offset:31744
v_mfma_f32_16x16x32_bf16 v[36:39], a[212:215], a[128:131], v[36:39]
ds_read_b128 a[128:131], v2 offset:23552
s_waitcnt vmcnt(9) lgkmcnt(12)
v_mfma_f32_16x16x32_bf16 v[24:27], a[192:195], a[188:191], v[24:27]
global_load_dwordx4 a[196:199], v0, s[74:75] offset:-1024
v_mfma_f32_16x16x32_bf16 v[24:27], a[208:211], a[184:187], v[24:27]
s_add_u32 s72, s12, 282624
s_addc_u32 s73, s13, 0
v_mfma_f32_16x16x32_bf16 v[56:59], a[208:211], a[180:183], v[56:59]
s_add_u32 s74, s12, 315392
s_addc_u32 s75, s13, 0
v_mfma_f32_16x16x32_bf16 v[56:59], a[192:195], a[176:179], v[56:59]
v_accvgpr_read_b32 v9, a96
s_waitcnt lgkmcnt(8)
v_mfma_f32_16x16x32_bf16 v[88:91], a[192:195], a[172:175], v[88:91]
global_load_dwordx4 a[216:219], v0, s[72:73] offset:-4096
v_mfma_f32_16x16x32_bf16 v[88:91], a[208:211], a[168:171], v[88:91]
s_add_u32 s30, s28, 8192
s_addc_u32 s31, s29, 0
v_mfma_f32_16x16x32_bf16 v[120:123], a[208:211], a[164:167], v[120:123]
global_load_lds_dwordx4 v0, s[30:31] nt
v_mfma_f32_16x16x32_bf16 v[120:123], a[192:195], a[160:163], v[120:123]
s_waitcnt lgkmcnt(4)
v_mfma_f32_16x16x32_bf16 v[152:155], a[192:195], a[156:159], v[152:155]
global_load_dwordx4 a[212:215], v0, s[74:75] offset:-4096
ds_write_b128 v3, v[20:23] offset:7168
buffer_store_dwordx4 v[20:23], v0, s[24:27], s60 offen offset:3072 sc1
v_mfma_f32_16x16x32_bf16 v[152:155], a[208:211], a[152:155], v[152:155]
v_accvgpr_read_b32 v11, a97
v_lshlrev_b32 v8, 16, v9
v_mfma_f32_16x16x32_bf16 v[184:187], a[208:211], a[148:151], v[184:187]
v_lshlrev_b32 v10, 16, v11
v_mfma_f32_16x16x32_bf16 v[184:187], a[192:195], a[144:147], v[184:187]
v_and_b32 v9, s53, v9
s_waitcnt lgkmcnt(0)
v_mfma_f32_16x16x32_bf16 v[216:219], a[192:195], a[140:143], v[216:219]
v_and_b32 v11, s53, v11
s_barrier
v_mfma_f32_16x16x32_bf16 v[216:219], a[208:211], a[136:139], v[216:219]
v_accvgpr_read_b32 v13, a98
v_mfma_f32_16x16x32_bf16 v[248:251], a[208:211], a[132:135], v[248:251]
global_load_dwordx4 a[208:211], v0, s[72:73] offset:-3072
v_mfma_f32_16x16x32_bf16 v[248:251], a[192:195], a[128:131], v[248:251]
v_accvgpr_read_b32 v15, a99
s_waitcnt vmcnt(13)
v_mfma_f32_16x16x32_bf16 v[252:255], a[220:223], a[128:131], v[252:255]
v_lshlrev_b32 v12, 16, v13
v_lshlrev_b32 v14, 16, v15
v_mfma_f32_16x16x32_bf16 v[252:255], a[200:203], a[132:135], v[252:255]
v_mfma_f32_16x16x32_bf16 v[220:223], a[200:203], a[136:139], v[220:223]
global_load_dwordx4 a[192:195], v0, s[74:75] offset:-3072
v_mfma_f32_16x16x32_bf16 v[220:223], a[220:223], a[140:143], v[220:223]
global_load_lds_dwordx4 v0, s[30:31] offset:1024 nt
v_mfma_f32_16x16x32_bf16 v[188:191], a[220:223], a[144:147], v[188:191]
v_and_b32 v13, s53, v13
v_and_b32 v15, s53, v15
v_mfma_f32_16x16x32_bf16 v[188:191], a[200:203], a[148:151], v[188:191]
s_add_u32 s54, s57, 32768
v_add_u32 v3, s54, v0
v_mfma_f32_16x16x32_bf16 v[156:159], a[200:203], a[152:155], v[156:159]
v_mul_f32 v8, v8, v48
v_mfma_f32_16x16x32_bf16 v[156:159], a[220:223], a[156:159], v[156:159]
v_mul_f32 v9, v9, v49
v_mul_f32 v10, v10, v50
v_mfma_f32_16x16x32_bf16 v[124:127], a[220:223], a[160:163], v[124:127]
v_mul_f32 v11, v11, v51
v_mfma_f32_16x16x32_bf16 v[124:127], a[200:203], a[164:167], v[124:127]
v_cvt_pk_bf16_f32 v16, v8, v9
v_cvt_pk_bf16_f32 v17, v10, v11
v_mfma_f32_16x16x32_bf16 v[92:95], a[200:203], a[168:171], v[92:95]
v_accvgpr_read_b32 v9, a100
v_mfma_f32_16x16x32_bf16 v[92:95], a[220:223], a[172:175], v[92:95]
v_accvgpr_read_b32 v11, a101
v_lshlrev_b32 v8, 16, v9
v_mfma_f32_16x16x32_bf16 v[60:63], a[220:223], a[176:179], v[60:63]
v_lshlrev_b32 v10, 16, v11
v_mfma_f32_16x16x32_bf16 v[60:63], a[200:203], a[180:183], v[60:63]
v_and_b32 v9, s53, v9
v_mfma_f32_16x16x32_bf16 v[28:31], a[200:203], a[184:187], v[28:31]
global_load_dwordx4 a[200:203], v0, s[72:73] offset:-2048
v_mfma_f32_16x16x32_bf16 v[28:31], a[220:223], a[188:191], v[28:31]
v_and_b32 v11, s53, v11
s_waitcnt vmcnt(12)
v_mfma_f32_16x16x32_bf16 v[32:35], a[228:231], a[188:191], v[32:35]
v_mul_f32 v12, v12, v52
v_mfma_f32_16x16x32_bf16 v[32:35], a[204:207], a[184:187], v[32:35]
v_mul_f32 v13, v13, v53
v_mfma_f32_16x16x32_bf16 v[64:67], a[204:207], a[180:183], v[64:67]
global_load_dwordx4 a[220:223], v0, s[74:75] offset:-2048
v_mfma_f32_16x16x32_bf16 v[64:67], a[228:231], a[176:179], v[64:67]
v_mul_f32 v14, v14, v54
v_mul_f32 v15, v15, v55
v_mfma_f32_16x16x32_bf16 v[96:99], a[228:231], a[172:175], v[96:99]
v_cvt_pk_bf16_f32 v18, v12, v13
v_mfma_f32_16x16x32_bf16 v[96:99], a[204:207], a[168:171], v[96:99]
v_cvt_pk_bf16_f32 v19, v14, v15
v_mfma_f32_16x16x32_bf16 v[128:131], a[204:207], a[164:167], v[128:131]
v_accvgpr_read_b32 v13, a102
v_accvgpr_read_b32 v15, a103
v_mfma_f32_16x16x32_bf16 v[128:131], a[228:231], a[160:163], v[128:131]
v_lshlrev_b32 v12, 16, v13
v_mfma_f32_16x16x32_bf16 v[160:163], a[228:231], a[156:159], v[160:163]
v_lshlrev_b32 v14, 16, v15
v_and_b32 v13, s53, v13
v_mfma_f32_16x16x32_bf16 v[160:163], a[204:207], a[152:155], v[160:163]
v_and_b32 v15, s53, v15
v_mfma_f32_16x16x32_bf16 v[192:195], a[204:207], a[148:151], v[192:195]
ds_write_b128 v3, v[16:19] offset:0
v_mfma_f32_16x16x32_bf16 v[192:195], a[228:231], a[144:147], v[192:195]
v_mul_f32 v8, v8, v80
v_mfma_f32_16x16x32_bf16 v[224:227], a[228:231], a[140:143], v[224:227]
v_mul_f32 v9, v9, v81
v_mul_f32 v10, v10, v82
v_mfma_f32_16x16x32_bf16 v[224:227], a[204:207], a[136:139], v[224:227]
v_mfma_f32_16x16x32_bf16 a[232:235], a[204:207], a[132:135], a[232:235]
global_load_dwordx4 a[204:207], v0, s[72:73] offset:-1024
v_mfma_f32_16x16x32_bf16 a[232:235], a[228:231], a[128:131], a[232:235]
v_add_u32 v2, 0, v0
v_mul_f32 v11, v11, v83
s_waitcnt vmcnt(10)
v_mfma_f32_16x16x32_bf16 a[236:239], a[224:227], a[128:131], a[236:239]
ds_read_b128 a[128:131], v2 offset:0
v_cvt_pk_bf16_f32 v20, v8, v9
v_mfma_f32_16x16x32_bf16 a[236:239], a[196:199], a[132:135], a[236:239]
ds_read_b128 a[132:135], v2 offset:8192
v_mfma_f32_16x16x32_bf16 v[228:231], a[196:199], a[136:139], v[228:231]
ds_read_b128 a[136:139], v2 offset:9216
v_cvt_pk_bf16_f32 v21, v10, v11
v_mfma_f32_16x16x32_bf16 v[228:231], a[224:227], a[140:143], v[228:231]
ds_read_b128 a[140:143], v2 offset:1024
v_accvgpr_read_b32 v9, a104
v_mfma_f32_16x16x32_bf16 v[196:199], a[224:227], a[144:147], v[196:199]
ds_read_b128 a[144:147], v2 offset:2048
v_mfma_f32_16x16x32_bf16 v[196:199], a[196:199], a[148:151], v[196:199]
ds_read_b128 a[148:151], v2 offset:10240
v_accvgpr_read_b32 v11, a105
v_mfma_f32_16x16x32_bf16 v[164:167], a[196:199], a[152:155], v[164:167]
ds_read_b128 a[152:155], v2 offset:11264
v_lshlrev_b32 v8, 16, v9
v_mfma_f32_16x16x32_bf16 v[164:167], a[224:227], a[156:159], v[164:167]
ds_read_b128 a[156:159], v2 offset:3072
s_add_u32 m0, s56, 114688
v_mfma_f32_16x16x32_bf16 v[132:135], a[224:227], a[160:163], v[132:135]
ds_read_b128 a[160:163], v2 offset:4096
v_lshlrev_b32 v10, 16, v11
v_mfma_f32_16x16x32_bf16 v[132:135], a[196:199], a[164:167], v[132:135]
ds_read_b128 a[164:167], v2 offset:12288
v_mfma_f32_16x16x32_bf16 v[100:103], a[196:199], a[168:171], v[100:103]
ds_read_b128 a[168:171], v2 offset:13312
v_and_b32 v9, s53, v9
v_mfma_f32_16x16x32_bf16 v[100:103], a[224:227], a[172:175], v[100:103]
ds_read_b128 a[172:175], v2 offset:5120
v_and_b32 v11, s53, v11
v_mfma_f32_16x16x32_bf16 v[68:71], a[224:227], a[176:179], v[68:71]
ds_read_b128 a[176:179], v2 offset:6144
s_mov_b32 s60, 98304
v_mfma_f32_16x16x32_bf16 v[68:71], a[196:199], a[180:183], v[68:71]
ds_read_b128 a[180:183], v2 offset:14336
v_mfma_f32_16x16x32_bf16 v[36:39], a[196:199], a[184:187], v[36:39]
ds_read_b128 a[184:187], v2 offset:15360
v_mfma_f32_16x16x32_bf16 v[36:39], a[224:227], a[188:191], v[36:39]
ds_read_b128 a[188:191], v2 offset:7168
s_waitcnt vmcnt(7) lgkmcnt(12)
v_mfma_f32_16x16x32_bf16 v[24:27], a[216:219], a[128:131], v[24:27]
global_load_dwordx4 a[228:231], v0, s[74:75] offset:-1024
v_mfma_f32_16x16x32_bf16 v[24:27], a[212:215], a[132:135], v[24:27]
s_add_u32 s72, s12, 348160
s_addc_u32 s73, s13, 0
v_mfma_f32_16x16x32_bf16 v[56:59], a[212:215], a[136:139], v[56:59]
s_add_u32 s74, s12, 380928
s_addc_u32 s75, s13, 0
v_mfma_f32_16x16x32_bf16 v[56:59], a[216:219], a[140:143], v[56:59]
s_waitcnt lgkmcnt(8)
v_mfma_f32_16x16x32_bf16 v[88:91], a[216:219], a[144:147], v[88:91]
global_load_dwordx4 a[196:199], v0, s[72:73] offset:-4096
v_mfma_f32_16x16x32_bf16 v[88:91], a[212:215], a[148:151], v[88:91]
s_add_u32 s30, s28, 16384
s_addc_u32 s31, s29, 0
v_mfma_f32_16x16x32_bf16 v[120:123], a[212:215], a[152:155], v[120:123]
global_load_lds_dwordx4 v0, s[30:31] nt
v_mfma_f32_16x16x32_bf16 v[120:123], a[216:219], a[156:159], v[120:123]
s_waitcnt lgkmcnt(4)
v_mfma_f32_16x16x32_bf16 v[152:155], a[216:219], a[160:163], v[152:155]
global_load_dwordx4 a[224:227], v0, s[74:75] offset:-4096
v_mfma_f32_16x16x32_bf16 v[152:155], a[212:215], a[164:167], v[152:155]
s_mov_b32 s38, 260
s_waitcnt vmcnt(10)
v_mfma_f32_16x16x32_bf16 v[184:187], a[212:215], a[168:171], v[184:187]
buffer_store_dword v6, v0, s[36:39], 0 offen offset:256 sc1
v_mfma_f32_16x16x32_bf16 v[184:187], a[216:219], a[172:175], v[184:187]
v_mul_f32 v12, v12, v84
s_waitcnt lgkmcnt(0)
v_mfma_f32_16x16x32_bf16 v[216:219], a[216:219], a[176:179], v[216:219]
v_mul_f32 v13, v13, v85
v_mfma_f32_16x16x32_bf16 v[216:219], a[212:215], a[180:183], v[216:219]
buffer_store_dwordx4 v[16:19], v0, s[24:27], s60 offen offset:0 sc1
v_mfma_f32_16x16x32_bf16 v[248:251], a[212:215], a[184:187], v[248:251]
global_load_dwordx4 a[212:215], v0, s[72:73] offset:-3072
v_mfma_f32_16x16x32_bf16 v[248:251], a[216:219], a[188:191], v[248:251]
v_mul_f32 v14, v14, v86
v_mul_f32 v15, v15, v87
s_waitcnt vmcnt(11)
v_mfma_f32_16x16x32_bf16 v[252:255], a[208:211], a[188:191], v[252:255]
v_cvt_pk_bf16_f32 v22, v12, v13
v_mfma_f32_16x16x32_bf16 v[252:255], a[192:195], a[184:187], v[252:255]
v_cvt_pk_bf16_f32 v23, v14, v15
v_mfma_f32_16x16x32_bf16 v[220:223], a[192:195], a[180:183], v[220:223]
global_load_dwordx4 a[216:219], v0, s[74:75] offset:-3072
v_mfma_f32_16x16x32_bf16 v[220:223], a[208:211], a[176:179], v[220:223]
v_accvgpr_read_b32 v13, a106
v_mfma_f32_16x16x32_bf16 v[188:191], a[208:211], a[172:175], v[188:191]
v_accvgpr_read_b32 v15, a107
v_mfma_f32_16x16x32_bf16 v[188:191], a[192:195], a[168:171], v[188:191]
global_load_lds_dwordx4 v0, s[30:31] offset:1024 nt
v_mfma_f32_16x16x32_bf16 v[156:159], a[192:195], a[164:167], v[156:159]
v_lshlrev_b32 v12, 16, v13
v_lshlrev_b32 v14, 16, v15
v_mfma_f32_16x16x32_bf16 v[156:159], a[208:211], a[160:163], v[156:159]
v_and_b32 v13, s53, v13
v_mfma_f32_16x16x32_bf16 v[124:127], a[208:211], a[156:159], v[124:127]
v_and_b32 v15, s53, v15
v_mfma_f32_16x16x32_bf16 v[124:127], a[192:195], a[152:155], v[124:127]
ds_write_b128 v3, v[20:23] offset:1024
v_mfma_f32_16x16x32_bf16 v[92:95], a[192:195], a[148:151], v[92:95]
v_mul_f32 v8, v8, v112
v_mul_f32 v9, v9, v113
v_mfma_f32_16x16x32_bf16 v[92:95], a[208:211], a[144:147], v[92:95]
v_mul_f32 v10, v10, v114
v_mfma_f32_16x16x32_bf16 v[60:63], a[208:211], a[140:143], v[60:63]
v_mul_f32 v11, v11, v115
v_mfma_f32_16x16x32_bf16 v[60:63], a[192:195], a[136:139], v[60:63]
v_cvt_pk_bf16_f32 v16, v8, v9
v_mfma_f32_16x16x32_bf16 v[28:31], a[192:195], a[132:135], v[28:31]
global_load_dwordx4 a[192:195], v0, s[72:73] offset:-2048
v_mfma_f32_16x16x32_bf16 v[28:31], a[208:211], a[128:131], v[28:31]
v_cvt_pk_bf16_f32 v17, v10, v11
s_waitcnt vmcnt(11)
v_mfma_f32_16x16x32_bf16 v[32:35], a[200:203], a[128:131], v[32:35]
v_accvgpr_read_b32 v9, a108
v_accvgpr_read_b32 v11, a109
v_mfma_f32_16x16x32_bf16 v[32:35], a[220:223], a[132:135], v[32:35]
v_mfma_f32_16x16x32_bf16 v[64:67], a[220:223], a[136:139], v[64:67]
global_load_dwordx4 a[208:211], v0, s[74:75] offset:-2048
v_mfma_f32_16x16x32_bf16 v[64:67], a[200:203], a[140:143], v[64:67]
s_add_u32 m0, s56, 122880
v_lshlrev_b32 v8, 16, v9
v_lshlrev_b32 v10, 16, v11
v_mfma_f32_16x16x32_bf16 v[96:99], a[200:203], a[144:147], v[96:99]
s_add_u32 s30, s28, 24576
s_addc_u32 s31, s29, 0
v_mfma_f32_16x16x32_bf16 v[96:99], a[220:223], a[148:151], v[96:99]
v_and_b32 v9, s53, v9
v_mfma_f32_16x16x32_bf16 v[128:131], a[220:223], a[152:155], v[128:131]
v_and_b32 v11, s53, v11
v_mfma_f32_16x16x32_bf16 v[128:131], a[200:203], a[156:159], v[128:131]
buffer_store_dwordx4 v[20:23], v0, s[24:27], s60 offen offset:1024 sc1
v_mfma_f32_16x16x32_bf16 v[160:163], a[200:203], a[160:163], v[160:163]
global_load_lds_dwordx4 v0, s[30:31] nt
v_mfma_f32_16x16x32_bf16 v[160:163], a[220:223], a[164:167], v[160:163]
v_mul_f32 v12, v12, v116
v_mfma_f32_16x16x32_bf16 v[192:195], a[220:223], a[168:171], v[192:195]
v_mul_f32 v13, v13, v117
v_mfma_f32_16x16x32_bf16 v[192:195], a[200:203], a[172:175], v[192:195]
v_mul_f32 v14, v14, v118
v_mfma_f32_16x16x32_bf16 v[224:227], a[200:203], a[176:179], v[224:227]
v_mul_f32 v15, v15, v119
v_cvt_pk_bf16_f32 v18, v12, v13
v_mfma_f32_16x16x32_bf16 v[224:227], a[220:223], a[180:183], v[224:227]
v_cvt_pk_bf16_f32 v19, v14, v15
v_mfma_f32_16x16x32_bf16 a[232:235], a[220:223], a[184:187], a[232:235]
global_load_dwordx4 a[220:223], v0, s[72:73] offset:-1024
v_mfma_f32_16x16x32_bf16 a[232:235], a[200:203], a[188:191], a[232:235]
v_accvgpr_read_b32 v13, a110
s_waitcnt vmcnt(13)
v_mfma_f32_16x16x32_bf16 a[236:239], a[204:207], a[188:191], a[236:239]
ds_read_b128 a[188:191], v2 offset:16384
v_mfma_f32_16x16x32_bf16 a[236:239], a[228:231], a[184:187], a[236:239]
ds_read_b128 a[184:187], v2 offset:24576
v_accvgpr_read_b32 v15, a111
v_mfma_f32_16x16x32_bf16 v[228:231], a[228:231], a[180:183], v[228:231]
ds_read_b128 a[180:183], v2 offset:25600
v_lshlrev_b32 v12, 16, v13
v_mfma_f32_16x16x32_bf16 v[228:231], a[204:207], a[176:179], v[228:231]
ds_read_b128 a[176:179], v2 offset:17408
v_lshlrev_b32 v14, 16, v15
v_mfma_f32_16x16x32_bf16 v[196:199], a[204:207], a[172:175], v[196:199]
ds_read_b128 a[172:175], v2 offset:18432
v_mfma_f32_16x16x32_bf16 v[196:199], a[228:231], a[168:171], v[196:199]
ds_read_b128 a[168:171], v2 offset:26624
v_and_b32 v13, s53, v13
v_mfma_f32_16x16x32_bf16 v[164:167], a[228:231], a[164:167], v[164:167]
ds_read_b128 a[164:167], v2 offset:27648
v_and_b32 v15, s53, v15
v_mfma_f32_16x16x32_bf16 v[164:167], a[204:207], a[160:163], v[164:167]
ds_read_b128 a[160:163], v2 offset:19456
v_mfma_f32_16x16x32_bf16 v[132:135], a[204:207], a[156:159], v[132:135]
ds_read_b128 a[156:159], v2 offset:20480
v_mfma_f32_16x16x32_bf16 v[132:135], a[228:231], a[152:155], v[132:135]
ds_read_b128 a[152:155], v2 offset:28672
v_mfma_f32_16x16x32_bf16 v[100:103], a[228:231], a[148:151], v[100:103]
ds_read_b128 a[148:151], v2 offset:29696
v_mul_f32 v8, v8, v144
v_mfma_f32_16x16x32_bf16 v[100:103], a[204:207], a[144:147], v[100:103]
ds_read_b128 a[144:147], v2 offset:21504
v_mul_f32 v9, v9, v145
v_mfma_f32_16x16x32_bf16 v[68:71], a[204:207], a[140:143], v[68:71]
ds_read_b128 a[140:143], v2 offset:22528
v_mfma_f32_16x16x32_bf16 v[68:71], a[228:231], a[136:139], v[68:71]
ds_read_b128 a[136:139], v2 offset:30720
v_mul_f32 v10, v10, v146
v_mfma_f32_16x16x32_bf16 v[36:39], a[228:231], a[132:135], v[36:39]
ds_read_b128 a[132:135], v2 offset:31744
v_mul_f32 v11, v11, v147
v_mfma_f32_16x16x32_bf16 v[36:39], a[204:207], a[128:131], v[36:39]
ds_read_b128 a[128:131], v2 offset:23552
s_waitcnt vmcnt(10) lgkmcnt(12)
v_mfma_f32_16x16x32_bf16 v[24:27], a[196:199], a[188:191], v[24:27]
global_load_dwordx4 a[200:203], v0, s[74:75] offset:-1024
v_mfma_f32_16x16x32_bf16 v[24:27], a[224:227], a[184:187], v[24:27]
s_add_u32 s72, s12, 397312
s_addc_u32 s73, s13, 0
v_mfma_f32_16x16x32_bf16 v[56:59], a[224:227], a[180:183], v[56:59]
s_add_u32 s74, s12, 430080
s_addc_u32 s75, s13, 0
v_mfma_f32_16x16x32_bf16 v[56:59], a[196:199], a[176:179], v[56:59]
s_waitcnt lgkmcnt(8)
v_mfma_f32_16x16x32_bf16 v[88:91], a[196:199], a[172:175], v[88:91]
global_load_dwordx4 a[228:231], v0, s[72:73] offset:-4096
v_mfma_f32_16x16x32_bf16 v[88:91], a[224:227], a[168:171], v[88:91]
global_load_lds_dwordx4 v0, s[30:31] offset:1024 nt
v_mfma_f32_16x16x32_bf16 v[120:123], a[224:227], a[164:167], v[120:123]
ds_write_b128 v3, v[16:19] offset:2048
v_mfma_f32_16x16x32_bf16 v[120:123], a[196:199], a[160:163], v[120:123]
v_cvt_pk_bf16_f32 v20, v8, v9
s_waitcnt lgkmcnt(5)
v_mfma_f32_16x16x32_bf16 v[152:155], a[196:199], a[156:159], v[152:155]
global_load_dwordx4 a[204:207], v0, s[74:75] offset:-4096
v_mfma_f32_16x16x32_bf16 v[152:155], a[224:227], a[152:155], v[152:155]
v_cvt_pk_bf16_f32 v21, v10, v11
v_accvgpr_read_b32 v9, a112
v_mfma_f32_16x16x32_bf16 v[184:187], a[224:227], a[148:151], v[184:187]
v_accvgpr_read_b32 v11, a113
v_lshlrev_b32 v8, 16, v9
v_mfma_f32_16x16x32_bf16 v[184:187], a[196:199], a[144:147], v[184:187]
v_lshlrev_b32 v10, 16, v11
s_waitcnt lgkmcnt(0)
v_mfma_f32_16x16x32_bf16 v[216:219], a[196:199], a[140:143], v[216:219]
L_pad9:
s_cbranch_execz L_pad13
v_and_b32 v9, s53, v9
s_barrier
v_mfma_f32_16x16x32_bf16 v[216:219], a[224:227], a[136:139], v[216:219]
s_mov_b32 s34, 192
v_and_b32 v11, s53, v11
v_mfma_f32_16x16x32_bf16 v[248:251], a[224:227], a[132:135], v[248:251]
global_load_dwordx4 a[224:227], v0, s[72:73] offset:-3072
v_mfma_f32_16x16x32_bf16 v[248:251], a[196:199], a[128:131], v[248:251]
s_waitcnt vmcnt(11)
v_mfma_f32_16x16x32_bf16 v[252:255], a[212:215], a[128:131], v[252:255]
buffer_load_dword v5, v0, s[32:35], 0 offen offset:128 sc1
v_mfma_f32_16x16x32_bf16 v[252:255], a[216:219], a[132:135], v[252:255]
buffer_store_dwordx4 v[16:19], v0, s[24:27], s60 offen offset:2048 sc1
v_mfma_f32_16x16x32_bf16 v[220:223], a[216:219], a[136:139], v[220:223]
global_load_dwordx4 a[196:199], v0, s[74:75] offset:-3072
v_mfma_f32_16x16x32_bf16 v[220:223], a[212:215], a[140:143], v[220:223]
v_mfma_f32_16x16x32_bf16 v[188:191], a[212:215], a[144:147], v[188:191]
v_mul_f32 v12, v12, v148
v_mfma_f32_16x16x32_bf16 v[188:191], a[216:219], a[148:151], v[188:191]
v_mul_f32 v13, v13, v149
v_mul_f32 v14, v14, v150
v_mfma_f32_16x16x32_bf16 v[156:159], a[216:219], a[152:155], v[156:159]
v_mul_f32 v15, v15, v151
v_mfma_f32_16x16x32_bf16 v[156:159], a[212:215], a[156:159], v[156:159]
v_cvt_pk_bf16_f32 v22, v12, v13
v_cvt_pk_bf16_f32 v23, v14, v15
v_mfma_f32_16x16x32_bf16 v[124:127], a[212:215], a[160:163], v[124:127]
v_accvgpr_read_b32 v13, a114
v_mfma_f32_16x16x32_bf16 v[124:127], a[216:219], a[164:167], v[124:127]
v_accvgpr_read_b32 v15, a115
v_lshlrev_b32 v12, 16, v13
v_mfma_f32_16x16x32_bf16 v[92:95], a[216:219], a[168:171], v[92:95]
v_lshlrev_b32 v14, 16, v15
v_mfma_f32_16x16x32_bf16 v[92:95], a[212:215], a[172:175], v[92:95]
v_and_b32 v13, s53, v13
v_and_b32 v15, s53, v15
v_mfma_f32_16x16x32_bf16 v[60:63], a[212:215], a[176:179], v[60:63]
ds_write_b128 v3, v[20:23] offset:3072
v_mfma_f32_16x16x32_bf16 v[60:63], a[216:219], a[180:183], v[60:63]
v_mfma_f32_16x16x32_bf16 v[28:31], a[216:219], a[184:187], v[28:31]
global_load_dwordx4 a[216:219], v0, s[72:73] offset:-2048
v_mfma_f32_16x16x32_bf16 v[28:31], a[212:215], a[188:191], v[28:31]
v_mul_f32 v8, v8, v176
s_waitcnt vmcnt(12)
v_mfma_f32_16x16x32_bf16 v[32:35], a[192:195], a[188:191], v[32:35]
v_mul_f32 v9, v9, v177
v_mfma_f32_16x16x32_bf16 v[32:35], a[208:211], a[184:187], v[32:35]
v_mul_f32 v10, v10, v178
v_mfma_f32_16x16x32_bf16 v[64:67], a[208:211], a[180:183], v[64:67]
global_load_dwordx4 a[212:215], v0, s[74:75] offset:-2048
v_mfma_f32_16x16x32_bf16 v[64:67], a[192:195], a[176:179], v[64:67]
v_mul_f32 v11, v11, v179
v_mfma_f32_16x16x32_bf16 v[96:99], a[192:195], a[172:175], v[96:99]
v_cvt_pk_bf16_f32 v16, v8, v9
v_cvt_pk_bf16_f32 v17, v10, v11
v_mfma_f32_16x16x32_bf16 v[96:99], a[208:211], a[168:171], v[96:99]
v_accvgpr_read_b32 v9, a116
v_mfma_f32_16x16x32_bf16 v[128:131], a[208:211], a[164:167], v[128:131]
v_accvgpr_read_b32 v11, a117
v_lshlrev_b32 v8, 16, v9
v_mfma_f32_16x16x32_bf16 v[128:131], a[192:195], a[160:163], v[128:131]
v_lshlrev_b32 v10, 16, v11
v_mfma_f32_16x16x32_bf16 v[160:163], a[192:195], a[156:159], v[160:163]
v_and_b32 v9, s53, v9
v_and_b32 v11, s53, v11
v_mfma_f32_16x16x32_bf16 v[160:163], a[208:211], a[152:155], v[160:163]
buffer_store_dwordx4 v[20:23], v0, s[24:27], s60 offen offset:3072 sc1
v_mfma_f32_16x16x32_bf16 v[192:195], a[208:211], a[148:151], v[192:195]
v_mfma_f32_16x16x32_bf16 v[192:195], a[192:195], a[144:147], v[192:195]
v_mul_f32 v12, v12, v180
v_mul_f32 v13, v13, v181
v_mfma_f32_16x16x32_bf16 v[224:227], a[192:195], a[140:143], v[224:227]
v_mul_f32 v14, v14, v182
v_mfma_f32_16x16x32_bf16 v[224:227], a[208:211], a[136:139], v[224:227]
v_mul_f32 v15, v15, v183
v_mfma_f32_16x16x32_bf16 a[232:235], a[208:211], a[132:135], a[232:235]
global_load_dwordx4 a[208:211], v0, s[72:73] offset:-1024
v_mfma_f32_16x16x32_bf16 a[232:235], a[192:195], a[128:131], a[232:235]
v_add_u32 v2, 65536, v0
s_waitcnt vmcnt(11)
v_mfma_f32_16x16x32_bf16 a[236:239], a[220:223], a[128:131], a[236:239]
ds_read_b128 a[128:131], v2 offset:32768
v_cvt_pk_bf16_f32 v18, v12, v13
v_mfma_f32_16x16x32_bf16 a[236:239], a[200:203], a[132:135], a[236:239]
ds_read_b128 a[132:135], v2 offset:40960
v_cvt_pk_bf16_f32 v19, v14, v15
v_mfma_f32_16x16x32_bf16 v[228:231], a[200:203], a[136:139], v[228:231]
ds_read_b128 a[136:139], v2 offset:41984
v_mfma_f32_16x16x32_bf16 v[228:231], a[220:223], a[140:143], v[228:231]
ds_read_b128 a[140:143], v2 offset:33792
v_accvgpr_read_b32 v13, a118
v_mfma_f32_16x16x32_bf16 v[196:199], a[220:223], a[144:147], v[196:199]
ds_read_b128 a[144:147], v2 offset:34816
v_accvgpr_read_b32 v15, a119
v_mfma_f32_16x16x32_bf16 v[196:199], a[200:203], a[148:151], v[196:199]
ds_read_b128 a[148:151], v2 offset:43008
v_lshlrev_b32 v12, 16, v13
v_mfma_f32_16x16x32_bf16 v[164:167], a[200:203], a[152:155], v[164:167]
ds_read_b128 a[152:155], v2 offset:44032
v_mfma_f32_16x16x32_bf16 v[164:167], a[220:223], a[156:159], v[164:167]
ds_read_b128 a[156:159], v2 offset:35840
v_lshlrev_b32 v14, 16, v15
v_mfma_f32_16x16x32_bf16 v[132:135], a[220:223], a[160:163], v[132:135]
ds_read_b128 a[160:163], v2 offset:36864
v_and_b32 v13, s53, v13
v_mfma_f32_16x16x32_bf16 v[132:135], a[200:203], a[164:167], v[132:135]
ds_read_b128 a[164:167], v2 offset:45056
v_and_b32 v15, s53, v15
v_mfma_f32_16x16x32_bf16 v[100:103], a[200:203], a[168:171], v[100:103]
ds_read_b128 a[168:171], v2 offset:46080
v_mfma_f32_16x16x32_bf16 v[100:103], a[220:223], a[172:175], v[100:103]
ds_read_b128 a[172:175], v2 offset:37888
v_mfma_f32_16x16x32_bf16 v[68:71], a[220:223], a[176:179], v[68:71]
ds_read_b128 a[176:179], v2 offset:38912
v_mfma_f32_16x16x32_bf16 v[68:71], a[200:203], a[180:183], v[68:71]
ds_read_b128 a[180:183], v2 offset:47104
v_mul_f32 v8, v8, v208
v_mfma_f32_16x16x32_bf16 v[36:39], a[200:203], a[184:187], v[36:39]
ds_read_b128 a[184:187], v2 offset:48128
v_mfma_f32_16x16x32_bf16 v[36:39], a[220:223], a[188:191], v[36:39]
ds_read_b128 a[188:191], v2 offset:39936
s_waitcnt vmcnt(8) lgkmcnt(12)
v_mfma_f32_16x16x32_bf16 v[24:27], a[228:231], a[128:131], v[24:27]
global_load_dwordx4 a[192:195], v0, s[74:75] offset:-1024
v_mfma_f32_16x16x32_bf16 v[24:27], a[204:207], a[132:135], v[24:27]
ds_write_b128 v3, v[16:19] offset:4096
v_mfma_f32_16x16x32_bf16 v[56:59], a[204:207], a[136:139], v[56:59]
v_mul_f32 v9, v9, v209
v_mul_f32 v10, v10, v210
v_mfma_f32_16x16x32_bf16 v[56:59], a[228:231], a[140:143], v[56:59]
v_mul_f32 v11, v11, v211
s_waitcnt lgkmcnt(9)
v_mfma_f32_16x16x32_bf16 v[88:91], a[228:231], a[144:147], v[88:91]
global_load_dwordx4 a[200:203], v0, s[72:73] offset:0
v_mfma_f32_16x16x32_bf16 v[88:91], a[204:207], a[148:151], v[88:91]
v_cvt_pk_bf16_f32 v20, v8, v9
v_cvt_pk_bf16_f32 v21, v10, v11
v_mfma_f32_16x16x32_bf16 v[120:123], a[204:207], a[152:155], v[120:123]
v_accvgpr_read_b32 v9, a120
v_mfma_f32_16x16x32_bf16 v[120:123], a[228:231], a[156:159], v[120:123]
v_accvgpr_read_b32 v11, a121
s_waitcnt lgkmcnt(5)
v_mfma_f32_16x16x32_bf16 v[152:155], a[228:231], a[160:163], v[152:155]
global_load_dwordx4 a[220:223], v0, s[74:75] offset:0
v_mfma_f32_16x16x32_bf16 v[152:155], a[204:207], a[164:167], v[152:155]
v_lshlrev_b32 v8, 16, v9
v_mfma_f32_16x16x32_bf16 v[184:187], a[204:207], a[168:171], v[184:187]
v_lshlrev_b32 v10, 16, v11
v_and_b32 v9, s53, v9
v_mfma_f32_16x16x32_bf16 v[184:187], a[228:231], a[172:175], v[184:187]
v_and_b32 v11, s53, v11
s_waitcnt lgkmcnt(0)
v_mfma_f32_16x16x32_bf16 v[216:219], a[228:231], a[176:179], v[216:219]
s_mov_b32 s60, 102400
s_barrier
v_mfma_f32_16x16x32_bf16 v[216:219], a[204:207], a[180:183], v[216:219]
s_waitcnt vmcnt(9)
v_mfma_f32_16x16x32_bf16 v[248:251], a[204:207], a[184:187], v[248:251]
global_load_dwordx4 a[204:207], v0, s[72:73] offset:1024
v_mfma_f32_16x16x32_bf16 v[248:251], a[228:231], a[188:191], v[248:251]
s_waitcnt vmcnt(8)
v_mfma_f32_16x16x32_bf16 v[252:255], a[224:227], a[188:191], v[252:255]
v_cmp_ne_u32 vcc, 16256, v5
v_mfma_f32_16x16x32_bf16 v[252:255], a[196:199], a[184:187], v[252:255]
buffer_store_dwordx4 v[16:19], v0, s[24:27], s60 offen offset:0 sc1
v_mfma_f32_16x16x32_bf16 v[220:223], a[196:199], a[180:183], v[220:223]
global_load_dwordx4 a[228:231], v0, s[74:75] offset:1024
v_mfma_f32_16x16x32_bf16 v[220:223], a[224:227], a[176:179], v[220:223]
v_mul_f32 v12, v12, v212
v_mul_f32 v13, v13, v213
v_mfma_f32_16x16x32_bf16 v[188:191], a[224:227], a[172:175], v[188:191]
s_and_b32 s3, vcc_lo, 15
s_cbranch_scc1 L_slow3
L_back3:
v_mfma_f32_16x16x32_bf16 v[188:191], a[196:199], a[168:171], v[188:191]
v_mul_f32 v14, v14, v214
v_mul_f32 v15, v15, v215
v_mfma_f32_16x16x32_bf16 v[156:159], a[196:199], a[164:167], v[156:159]
v_cvt_pk_bf16_f32 v22, v12, v13
v_cvt_pk_bf16_f32 v23, v14, v15
v_mfma_f32_16x16x32_bf16 v[156:159], a[224:227], a[160:163], v[156:159]
s_add_u32 m0, s56, 98304
v_accvgpr_read_b32 v13, a122
v_mfma_f32_16x16x32_bf16 v[124:127], a[224:227], a[156:159], v[124:127]
s_add_u32 s30, s28, 32768
s_addc_u32 s31, s29, 0
v_mfma_f32_16x16x32_bf16 v[124:127], a[196:199], a[152:155], v[124:127]
v_accvgpr_read_b32 v15, a123
v_lshlrev_b32 v12, 16, v13
v_mfma_f32_16x16x32_bf16 v[92:95], a[196:199], a[148:151], v[92:95]
v_mfma_f32_16x16x32_bf16 v[92:95], a[224:227], a[144:147], v[92:95]
global_load_lds_dwordx4 v0, s[30:31] nt
v_mfma_f32_16x16x32_bf16 v[60:63], a[224:227], a[140:143], v[60:63]
v_lshlrev_b32 v14, 16, v15
v_and_b32 v13, s53, v13
v_mfma_f32_16x16x32_bf16 v[60:63], a[196:199], a[136:139], v[60:63]
v_mfma_f32_16x16x32_bf16 v[28:31], a[196:199], a[132:135], v[28:31]
global_load_dwordx4 a[196:199], v0, s[72:73] offset:2048
v_mfma_f32_16x16x32_bf16 v[28:31], a[224:227], a[128:131], v[28:31]
v_and_b32 v15, s53, v15
s_waitcnt vmcnt(10)
v_mfma_f32_16x16x32_bf16 v[32:35], a[216:219], a[128:131], v[32:35]
ds_write_b128 v3, v[20:23] offset:5120
v_mfma_f32_16x16x32_bf16 v[32:35], a[212:215], a[132:135], v[32:35]
v_mul_f32 v8, v8, v240
v_mfma_f32_16x16x32_bf16 v[64:67], a[212:215], a[136:139], v[64:67]
global_load_dwordx4 a[224:227], v0, s[74:75] offset:2048
v_mfma_f32_16x16x32_bf16 v[64:67], a[216:219], a[140:143], v[64:67]
v_mul_f32 v9, v9, v241
v_mfma_f32_16x16x32_bf16 v[96:99], a[216:219], a[144:147], v[96:99]
v_mul_f32 v10, v10, v242
v_mul_f32 v11, v11, v243
v_mfma_f32_16x16x32_bf16 v[96:99], a[212:215], a[148:151], v[96:99]
v_mfma_f32_16x16x32_bf16 v[128:131], a[212:215], a[152:155], v[128:131]
global_load_lds_dwordx4 v0, s[30:31] offset:1024 nt
v_mfma_f32_16x16x32_bf16 v[128:131], a[216:219], a[156:159], v[128:131]
v_cvt_pk_bf16_f32 v16, v8, v9
v_cvt_pk_bf16_f32 v17, v10, v11
v_mfma_f32_16x16x32_bf16 v[160:163], a[216:219], a[160:163], v[160:163]
v_accvgpr_read_b32 v9, a124
v_mfma_f32_16x16x32_bf16 v[160:163], a[212:215], a[164:167], v[160:163]
v_accvgpr_read_b32 v11, a125
v_lshlrev_b32 v8, 16, v9
v_mfma_f32_16x16x32_bf16 v[192:195], a[212:215], a[168:171], v[192:195]
v_lshlrev_b32 v10, 16, v11
v_mfma_f32_16x16x32_bf16 v[192:195], a[216:219], a[172:175], v[192:195]
v_and_b32 v9, s53, v9
v_and_b32 v11, s53, v11
v_mfma_f32_16x16x32_bf16 v[224:227], a[216:219], a[176:179], v[224:227]
buffer_store_dwordx4 v[20:23], v0, s[24:27], s60 offen offset:1024 sc1
v_mfma_f32_16x16x32_bf16 v[224:227], a[212:215], a[180:183], v[224:227]
v_mfma_f32_16x16x32_bf16 a[232:235], a[212:215], a[184:187], a[232:235]
global_load_dwordx4 a[212:215], v0, s[72:73] offset:3072
v_mfma_f32_16x16x32_bf16 a[232:235], a[216:219], a[188:191], a[232:235]
s_add_u32 m0, s56, 106496
s_waitcnt vmcnt(11)
v_mfma_f32_16x16x32_bf16 a[236:239], a[208:211], a[188:191], a[236:239]
s_add_u32 s30, s28, 40960
s_addc_u32 s31, s29, 0
v_mfma_f32_16x16x32_bf16 a[236:239], a[192:195], a[184:187], a[236:239]
v_mul_f32 v12, v12, v244
v_mfma_f32_16x16x32_bf16 v[228:231], a[192:195], a[180:183], v[228:231]
global_load_dwordx4 a[216:219], v0, s[74:75] offset:3072
v_mfma_f32_16x16x32_bf16 v[228:231], a[208:211], a[176:179], v[228:231]
s_add_u32 s72, s12, 462848
s_addc_u32 s73, s13, 0
v_mfma_f32_16x16x32_bf16 v[196:199], a[208:211], a[172:175], v[196:199]
v_mul_f32 v13, v13, v245
v_mfma_f32_16x16x32_bf16 v[196:199], a[192:195], a[168:171], v[196:199]
v_mul_f32 v14, v14, v246
v_mfma_f32_16x16x32_bf16 v[164:167], a[192:195], a[164:167], v[164:167]
s_add_u32 s74, s12, 495616
s_addc_u32 s75, s13, 0
v_mfma_f32_16x16x32_bf16 v[164:167], a[208:211], a[160:163], v[164:167]
global_load_lds_dwordx4 v0, s[30:31] nt
v_mfma_f32_16x16x32_bf16 v[132:135], a[208:211], a[156:159], v[132:135]
v_mul_f32 v15, v15, v247
v_cvt_pk_bf16_f32 v18, v12, v13
v_mfma_f32_16x16x32_bf16 v[132:135], a[192:195], a[152:155], v[132:135]
v_cvt_pk_bf16_f32 v19, v14, v15
v_mfma_f32_16x16x32_bf16 v[100:103], a[192:195], a[148:151], v[100:103]
v_accvgpr_read_b32 v13, a126
v_accvgpr_read_b32 v15, a127
v_mfma_f32_16x16x32_bf16 v[100:103], a[208:211], a[144:147], v[100:103]
v_lshlrev_b32 v12, 16, v13
v_mfma_f32_16x16x32_bf16 v[68:71], a[208:211], a[140:143], v[68:71]
v_lshlrev_b32 v14, 16, v15
v_and_b32 v13, s53, v13
v_mfma_f32_16x16x32_bf16 v[68:71], a[192:195], a[136:139], v[68:71]
v_and_b32 v15, s53, v15
v_mfma_f32_16x16x32_bf16 v[36:39], a[192:195], a[132:135], v[36:39]
global_load_dwordx4 a[192:195], v0, s[72:73] offset:-4096
v_mfma_f32_16x16x32_bf16 v[36:39], a[208:211], a[128:131], v[36:39]
s_waitcnt vmcnt(12)
v_mfma_f32_16x16x32_bf16 v[40:43], a[200:203], a[128:131], v[40:43]
global_load_lds_dwordx4 v0, s[30:31] offset:1024 nt
v_mfma_f32_16x16x32_bf16 v[40:43], a[220:223], a[132:135], v[40:43]
ds_write_b128 v3, v[16:19] offset:6144
v_mfma_f32_16x16x32_bf16 v[72:75], a[220:223], a[136:139], v[72:75]
global_load_dwordx4 a[208:211], v0, s[74:75] offset:-4096
v_mfma_f32_16x16x32_bf16 v[72:75], a[200:203], a[140:143], v[72:75]
v_mfma_f32_16x16x32_bf16 v[104:107], a[200:203], a[144:147], v[104:107]
v_accvgpr_read_b32 v20, a248
v_accvgpr_read_b32 v21, a249
v_mfma_f32_16x16x32_bf16 v[104:107], a[220:223], a[148:151], v[104:107]
v_mul_f32 v8, v8, v20
v_mfma_f32_16x16x32_bf16 v[136:139], a[220:223], a[152:155], v[136:139]
v_mul_f32 v9, v9, v21
v_mfma_f32_16x16x32_bf16 v[136:139], a[200:203], a[156:159], v[136:139]
v_accvgpr_read_b32 v20, a250
v_accvgpr_read_b32 v21, a251
v_mfma_f32_16x16x32_bf16 v[168:171], a[200:203], a[160:163], v[168:171]
v_mul_f32 v10, v10, v20
v_mfma_f32_16x16x32_bf16 v[168:171], a[220:223], a[164:167], v[168:171]
v_mul_f32 v11, v11, v21
v_cvt_pk_bf16_f32 v20, v8, v9
v_mfma_f32_16x16x32_bf16 v[200:203], a[220:223], a[168:171], v[200:203]
v_cvt_pk_bf16_f32 v21, v10, v11
v_mfma_f32_16x16x32_bf16 v[200:203], a[200:203], a[172:175], v[200:203]
buffer_store_dwordx4 v[16:19], v0, s[24:27], s60 offen offset:2048 sc1
v_mfma_f32_16x16x32_bf16 v[232:235], a[200:203], a[176:179], v[232:235]
v_accvgpr_read_b32 v22, a252
v_mfma_f32_16x16x32_bf16 v[232:235], a[220:223], a[180:183], v[232:235]
v_mfma_f32_16x16x32_bf16 a[240:243], a[220:223], a[184:187], a[240:243]
global_load_dwordx4 a[220:223], v0, s[72:73] offset:-3072
v_mfma_f32_16x16x32_bf16 a[240:243], a[200:203], a[188:191], a[240:243]
v_accvgpr_read_b32 v23, a253
v_mul_f32 v12, v12, v22
s_waitcnt vmcnt(13)
v_mfma_f32_16x16x32_bf16 a[244:247], a[204:207], a[188:191], a[244:247]
v_mul_f32 v13, v13, v23
v_mfma_f32_16x16x32_bf16 a[244:247], a[228:231], a[184:187], a[244:247]
v_accvgpr_read_b32 v22, a254
v_mfma_f32_16x16x32_bf16 v[236:239], a[228:231], a[180:183], v[236:239]
global_load_dwordx4 a[200:203], v0, s[74:75] offset:-3072
v_mfma_f32_16x16x32_bf16 v[236:239], a[204:207], a[176:179], v[236:239]
v_accvgpr_read_b32 v23, a255
v_mfma_f32_16x16x32_bf16 v[204:207], a[204:207], a[172:175], v[204:207]
v_mul_f32 v14, v14, v22
v_mul_f32 v15, v15, v23
v_mfma_f32_16x16x32_bf16 v[204:207], a[228:231], a[168:171], v[204:207]
v_cvt_pk_bf16_f32 v22, v12, v13
v_mfma_f32_16x16x32_bf16 v[172:175], a[228:231], a[164:167], v[172:175]
v_cvt_pk_bf16_f32 v23, v14, v15
v_mfma_f32_16x16x32_bf16 v[172:175], a[204:207], a[160:163], v[172:175]
ds_write_b128 v3, v[20:23] offset:7168
v_mfma_f32_16x16x32_bf16 v[140:143], a[204:207], a[156:159], v[140:143]
buffer_store_dwordx4 v[20:23], v0, s[24:27], s60 offen offset:3072 sc1
v_mfma_f32_16x16x32_bf16 v[140:143], a[228:231], a[152:155], v[140:143]
v_mfma_f32_16x16x32_bf16 v[108:111], a[228:231], a[148:151], v[108:111]
v_mfma_f32_16x16x32_bf16 v[108:111], a[204:207], a[144:147], v[108:111]
v_mfma_f32_16x16x32_bf16 v[76:79], a[204:207], a[140:143], v[76:79]
v_mfma_f32_16x16x32_bf16 v[76:79], a[228:231], a[136:139], v[76:79]
v_mfma_f32_16x16x32_bf16 v[44:47], a[228:231], a[132:135], v[44:47]
global_load_dwordx4 a[228:231], v0, s[72:73] offset:-2048
v_mfma_f32_16x16x32_bf16 v[44:47], a[204:207], a[128:131], v[44:47]
s_waitcnt vmcnt(13)
v_mfma_f32_16x16x32_bf16 v[48:51], a[196:199], a[128:131], v[48:51]
v_mfma_f32_16x16x32_bf16 v[48:51], a[224:227], a[132:135], v[48:51]
v_mfma_f32_16x16x32_bf16 v[80:83], a[224:227], a[136:139], v[80:83]
global_load_dwordx4 a[204:207], v0, s[74:75] offset:-2048
v_mfma_f32_16x16x32_bf16 v[80:83], a[196:199], a[140:143], v[80:83]
v_mfma_f32_16x16x32_bf16 v[112:115], a[196:199], a[144:147], v[112:115]
v_mfma_f32_16x16x32_bf16 v[112:115], a[224:227], a[148:151], v[112:115]
v_mfma_f32_16x16x32_bf16 v[144:147], a[224:227], a[152:155], v[144:147]
v_mfma_f32_16x16x32_bf16 v[144:147], a[196:199], a[156:159], v[144:147]
v_mfma_f32_16x16x32_bf16 v[176:179], a[196:199], a[160:163], v[176:179]
v_mfma_f32_16x16x32_bf16 v[176:179], a[224:227], a[164:167], v[176:179]
v_mfma_f32_16x16x32_bf16 v[208:211], a[224:227], a[168:171], v[208:211]
v_mfma_f32_16x16x32_bf16 v[208:211], a[196:199], a[172:175], v[208:211]
v_mfma_f32_16x16x32_bf16 v[240:243], a[196:199], a[176:179], v[240:243]
v_mfma_f32_16x16x32_bf16 v[240:243], a[224:227], a[180:183], v[240:243]
v_mfma_f32_16x16x32_bf16 a[248:251], a[224:227], a[184:187], a[248:251]
global_load_dwordx4 a[224:227], v0, s[72:73] offset:-1024
v_mfma_f32_16x16x32_bf16 a[248:251], a[196:199], a[188:191], a[248:251]
s_waitcnt vmcnt(11)
v_mfma_f32_16x16x32_bf16 a[252:255], a[212:215], a[188:191], a[252:255]
ds_read_b128 a[188:191], v2 offset:49152
v_mfma_f32_16x16x32_bf16 a[252:255], a[216:219], a[184:187], a[252:255]
ds_read_b128 a[184:187], v2 offset:57344
v_mfma_f32_16x16x32_bf16 v[244:247], a[216:219], a[180:183], v[244:247]
ds_read_b128 a[180:183], v2 offset:58368
v_mfma_f32_16x16x32_bf16 v[244:247], a[212:215], a[176:179], v[244:247]
ds_read_b128 a[176:179], v2 offset:50176
v_mfma_f32_16x16x32_bf16 v[212:215], a[212:215], a[172:175], v[212:215]
ds_read_b128 a[172:175], v2 offset:51200
v_mfma_f32_16x16x32_bf16 v[212:215], a[216:219], a[168:171], v[212:215]
ds_read_b128 a[168:171], v2 offset:59392
v_mfma_f32_16x16x32_bf16 v[180:183], a[216:219], a[164:167], v[180:183]
ds_read_b128 a[164:167], v2 offset:60416
v_mfma_f32_16x16x32_bf16 v[180:183], a[212:215], a[160:163], v[180:183]
ds_read_b128 a[160:163], v2 offset:52224
v_mfma_f32_16x16x32_bf16 v[148:151], a[212:215], a[156:159], v[148:151]
ds_read_b128 a[156:159], v2 offset:53248
v_mfma_f32_16x16x32_bf16 v[148:151], a[216:219], a[152:155], v[148:151]
ds_read_b128 a[152:155], v2 offset:61440
v_mfma_f32_16x16x32_bf16 v[116:119], a[216:219], a[148:151], v[116:119]
ds_read_b128 a[148:151], v2 offset:62464
v_mfma_f32_16x16x32_bf16 v[116:119], a[212:215], a[144:147], v[116:119]
ds_read_b128 a[144:147], v2 offset:54272
v_mfma_f32_16x16x32_bf16 v[84:87], a[212:215], a[140:143], v[84:87]
ds_read_b128 a[140:143], v2 offset:55296
v_mfma_f32_16x16x32_bf16 v[84:87], a[216:219], a[136:139], v[84:87]
ds_read_b128 a[136:139], v2 offset:63488
v_mfma_f32_16x16x32_bf16 v[52:55], a[216:219], a[132:135], v[52:55]
ds_read_b128 a[132:135], v2 offset:64512
v_mfma_f32_16x16x32_bf16 v[52:55], a[212:215], a[128:131], v[52:55]
ds_read_b128 a[128:131], v2 offset:56320
s_waitcnt vmcnt(7) lgkmcnt(12)
v_mfma_f32_16x16x32_bf16 v[24:27], a[192:195], a[188:191], v[24:27]
global_load_dwordx4 a[196:199], v0, s[74:75] offset:-1024
v_mfma_f32_16x16x32_bf16 v[24:27], a[208:211], a[184:187], v[24:27]
v_lshrrev_b32 v16, 4, v0
v_and_b32 v16, 48, v16
v_mfma_f32_16x16x32_bf16 v[56:59], a[208:211], a[180:183], v[56:59]
s_add_u32 s67, s66, 2048
v_mfma_f32_16x16x32_bf16 v[56:59], a[192:195], a[176:179], v[56:59]
s_waitcnt lgkmcnt(8)
v_mfma_f32_16x16x32_bf16 v[88:91], a[192:195], a[172:175], v[88:91]
global_load_dwordx4 a[216:219], v0, s[72:73] offset:0
v_mfma_f32_16x16x32_bf16 v[88:91], a[208:211], a[168:171], v[88:91]
buffer_load_dwordx4 v[16:19], v16, s[16:19], s67 offen offset:0
v_mfma_f32_16x16x32_bf16 v[120:123], a[208:211], a[164:167], v[120:123]
v_mfma_f32_16x16x32_bf16 v[120:123], a[192:195], a[160:163], v[120:123]
s_waitcnt lgkmcnt(4)
v_mfma_f32_16x16x32_bf16 v[152:155], a[192:195], a[156:159], v[152:155]
global_load_dwordx4 a[212:215], v0, s[74:75] offset:0
v_mfma_f32_16x16x32_bf16 v[152:155], a[208:211], a[152:155], v[152:155]
v_mfma_f32_16x16x32_bf16 v[184:187], a[208:211], a[148:151], v[184:187]
v_mfma_f32_16x16x32_bf16 v[184:187], a[192:195], a[144:147], v[184:187]
s_waitcnt lgkmcnt(0)
v_mfma_f32_16x16x32_bf16 v[216:219], a[192:195], a[140:143], v[216:219]
s_barrier
v_mfma_f32_16x16x32_bf16 v[216:219], a[208:211], a[136:139], v[216:219]
s_add_u32 m0, s56, 114688
v_mfma_f32_16x16x32_bf16 v[248:251], a[208:211], a[132:135], v[248:251]
global_load_dwordx4 a[208:211], v0, s[72:73] offset:1024
v_mfma_f32_16x16x32_bf16 v[248:251], a[192:195], a[128:131], v[248:251]
s_waitcnt vmcnt(9)
v_mfma_f32_16x16x32_bf16 v[252:255], a[220:223], a[128:131], v[252:255]
s_add_u32 s30, s28, 49152
s_addc_u32 s31, s29, 0
v_mfma_f32_16x16x32_bf16 v[252:255], a[200:203], a[132:135], v[252:255]
v_mfma_f32_16x16x32_bf16 v[220:223], a[200:203], a[136:139], v[220:223]
global_load_dwordx4 a[192:195], v0, s[74:75] offset:1024
v_mfma_f32_16x16x32_bf16 v[220:223], a[220:223], a[140:143], v[220:223]
v_mfma_f32_16x16x32_bf16 v[188:191], a[220:223], a[144:147], v[188:191]
v_mfma_f32_16x16x32_bf16 v[188:191], a[200:203], a[148:151], v[188:191]
global_load_lds_dwordx4 v0, s[30:31] nt
v_mfma_f32_16x16x32_bf16 v[156:159], a[200:203], a[152:155], v[156:159]
v_mfma_f32_16x16x32_bf16 v[156:159], a[220:223], a[156:159], v[156:159]
v_mfma_f32_16x16x32_bf16 v[124:127], a[220:223], a[160:163], v[124:127]
v_mfma_f32_16x16x32_bf16 v[124:127], a[200:203], a[164:167], v[124:127]
v_mfma_f32_16x16x32_bf16 v[92:95], a[200:203], a[168:171], v[92:95]
s_mov_b32 s38, 388
s_waitcnt vmcnt(10)
v_mfma_f32_16x16x32_bf16 v[92:95], a[220:223], a[172:175], v[92:95]
buffer_store_dword v6, v0, s[36:39], 0 offen offset:384 sc1
v_mfma_f32_16x16x32_bf16 v[60:63], a[220:223], a[176:179], v[60:63]
v_mfma_f32_16x16x32_bf16 v[60:63], a[200:203], a[180:183], v[60:63]
v_mfma_f32_16x16x32_bf16 v[28:31], a[200:203], a[184:187], v[28:31]
global_load_dwordx4 a[200:203], v0, s[72:73] offset:2048
v_mfma_f32_16x16x32_bf16 v[28:31], a[220:223], a[188:191], v[28:31]
s_waitcnt vmcnt(10)
v_mfma_f32_16x16x32_bf16 v[32:35], a[228:231], a[188:191], v[32:35]
global_load_lds_dwordx4 v0, s[30:31] offset:1024 nt
v_mfma_f32_16x16x32_bf16 v[32:35], a[204:207], a[184:187], v[32:35]
v_mfma_f32_16x16x32_bf16 v[64:67], a[204:207], a[180:183], v[64:67]
global_load_dwordx4 a[220:223], v0, s[74:75] offset:2048
v_mfma_f32_16x16x32_bf16 v[64:67], a[228:231], a[176:179], v[64:67]
v_mfma_f32_16x16x32_bf16 v[96:99], a[228:231], a[172:175], v[96:99]
v_mfma_f32_16x16x32_bf16 v[96:99], a[204:207], a[168:171], v[96:99]
v_mfma_f32_16x16x32_bf16 v[128:131], a[204:207], a[164:167], v[128:131]
v_mfma_f32_16x16x32_bf16 v[128:131], a[228:231], a[160:163], v[128:131]
v_mfma_f32_16x16x32_bf16 v[160:163], a[228:231], a[156:159], v[160:163]
v_mfma_f32_16x16x32_bf16 v[160:163], a[204:207], a[152:155], v[160:163]
v_mfma_f32_16x16x32_bf16 v[192:195], a[204:207], a[148:151], v[192:195]
s_add_u32 m0, s56, 122880
v_mfma_f32_16x16x32_bf16 v[192:195], a[228:231], a[144:147], v[192:195]
s_add_u32 s30, s28, 57344
s_addc_u32 s31, s29, 0
v_mfma_f32_16x16x32_bf16 v[224:227], a[228:231], a[140:143], v[224:227]
v_mfma_f32_16x16x32_bf16 v[224:227], a[204:207], a[136:139], v[224:227]
v_mfma_f32_16x16x32_bf16 a[232:235], a[204:207], a[132:135], a[232:235]
global_load_dwordx4 a[204:207], v0, s[72:73] offset:3072
v_mfma_f32_16x16x32_bf16 a[232:235], a[228:231], a[128:131], a[232:235]
s_waitcnt vmcnt(11)
v_mfma_f32_16x16x32_bf16 a[236:239], a[224:227], a[128:131], a[236:239]
global_load_lds_dwordx4 v0, s[30:31] nt
v_mfma_f32_16x16x32_bf16 a[236:239], a[196:199], a[132:135], a[236:239]
v_mfma_f32_16x16x32_bf16 v[228:231], a[196:199], a[136:139], v[228:231]
global_load_dwordx4 a[228:231], v0, s[74:75] offset:3072
v_mfma_f32_16x16x32_bf16 v[228:231], a[224:227], a[140:143], v[228:231]
s_add_u32 s72, s12, 405504
s_addc_u32 s73, s13, 0
v_mfma_f32_16x16x32_bf16 v[196:199], a[224:227], a[144:147], v[196:199]
v_mfma_f32_16x16x32_bf16 v[196:199], a[196:199], a[148:151], v[196:199]
v_mfma_f32_16x16x32_bf16 v[164:167], a[196:199], a[152:155], v[164:167]
s_add_u32 s74, s12, 438272
s_addc_u32 s75, s13, 0
v_mfma_f32_16x16x32_bf16 v[164:167], a[224:227], a[156:159], v[164:167]
v_mfma_f32_16x16x32_bf16 v[132:135], a[224:227], a[160:163], v[132:135]
v_mfma_f32_16x16x32_bf16 v[132:135], a[196:199], a[164:167], v[132:135]
v_mfma_f32_16x16x32_bf16 v[100:103], a[196:199], a[168:171], v[100:103]
v_mfma_f32_16x16x32_bf16 v[100:103], a[224:227], a[172:175], v[100:103]
v_mfma_f32_16x16x32_bf16 v[68:71], a[224:227], a[176:179], v[68:71]
v_mfma_f32_16x16x32_bf16 v[68:71], a[196:199], a[180:183], v[68:71]
global_load_lds_dwordx4 v0, s[30:31] offset:1024 nt
v_mfma_f32_16x16x32_bf16 v[36:39], a[196:199], a[184:187], v[36:39]
global_load_dwordx4 a[196:199], v0, s[72:73] offset:-4096
v_mfma_f32_16x16x32_bf16 v[36:39], a[224:227], a[188:191], v[36:39]
s_waitcnt vmcnt(12)
v_mfma_f32_16x16x32_bf16 v[40:43], a[216:219], a[188:191], v[40:43]
v_mfma_f32_16x16x32_bf16 v[40:43], a[212:215], a[184:187], v[40:43]
v_mfma_f32_16x16x32_bf16 v[72:75], a[212:215], a[180:183], v[72:75]
global_load_dwordx4 a[224:227], v0, s[74:75] offset:-4096
v_mfma_f32_16x16x32_bf16 v[72:75], a[216:219], a[176:179], v[72:75]
v_mfma_f32_16x16x32_bf16 v[104:107], a[216:219], a[172:175], v[104:107]
v_mfma_f32_16x16x32_bf16 v[104:107], a[212:215], a[168:171], v[104:107]
v_mfma_f32_16x16x32_bf16 v[136:139], a[212:215], a[164:167], v[136:139]
v_mfma_f32_16x16x32_bf16 v[136:139], a[216:219], a[160:163], v[136:139]
v_mfma_f32_16x16x32_bf16 v[168:171], a[216:219], a[156:159], v[168:171]
v_mfma_f32_16x16x32_bf16 v[168:171], a[212:215], a[152:155], v[168:171]
v_mfma_f32_16x16x32_bf16 v[200:203], a[212:215], a[148:151], v[200:203]
v_mfma_f32_16x16x32_bf16 v[200:203], a[216:219], a[144:147], v[200:203]
v_mfma_f32_16x16x32_bf16 v[232:235], a[216:219], a[140:143], v[232:235]
v_mfma_f32_16x16x32_bf16 v[232:235], a[212:215], a[136:139], v[232:235]
s_mov_b32 s34, 320
v_mfma_f32_16x16x32_bf16 a[240:243], a[212:215], a[132:135], a[240:243]
global_load_dwordx4 a[212:215], v0, s[72:73] offset:-3072
v_mfma_f32_16x16x32_bf16 a[240:243], a[216:219], a[128:131], a[240:243]
s_waitcnt vmcnt(12)
v_mfma_f32_16x16x32_bf16 a[244:247], a[208:211], a[128:131], a[244:247]
buffer_load_dword v5, v0, s[32:35], 0 offen offset:256 sc1
v_mfma_f32_16x16x32_bf16 a[244:247], a[192:195], a[132:135], a[244:247]
v_mfma_f32_16x16x32_bf16 v[236:239], a[192:195], a[136:139], v[236:239]
global_load_dwordx4 a[216:219], v0, s[74:75] offset:-3072
v_mfma_f32_16x16x32_bf16 v[236:239], a[208:211], a[140:143], v[236:239]
v_mfma_f32_16x16x32_bf16 v[204:207], a[208:211], a[144:147], v[204:207]
v_mfma_f32_16x16x32_bf16 v[204:207], a[192:195], a[148:151], v[204:207]
v_mfma_f32_16x16x32_bf16 v[172:175], a[192:195], a[152:155], v[172:175]
v_mfma_f32_16x16x32_bf16 v[172:175], a[208:211], a[156:159], v[172:175]
v_mfma_f32_16x16x32_bf16 v[140:143], a[208:211], a[160:163], v[140:143]
v_mfma_f32_16x16x32_bf16 v[140:143], a[192:195], a[164:167], v[140:143]
v_mfma_f32_16x16x32_bf16 v[108:111], a[192:195], a[168:171], v[108:111]
v_mfma_f32_16x16x32_bf16 v[108:111], a[208:211], a[172:175], v[108:111]
v_mfma_f32_16x16x32_bf16 v[76:79], a[208:211], a[176:179], v[76:79]
v_mfma_f32_16x16x32_bf16 v[76:79], a[192:195], a[180:183], v[76:79]
v_mfma_f32_16x16x32_bf16 v[44:47], a[192:195], a[184:187], v[44:47]
global_load_dwordx4 a[192:195], v0, s[72:73] offset:-2048
v_mfma_f32_16x16x32_bf16 v[44:47], a[208:211], a[188:191], v[44:47]
s_waitcnt vmcnt(10)
v_mfma_f32_16x16x32_bf16 v[48:51], a[200:203], a[188:191], v[48:51]
v_mfma_f32_16x16x32_bf16 v[48:51], a[220:223], a[184:187], v[48:51]
v_mfma_f32_16x16x32_bf16 v[80:83], a[220:223], a[180:183], v[80:83]
global_load_dwordx4 a[208:211], v0, s[74:75] offset:-2048
v_mfma_f32_16x16x32_bf16 v[80:83], a[200:203], a[176:179], v[80:83]
v_mfma_f32_16x16x32_bf16 v[112:115], a[200:203], a[172:175], v[112:115]
v_mfma_f32_16x16x32_bf16 v[112:115], a[220:223], a[168:171], v[112:115]
v_mfma_f32_16x16x32_bf16 v[144:147], a[220:223], a[164:167], v[144:147]
v_mfma_f32_16x16x32_bf16 v[144:147], a[200:203], a[160:163], v[144:147]
v_mfma_f32_16x16x32_bf16 v[176:179], a[200:203], a[156:159], v[176:179]
v_mfma_f32_16x16x32_bf16 v[176:179], a[220:223], a[152:155], v[176:179]
v_mfma_f32_16x16x32_bf16 v[208:211], a[220:223], a[148:151], v[208:211]
v_mfma_f32_16x16x32_bf16 v[208:211], a[200:203], a[144:147], v[208:211]
v_mfma_f32_16x16x32_bf16 v[240:243], a[200:203], a[140:143], v[240:243]
v_mfma_f32_16x16x32_bf16 v[240:243], a[220:223], a[136:139], v[240:243]
v_mfma_f32_16x16x32_bf16 a[248:251], a[220:223], a[132:135], a[248:251]
global_load_dwordx4 a[220:223], v0, s[72:73] offset:-1024
v_mfma_f32_16x16x32_bf16 a[248:251], a[200:203], a[128:131], a[248:251]
s_waitcnt vmcnt(9)
v_mfma_f32_16x16x32_bf16 a[252:255], a[204:207], a[128:131], a[252:255]
ds_read_b128 a[128:131], v2 offset:32768
v_mfma_f32_16x16x32_bf16 a[252:255], a[228:231], a[132:135], a[252:255]
ds_read_b128 a[132:135], v2 offset:40960
v_mfma_f32_16x16x32_bf16 v[244:247], a[228:231], a[136:139], v[244:247]
ds_read_b128 a[136:139], v2 offset:41984
v_mfma_f32_16x16x32_bf16 v[244:247], a[204:207], a[140:143], v[244:247]
ds_read_b128 a[140:143], v2 offset:33792
v_mfma_f32_16x16x32_bf16 v[212:215], a[204:207], a[144:147], v[212:215]
ds_read_b128 a[144:147], v2 offset:34816
v_mfma_f32_16x16x32_bf16 v[212:215], a[228:231], a[148:151], v[212:215]
ds_read_b128 a[148:151], v2 offset:43008
v_mfma_f32_16x16x32_bf16 v[180:183], a[228:231], a[152:155], v[180:183]
ds_read_b128 a[152:155], v2 offset:44032
v_mfma_f32_16x16x32_bf16 v[180:183], a[204:207], a[156:159], v[180:183]
ds_read_b128 a[156:159], v2 offset:35840
L_pad10:
s_cbranch_execz L_pad14
v_mfma_f32_16x16x32_bf16 v[148:151], a[204:207], a[160:163], v[148:151]
ds_read_b128 a[160:163], v2 offset:36864
v_mfma_f32_16x16x32_bf16 v[148:151], a[228:231], a[164:167], v[148:151]
ds_read_b128 a[164:167], v2 offset:45056
v_mfma_f32_16x16x32_bf16 v[116:119], a[228:231], a[168:171], v[116:119]
ds_read_b128 a[168:171], v2 offset:46080
v_mfma_f32_16x16x32_bf16 v[116:119], a[204:207], a[172:175], v[116:119]
ds_read_b128 a[172:175], v2 offset:37888
v_mfma_f32_16x16x32_bf16 v[84:87], a[204:207], a[176:179], v[84:87]
ds_read_b128 a[176:179], v2 offset:38912
v_mfma_f32_16x16x32_bf16 v[84:87], a[228:231], a[180:183], v[84:87]
ds_read_b128 a[180:183], v2 offset:47104
v_mfma_f32_16x16x32_bf16 v[52:55], a[228:231], a[184:187], v[52:55]
ds_read_b128 a[184:187], v2 offset:48128
v_mfma_f32_16x16x32_bf16 v[52:55], a[204:207], a[188:191], v[52:55]
ds_read_b128 a[188:191], v2 offset:39936
s_waitcnt vmcnt(6) lgkmcnt(12)
v_mfma_f32_16x16x32_bf16 v[24:27], a[196:199], a[128:131], v[24:27]
global_load_dwordx4 a[200:203], v0, s[74:75] offset:-1024
v_mfma_f32_16x16x32_bf16 v[24:27], a[224:227], a[132:135], v[24:27]
v_mfma_f32_16x16x32_bf16 v[56:59], a[224:227], a[136:139], v[56:59]
v_mfma_f32_16x16x32_bf16 v[56:59], a[196:199], a[140:143], v[56:59]
s_waitcnt lgkmcnt(8)
v_mfma_f32_16x16x32_bf16 v[88:91], a[196:199], a[144:147], v[88:91]
global_load_dwordx4 a[228:231], v0, s[72:73] offset:0
v_mfma_f32_16x16x32_bf16 v[88:91], a[224:227], a[148:151], v[88:91]
v_mfma_f32_16x16x32_bf16 v[120:123], a[224:227], a[152:155], v[120:123]
v_mfma_f32_16x16x32_bf16 v[120:123], a[196:199], a[156:159], v[120:123]
s_waitcnt lgkmcnt(4)
v_mfma_f32_16x16x32_bf16 v[152:155], a[196:199], a[160:163], v[152:155]
global_load_dwordx4 a[204:207], v0, s[74:75] offset:0
v_mfma_f32_16x16x32_bf16 v[152:155], a[224:227], a[164:167], v[152:155]
v_mfma_f32_16x16x32_bf16 v[184:187], a[224:227], a[168:171], v[184:187]
v_mfma_f32_16x16x32_bf16 v[184:187], a[196:199], a[172:175], v[184:187]
s_waitcnt lgkmcnt(0)
v_mfma_f32_16x16x32_bf16 v[216:219], a[196:199], a[176:179], v[216:219]
s_barrier
v_mfma_f32_16x16x32_bf16 v[216:219], a[224:227], a[180:183], v[216:219]
s_waitcnt vmcnt(7)
v_mfma_f32_16x16x32_bf16 v[248:251], a[224:227], a[184:187], v[248:251]
global_load_dwordx4 a[224:227], v0, s[72:73] offset:1024
v_mfma_f32_16x16x32_bf16 v[248:251], a[196:199], a[188:191], v[248:251]
s_waitcnt vmcnt(7)
v_mfma_f32_16x16x32_bf16 v[252:255], a[212:215], a[188:191], v[252:255]
v_cmp_ne_u32 vcc, 16256, v5
v_mfma_f32_16x16x32_bf16 v[252:255], a[216:219], a[184:187], v[252:255]
v_mfma_f32_16x16x32_bf16 v[220:223], a[216:219], a[180:183], v[220:223]
global_load_dwordx4 a[196:199], v0, s[74:75] offset:1024
v_mfma_f32_16x16x32_bf16 v[220:223], a[212:215], a[176:179], v[220:223]
v_mfma_f32_16x16x32_bf16 v[188:191], a[212:215], a[172:175], v[188:191]
s_and_b32 s3, vcc_lo, 15
s_cbranch_scc1 L_slow4
L_back4:
v_mfma_f32_16x16x32_bf16 v[188:191], a[216:219], a[168:171], v[188:191]
v_mfma_f32_16x16x32_bf16 v[156:159], a[216:219], a[164:167], v[156:159]
v_mfma_f32_16x16x32_bf16 v[156:159], a[212:215], a[160:163], v[156:159]
s_add_u32 m0, s56, 98304
v_mfma_f32_16x16x32_bf16 v[124:127], a[212:215], a[156:159], v[124:127]
s_add_u32 s30, s28, 65536
s_addc_u32 s31, s29, 0
v_mfma_f32_16x16x32_bf16 v[124:127], a[216:219], a[152:155], v[124:127]
v_mfma_f32_16x16x32_bf16 v[92:95], a[216:219], a[148:151], v[92:95]
v_mfma_f32_16x16x32_bf16 v[92:95], a[212:215], a[144:147], v[92:95]
global_load_lds_dwordx4 v0, s[30:31] nt
v_mfma_f32_16x16x32_bf16 v[60:63], a[212:215], a[140:143], v[60:63]
v_mfma_f32_16x16x32_bf16 v[60:63], a[216:219], a[136:139], v[60:63]
v_mfma_f32_4x4x4_16b_bf16 v[8:11], v[6:7], v[16:17], 0
v_mfma_f32_4x4x4_16b_bf16 v[12:15], v[6:7], v[18:19], 0
v_mfma_f32_16x16x32_bf16 v[28:31], a[216:219], a[132:135], v[28:31]
global_load_dwordx4 a[216:219], v0, s[72:73] offset:2048
v_mfma_f32_16x16x32_bf16 v[28:31], a[212:215], a[128:131], v[28:31]
s_waitcnt vmcnt(8)
v_mfma_f32_16x16x32_bf16 v[32:35], a[192:195], a[128:131], v[32:35]
v_mfma_f32_16x16x32_bf16 v[32:35], a[208:211], a[132:135], v[32:35]
v_mfma_f32_16x16x32_bf16 v[64:67], a[208:211], a[136:139], v[64:67]
global_load_dwordx4 a[212:215], v0, s[74:75] offset:2048
v_mfma_f32_16x16x32_bf16 v[64:67], a[192:195], a[140:143], v[64:67]
v_mfma_f32_16x16x32_bf16 v[96:99], a[192:195], a[144:147], v[96:99]
v_mfma_f32_16x16x32_bf16 v[96:99], a[208:211], a[148:151], v[96:99]
v_add_f32 v24, v24, v8
v_mfma_f32_16x16x32_bf16 v[128:131], a[208:211], a[152:155], v[128:131]
global_load_lds_dwordx4 v0, s[30:31] offset:1024 nt
v_mfma_f32_16x16x32_bf16 v[128:131], a[192:195], a[156:159], v[128:131]
v_add_f32 v25, v25, v9
v_mfma_f32_16x16x32_bf16 v[160:163], a[192:195], a[160:163], v[160:163]
v_add_f32 v26, v26, v10
v_mfma_f32_16x16x32_bf16 v[160:163], a[208:211], a[164:167], v[160:163]
v_add_f32 v27, v27, v11
v_mfma_f32_16x16x32_bf16 v[192:195], a[208:211], a[168:171], v[192:195]
v_add_f32 v28, v28, v12
v_add_f32 v29, v29, v13
v_mfma_f32_16x16x32_bf16 v[192:195], a[192:195], a[172:175], v[192:195]
v_add_f32 v30, v30, v14
v_mfma_f32_16x16x32_bf16 v[224:227], a[192:195], a[176:179], v[224:227]
v_add_f32 v31, v31, v15
v_mfma_f32_16x16x32_bf16 v[224:227], a[208:211], a[180:183], v[224:227]
v_mfma_f32_16x16x32_bf16 a[232:235], a[208:211], a[184:187], a[232:235]
global_load_dwordx4 a[208:211], v0, s[72:73] offset:3072
v_mfma_f32_16x16x32_bf16 a[232:235], a[192:195], a[188:191], a[232:235]
s_add_u32 m0, s56, 106496
v_add_f32 v56, v56, v8
s_waitcnt vmcnt(9)
v_mfma_f32_16x16x32_bf16 a[236:239], a[220:223], a[188:191], a[236:239]
s_add_u32 s30, s28, 73728
s_addc_u32 s31, s29, 0
v_mfma_f32_16x16x32_bf16 a[236:239], a[200:203], a[184:187], a[236:239]
v_mfma_f32_16x16x32_bf16 v[228:231], a[200:203], a[180:183], v[228:231]
global_load_dwordx4 a[192:195], v0, s[74:75] offset:3072
v_mfma_f32_16x16x32_bf16 v[228:231], a[220:223], a[176:179], v[228:231]
s_add_u32 s72, s12, 471040
s_addc_u32 s73, s13, 0
v_mfma_f32_16x16x32_bf16 v[196:199], a[220:223], a[172:175], v[196:199]
v_add_f32 v57, v57, v9
v_mfma_f32_16x16x32_bf16 v[196:199], a[200:203], a[168:171], v[196:199]
v_add_f32 v58, v58, v10
v_add_f32 v59, v59, v11
v_mfma_f32_16x16x32_bf16 v[164:167], a[200:203], a[164:167], v[164:167]
s_add_u32 s74, s12, 503808
s_addc_u32 s75, s13, 0
v_mfma_f32_16x16x32_bf16 v[164:167], a[220:223], a[160:163], v[164:167]
global_load_lds_dwordx4 v0, s[30:31] nt
v_mfma_f32_16x16x32_bf16 v[132:135], a[220:223], a[156:159], v[132:135]
v_add_f32 v60, v60, v12
v_mfma_f32_16x16x32_bf16 v[132:135], a[200:203], a[152:155], v[132:135]
v_add_f32 v61, v61, v13
v_mfma_f32_16x16x32_bf16 v[100:103], a[200:203], a[148:151], v[100:103]
v_add_f32 v62, v62, v14
v_mfma_f32_16x16x32_bf16 v[100:103], a[220:223], a[144:147], v[100:103]
v_add_f32 v63, v63, v15
v_mfma_f32_16x16x32_bf16 v[68:71], a[220:223], a[140:143], v[68:71]
v_add_f32 v88, v88, v8
v_mfma_f32_16x16x32_bf16 v[68:71], a[200:203], a[136:139], v[68:71]
v_add_f32 v89, v89, v9
v_mfma_f32_16x16x32_bf16 v[36:39], a[200:203], a[132:135], v[36:39]
global_load_dwordx4 a[200:203], v0, s[72:73] offset:-4096
v_mfma_f32_16x16x32_bf16 v[36:39], a[220:223], a[128:131], v[36:39]
s_waitcnt vmcnt(10)
v_mfma_f32_16x16x32_bf16 v[40:43], a[228:231], a[128:131], v[40:43]
global_load_lds_dwordx4 v0, s[30:31] offset:1024 nt
v_mfma_f32_16x16x32_bf16 v[40:43], a[204:207], a[132:135], v[40:43]
v_add_f32 v90, v90, v10
v_mfma_f32_16x16x32_bf16 v[72:75], a[204:207], a[136:139], v[72:75]
global_load_dwordx4 a[220:223], v0, s[74:75] offset:-4096
v_mfma_f32_16x16x32_bf16 v[72:75], a[228:231], a[140:143], v[72:75]
v_add_f32 v91, v91, v11
v_mfma_f32_16x16x32_bf16 v[104:107], a[228:231], a[144:147], v[104:107]
v_add_f32 v92, v92, v12
v_mfma_f32_16x16x32_bf16 v[104:107], a[204:207], a[148:151], v[104:107]
v_add_f32 v93, v93, v13
v_mfma_f32_16x16x32_bf16 v[136:139], a[204:207], a[152:155], v[136:139]
v_add_f32 v94, v94, v14
v_mfma_f32_16x16x32_bf16 v[136:139], a[228:231], a[156:159], v[136:139]
v_add_f32 v95, v95, v15
v_mfma_f32_16x16x32_bf16 v[168:171], a[228:231], a[160:163], v[168:171]
v_add_f32 v120, v120, v8
v_add_f32 v121, v121, v9
v_mfma_f32_16x16x32_bf16 v[168:171], a[204:207], a[164:167], v[168:171]
v_add_f32 v122, v122, v10
v_mfma_f32_16x16x32_bf16 v[200:203], a[204:207], a[168:171], v[200:203]
v_add_f32 v123, v123, v11
v_mfma_f32_16x16x32_bf16 v[200:203], a[228:231], a[172:175], v[200:203]
v_add_f32 v124, v124, v12
v_mfma_f32_16x16x32_bf16 v[232:235], a[228:231], a[176:179], v[232:235]
v_add_f32 v125, v125, v13
v_mfma_f32_16x16x32_bf16 v[232:235], a[204:207], a[180:183], v[232:235]
v_add_f32 v126, v126, v14
v_mfma_f32_16x16x32_bf16 a[240:243], a[204:207], a[184:187], a[240:243]
global_load_dwordx4 a[204:207], v0, s[72:73] offset:-3072
v_mfma_f32_16x16x32_bf16 a[240:243], a[228:231], a[188:191], a[240:243]
v_add_f32 v127, v127, v15
s_waitcnt vmcnt(11)
v_mfma_f32_16x16x32_bf16 a[244:247], a[224:227], a[188:191], a[244:247]
v_add_f32 v152, v152, v8
v_mfma_f32_16x16x32_bf16 a[244:247], a[196:199], a[184:187], a[244:247]
v_mfma_f32_16x16x32_bf16 v[236:239], a[196:199], a[180:183], v[236:239]
global_load_dwordx4 a[228:231], v0, s[74:75] offset:-3072
v_mfma_f32_16x16x32_bf16 v[236:239], a[224:227], a[176:179], v[236:239]
v_add_f32 v153, v153, v9
v_mfma_f32_16x16x32_bf16 v[204:207], a[224:227], a[172:175], v[204:207]
v_add_f32 v154, v154, v10
v_mfma_f32_16x16x32_bf16 v[204:207], a[196:199], a[168:171], v[204:207]
v_add_f32 v155, v155, v11
v_add_f32 v156, v156, v12
v_mfma_f32_16x16x32_bf16 v[172:175], a[196:199], a[164:167], v[172:175]
v_add_f32 v157, v157, v13
v_mfma_f32_16x16x32_bf16 v[172:175], a[224:227], a[160:163], v[172:175]
v_add_f32 v158, v158, v14
v_mfma_f32_16x16x32_bf16 v[140:143], a[224:227], a[156:159], v[140:143]
v_add_f32 v159, v159, v15
v_mfma_f32_16x16x32_bf16 v[140:143], a[196:199], a[152:155], v[140:143]
v_add_f32 v184, v184, v8
v_mfma_f32_16x16x32_bf16 v[108:111], a[196:199], a[148:151], v[108:111]
v_add_f32 v185, v185, v9
v_mfma_f32_16x16x32_bf16 v[108:111], a[224:227], a[144:147], v[108:111]
v_add_f32 v186, v186, v10
v_mfma_f32_16x16x32_bf16 v[76:79], a[224:227], a[140:143], v[76:79]
v_add_f32 v187, v187, v11
v_add_f32 v188, v188, v12
v_mfma_f32_16x16x32_bf16 v[76:79], a[196:199], a[136:139], v[76:79]
v_mfma_f32_16x16x32_bf16 v[44:47], a[196:199], a[132:135], v[44:47]
global_load_dwordx4 a[196:199], v0, s[72:73] offset:-2048
v_mfma_f32_16x16x32_bf16 v[44:47], a[224:227], a[128:131], v[44:47]
v_add_f32 v189, v189, v13
s_waitcnt vmcnt(10)
v_mfma_f32_16x16x32_bf16 v[48:51], a[216:219], a[128:131], v[48:51]
v_add_f32 v190, v190, v14
v_mfma_f32_16x16x32_bf16 v[48:51], a[212:215], a[132:135], v[48:51]
v_add_f32 v191, v191, v15
v_mfma_f32_16x16x32_bf16 v[80:83], a[212:215], a[136:139], v[80:83]
global_load_dwordx4 a[224:227], v0, s[74:75] offset:-2048
v_mfma_f32_16x16x32_bf16 v[80:83], a[216:219], a[140:143], v[80:83]
v_add_f32 v216, v216, v8
v_mfma_f32_16x16x32_bf16 v[112:115], a[216:219], a[144:147], v[112:115]
v_add_f32 v217, v217, v9
v_mfma_f32_16x16x32_bf16 v[112:115], a[212:215], a[148:151], v[112:115]
v_add_f32 v218, v218, v10
v_mfma_f32_16x16x32_bf16 v[144:147], a[212:215], a[152:155], v[144:147]
v_add_f32 v219, v219, v11
v_mfma_f32_16x16x32_bf16 v[144:147], a[216:219], a[156:159], v[144:147]
v_add_f32 v220, v220, v12
v_mfma_f32_16x16x32_bf16 v[176:179], a[216:219], a[160:163], v[176:179]
v_add_f32 v221, v221, v13
v_add_f32 v222, v222, v14
v_mfma_f32_16x16x32_bf16 v[176:179], a[212:215], a[164:167], v[176:179]
v_add_f32 v223, v223, v15
v_mfma_f32_16x16x32_bf16 v[208:211], a[212:215], a[168:171], v[208:211]
v_add_f32 v248, v248, v8
v_mfma_f32_16x16x32_bf16 v[208:211], a[216:219], a[172:175], v[208:211]
v_add_f32 v249, v249, v9
v_mfma_f32_16x16x32_bf16 v[240:243], a[216:219], a[176:179], v[240:243]
v_add_f32 v250, v250, v10
v_mfma_f32_16x16x32_bf16 v[240:243], a[212:215], a[180:183], v[240:243]
v_add_f32 v251, v251, v11
v_mfma_f32_16x16x32_bf16 a[248:251], a[212:215], a[184:187], a[248:251]
global_load_dwordx4 a[212:215], v0, s[72:73] offset:-1024
v_mfma_f32_16x16x32_bf16 a[248:251], a[216:219], a[188:191], a[248:251]
v_add_f32 v252, v252, v12
s_waitcnt vmcnt(9)
v_mfma_f32_16x16x32_bf16 a[252:255], a[208:211], a[188:191], a[252:255]
ds_read_b128 a[188:191], v2 offset:49152
v_mfma_f32_16x16x32_bf16 a[252:255], a[192:195], a[184:187], a[252:255]
ds_read_b128 a[184:187], v2 offset:57344
v_add_f32 v253, v253, v13
v_mfma_f32_16x16x32_bf16 v[244:247], a[192:195], a[180:183], v[244:247]
ds_read_b128 a[180:183], v2 offset:58368
v_mfma_f32_16x16x32_bf16 v[244:247], a[208:211], a[176:179], v[244:247]
ds_read_b128 a[176:179], v2 offset:50176
v_add_f32 v254, v254, v14
v_mfma_f32_16x16x32_bf16 v[212:215], a[208:211], a[172:175], v[212:215]
ds_read_b128 a[172:175], v2 offset:51200
v_mfma_f32_16x16x32_bf16 v[212:215], a[192:195], a[168:171], v[212:215]
ds_read_b128 a[168:171], v2 offset:59392
v_add_f32 v255, v255, v15
v_mfma_f32_16x16x32_bf16 v[180:183], a[192:195], a[164:167], v[180:183]
ds_read_b128 a[164:167], v2 offset:60416
v_mfma_f32_16x16x32_bf16 v[180:183], a[208:211], a[160:163], v[180:183]
ds_read_b128 a[160:163], v2 offset:52224
v_mfma_f32_16x16x32_bf16 v[148:151], a[208:211], a[156:159], v[148:151]
ds_read_b128 a[156:159], v2 offset:53248
v_mfma_f32_16x16x32_bf16 v[148:151], a[192:195], a[152:155], v[148:151]
ds_read_b128 a[152:155], v2 offset:61440
v_lshrrev_b32 v16, 4, v0
v_mfma_f32_16x16x32_bf16 v[116:119], a[192:195], a[148:151], v[116:119]
ds_read_b128 a[148:151], v2 offset:62464
v_and_b32 v16, 48, v16
v_mfma_f32_16x16x32_bf16 v[116:119], a[208:211], a[144:147], v[116:119]
ds_read_b128 a[144:147], v2 offset:54272
s_add_u32 s67, s66, 2048
v_mfma_f32_16x16x32_bf16 v[84:87], a[208:211], a[140:143], v[84:87]
ds_read_b128 a[140:143], v2 offset:55296
v_mfma_f32_16x16x32_bf16 v[84:87], a[192:195], a[136:139], v[84:87]
ds_read_b128 a[136:139], v2 offset:63488
v_mfma_f32_16x16x32_bf16 v[52:55], a[192:195], a[132:135], v[52:55]
ds_read_b128 a[132:135], v2 offset:64512
v_mfma_f32_16x16x32_bf16 v[52:55], a[208:211], a[128:131], v[52:55]
ds_read_b128 a[128:131], v2 offset:56320
s_waitcnt vmcnt(5) lgkmcnt(12)
v_mfma_f32_16x16x32_bf16 v[24:27], a[200:203], a[188:191], v[24:27]
global_load_dwordx4 a[216:219], v0, s[74:75] offset:-1024
buffer_load_dwordx4 v[16:19], v16, s[16:19], s67 offen offset:64
v_mfma_f32_16x16x32_bf16 v[24:27], a[220:223], a[184:187], v[24:27]
v_mfma_f32_16x16x32_bf16 v[56:59], a[220:223], a[180:183], v[56:59]
v_mfma_f32_16x16x32_bf16 v[56:59], a[200:203], a[176:179], v[56:59]
s_waitcnt lgkmcnt(8)
v_mfma_f32_16x16x32_bf16 v[88:91], a[200:203], a[172:175], v[88:91]
global_load_dwordx4 a[192:195], v0, s[72:73] offset:0
v_mfma_f32_16x16x32_bf16 v[88:91], a[220:223], a[168:171], v[88:91]
v_mfma_f32_16x16x32_bf16 v[120:123], a[220:223], a[164:167], v[120:123]
v_mfma_f32_16x16x32_bf16 v[120:123], a[200:203], a[160:163], v[120:123]
s_waitcnt lgkmcnt(4)
v_mfma_f32_16x16x32_bf16 v[152:155], a[200:203], a[156:159], v[152:155]
global_load_dwordx4 a[208:211], v0, s[74:75] offset:0
v_mfma_f32_16x16x32_bf16 v[152:155], a[220:223], a[152:155], v[152:155]
v_mfma_f32_16x16x32_bf16 v[184:187], a[220:223], a[148:151], v[184:187]
v_mfma_f32_16x16x32_bf16 v[184:187], a[200:203], a[144:147], v[184:187]
s_waitcnt lgkmcnt(0)
v_mfma_f32_16x16x32_bf16 v[216:219], a[200:203], a[140:143], v[216:219]
v_mfma_f32_16x16x32_bf16 v[216:219], a[220:223], a[136:139], v[216:219]
v_mfma_f32_16x16x32_bf16 v[248:251], a[220:223], a[132:135], v[248:251]
global_load_dwordx4 a[220:223], v0, s[72:73] offset:1024
v_mfma_f32_16x16x32_bf16 v[248:251], a[200:203], a[128:131], v[248:251]
s_waitcnt vmcnt(8)
v_mfma_f32_16x16x32_bf16 v[252:255], a[204:207], a[128:131], v[252:255]
v_mfma_f32_16x16x32_bf16 v[252:255], a[228:231], a[132:135], v[252:255]
v_mfma_f32_16x16x32_bf16 v[220:223], a[228:231], a[136:139], v[220:223]
global_load_dwordx4 a[200:203], v0, s[74:75] offset:1024
v_mfma_f32_16x16x32_bf16 v[220:223], a[204:207], a[140:143], v[220:223]
v_mfma_f32_16x16x32_bf16 v[188:191], a[204:207], a[144:147], v[188:191]
v_mfma_f32_16x16x32_bf16 v[188:191], a[228:231], a[148:151], v[188:191]
v_mfma_f32_16x16x32_bf16 v[156:159], a[228:231], a[152:155], v[156:159]
v_mfma_f32_16x16x32_bf16 v[156:159], a[204:207], a[156:159], v[156:159]
v_mfma_f32_16x16x32_bf16 v[124:127], a[204:207], a[160:163], v[124:127]
v_mfma_f32_16x16x32_bf16 v[124:127], a[228:231], a[164:167], v[124:127]
v_mfma_f32_16x16x32_bf16 v[92:95], a[228:231], a[168:171], v[92:95]
v_mfma_f32_16x16x32_bf16 v[92:95], a[204:207], a[172:175], v[92:95]
v_mfma_f32_16x16x32_bf16 v[60:63], a[204:207], a[176:179], v[60:63]
v_mfma_f32_16x16x32_bf16 v[60:63], a[228:231], a[180:183], v[60:63]
v_mfma_f32_16x16x32_bf16 v[28:31], a[228:231], a[184:187], v[28:31]
global_load_dwordx4 a[228:231], v0, s[72:73] offset:2048
v_mfma_f32_16x16x32_bf16 v[28:31], a[204:207], a[188:191], v[28:31]
s_waitcnt vmcnt(8)
v_mfma_f32_16x16x32_bf16 v[32:35], a[196:199], a[188:191], v[32:35]
v_mfma_f32_16x16x32_bf16 v[32:35], a[224:227], a[184:187], v[32:35]
v_mfma_f32_16x16x32_bf16 v[64:67], a[224:227], a[180:183], v[64:67]
global_load_dwordx4 a[204:207], v0, s[74:75] offset:2048
v_mfma_f32_16x16x32_bf16 v[64:67], a[196:199], a[176:179], v[64:67]
v_mfma_f32_16x16x32_bf16 v[96:99], a[196:199], a[172:175], v[96:99]
v_mfma_f32_16x16x32_bf16 v[96:99], a[224:227], a[168:171], v[96:99]
v_mfma_f32_16x16x32_bf16 v[128:131], a[224:227], a[164:167], v[128:131]
v_mfma_f32_16x16x32_bf16 v[128:131], a[196:199], a[160:163], v[128:131]
v_mfma_f32_16x16x32_bf16 v[160:163], a[196:199], a[156:159], v[160:163]
v_mfma_f32_16x16x32_bf16 v[160:163], a[224:227], a[152:155], v[160:163]
v_mfma_f32_16x16x32_bf16 v[192:195], a[224:227], a[148:151], v[192:195]
v_mfma_f32_16x16x32_bf16 v[192:195], a[196:199], a[144:147], v[192:195]
v_mfma_f32_16x16x32_bf16 v[224:227], a[196:199], a[140:143], v[224:227]
v_mfma_f32_16x16x32_bf16 v[224:227], a[224:227], a[136:139], v[224:227]
v_mfma_f32_16x16x32_bf16 a[232:235], a[224:227], a[132:135], a[232:235]
global_load_dwordx4 a[224:227], v0, s[72:73] offset:3072
v_mfma_f32_16x16x32_bf16 a[232:235], a[196:199], a[128:131], a[232:235]
s_waitcnt vmcnt(8)
v_mfma_f32_16x16x32_bf16 a[236:239], a[212:215], a[128:131], a[236:239]
v_mfma_f32_16x16x32_bf16 a[236:239], a[216:219], a[132:135], a[236:239]
v_mfma_f32_16x16x32_bf16 v[228:231], a[216:219], a[136:139], v[228:231]
global_load_dwordx4 a[196:199], v0, s[74:75] offset:3072
v_mfma_f32_16x16x32_bf16 v[228:231], a[212:215], a[140:143], v[228:231]
s_add_u32 s72, s12, 290816
s_addc_u32 s73, s13, 0
v_mfma_f32_16x16x32_bf16 v[196:199], a[212:215], a[144:147], v[196:199]
v_mfma_f32_16x16x32_bf16 v[196:199], a[216:219], a[148:151], v[196:199]
v_mfma_f32_16x16x32_bf16 v[164:167], a[216:219], a[152:155], v[164:167]
s_add_u32 s74, s12, 323584
s_addc_u32 s75, s13, 0
v_mfma_f32_16x16x32_bf16 v[164:167], a[212:215], a[156:159], v[164:167]
v_mfma_f32_16x16x32_bf16 v[132:135], a[212:215], a[160:163], v[132:135]
v_mfma_f32_16x16x32_bf16 v[132:135], a[216:219], a[164:167], v[132:135]
v_mfma_f32_16x16x32_bf16 v[100:103], a[216:219], a[168:171], v[100:103]
v_mfma_f32_16x16x32_bf16 v[100:103], a[212:215], a[172:175], v[100:103]
s_waitcnt vmcnt(8)
v_mfma_f32_16x16x32_bf16 v[68:71], a[212:215], a[176:179], v[68:71]
v_mfma_f32_16x16x32_bf16 v[68:71], a[216:219], a[180:183], v[68:71]
v_mfma_f32_4x4x4_16b_bf16 v[8:11], v[6:7], v[16:17], 0
v_mfma_f32_4x4x4_16b_bf16 v[12:15], v[6:7], v[18:19], 0
v_mfma_f32_16x16x32_bf16 v[36:39], a[216:219], a[184:187], v[36:39]
global_load_dwordx4 a[216:219], v0, s[72:73] offset:-4096
v_mfma_f32_16x16x32_bf16 v[36:39], a[212:215], a[188:191], v[36:39]
s_waitcnt vmcnt(7)
v_mfma_f32_16x16x32_bf16 v[40:43], a[192:195], a[188:191], v[40:43]
v_mfma_f32_16x16x32_bf16 v[40:43], a[208:211], a[184:187], v[40:43]
v_mfma_f32_16x16x32_bf16 v[72:75], a[208:211], a[180:183], v[72:75]
global_load_dwordx4 a[212:215], v0, s[74:75] offset:-4096
v_mfma_f32_16x16x32_bf16 v[72:75], a[192:195], a[176:179], v[72:75]
v_mfma_f32_16x16x32_bf16 v[104:107], a[192:195], a[172:175], v[104:107]
v_mfma_f32_16x16x32_bf16 v[104:107], a[208:211], a[168:171], v[104:107]
v_add_f32 v32, v32, v8
v_add_f32 v33, v33, v9
v_mfma_f32_16x16x32_bf16 v[136:139], a[208:211], a[164:167], v[136:139]
v_add_f32 v34, v34, v10
v_mfma_f32_16x16x32_bf16 v[136:139], a[192:195], a[160:163], v[136:139]
v_add_f32 v35, v35, v11
v_mfma_f32_16x16x32_bf16 v[168:171], a[192:195], a[156:159], v[168:171]
v_add_f32 v36, v36, v12
v_mfma_f32_16x16x32_bf16 v[168:171], a[208:211], a[152:155], v[168:171]
v_add_f32 v37, v37, v13
v_mfma_f32_16x16x32_bf16 v[200:203], a[208:211], a[148:151], v[200:203]
v_add_f32 v38, v38, v14
v_mfma_f32_16x16x32_bf16 v[200:203], a[192:195], a[144:147], v[200:203]
v_add_f32 v39, v39, v15
v_mfma_f32_16x16x32_bf16 v[232:235], a[192:195], a[140:143], v[232:235]
v_add_f32 v64, v64, v8
v_mfma_f32_16x16x32_bf16 v[232:235], a[208:211], a[136:139], v[232:235]
v_mfma_f32_16x16x32_bf16 a[240:243], a[208:211], a[132:135], a[240:243]
global_load_dwordx4 a[208:211], v0, s[72:73] offset:-3072
v_mfma_f32_16x16x32_bf16 a[240:243], a[192:195], a[128:131], a[240:243]
v_add_f32 v65, v65, v9
s_waitcnt vmcnt(7)
v_mfma_f32_16x16x32_bf16 a[244:247], a[220:223], a[128:131], a[244:247]
v_add_f32 v66, v66, v10
v_mfma_f32_16x16x32_bf16 a[244:247], a[200:203], a[132:135], a[244:247]
v_mfma_f32_16x16x32_bf16 v[236:239], a[200:203], a[136:139], v[236:239]
global_load_dwordx4 a[192:195], v0, s[74:75] offset:-3072
v_mfma_f32_16x16x32_bf16 v[236:239], a[220:223], a[140:143], v[236:239]
v_add_f32 v67, v67, v11
v_mfma_f32_16x16x32_bf16 v[204:207], a[220:223], a[144:147], v[204:207]
v_add_f32 v68, v68, v12
v_lshlrev_b32 v3, 10, v0
v_mfma_f32_16x16x32_bf16 v[204:207], a[200:203], a[148:151], v[204:207]
v_add_f32 v69, v69, v13
v_mfma_f32_16x16x32_bf16 v[172:175], a[200:203], a[152:155], v[172:175]
v_add_f32 v70, v70, v14
v_mfma_f32_16x16x32_bf16 v[172:175], a[220:223], a[156:159], v[172:175]
v_add_f32 v71, v71, v15
v_mfma_f32_16x16x32_bf16 v[140:143], a[220:223], a[160:163], v[140:143]
v_add_f32 v96, v96, v8
v_mfma_f32_16x16x32_bf16 v[140:143], a[200:203], a[164:167], v[140:143]
v_add_f32 v97, v97, v9
v_mfma_f32_16x16x32_bf16 v[108:111], a[200:203], a[168:171], v[108:111]
v_add_f32 v98, v98, v10
v_mfma_f32_16x16x32_bf16 v[108:111], a[220:223], a[172:175], v[108:111]
v_add_f32 v99, v99, v11
buffer_load_dword v3, v3, s[40:43], s63 offen
v_mfma_f32_16x16x32_bf16 v[76:79], a[220:223], a[176:179], v[76:79]
v_add_f32 v100, v100, v12
v_mfma_f32_16x16x32_bf16 v[76:79], a[200:203], a[180:183], v[76:79]
v_add_f32 v101, v101, v13
v_mfma_f32_16x16x32_bf16 v[44:47], a[200:203], a[184:187], v[44:47]
global_load_dwordx4 a[200:203], v0, s[72:73] offset:-2048
v_mfma_f32_16x16x32_bf16 v[44:47], a[220:223], a[188:191], v[44:47]
v_add_f32 v102, v102, v14
s_waitcnt vmcnt(8)
v_mfma_f32_16x16x32_bf16 v[48:51], a[228:231], a[188:191], v[48:51]
v_add_f32 v103, v103, v15
v_mfma_f32_16x16x32_bf16 v[48:51], a[204:207], a[184:187], v[48:51]
v_mfma_f32_16x16x32_bf16 v[80:83], a[204:207], a[180:183], v[80:83]
global_load_dwordx4 a[220:223], v0, s[74:75] offset:-2048
v_mfma_f32_16x16x32_bf16 v[80:83], a[228:231], a[176:179], v[80:83]
v_add_f32 v128, v128, v8
v_mfma_f32_16x16x32_bf16 v[112:115], a[228:231], a[172:175], v[112:115]
v_add_f32 v129, v129, v9
v_mfma_f32_16x16x32_bf16 v[112:115], a[204:207], a[168:171], v[112:115]
v_add_f32 v130, v130, v10
v_mfma_f32_16x16x32_bf16 v[144:147], a[204:207], a[164:167], v[144:147]
v_add_f32 v131, v131, v11
v_mfma_f32_16x16x32_bf16 v[144:147], a[228:231], a[160:163], v[144:147]
v_add_f32 v132, v132, v12
v_mfma_f32_16x16x32_bf16 v[176:179], a[228:231], a[156:159], v[176:179]
v_add_f32 v133, v133, v13
v_mfma_f32_16x16x32_bf16 v[176:179], a[204:207], a[152:155], v[176:179]
v_add_f32 v134, v134, v14
v_mfma_f32_16x16x32_bf16 v[208:211], a[204:207], a[148:151], v[208:211]
v_add_f32 v135, v135, v15
v_mfma_f32_16x16x32_bf16 v[208:211], a[228:231], a[144:147], v[208:211]
v_add_f32 v160, v160, v8
v_mfma_f32_16x16x32_bf16 v[240:243], a[228:231], a[140:143], v[240:243]
v_add_f32 v161, v161, v9
v_mfma_f32_16x16x32_bf16 v[240:243], a[204:207], a[136:139], v[240:243]
v_add_f32 v162, v162, v10
v_mfma_f32_16x16x32_bf16 a[248:251], a[204:207], a[132:135], a[248:251]
global_load_dwordx4 a[204:207], v0, s[72:73] offset:-1024
v_mfma_f32_16x16x32_bf16 a[248:251], a[228:231], a[128:131], a[248:251]
v_add_u32 v2, 0, v0
s_waitcnt vmcnt(8)
v_mfma_f32_16x16x32_bf16 a[252:255], a[224:227], a[128:131], a[252:255]
ds_read_b128 a[128:131], v2 offset:32768
v_add_f32 v163, v163, v11
v_mfma_f32_16x16x32_bf16 a[252:255], a[196:199], a[132:135], a[252:255]
ds_read_b128 a[132:135], v2 offset:40960
v_mfma_f32_16x16x32_bf16 v[244:247], a[196:199], a[136:139], v[244:247]
ds_read_b128 a[136:139], v2 offset:41984
v_add_f32 v164, v164, v12
v_mfma_f32_16x16x32_bf16 v[244:247], a[224:227], a[140:143], v[244:247]
ds_read_b128 a[140:143], v2 offset:33792
v_mfma_f32_16x16x32_bf16 v[212:215], a[224:227], a[144:147], v[212:215]
ds_read_b128 a[144:147], v2 offset:34816
v_add_f32 v165, v165, v13
v_mfma_f32_16x16x32_bf16 v[212:215], a[196:199], a[148:151], v[212:215]
ds_read_b128 a[148:151], v2 offset:43008
v_mfma_f32_16x16x32_bf16 v[180:183], a[196:199], a[152:155], v[180:183]
ds_read_b128 a[152:155], v2 offset:44032
v_add_f32 v166, v166, v14
v_mfma_f32_16x16x32_bf16 v[180:183], a[224:227], a[156:159], v[180:183]
ds_read_b128 a[156:159], v2 offset:35840
v_mfma_f32_16x16x32_bf16 v[148:151], a[224:227], a[160:163], v[148:151]
ds_read_b128 a[160:163], v2 offset:36864
v_add_f32 v167, v167, v15
v_mfma_f32_16x16x32_bf16 v[148:151], a[196:199], a[164:167], v[148:151]
ds_read_b128 a[164:167], v2 offset:45056
v_mfma_f32_16x16x32_bf16 v[116:119], a[196:199], a[168:171], v[116:119]
ds_read_b128 a[168:171], v2 offset:46080
v_add_f32 v192, v192, v8
v_mfma_f32_16x16x32_bf16 v[116:119], a[224:227], a[172:175], v[116:119]
ds_read_b128 a[172:175], v2 offset:37888
v_mfma_f32_16x16x32_bf16 v[84:87], a[224:227], a[176:179], v[84:87]
ds_read_b128 a[176:179], v2 offset:38912
v_add_f32 v193, v193, v9
v_mfma_f32_16x16x32_bf16 v[84:87], a[196:199], a[180:183], v[84:87]
ds_read_b128 a[180:183], v2 offset:47104
v_mfma_f32_16x16x32_bf16 v[52:55], a[196:199], a[184:187], v[52:55]
ds_read_b128 a[184:187], v2 offset:48128
v_add_f32 v194, v194, v10
v_mfma_f32_16x16x32_bf16 v[52:55], a[224:227], a[188:191], v[52:55]
ds_read_b128 a[188:191], v2 offset:39936
s_waitcnt vmcnt(6) lgkmcnt(12)
v_mfma_f32_16x16x32_bf16 v[24:27], a[216:219], a[128:131], v[24:27]
global_load_dwordx4 a[228:231], v0, s[74:75] offset:-1024
v_mfma_f32_16x16x32_bf16 v[24:27], a[212:215], a[132:135], v[24:27]
v_add_f32 v195, v195, v11
v_mfma_f32_16x16x32_bf16 v[56:59], a[212:215], a[136:139], v[56:59]
v_add_f32 v196, v196, v12
v_mfma_f32_16x16x32_bf16 v[56:59], a[216:219], a[140:143], v[56:59]
s_waitcnt lgkmcnt(8)
v_mfma_f32_16x16x32_bf16 v[88:91], a[216:219], a[144:147], v[88:91]
global_load_dwordx4 a[196:199], v0, s[72:73] offset:0
v_mfma_f32_16x16x32_bf16 v[88:91], a[212:215], a[148:151], v[88:91]
v_add_f32 v197, v197, v13
v_mfma_f32_16x16x32_bf16 v[120:123], a[212:215], a[152:155], v[120:123]
v_add_f32 v198, v198, v14
v_mfma_f32_16x16x32_bf16 v[120:123], a[216:219], a[156:159], v[120:123]
s_waitcnt lgkmcnt(4)
v_mfma_f32_16x16x32_bf16 v[152:155], a[216:219], a[160:163], v[152:155]
global_load_dwordx4 a[224:227], v0, s[74:75] offset:0
v_mfma_f32_16x16x32_bf16 v[152:155], a[212:215], a[164:167], v[152:155]
v_add_f32 v199, v199, v15
v_mfma_f32_16x16x32_bf16 v[184:187], a[212:215], a[168:171], v[184:187]
v_add_f32 v224, v224, v8
v_mfma_f32_16x16x32_bf16 v[184:187], a[216:219], a[172:175], v[184:187]
v_add_f32 v225, v225, v9
s_waitcnt lgkmcnt(0)
v_mfma_f32_16x16x32_bf16 v[216:219], a[216:219], a[176:179], v[216:219]
v_add_f32 v226, v226, v10
v_mfma_f32_16x16x32_bf16 v[216:219], a[212:215], a[180:183], v[216:219]
v_mfma_f32_16x16x32_bf16 v[248:251], a[212:215], a[184:187], v[248:251]
global_load_dwordx4 a[212:215], v0, s[72:73] offset:1024
v_mfma_f32_16x16x32_bf16 v[248:251], a[216:219], a[188:191], v[248:251]
v_add_f32 v227, v227, v11
s_waitcnt vmcnt(8)
v_mfma_f32_16x16x32_bf16 v[252:255], a[208:211], a[188:191], v[252:255]
v_add_f32 v228, v228, v12
v_mfma_f32_16x16x32_bf16 v[252:255], a[192:195], a[184:187], v[252:255]
v_mfma_f32_16x16x32_bf16 v[220:223], a[192:195], a[180:183], v[220:223]
global_load_dwordx4 a[216:219], v0, s[74:75] offset:1024
v_mfma_f32_16x16x32_bf16 v[220:223], a[208:211], a[176:179], v[220:223]
v_add_f32 v229, v229, v13
v_mfma_f32_16x16x32_bf16 v[188:191], a[208:211], a[172:175], v[188:191]
v_add_f32 v230, v230, v14
v_mfma_f32_16x16x32_bf16 v[188:191], a[192:195], a[168:171], v[188:191]
v_add_f32 v231, v231, v15
v_mfma_f32_16x16x32_bf16 v[156:159], a[192:195], a[164:167], v[156:159]
v_mfma_f32_4x4x4_16b_bf16 a[232:235], v[6:7], v[16:17], a[232:235]
v_mfma_f32_4x4x4_16b_bf16 a[236:239], v[6:7], v[18:19], a[236:239]
v_mfma_f32_16x16x32_bf16 v[156:159], a[208:211], a[160:163], v[156:159]
v_mfma_f32_16x16x32_bf16 v[124:127], a[208:211], a[156:159], v[124:127]
v_mfma_f32_16x16x32_bf16 v[124:127], a[192:195], a[152:155], v[124:127]
v_lshrrev_b32 v16, 4, v0
v_mfma_f32_16x16x32_bf16 v[92:95], a[192:195], a[148:151], v[92:95]
v_and_b32 v16, 48, v16
v_mfma_f32_16x16x32_bf16 v[92:95], a[208:211], a[144:147], v[92:95]
s_add_u32 s67, s66, 2048
v_mfma_f32_16x16x32_bf16 v[60:63], a[208:211], a[140:143], v[60:63]
buffer_load_dwordx4 v[16:19], v16, s[16:19], s67 offen offset:128
v_mfma_f32_16x16x32_bf16 v[60:63], a[192:195], a[136:139], v[60:63]
v_mfma_f32_16x16x32_bf16 v[28:31], a[192:195], a[132:135], v[28:31]
global_load_dwordx4 a[192:195], v0, s[72:73] offset:2048
v_mfma_f32_16x16x32_bf16 v[28:31], a[208:211], a[128:131], v[28:31]
s_waitcnt vmcnt(8)
v_mfma_f32_16x16x32_bf16 v[32:35], a[200:203], a[128:131], v[32:35]
v_mfma_f32_16x16x32_bf16 v[32:35], a[220:223], a[132:135], v[32:35]
v_mfma_f32_16x16x32_bf16 v[64:67], a[220:223], a[136:139], v[64:67]
global_load_dwordx4 a[208:211], v0, s[74:75] offset:2048
v_mfma_f32_16x16x32_bf16 v[64:67], a[200:203], a[140:143], v[64:67]
v_mfma_f32_16x16x32_bf16 v[96:99], a[200:203], a[144:147], v[96:99]
v_mfma_f32_16x16x32_bf16 v[96:99], a[220:223], a[148:151], v[96:99]
v_mfma_f32_16x16x32_bf16 v[128:131], a[220:223], a[152:155], v[128:131]
v_mfma_f32_16x16x32_bf16 v[128:131], a[200:203], a[156:159], v[128:131]
v_mfma_f32_16x16x32_bf16 v[160:163], a[200:203], a[160:163], v[160:163]
v_mfma_f32_16x16x32_bf16 v[160:163], a[220:223], a[164:167], v[160:163]
v_mfma_f32_16x16x32_bf16 v[192:195], a[220:223], a[168:171], v[192:195]
v_mfma_f32_16x16x32_bf16 v[192:195], a[200:203], a[172:175], v[192:195]
v_mfma_f32_16x16x32_bf16 v[224:227], a[200:203], a[176:179], v[224:227]
v_mfma_f32_16x16x32_bf16 v[224:227], a[220:223], a[180:183], v[224:227]
v_mfma_f32_16x16x32_bf16 a[232:235], a[220:223], a[184:187], a[232:235]
global_load_dwordx4 a[220:223], v0, s[72:73] offset:3072
v_mfma_f32_16x16x32_bf16 a[232:235], a[200:203], a[188:191], a[232:235]
s_waitcnt vmcnt(8)
v_mfma_f32_16x16x32_bf16 a[236:239], a[204:207], a[188:191], a[236:239]
v_mfma_f32_16x16x32_bf16 a[236:239], a[228:231], a[184:187], a[236:239]
v_mfma_f32_16x16x32_bf16 v[228:231], a[228:231], a[180:183], v[228:231]
global_load_dwordx4 a[200:203], v0, s[74:75] offset:3072
v_mfma_f32_16x16x32_bf16 v[228:231], a[204:207], a[176:179], v[228:231]
s_add_u32 s72, s12, 356352
s_addc_u32 s73, s13, 0
v_mfma_f32_16x16x32_bf16 v[196:199], a[204:207], a[172:175], v[196:199]
v_mfma_f32_16x16x32_bf16 v[196:199], a[228:231], a[168:171], v[196:199]
v_mfma_f32_16x16x32_bf16 v[164:167], a[228:231], a[164:167], v[164:167]
s_add_u32 s74, s12, 389120
s_addc_u32 s75, s13, 0
v_mfma_f32_16x16x32_bf16 v[164:167], a[204:207], a[160:163], v[164:167]
L_pad11:
s_cbranch_execz L_pad15
v_mfma_f32_16x16x32_bf16 v[132:135], a[204:207], a[156:159], v[132:135]
v_mfma_f32_16x16x32_bf16 v[132:135], a[228:231], a[152:155], v[132:135]
v_mfma_f32_16x16x32_bf16 v[100:103], a[228:231], a[148:151], v[100:103]
v_mfma_f32_16x16x32_bf16 v[100:103], a[204:207], a[144:147], v[100:103]
v_mfma_f32_16x16x32_bf16 v[68:71], a[204:207], a[140:143], v[68:71]
v_mfma_f32_16x16x32_bf16 v[68:71], a[228:231], a[136:139], v[68:71]
v_mfma_f32_16x16x32_bf16 v[36:39], a[228:231], a[132:135], v[36:39]
global_load_dwordx4 a[228:231], v0, s[72:73] offset:-4096
v_mfma_f32_16x16x32_bf16 v[36:39], a[204:207], a[128:131], v[36:39]
s_waitcnt vmcnt(8)
v_mfma_f32_16x16x32_bf16 v[40:43], a[196:199], a[128:131], v[40:43]
v_mfma_f32_16x16x32_bf16 v[40:43], a[224:227], a[132:135], v[40:43]
v_mfma_f32_16x16x32_bf16 v[72:75], a[224:227], a[136:139], v[72:75]
global_load_dwordx4 a[204:207], v0, s[74:75] offset:-4096
v_mfma_f32_16x16x32_bf16 v[72:75], a[196:199], a[140:143], v[72:75]
v_mfma_f32_16x16x32_bf16 v[104:107], a[196:199], a[144:147], v[104:107]
v_mfma_f32_16x16x32_bf16 v[104:107], a[224:227], a[148:151], v[104:107]
v_mfma_f32_16x16x32_bf16 v[136:139], a[224:227], a[152:155], v[136:139]
v_mfma_f32_16x16x32_bf16 v[136:139], a[196:199], a[156:159], v[136:139]
v_mfma_f32_16x16x32_bf16 v[168:171], a[196:199], a[160:163], v[168:171]
v_mfma_f32_16x16x32_bf16 v[168:171], a[224:227], a[164:167], v[168:171]
v_mfma_f32_16x16x32_bf16 v[200:203], a[224:227], a[168:171], v[200:203]
v_mfma_f32_16x16x32_bf16 v[200:203], a[196:199], a[172:175], v[200:203]
v_mfma_f32_16x16x32_bf16 v[232:235], a[196:199], a[176:179], v[232:235]
v_mfma_f32_16x16x32_bf16 v[232:235], a[224:227], a[180:183], v[232:235]
v_mfma_f32_16x16x32_bf16 a[240:243], a[224:227], a[184:187], a[240:243]
global_load_dwordx4 a[224:227], v0, s[72:73] offset:-3072
v_mfma_f32_16x16x32_bf16 a[240:243], a[196:199], a[188:191], a[240:243]
s_waitcnt vmcnt(8)
v_mfma_f32_16x16x32_bf16 a[244:247], a[212:215], a[188:191], a[244:247]
v_mfma_f32_16x16x32_bf16 a[244:247], a[216:219], a[184:187], a[244:247]
v_mfma_f32_16x16x32_bf16 v[236:239], a[216:219], a[180:183], v[236:239]
global_load_dwordx4 a[196:199], v0, s[74:75] offset:-3072
v_mfma_f32_16x16x32_bf16 v[236:239], a[212:215], a[176:179], v[236:239]
v_mfma_f32_16x16x32_bf16 v[204:207], a[212:215], a[172:175], v[204:207]
v_mfma_f32_16x16x32_bf16 v[204:207], a[216:219], a[168:171], v[204:207]
v_mfma_f32_16x16x32_bf16 v[172:175], a[216:219], a[164:167], v[172:175]
v_mfma_f32_16x16x32_bf16 v[172:175], a[212:215], a[160:163], v[172:175]
v_mfma_f32_16x16x32_bf16 v[140:143], a[212:215], a[156:159], v[140:143]
v_mfma_f32_16x16x32_bf16 v[140:143], a[216:219], a[152:155], v[140:143]
v_mfma_f32_16x16x32_bf16 v[108:111], a[216:219], a[148:151], v[108:111]
v_mfma_f32_16x16x32_bf16 v[108:111], a[212:215], a[144:147], v[108:111]
s_waitcnt vmcnt(8)
v_mfma_f32_16x16x32_bf16 v[76:79], a[212:215], a[140:143], v[76:79]
v_mfma_f32_16x16x32_bf16 v[76:79], a[216:219], a[136:139], v[76:79]
v_mfma_f32_4x4x4_16b_bf16 v[8:11], v[6:7], v[16:17], 0
v_mfma_f32_4x4x4_16b_bf16 v[12:15], v[6:7], v[18:19], 0
v_mfma_f32_16x16x32_bf16 v[44:47], a[216:219], a[132:135], v[44:47]
global_load_dwordx4 a[216:219], v0, s[72:73] offset:-2048
v_mfma_f32_16x16x32_bf16 v[44:47], a[212:215], a[128:131], v[44:47]
s_waitcnt vmcnt(7)
v_mfma_f32_16x16x32_bf16 v[48:51], a[192:195], a[128:131], v[48:51]
v_mfma_f32_16x16x32_bf16 v[48:51], a[208:211], a[132:135], v[48:51]
v_mfma_f32_16x16x32_bf16 v[80:83], a[208:211], a[136:139], v[80:83]
global_load_dwordx4 a[212:215], v0, s[74:75] offset:-2048
v_mfma_f32_16x16x32_bf16 v[80:83], a[192:195], a[140:143], v[80:83]
v_mfma_f32_16x16x32_bf16 v[112:115], a[192:195], a[144:147], v[112:115]
v_mfma_f32_16x16x32_bf16 v[112:115], a[208:211], a[148:151], v[112:115]
v_add_f32 v40, v40, v8
v_add_f32 v41, v41, v9
v_mfma_f32_16x16x32_bf16 v[144:147], a[208:211], a[152:155], v[144:147]
v_add_f32 v42, v42, v10
v_mfma_f32_16x16x32_bf16 v[144:147], a[192:195], a[156:159], v[144:147]
v_add_f32 v43, v43, v11
v_mfma_f32_16x16x32_bf16 v[176:179], a[192:195], a[160:163], v[176:179]
v_add_f32 v44, v44, v12
v_mfma_f32_16x16x32_bf16 v[176:179], a[208:211], a[164:167], v[176:179]
v_add_f32 v45, v45, v13
v_mfma_f32_16x16x32_bf16 v[208:211], a[208:211], a[168:171], v[208:211]
v_add_f32 v46, v46, v14
v_add_f32 v47, v47, v15
v_mfma_f32_16x16x32_bf16 v[208:211], a[192:195], a[172:175], v[208:211]
v_add_f32 v72, v72, v8
v_mfma_f32_16x16x32_bf16 v[240:243], a[192:195], a[176:179], v[240:243]
v_add_f32 v73, v73, v9
v_mfma_f32_16x16x32_bf16 v[240:243], a[208:211], a[180:183], v[240:243]
v_mfma_f32_16x16x32_bf16 a[248:251], a[208:211], a[184:187], a[248:251]
global_load_dwordx4 a[208:211], v0, s[72:73] offset:-1024
v_mfma_f32_16x16x32_bf16 a[248:251], a[192:195], a[188:191], a[248:251]
v_add_f32 v74, v74, v10
s_waitcnt vmcnt(7)
v_mfma_f32_16x16x32_bf16 a[252:255], a[220:223], a[188:191], a[252:255]
ds_read_b128 a[188:191], v2 offset:49152
v_add_f32 v75, v75, v11
v_mfma_f32_16x16x32_bf16 a[252:255], a[200:203], a[184:187], a[252:255]
ds_read_b128 a[184:187], v2 offset:57344
v_add_f32 v76, v76, v12
v_mfma_f32_16x16x32_bf16 v[244:247], a[200:203], a[180:183], v[244:247]
ds_read_b128 a[180:183], v2 offset:58368
v_mfma_f32_16x16x32_bf16 v[244:247], a[220:223], a[176:179], v[244:247]
ds_read_b128 a[176:179], v2 offset:50176
v_add_f32 v77, v77, v13
v_mfma_f32_16x16x32_bf16 v[212:215], a[220:223], a[172:175], v[212:215]
ds_read_b128 a[172:175], v2 offset:51200
v_mfma_f32_16x16x32_bf16 v[212:215], a[200:203], a[168:171], v[212:215]
ds_read_b128 a[168:171], v2 offset:59392
v_add_f32 v78, v78, v14
v_mfma_f32_16x16x32_bf16 v[180:183], a[200:203], a[164:167], v[180:183]
ds_read_b128 a[164:167], v2 offset:60416
v_mfma_f32_16x16x32_bf16 v[180:183], a[220:223], a[160:163], v[180:183]
ds_read_b128 a[160:163], v2 offset:52224
v_add_f32 v79, v79, v15
v_mfma_f32_16x16x32_bf16 v[148:151], a[220:223], a[156:159], v[148:151]
ds_read_b128 a[156:159], v2 offset:53248
v_add_f32 v104, v104, v8
v_mfma_f32_16x16x32_bf16 v[148:151], a[200:203], a[152:155], v[148:151]
ds_read_b128 a[152:155], v2 offset:61440
v_mfma_f32_16x16x32_bf16 v[116:119], a[200:203], a[148:151], v[116:119]
ds_read_b128 a[148:151], v2 offset:62464
v_add_f32 v105, v105, v9
v_mfma_f32_16x16x32_bf16 v[116:119], a[220:223], a[144:147], v[116:119]
ds_read_b128 a[144:147], v2 offset:54272
v_mfma_f32_16x16x32_bf16 v[84:87], a[220:223], a[140:143], v[84:87]
ds_read_b128 a[140:143], v2 offset:55296
v_add_f32 v106, v106, v10
v_mfma_f32_16x16x32_bf16 v[84:87], a[200:203], a[136:139], v[84:87]
ds_read_b128 a[136:139], v2 offset:63488
v_add_f32 v107, v107, v11
v_mfma_f32_16x16x32_bf16 v[52:55], a[200:203], a[132:135], v[52:55]
ds_read_b128 a[132:135], v2 offset:64512
v_mfma_f32_16x16x32_bf16 v[52:55], a[220:223], a[128:131], v[52:55]
ds_read_b128 a[128:131], v2 offset:56320
s_waitcnt vmcnt(5) lgkmcnt(12)
v_mfma_f32_16x16x32_bf16 v[24:27], a[228:231], a[188:191], v[24:27]
global_load_dwordx4 a[192:195], v0, s[74:75] offset:-1024
v_mfma_f32_16x16x32_bf16 v[24:27], a[204:207], a[184:187], v[24:27]
v_add_f32 v108, v108, v12
v_mfma_f32_16x16x32_bf16 v[56:59], a[204:207], a[180:183], v[56:59]
v_add_f32 v109, v109, v13
v_add_f32 v110, v110, v14
v_mfma_f32_16x16x32_bf16 v[56:59], a[228:231], a[176:179], v[56:59]
s_waitcnt lgkmcnt(8)
v_mfma_f32_16x16x32_bf16 v[88:91], a[228:231], a[172:175], v[88:91]
global_load_dwordx4 a[200:203], v0, s[72:73] offset:0
v_mfma_f32_16x16x32_bf16 v[88:91], a[204:207], a[168:171], v[88:91]
v_add_f32 v111, v111, v15
v_mfma_f32_16x16x32_bf16 v[120:123], a[204:207], a[164:167], v[120:123]
v_add_f32 v136, v136, v8
v_mfma_f32_16x16x32_bf16 v[120:123], a[228:231], a[160:163], v[120:123]
s_waitcnt lgkmcnt(4)
v_mfma_f32_16x16x32_bf16 v[152:155], a[228:231], a[156:159], v[152:155]
global_load_dwordx4 a[220:223], v0, s[74:75] offset:0
v_mfma_f32_16x16x32_bf16 v[152:155], a[204:207], a[152:155], v[152:155]
v_add_f32 v137, v137, v9
v_add_f32 v138, v138, v10
v_mfma_f32_16x16x32_bf16 v[184:187], a[204:207], a[148:151], v[184:187]
v_add_f32 v139, v139, v11
v_mfma_f32_16x16x32_bf16 v[184:187], a[228:231], a[144:147], v[184:187]
v_add_f32 v140, v140, v12
s_waitcnt lgkmcnt(0)
v_mfma_f32_16x16x32_bf16 v[216:219], a[228:231], a[140:143], v[216:219]
v_add_f32 v141, v141, v13
s_barrier
v_mfma_f32_16x16x32_bf16 v[216:219], a[204:207], a[136:139], v[216:219]
s_add_u32 m0, s56, 114688
v_mfma_f32_16x16x32_bf16 v[248:251], a[204:207], a[132:135], v[248:251]
global_load_dwordx4 a[204:207], v0, s[72:73] offset:1024
v_mfma_f32_16x16x32_bf16 v[248:251], a[228:231], a[128:131], v[248:251]
v_add_f32 v142, v142, v14
s_waitcnt vmcnt(7)
v_mfma_f32_16x16x32_bf16 v[252:255], a[224:227], a[128:131], v[252:255]
s_add_u32 s30, s28, 81920
s_addc_u32 s31, s29, 0
v_mfma_f32_16x16x32_bf16 v[252:255], a[196:199], a[132:135], v[252:255]
v_add_f32 v143, v143, v15
v_mfma_f32_16x16x32_bf16 v[220:223], a[196:199], a[136:139], v[220:223]
global_load_dwordx4 a[228:231], v0, s[74:75] offset:1024
v_mfma_f32_16x16x32_bf16 v[220:223], a[224:227], a[140:143], v[220:223]
v_add_f32 v168, v168, v8
v_mfma_f32_16x16x32_bf16 v[188:191], a[224:227], a[144:147], v[188:191]
v_mfma_f32_16x16x32_bf16 v[188:191], a[196:199], a[148:151], v[188:191]
global_load_lds_dwordx4 v0, s[30:31] nt
v_mfma_f32_16x16x32_bf16 v[156:159], a[196:199], a[152:155], v[156:159]
v_add_f32 v169, v169, v9
v_add_f32 v170, v170, v10
v_mfma_f32_16x16x32_bf16 v[156:159], a[224:227], a[156:159], v[156:159]
v_add_f32 v171, v171, v11
v_mfma_f32_16x16x32_bf16 v[124:127], a[224:227], a[160:163], v[124:127]
v_add_f32 v172, v172, v12
v_mfma_f32_16x16x32_bf16 v[124:127], a[196:199], a[164:167], v[124:127]
v_add_f32 v173, v173, v13
v_mfma_f32_16x16x32_bf16 v[92:95], a[196:199], a[168:171], v[92:95]
v_add_f32 v174, v174, v14
v_mfma_f32_16x16x32_bf16 v[92:95], a[224:227], a[172:175], v[92:95]
v_add_f32 v175, v175, v15
v_mfma_f32_16x16x32_bf16 v[60:63], a[224:227], a[176:179], v[60:63]
v_add_f32 v200, v200, v8
v_add_f32 v201, v201, v9
v_mfma_f32_16x16x32_bf16 v[60:63], a[196:199], a[180:183], v[60:63]
v_mfma_f32_16x16x32_bf16 v[28:31], a[196:199], a[184:187], v[28:31]
global_load_dwordx4 a[196:199], v0, s[72:73] offset:2048
v_mfma_f32_16x16x32_bf16 v[28:31], a[224:227], a[188:191], v[28:31]
v_add_f32 v202, v202, v10
s_waitcnt vmcnt(8)
v_mfma_f32_16x16x32_bf16 v[32:35], a[216:219], a[188:191], v[32:35]
global_load_lds_dwordx4 v0, s[30:31] offset:1024 nt
v_mfma_f32_16x16x32_bf16 v[32:35], a[212:215], a[184:187], v[32:35]
v_mfma_f32_16x16x32_bf16 v[64:67], a[212:215], a[180:183], v[64:67]
global_load_dwordx4 a[224:227], v0, s[74:75] offset:2048
v_mfma_f32_16x16x32_bf16 v[64:67], a[216:219], a[176:179], v[64:67]
v_add_f32 v203, v203, v11
v_mfma_f32_16x16x32_bf16 v[96:99], a[216:219], a[172:175], v[96:99]
v_add_f32 v204, v204, v12
v_mfma_f32_16x16x32_bf16 v[96:99], a[212:215], a[168:171], v[96:99]
v_add_f32 v205, v205, v13
v_add_f32 v206, v206, v14
v_mfma_f32_16x16x32_bf16 v[128:131], a[212:215], a[164:167], v[128:131]
v_add_f32 v207, v207, v15
v_mfma_f32_16x16x32_bf16 v[128:131], a[216:219], a[160:163], v[128:131]
v_add_f32 v232, v232, v8
v_mfma_f32_16x16x32_bf16 v[160:163], a[216:219], a[156:159], v[160:163]
v_add_f32 v233, v233, v9
v_mfma_f32_16x16x32_bf16 v[160:163], a[212:215], a[152:155], v[160:163]
v_add_f32 v234, v234, v10
v_mfma_f32_16x16x32_bf16 v[192:195], a[212:215], a[148:151], v[192:195]
s_add_u32 m0, s56, 122880
v_add_f32 v235, v235, v11
v_add_f32 v236, v236, v12
v_mfma_f32_16x16x32_bf16 v[192:195], a[216:219], a[144:147], v[192:195]
s_add_u32 s30, s28, 90112
s_addc_u32 s31, s29, 0
v_mfma_f32_16x16x32_bf16 v[224:227], a[216:219], a[140:143], v[224:227]
v_add_f32 v237, v237, v13
v_mfma_f32_16x16x32_bf16 v[224:227], a[212:215], a[136:139], v[224:227]
v_mfma_f32_16x16x32_bf16 a[232:235], a[212:215], a[132:135], a[232:235]
global_load_dwordx4 a[212:215], v0, s[72:73] offset:3072
v_mfma_f32_16x16x32_bf16 a[232:235], a[216:219], a[128:131], a[232:235]
v_add_f32 v238, v238, v14
s_waitcnt vmcnt(9)
v_mfma_f32_16x16x32_bf16 a[236:239], a[208:211], a[128:131], a[236:239]
global_load_lds_dwordx4 v0, s[30:31] nt
v_mfma_f32_16x16x32_bf16 a[236:239], a[192:195], a[132:135], a[236:239]
v_mfma_f32_16x16x32_bf16 v[228:231], a[192:195], a[136:139], v[228:231]
global_load_dwordx4 a[216:219], v0, s[74:75] offset:3072
v_mfma_f32_16x16x32_bf16 v[228:231], a[208:211], a[140:143], v[228:231]
s_add_u32 s72, s12, 413696
s_addc_u32 s73, s13, 0
v_mfma_f32_16x16x32_bf16 v[196:199], a[208:211], a[144:147], v[196:199]
v_add_f32 v239, v239, v15
v_mfma_f32_16x16x32_bf16 v[196:199], a[192:195], a[148:151], v[196:199]
v_mfma_f32_4x4x4_16b_bf16 a[240:243], v[6:7], v[16:17], a[240:243]
v_mfma_f32_4x4x4_16b_bf16 a[244:247], v[6:7], v[18:19], a[244:247]
v_mfma_f32_16x16x32_bf16 v[164:167], a[192:195], a[152:155], v[164:167]
s_add_u32 s74, s12, 446464
s_addc_u32 s75, s13, 0
v_mfma_f32_16x16x32_bf16 v[164:167], a[208:211], a[156:159], v[164:167]
v_mfma_f32_16x16x32_bf16 v[132:135], a[208:211], a[160:163], v[132:135]
v_mfma_f32_16x16x32_bf16 v[132:135], a[192:195], a[164:167], v[132:135]
v_lshrrev_b32 v16, 4, v0
v_mfma_f32_16x16x32_bf16 v[100:103], a[192:195], a[168:171], v[100:103]
v_and_b32 v16, 48, v16
v_mfma_f32_16x16x32_bf16 v[100:103], a[208:211], a[172:175], v[100:103]
s_add_u32 s67, s66, 2048
v_mfma_f32_16x16x32_bf16 v[68:71], a[208:211], a[176:179], v[68:71]
buffer_load_dwordx4 v[16:19], v16, s[16:19], s67 offen offset:192
v_mfma_f32_16x16x32_bf16 v[68:71], a[192:195], a[180:183], v[68:71]
global_load_lds_dwordx4 v0, s[30:31] offset:1024 nt
v_mfma_f32_16x16x32_bf16 v[36:39], a[192:195], a[184:187], v[36:39]
global_load_dwordx4 a[192:195], v0, s[72:73] offset:-4096
v_mfma_f32_16x16x32_bf16 v[36:39], a[208:211], a[188:191], v[36:39]
s_waitcnt vmcnt(12)
v_mfma_f32_16x16x32_bf16 v[40:43], a[200:203], a[188:191], v[40:43]
v_mfma_f32_16x16x32_bf16 v[40:43], a[220:223], a[184:187], v[40:43]
v_mfma_f32_16x16x32_bf16 v[72:75], a[220:223], a[180:183], v[72:75]
global_load_dwordx4 a[208:211], v0, s[74:75] offset:-4096
v_mfma_f32_16x16x32_bf16 v[72:75], a[200:203], a[176:179], v[72:75]
v_mfma_f32_16x16x32_bf16 v[104:107], a[200:203], a[172:175], v[104:107]
v_mfma_f32_16x16x32_bf16 v[104:107], a[220:223], a[168:171], v[104:107]
v_mfma_f32_16x16x32_bf16 v[136:139], a[220:223], a[164:167], v[136:139]
v_mfma_f32_16x16x32_bf16 v[136:139], a[200:203], a[160:163], v[136:139]
v_mfma_f32_16x16x32_bf16 v[168:171], a[200:203], a[156:159], v[168:171]
v_mfma_f32_16x16x32_bf16 v[168:171], a[220:223], a[152:155], v[168:171]
v_mfma_f32_16x16x32_bf16 v[200:203], a[220:223], a[148:151], v[200:203]
v_mfma_f32_16x16x32_bf16 v[200:203], a[200:203], a[144:147], v[200:203]
v_mfma_f32_16x16x32_bf16 v[232:235], a[200:203], a[140:143], v[232:235]
v_mfma_f32_16x16x32_bf16 v[232:235], a[220:223], a[136:139], v[232:235]
s_mov_b32 s34, 448
v_mfma_f32_16x16x32_bf16 a[240:243], a[220:223], a[132:135], a[240:243]
global_load_dwordx4 a[220:223], v0, s[72:73] offset:-3072
v_mfma_f32_16x16x32_bf16 a[240:243], a[200:203], a[128:131], a[240:243]
s_waitcnt vmcnt(12)
v_mfma_f32_16x16x32_bf16 a[244:247], a[204:207], a[128:131], a[244:247]
buffer_load_dword v5, v0, s[32:35], 0 offen offset:384 sc1
v_mfma_f32_16x16x32_bf16 a[244:247], a[228:231], a[132:135], a[244:247]
v_mfma_f32_16x16x32_bf16 v[236:239], a[228:231], a[136:139], v[236:239]
global_load_dwordx4 a[200:203], v0, s[74:75] offset:-3072
v_mfma_f32_16x16x32_bf16 v[236:239], a[204:207], a[140:143], v[236:239]
v_mfma_f32_16x16x32_bf16 v[204:207], a[204:207], a[144:147], v[204:207]
v_mfma_f32_16x16x32_bf16 v[204:207], a[228:231], a[148:151], v[204:207]
v_mfma_f32_16x16x32_bf16 v[172:175], a[228:231], a[152:155], v[172:175]
v_mfma_f32_16x16x32_bf16 v[172:175], a[204:207], a[156:159], v[172:175]
v_mfma_f32_16x16x32_bf16 v[140:143], a[204:207], a[160:163], v[140:143]
v_mfma_f32_16x16x32_bf16 v[140:143], a[228:231], a[164:167], v[140:143]
v_mfma_f32_16x16x32_bf16 v[108:111], a[228:231], a[168:171], v[108:111]
v_mfma_f32_16x16x32_bf16 v[108:111], a[204:207], a[172:175], v[108:111]
v_mfma_f32_16x16x32_bf16 v[76:79], a[204:207], a[176:179], v[76:79]
v_mfma_f32_16x16x32_bf16 v[76:79], a[228:231], a[180:183], v[76:79]
v_mfma_f32_16x16x32_bf16 v[44:47], a[228:231], a[184:187], v[44:47]
global_load_dwordx4 a[228:231], v0, s[72:73] offset:-2048
v_mfma_f32_16x16x32_bf16 v[44:47], a[204:207], a[188:191], v[44:47]
s_waitcnt vmcnt(11)
v_mfma_f32_16x16x32_bf16 v[48:51], a[196:199], a[188:191], v[48:51]
v_mfma_f32_16x16x32_bf16 v[48:51], a[224:227], a[184:187], v[48:51]
v_mfma_f32_16x16x32_bf16 v[80:83], a[224:227], a[180:183], v[80:83]
global_load_dwordx4 a[204:207], v0, s[74:75] offset:-2048
v_mfma_f32_16x16x32_bf16 v[80:83], a[196:199], a[176:179], v[80:83]
v_mfma_f32_16x16x32_bf16 v[112:115], a[196:199], a[172:175], v[112:115]
v_mfma_f32_16x16x32_bf16 v[112:115], a[224:227], a[168:171], v[112:115]
v_mfma_f32_16x16x32_bf16 v[144:147], a[224:227], a[164:167], v[144:147]
v_mfma_f32_16x16x32_bf16 v[144:147], a[196:199], a[160:163], v[144:147]
v_mfma_f32_16x16x32_bf16 v[176:179], a[196:199], a[156:159], v[176:179]
v_mfma_f32_16x16x32_bf16 v[176:179], a[224:227], a[152:155], v[176:179]
v_mfma_f32_16x16x32_bf16 v[208:211], a[224:227], a[148:151], v[208:211]
v_mfma_f32_16x16x32_bf16 v[208:211], a[196:199], a[144:147], v[208:211]
v_mfma_f32_16x16x32_bf16 v[240:243], a[196:199], a[140:143], v[240:243]
v_mfma_f32_16x16x32_bf16 v[240:243], a[224:227], a[136:139], v[240:243]
v_mfma_f32_16x16x32_bf16 a[248:251], a[224:227], a[132:135], a[248:251]
global_load_dwordx4 a[224:227], v0, s[72:73] offset:-1024
v_mfma_f32_16x16x32_bf16 a[248:251], a[196:199], a[128:131], a[248:251]
v_add_u32 v2, 65536, v0
s_waitcnt vmcnt(10)
v_mfma_f32_16x16x32_bf16 a[252:255], a[212:215], a[128:131], a[252:255]
ds_read_b128 a[128:131], v2 offset:32768
v_mfma_f32_16x16x32_bf16 a[252:255], a[216:219], a[132:135], a[252:255]
ds_read_b128 a[132:135], v2 offset:40960
v_mfma_f32_16x16x32_bf16 v[244:247], a[216:219], a[136:139], v[244:247]
ds_read_b128 a[136:139], v2 offset:41984
v_mfma_f32_16x16x32_bf16 v[244:247], a[212:215], a[140:143], v[244:247]
ds_read_b128 a[140:143], v2 offset:33792
v_mfma_f32_16x16x32_bf16 v[212:215], a[212:215], a[144:147], v[212:215]
ds_read_b128 a[144:147], v2 offset:34816
v_mfma_f32_16x16x32_bf16 v[212:215], a[216:219], a[148:151], v[212:215]
ds_read_b128 a[148:151], v2 offset:43008
v_mfma_f32_16x16x32_bf16 v[180:183], a[216:219], a[152:155], v[180:183]
ds_read_b128 a[152:155], v2 offset:44032
v_mfma_f32_16x16x32_bf16 v[180:183], a[212:215], a[156:159], v[180:183]
ds_read_b128 a[156:159], v2 offset:35840
v_mfma_f32_16x16x32_bf16 v[148:151], a[212:215], a[160:163], v[148:151]
ds_read_b128 a[160:163], v2 offset:36864
v_mfma_f32_16x16x32_bf16 v[148:151], a[216:219], a[164:167], v[148:151]
ds_read_b128 a[164:167], v2 offset:45056
v_mfma_f32_16x16x32_bf16 v[116:119], a[216:219], a[168:171], v[116:119]
ds_read_b128 a[168:171], v2 offset:46080
v_mfma_f32_16x16x32_bf16 v[116:119], a[212:215], a[172:175], v[116:119]
ds_read_b128 a[172:175], v2 offset:37888
s_waitcnt vmcnt(9)
v_mfma_f32_16x16x32_bf16 v[84:87], a[212:215], a[176:179], v[84:87]
ds_read_b128 a[176:179], v2 offset:38912
v_mfma_f32_16x16x32_bf16 v[84:87], a[216:219], a[180:183], v[84:87]
ds_read_b128 a[180:183], v2 offset:47104
v_mfma_f32_4x4x4_16b_bf16 v[8:11], v[6:7], v[16:17], 0
v_mfma_f32_4x4x4_16b_bf16 v[12:15], v[6:7], v[18:19], 0
v_mfma_f32_16x16x32_bf16 v[52:55], a[216:219], a[184:187], v[52:55]
ds_read_b128 a[184:187], v2 offset:48128
v_mfma_f32_16x16x32_bf16 v[52:55], a[212:215], a[188:191], v[52:55]
ds_read_b128 a[188:191], v2 offset:39936
s_waitcnt vmcnt(6) lgkmcnt(12)
v_mfma_f32_16x16x32_bf16 v[24:27], a[192:195], a[128:131], v[24:27]
global_load_dwordx4 a[196:199], v0, s[74:75] offset:-1024
v_mfma_f32_16x16x32_bf16 v[24:27], a[208:211], a[132:135], v[24:27]
v_mfma_f32_16x16x32_bf16 v[56:59], a[208:211], a[136:139], v[56:59]
v_mfma_f32_16x16x32_bf16 v[56:59], a[192:195], a[140:143], v[56:59]
s_waitcnt lgkmcnt(8)
v_mfma_f32_16x16x32_bf16 v[88:91], a[192:195], a[144:147], v[88:91]
global_load_dwordx4 a[216:219], v0, s[72:73] offset:0
v_mfma_f32_16x16x32_bf16 v[88:91], a[208:211], a[148:151], v[88:91]
v_add_f32 v48, v48, v8
v_add_f32 v49, v49, v9
v_mfma_f32_16x16x32_bf16 v[120:123], a[208:211], a[152:155], v[120:123]
v_add_f32 v50, v50, v10
v_mfma_f32_16x16x32_bf16 v[120:123], a[192:195], a[156:159], v[120:123]
s_waitcnt lgkmcnt(4)
v_mfma_f32_16x16x32_bf16 v[152:155], a[192:195], a[160:163], v[152:155]
global_load_dwordx4 a[212:215], v0, s[74:75] offset:0
v_mfma_f32_16x16x32_bf16 v[152:155], a[208:211], a[164:167], v[152:155]
v_add_f32 v51, v51, v11
v_mfma_f32_16x16x32_bf16 v[184:187], a[208:211], a[168:171], v[184:187]
v_add_f32 v52, v52, v12
v_mfma_f32_16x16x32_bf16 v[184:187], a[192:195], a[172:175], v[184:187]
v_add_f32 v53, v53, v13
s_waitcnt lgkmcnt(0)
v_mfma_f32_16x16x32_bf16 v[216:219], a[192:195], a[176:179], v[216:219]
v_add_f32 v54, v54, v14
s_barrier
v_mfma_f32_16x16x32_bf16 v[216:219], a[208:211], a[180:183], v[216:219]
s_waitcnt vmcnt(7)
v_mfma_f32_16x16x32_bf16 v[248:251], a[208:211], a[184:187], v[248:251]
global_load_dwordx4 a[208:211], v0, s[72:73] offset:1024
v_mfma_f32_16x16x32_bf16 v[248:251], a[192:195], a[188:191], v[248:251]
v_add_f32 v55, v55, v15
s_waitcnt vmcnt(7)
v_mfma_f32_16x16x32_bf16 v[252:255], a[220:223], a[188:191], v[252:255]
v_cmp_ne_u32 vcc, 16256, v5
v_add_f32 v80, v80, v8
v_mfma_f32_16x16x32_bf16 v[252:255], a[200:203], a[184:187], v[252:255]
v_mfma_f32_16x16x32_bf16 v[220:223], a[200:203], a[180:183], v[220:223]
global_load_dwordx4 a[192:195], v0, s[74:75] offset:1024
v_mfma_f32_16x16x32_bf16 v[220:223], a[220:223], a[176:179], v[220:223]
v_add_f32 v81, v81, v9
v_mfma_f32_16x16x32_bf16 v[188:191], a[220:223], a[172:175], v[188:191]
s_and_b32 s3, vcc_lo, 15
s_cbranch_scc1 L_slow5
L_back5:
v_mfma_f32_16x16x32_bf16 v[188:191], a[200:203], a[168:171], v[188:191]
v_add_f32 v82, v82, v10
v_mfma_f32_16x16x32_bf16 v[156:159], a[200:203], a[164:167], v[156:159]
v_add_f32 v83, v83, v11
v_add_f32 v84, v84, v12
v_mfma_f32_16x16x32_bf16 v[156:159], a[220:223], a[160:163], v[156:159]
s_add_u32 m0, s56, 98304
v_add_f32 v85, v85, v13
v_mfma_f32_16x16x32_bf16 v[124:127], a[220:223], a[156:159], v[124:127]
s_add_u32 s30, s28, 98304
s_addc_u32 s31, s29, 0
v_mfma_f32_16x16x32_bf16 v[124:127], a[200:203], a[152:155], v[124:127]
v_add_f32 v86, v86, v14
v_mfma_f32_16x16x32_bf16 v[92:95], a[200:203], a[148:151], v[92:95]
v_mfma_f32_16x16x32_bf16 v[92:95], a[220:223], a[144:147], v[92:95]
global_load_lds_dwordx4 v0, s[30:31] nt
v_mfma_f32_16x16x32_bf16 v[60:63], a[220:223], a[140:143], v[60:63]
v_add_f32 v87, v87, v15
v_mfma_f32_16x16x32_bf16 v[60:63], a[200:203], a[136:139], v[60:63]
v_add_f32 v112, v112, v8
v_mfma_f32_16x16x32_bf16 v[28:31], a[200:203], a[132:135], v[28:31]
global_load_dwordx4 a[200:203], v0, s[72:73] offset:2048
v_mfma_f32_16x16x32_bf16 v[28:31], a[220:223], a[128:131], v[28:31]
v_add_f32 v113, v113, v9
s_waitcnt vmcnt(8)
v_mfma_f32_16x16x32_bf16 v[32:35], a[228:231], a[128:131], v[32:35]
v_add_f32 v114, v114, v10
v_mfma_f32_16x16x32_bf16 v[32:35], a[204:207], a[132:135], v[32:35]
v_mfma_f32_16x16x32_bf16 v[64:67], a[204:207], a[136:139], v[64:67]
global_load_dwordx4 a[220:223], v0, s[74:75] offset:2048
v_mfma_f32_16x16x32_bf16 v[64:67], a[228:231], a[140:143], v[64:67]
v_add_f32 v115, v115, v11
v_add_f32 v116, v116, v12
v_mfma_f32_16x16x32_bf16 v[96:99], a[228:231], a[144:147], v[96:99]
v_add_f32 v117, v117, v13
v_mfma_f32_16x16x32_bf16 v[96:99], a[204:207], a[148:151], v[96:99]
v_mfma_f32_16x16x32_bf16 v[128:131], a[204:207], a[152:155], v[128:131]
global_load_lds_dwordx4 v0, s[30:31] offset:1024 nt
v_mfma_f32_16x16x32_bf16 v[128:131], a[228:231], a[156:159], v[128:131]
v_add_f32 v118, v118, v14
v_mfma_f32_16x16x32_bf16 v[160:163], a[228:231], a[160:163], v[160:163]
v_add_f32 v119, v119, v15
v_mfma_f32_16x16x32_bf16 v[160:163], a[204:207], a[164:167], v[160:163]
v_add_f32 v144, v144, v8
v_mfma_f32_16x16x32_bf16 v[192:195], a[204:207], a[168:171], v[192:195]
v_add_f32 v145, v145, v9
v_add_f32 v146, v146, v10
v_mfma_f32_16x16x32_bf16 v[192:195], a[228:231], a[172:175], v[192:195]
v_add_f32 v147, v147, v11
v_mfma_f32_16x16x32_bf16 v[224:227], a[228:231], a[176:179], v[224:227]
v_add_f32 v148, v148, v12
v_mfma_f32_16x16x32_bf16 v[224:227], a[204:207], a[180:183], v[224:227]
v_mfma_f32_16x16x32_bf16 a[232:235], a[204:207], a[184:187], a[232:235]
global_load_dwordx4 a[204:207], v0, s[72:73] offset:3072
v_mfma_f32_16x16x32_bf16 a[232:235], a[228:231], a[188:191], a[232:235]
s_add_u32 m0, s56, 106496
v_add_f32 v149, v149, v13
s_waitcnt vmcnt(9)
v_mfma_f32_16x16x32_bf16 a[236:239], a[224:227], a[188:191], a[236:239]
s_add_u32 s30, s28, 106496
s_addc_u32 s31, s29, 0
v_mfma_f32_16x16x32_bf16 a[236:239], a[196:199], a[184:187], a[236:239]
v_mfma_f32_16x16x32_bf16 v[228:231], a[196:199], a[180:183], v[228:231]
global_load_dwordx4 a[228:231], v0, s[74:75] offset:3072
v_mfma_f32_16x16x32_bf16 v[228:231], a[224:227], a[176:179], v[228:231]
s_add_u32 s72, s12, 479232
s_addc_u32 s73, s13, 0
v_mfma_f32_16x16x32_bf16 v[196:199], a[224:227], a[172:175], v[196:199]
v_add_f32 v150, v150, v14
v_mfma_f32_16x16x32_bf16 v[196:199], a[196:199], a[168:171], v[196:199]
v_add_f32 v151, v151, v15
v_mfma_f32_16x16x32_bf16 v[164:167], a[196:199], a[164:167], v[164:167]
s_add_u32 s74, s12, 512000
s_addc_u32 s75, s13, 0
v_mfma_f32_16x16x32_bf16 v[164:167], a[224:227], a[160:163], v[164:167]
global_load_lds_dwordx4 v0, s[30:31] nt
v_mfma_f32_16x16x32_bf16 v[132:135], a[224:227], a[156:159], v[132:135]
v_add_f32 v176, v176, v8
v_mfma_f32_16x16x32_bf16 v[132:135], a[196:199], a[152:155], v[132:135]
v_add_f32 v177, v177, v9
v_mfma_f32_16x16x32_bf16 v[100:103], a[196:199], a[148:151], v[100:103]
v_add_f32 v178, v178, v10
v_add_f32 v179, v179, v11
v_mfma_f32_16x16x32_bf16 v[100:103], a[224:227], a[144:147], v[100:103]
v_add_f32 v180, v180, v12
v_mfma_f32_16x16x32_bf16 v[68:71], a[224:227], a[140:143], v[68:71]
v_add_f32 v181, v181, v13
v_mfma_f32_16x16x32_bf16 v[68:71], a[196:199], a[136:139], v[68:71]
v_mfma_f32_16x16x32_bf16 v[36:39], a[196:199], a[132:135], v[36:39]
global_load_dwordx4 a[196:199], v0, s[72:73] offset:-4096
v_mfma_f32_16x16x32_bf16 v[36:39], a[224:227], a[128:131], v[36:39]
v_add_f32 v182, v182, v14
s_waitcnt vmcnt(10)
v_mfma_f32_16x16x32_bf16 v[40:43], a[216:219], a[128:131], v[40:43]
global_load_lds_dwordx4 v0, s[30:31] offset:1024 nt
v_mfma_f32_16x16x32_bf16 v[40:43], a[212:215], a[132:135], v[40:43]
v_mfma_f32_16x16x32_bf16 v[72:75], a[212:215], a[136:139], v[72:75]
global_load_dwordx4 a[224:227], v0, s[74:75] offset:-4096
v_mfma_f32_16x16x32_bf16 v[72:75], a[216:219], a[140:143], v[72:75]
v_add_f32 v183, v183, v15
v_mfma_f32_16x16x32_bf16 v[104:107], a[216:219], a[144:147], v[104:107]
v_add_f32 v208, v208, v8
v_mfma_f32_16x16x32_bf16 v[104:107], a[212:215], a[148:151], v[104:107]
v_add_f32 v209, v209, v9
v_mfma_f32_16x16x32_bf16 v[136:139], a[212:215], a[152:155], v[136:139]
v_add_f32 v210, v210, v10
v_add_f32 v211, v211, v11
v_mfma_f32_16x16x32_bf16 v[136:139], a[216:219], a[156:159], v[136:139]
v_add_f32 v212, v212, v12
v_mfma_f32_16x16x32_bf16 v[168:171], a[216:219], a[160:163], v[168:171]
v_add_f32 v213, v213, v13
v_mfma_f32_16x16x32_bf16 v[168:171], a[212:215], a[164:167], v[168:171]
v_add_f32 v214, v214, v14
v_mfma_f32_16x16x32_bf16 v[200:203], a[212:215], a[168:171], v[200:203]
v_add_f32 v215, v215, v15
v_mfma_f32_16x16x32_bf16 v[200:203], a[216:219], a[172:175], v[200:203]
v_add_f32 v240, v240, v8
v_mfma_f32_16x16x32_bf16 v[232:235], a[216:219], a[176:179], v[232:235]
v_add_f32 v241, v241, v9
v_mfma_f32_16x16x32_bf16 v[232:235], a[212:215], a[180:183], v[232:235]
v_add_f32 v242, v242, v10
v_mfma_f32_16x16x32_bf16 a[240:243], a[212:215], a[184:187], a[240:243]
global_load_dwordx4 a[212:215], v0, s[72:73] offset:-3072
v_mfma_f32_16x16x32_bf16 a[240:243], a[216:219], a[188:191], a[240:243]
s_waitcnt vmcnt(11)
v_mfma_f32_16x16x32_bf16 a[244:247], a[208:211], a[188:191], a[244:247]
v_add_f32 v243, v243, v11
v_add_f32 v244, v244, v12
v_mfma_f32_16x16x32_bf16 a[244:247], a[192:195], a[184:187], a[244:247]
v_mfma_f32_16x16x32_bf16 v[236:239], a[192:195], a[180:183], v[236:239]
global_load_dwordx4 a[216:219], v0, s[74:75] offset:-3072
v_mfma_f32_16x16x32_bf16 v[236:239], a[208:211], a[176:179], v[236:239]
v_add_f32 v245, v245, v13
v_mfma_f32_16x16x32_bf16 v[204:207], a[208:211], a[172:175], v[204:207]
v_add_f32 v246, v246, v14
v_mfma_f32_16x16x32_bf16 v[204:207], a[192:195], a[168:171], v[204:207]
v_add_f32 v247, v247, v15
v_mfma_f32_16x16x32_bf16 v[172:175], a[192:195], a[164:167], v[172:175]
v_mfma_f32_4x4x4_16b_bf16 a[248:251], v[6:7], v[16:17], a[248:251]
v_mfma_f32_4x4x4_16b_bf16 a[252:255], v[6:7], v[18:19], a[252:255]
v_mfma_f32_16x16x32_bf16 v[172:175], a[208:211], a[160:163], v[172:175]
v_mfma_f32_16x16x32_bf16 v[140:143], a[208:211], a[156:159], v[140:143]
v_mfma_f32_16x16x32_bf16 v[140:143], a[192:195], a[152:155], v[140:143]
v_mfma_f32_16x16x32_bf16 v[108:111], a[192:195], a[148:151], v[108:111]
v_mfma_f32_16x16x32_bf16 v[108:111], a[208:211], a[144:147], v[108:111]
v_mfma_f32_16x16x32_bf16 v[76:79], a[208:211], a[140:143], v[76:79]
v_mfma_f32_16x16x32_bf16 v[76:79], a[192:195], a[136:139], v[76:79]
v_mfma_f32_16x16x32_bf16 v[44:47], a[192:195], a[132:135], v[44:47]
global_load_dwordx4 a[192:195], v0, s[72:73] offset:-2048
v_mfma_f32_16x16x32_bf16 v[44:47], a[208:211], a[128:131], v[44:47]
s_waitcnt vmcnt(10)
v_mfma_f32_16x16x32_bf16 v[48:51], a[200:203], a[128:131], v[48:51]
v_mfma_f32_16x16x32_bf16 v[48:51], a[220:223], a[132:135], v[48:51]
v_mfma_f32_16x16x32_bf16 v[80:83], a[220:223], a[136:139], v[80:83]
global_load_dwordx4 a[208:211], v0, s[74:75] offset:-2048
v_mfma_f32_16x16x32_bf16 v[80:83], a[200:203], a[140:143], v[80:83]
v_mfma_f32_16x16x32_bf16 v[112:115], a[200:203], a[144:147], v[112:115]
v_mfma_f32_16x16x32_bf16 v[112:115], a[220:223], a[148:151], v[112:115]
v_mfma_f32_16x16x32_bf16 v[144:147], a[220:223], a[152:155], v[144:147]
v_mfma_f32_16x16x32_bf16 v[144:147], a[200:203], a[156:159], v[144:147]
v_mfma_f32_16x16x32_bf16 v[176:179], a[200:203], a[160:163], v[176:179]
v_mfma_f32_16x16x32_bf16 v[176:179], a[220:223], a[164:167], v[176:179]
v_mfma_f32_16x16x32_bf16 v[208:211], a[220:223], a[168:171], v[208:211]
v_mfma_f32_16x16x32_bf16 v[208:211], a[200:203], a[172:175], v[208:211]
v_mfma_f32_16x16x32_bf16 v[240:243], a[200:203], a[176:179], v[240:243]
v_mfma_f32_16x16x32_bf16 v[240:243], a[220:223], a[180:183], v[240:243]
v_mfma_f32_16x16x32_bf16 a[248:251], a[220:223], a[184:187], a[248:251]
global_load_dwordx4 a[220:223], v0, s[72:73] offset:-1024
v_mfma_f32_16x16x32_bf16 a[248:251], a[200:203], a[188:191], a[248:251]
s_waitcnt vmcnt(9)
v_mfma_f32_16x16x32_bf16 a[252:255], a[204:207], a[188:191], a[252:255]
ds_read_b128 a[188:191], v2 offset:49152
v_mfma_f32_16x16x32_bf16 a[252:255], a[228:231], a[184:187], a[252:255]
ds_read_b128 a[184:187], v2 offset:57344
v_mfma_f32_16x16x32_bf16 v[244:247], a[228:231], a[180:183], v[244:247]
ds_read_b128 a[180:183], v2 offset:58368
v_mfma_f32_16x16x32_bf16 v[244:247], a[204:207], a[176:179], v[244:247]
ds_read_b128 a[176:179], v2 offset:50176
v_mfma_f32_16x16x32_bf16 v[212:215], a[204:207], a[172:175], v[212:215]
ds_read_b128 a[172:175], v2 offset:51200
v_mfma_f32_16x16x32_bf16 v[212:215], a[228:231], a[168:171], v[212:215]
ds_read_b128 a[168:171], v2 offset:59392
v_mfma_f32_16x16x32_bf16 v[180:183], a[228:231], a[164:167], v[180:183]
ds_read_b128 a[164:167], v2 offset:60416
v_mfma_f32_16x16x32_bf16 v[180:183], a[204:207], a[160:163], v[180:183]
ds_read_b128 a[160:163], v2 offset:52224
v_mfma_f32_16x16x32_bf16 v[148:151], a[204:207], a[156:159], v[148:151]
L_pad12:
s_cbranch_execz L_pad16
ds_read_b128 a[156:159], v2 offset:53248
v_mfma_f32_16x16x32_bf16 v[148:151], a[228:231], a[152:155], v[148:151]
ds_read_b128 a[152:155], v2 offset:61440
v_mfma_f32_16x16x32_bf16 v[116:119], a[228:231], a[148:151], v[116:119]
ds_read_b128 a[148:151], v2 offset:62464
v_mfma_f32_16x16x32_bf16 v[116:119], a[204:207], a[144:147], v[116:119]
ds_read_b128 a[144:147], v2 offset:54272
v_mfma_f32_16x16x32_bf16 v[84:87], a[204:207], a[140:143], v[84:87]
ds_read_b128 a[140:143], v2 offset:55296
v_mfma_f32_16x16x32_bf16 v[84:87], a[228:231], a[136:139], v[84:87]
ds_read_b128 a[136:139], v2 offset:63488
v_mfma_f32_16x16x32_bf16 v[52:55], a[228:231], a[132:135], v[52:55]
ds_read_b128 a[132:135], v2 offset:64512
v_mfma_f32_16x16x32_bf16 v[52:55], a[204:207], a[128:131], v[52:55]
ds_read_b128 a[128:131], v2 offset:56320
s_waitcnt vmcnt(5) lgkmcnt(12)
v_mfma_f32_16x16x32_bf16 v[24:27], a[196:199], a[188:191], v[24:27]
global_load_dwordx4 a[200:203], v0, s[74:75] offset:-1024
v_mfma_f32_16x16x32_bf16 v[24:27], a[224:227], a[184:187], v[24:27]
v_mfma_f32_16x16x32_bf16 v[56:59], a[224:227], a[180:183], v[56:59]
v_mfma_f32_16x16x32_bf16 v[56:59], a[196:199], a[176:179], v[56:59]
s_waitcnt lgkmcnt(8)
v_mfma_f32_16x16x32_bf16 v[88:91], a[196:199], a[172:175], v[88:91]
global_load_dwordx4 a[228:231], v0, s[72:73] offset:0
v_mfma_f32_16x16x32_bf16 v[88:91], a[224:227], a[168:171], v[88:91]
v_mfma_f32_16x16x32_bf16 v[120:123], a[224:227], a[164:167], v[120:123]
v_mfma_f32_16x16x32_bf16 v[120:123], a[196:199], a[160:163], v[120:123]
s_waitcnt lgkmcnt(4)
v_mfma_f32_16x16x32_bf16 v[152:155], a[196:199], a[156:159], v[152:155]
global_load_dwordx4 a[204:207], v0, s[74:75] offset:0
v_mfma_f32_16x16x32_bf16 v[152:155], a[224:227], a[152:155], v[152:155]
v_mfma_f32_16x16x32_bf16 v[184:187], a[224:227], a[148:151], v[184:187]
v_mfma_f32_16x16x32_bf16 v[184:187], a[196:199], a[144:147], v[184:187]
s_waitcnt lgkmcnt(0)
v_mfma_f32_16x16x32_bf16 v[216:219], a[196:199], a[140:143], v[216:219]
s_barrier
v_mfma_f32_16x16x32_bf16 v[216:219], a[224:227], a[136:139], v[216:219]
s_add_u32 m0, s56, 114688
v_mfma_f32_16x16x32_bf16 v[248:251], a[224:227], a[132:135], v[248:251]
global_load_dwordx4 a[224:227], v0, s[72:73] offset:1024
v_mfma_f32_16x16x32_bf16 v[248:251], a[196:199], a[128:131], v[248:251]
s_waitcnt vmcnt(7)
v_mfma_f32_16x16x32_bf16 v[252:255], a[212:215], a[128:131], v[252:255]
s_add_u32 s30, s28, 114688
s_addc_u32 s31, s29, 0
v_mfma_f32_16x16x32_bf16 v[252:255], a[216:219], a[132:135], v[252:255]
v_mfma_f32_16x16x32_bf16 v[220:223], a[216:219], a[136:139], v[220:223]
global_load_dwordx4 a[196:199], v0, s[74:75] offset:1024
v_mfma_f32_16x16x32_bf16 v[220:223], a[212:215], a[140:143], v[220:223]
v_mfma_f32_16x16x32_bf16 v[188:191], a[212:215], a[144:147], v[188:191]
v_mfma_f32_16x16x32_bf16 v[188:191], a[216:219], a[148:151], v[188:191]
global_load_lds_dwordx4 v0, s[30:31] nt
v_mfma_f32_16x16x32_bf16 v[156:159], a[216:219], a[152:155], v[156:159]
v_mfma_f32_16x16x32_bf16 v[156:159], a[212:215], a[156:159], v[156:159]
v_mfma_f32_16x16x32_bf16 v[124:127], a[212:215], a[160:163], v[124:127]
v_mfma_f32_16x16x32_bf16 v[124:127], a[216:219], a[164:167], v[124:127]
v_mfma_f32_16x16x32_bf16 v[92:95], a[216:219], a[168:171], v[92:95]
v_mfma_f32_16x16x32_bf16 v[92:95], a[212:215], a[172:175], v[92:95]
v_mfma_f32_16x16x32_bf16 v[60:63], a[212:215], a[176:179], v[60:63]
v_mfma_f32_16x16x32_bf16 v[60:63], a[216:219], a[180:183], v[60:63]
v_mfma_f32_16x16x32_bf16 v[28:31], a[216:219], a[184:187], v[28:31]
global_load_dwordx4 a[216:219], v0, s[72:73] offset:2048
v_mfma_f32_16x16x32_bf16 v[28:31], a[212:215], a[188:191], v[28:31]
s_waitcnt vmcnt(8)
v_mfma_f32_16x16x32_bf16 v[32:35], a[192:195], a[188:191], v[32:35]
global_load_lds_dwordx4 v0, s[30:31] offset:1024 nt
v_mfma_f32_16x16x32_bf16 v[32:35], a[208:211], a[184:187], v[32:35]
v_mfma_f32_16x16x32_bf16 v[64:67], a[208:211], a[180:183], v[64:67]
global_load_dwordx4 a[212:215], v0, s[74:75] offset:2048
v_mfma_f32_16x16x32_bf16 v[64:67], a[192:195], a[176:179], v[64:67]
v_mfma_f32_16x16x32_bf16 v[96:99], a[192:195], a[172:175], v[96:99]
v_mfma_f32_16x16x32_bf16 v[96:99], a[208:211], a[168:171], v[96:99]
v_mfma_f32_16x16x32_bf16 v[128:131], a[208:211], a[164:167], v[128:131]
v_mfma_f32_16x16x32_bf16 v[128:131], a[192:195], a[160:163], v[128:131]
v_mfma_f32_16x16x32_bf16 v[160:163], a[192:195], a[156:159], v[160:163]
v_mfma_f32_16x16x32_bf16 v[160:163], a[208:211], a[152:155], v[160:163]
v_mfma_f32_16x16x32_bf16 v[192:195], a[208:211], a[148:151], v[192:195]
s_add_u32 m0, s56, 122880
v_mfma_f32_16x16x32_bf16 v[192:195], a[192:195], a[144:147], v[192:195]
s_add_u32 s30, s28, 122880
s_addc_u32 s31, s29, 0
v_mfma_f32_16x16x32_bf16 v[224:227], a[192:195], a[140:143], v[224:227]
v_mfma_f32_16x16x32_bf16 v[224:227], a[208:211], a[136:139], v[224:227]
v_mfma_f32_16x16x32_bf16 a[232:235], a[208:211], a[132:135], a[232:235]
global_load_dwordx4 a[208:211], v0, s[72:73] offset:3072
v_mfma_f32_16x16x32_bf16 a[232:235], a[192:195], a[128:131], a[232:235]
s_waitcnt vmcnt(9)
v_mfma_f32_16x16x32_bf16 a[236:239], a[220:223], a[128:131], a[236:239]
global_load_lds_dwordx4 v0, s[30:31] nt
v_mfma_f32_16x16x32_bf16 a[236:239], a[200:203], a[132:135], a[236:239]
v_mfma_f32_16x16x32_bf16 v[228:231], a[200:203], a[136:139], v[228:231]
global_load_dwordx4 a[192:195], v0, s[74:75] offset:3072
v_mfma_f32_16x16x32_bf16 v[228:231], a[220:223], a[140:143], v[228:231]
s_add_u32 s72, s12, 421888
s_addc_u32 s73, s13, 0
v_mfma_f32_16x16x32_bf16 v[196:199], a[220:223], a[144:147], v[196:199]
v_mfma_f32_16x16x32_bf16 v[196:199], a[200:203], a[148:151], v[196:199]
v_mfma_f32_16x16x32_bf16 v[164:167], a[200:203], a[152:155], v[164:167]
s_add_u32 s74, s12, 454656
s_addc_u32 s75, s13, 0
v_mfma_f32_16x16x32_bf16 v[164:167], a[220:223], a[156:159], v[164:167]
v_mfma_f32_16x16x32_bf16 v[132:135], a[220:223], a[160:163], v[132:135]
v_mfma_f32_16x16x32_bf16 v[132:135], a[200:203], a[164:167], v[132:135]
v_mfma_f32_16x16x32_bf16 v[100:103], a[200:203], a[168:171], v[100:103]
v_mfma_f32_16x16x32_bf16 v[100:103], a[220:223], a[172:175], v[100:103]
v_mfma_f32_16x16x32_bf16 v[68:71], a[220:223], a[176:179], v[68:71]
v_mfma_f32_16x16x32_bf16 v[68:71], a[200:203], a[180:183], v[68:71]
global_load_lds_dwordx4 v0, s[30:31] offset:1024 nt
v_mfma_f32_16x16x32_bf16 v[36:39], a[200:203], a[184:187], v[36:39]
global_load_dwordx4 a[200:203], v0, s[72:73] offset:-4096
v_mfma_f32_16x16x32_bf16 v[36:39], a[220:223], a[188:191], v[36:39]
s_waitcnt vmcnt(11)
v_mfma_f32_16x16x32_bf16 v[40:43], a[228:231], a[188:191], v[40:43]
v_mfma_f32_16x16x32_bf16 v[40:43], a[204:207], a[184:187], v[40:43]
v_mfma_f32_16x16x32_bf16 v[72:75], a[204:207], a[180:183], v[72:75]
global_load_dwordx4 a[220:223], v0, s[74:75] offset:-4096
v_mfma_f32_16x16x32_bf16 v[72:75], a[228:231], a[176:179], v[72:75]
v_mfma_f32_16x16x32_bf16 v[104:107], a[228:231], a[172:175], v[104:107]
v_mfma_f32_16x16x32_bf16 v[104:107], a[204:207], a[168:171], v[104:107]
v_mfma_f32_16x16x32_bf16 v[136:139], a[204:207], a[164:167], v[136:139]
v_mfma_f32_16x16x32_bf16 v[136:139], a[228:231], a[160:163], v[136:139]
v_mfma_f32_16x16x32_bf16 v[168:171], a[228:231], a[156:159], v[168:171]
v_mfma_f32_16x16x32_bf16 v[168:171], a[204:207], a[152:155], v[168:171]
v_mfma_f32_16x16x32_bf16 v[200:203], a[204:207], a[148:151], v[200:203]
v_mfma_f32_16x16x32_bf16 v[200:203], a[228:231], a[144:147], v[200:203]
v_mfma_f32_16x16x32_bf16 v[232:235], a[228:231], a[140:143], v[232:235]
v_mfma_f32_16x16x32_bf16 v[232:235], a[204:207], a[136:139], v[232:235]
v_mfma_f32_16x16x32_bf16 a[240:243], a[204:207], a[132:135], a[240:243]
global_load_dwordx4 a[204:207], v0, s[72:73] offset:-3072
v_mfma_f32_16x16x32_bf16 a[240:243], a[228:231], a[128:131], a[240:243]
s_waitcnt vmcnt(11)
v_mfma_f32_16x16x32_bf16 a[244:247], a[224:227], a[128:131], a[244:247]
v_mfma_f32_16x16x32_bf16 a[244:247], a[196:199], a[132:135], a[244:247]
v_mfma_f32_16x16x32_bf16 v[236:239], a[196:199], a[136:139], v[236:239]
global_load_dwordx4 a[228:231], v0, s[74:75] offset:-3072
v_mfma_f32_16x16x32_bf16 v[236:239], a[224:227], a[140:143], v[236:239]
v_mfma_f32_16x16x32_bf16 v[204:207], a[224:227], a[144:147], v[204:207]
v_mfma_f32_16x16x32_bf16 v[204:207], a[196:199], a[148:151], v[204:207]
v_mfma_f32_16x16x32_bf16 v[172:175], a[196:199], a[152:155], v[172:175]
v_mfma_f32_16x16x32_bf16 v[172:175], a[224:227], a[156:159], v[172:175]
v_mfma_f32_16x16x32_bf16 v[140:143], a[224:227], a[160:163], v[140:143]
v_mfma_f32_16x16x32_bf16 v[140:143], a[196:199], a[164:167], v[140:143]
v_mfma_f32_16x16x32_bf16 v[108:111], a[196:199], a[168:171], v[108:111]
v_mfma_f32_16x16x32_bf16 v[108:111], a[224:227], a[172:175], v[108:111]
v_mfma_f32_16x16x32_bf16 v[76:79], a[224:227], a[176:179], v[76:79]
v_mfma_f32_16x16x32_bf16 v[76:79], a[196:199], a[180:183], v[76:79]
v_mfma_f32_16x16x32_bf16 v[44:47], a[196:199], a[184:187], v[44:47]
global_load_dwordx4 a[196:199], v0, s[72:73] offset:-2048
v_mfma_f32_16x16x32_bf16 v[44:47], a[224:227], a[188:191], v[44:47]
s_waitcnt vmcnt(9)
v_mfma_f32_16x16x32_bf16 v[48:51], a[216:219], a[188:191], v[48:51]
v_mfma_f32_16x16x32_bf16 v[48:51], a[212:215], a[184:187], v[48:51]
v_mfma_f32_16x16x32_bf16 v[80:83], a[212:215], a[180:183], v[80:83]
global_load_dwordx4 a[224:227], v0, s[74:75] offset:-2048
v_mfma_f32_16x16x32_bf16 v[80:83], a[216:219], a[176:179], v[80:83]
v_mfma_f32_16x16x32_bf16 v[112:115], a[216:219], a[172:175], v[112:115]
v_mfma_f32_16x16x32_bf16 v[112:115], a[212:215], a[168:171], v[112:115]
v_mfma_f32_16x16x32_bf16 v[144:147], a[212:215], a[164:167], v[144:147]
v_mfma_f32_16x16x32_bf16 v[144:147], a[216:219], a[160:163], v[144:147]
v_mfma_f32_16x16x32_bf16 v[176:179], a[216:219], a[156:159], v[176:179]
v_mfma_f32_16x16x32_bf16 v[176:179], a[212:215], a[152:155], v[176:179]
v_mfma_f32_16x16x32_bf16 v[208:211], a[212:215], a[148:151], v[208:211]
v_mfma_f32_16x16x32_bf16 v[208:211], a[216:219], a[144:147], v[208:211]
v_mfma_f32_16x16x32_bf16 v[240:243], a[216:219], a[140:143], v[240:243]
v_mfma_f32_16x16x32_bf16 v[240:243], a[212:215], a[136:139], v[240:243]
v_mfma_f32_16x16x32_bf16 a[248:251], a[212:215], a[132:135], a[248:251]
global_load_dwordx4 a[212:215], v0, s[72:73] offset:-1024
v_mfma_f32_16x16x32_bf16 a[248:251], a[216:219], a[128:131], a[248:251]
s_waitcnt vmcnt(8)
v_mfma_f32_16x16x32_bf16 a[252:255], a[208:211], a[128:131], a[252:255]
ds_read_b128 a[128:131], v2 offset:32768
v_mfma_f32_16x16x32_bf16 a[252:255], a[192:195], a[132:135], a[252:255]
ds_read_b128 a[132:135], v2 offset:40960
v_mfma_f32_16x16x32_bf16 v[244:247], a[192:195], a[136:139], v[244:247]
ds_read_b128 a[136:139], v2 offset:41984
v_mfma_f32_16x16x32_bf16 v[244:247], a[208:211], a[140:143], v[244:247]
ds_read_b128 a[140:143], v2 offset:33792
v_mfma_f32_16x16x32_bf16 v[212:215], a[208:211], a[144:147], v[212:215]
ds_read_b128 a[144:147], v2 offset:34816
v_mfma_f32_16x16x32_bf16 v[212:215], a[192:195], a[148:151], v[212:215]
ds_read_b128 a[148:151], v2 offset:43008
v_mfma_f32_16x16x32_bf16 v[180:183], a[192:195], a[152:155], v[180:183]
ds_read_b128 a[152:155], v2 offset:44032
v_mfma_f32_16x16x32_bf16 v[180:183], a[208:211], a[156:159], v[180:183]
ds_read_b128 a[156:159], v2 offset:35840
v_mfma_f32_16x16x32_bf16 v[148:151], a[208:211], a[160:163], v[148:151]
ds_read_b128 a[160:163], v2 offset:36864
v_mfma_f32_16x16x32_bf16 v[148:151], a[192:195], a[164:167], v[148:151]
ds_read_b128 a[164:167], v2 offset:45056
v_mfma_f32_16x16x32_bf16 v[116:119], a[192:195], a[168:171], v[116:119]
ds_read_b128 a[168:171], v2 offset:46080
v_mfma_f32_16x16x32_bf16 v[116:119], a[208:211], a[172:175], v[116:119]
ds_read_b128 a[172:175], v2 offset:37888
v_mfma_f32_16x16x32_bf16 v[84:87], a[208:211], a[176:179], v[84:87]
ds_read_b128 a[176:179], v2 offset:38912
v_mfma_f32_16x16x32_bf16 v[84:87], a[192:195], a[180:183], v[84:87]
ds_read_b128 a[180:183], v2 offset:47104
v_mfma_f32_16x16x32_bf16 v[52:55], a[192:195], a[184:187], v[52:55]
ds_read_b128 a[184:187], v2 offset:48128
v_mfma_f32_16x16x32_bf16 v[52:55], a[208:211], a[188:191], v[52:55]
ds_read_b128 a[188:191], v2 offset:39936
s_waitcnt vmcnt(5) lgkmcnt(12)
v_mfma_f32_16x16x32_bf16 v[24:27], a[200:203], a[128:131], v[24:27]
global_load_dwordx4 a[216:219], v0, s[74:75] offset:-1024
v_mfma_f32_16x16x32_bf16 v[24:27], a[220:223], a[132:135], v[24:27]
v_mfma_f32_16x16x32_bf16 v[56:59], a[220:223], a[136:139], v[56:59]
v_mfma_f32_16x16x32_bf16 v[56:59], a[200:203], a[140:143], v[56:59]
s_waitcnt lgkmcnt(8)
v_mfma_f32_16x16x32_bf16 v[88:91], a[200:203], a[144:147], v[88:91]
global_load_dwordx4 a[192:195], v0, s[72:73] offset:0
v_mfma_f32_16x16x32_bf16 v[88:91], a[220:223], a[148:151], v[88:91]
v_mfma_f32_16x16x32_bf16 v[120:123], a[220:223], a[152:155], v[120:123]
v_mfma_f32_16x16x32_bf16 v[120:123], a[200:203], a[156:159], v[120:123]
s_waitcnt lgkmcnt(4)
v_mfma_f32_16x16x32_bf16 v[152:155], a[200:203], a[160:163], v[152:155]
global_load_dwordx4 a[208:211], v0, s[74:75] offset:0
v_mfma_f32_16x16x32_bf16 v[152:155], a[220:223], a[164:167], v[152:155]
v_mfma_f32_16x16x32_bf16 v[184:187], a[220:223], a[168:171], v[184:187]
v_mfma_f32_16x16x32_bf16 v[184:187], a[200:203], a[172:175], v[184:187]
s_waitcnt lgkmcnt(0)
v_mfma_f32_16x16x32_bf16 v[216:219], a[200:203], a[176:179], v[216:219]
s_barrier
v_mfma_f32_16x16x32_bf16 v[216:219], a[220:223], a[180:183], v[216:219]
v_mfma_f32_16x16x32_bf16 v[248:251], a[220:223], a[184:187], v[248:251]
global_load_dwordx4 a[220:223], v0, s[72:73] offset:1024
v_mfma_f32_16x16x32_bf16 v[248:251], a[200:203], a[188:191], v[248:251]
s_waitcnt vmcnt(7)
v_mfma_f32_16x16x32_bf16 v[252:255], a[204:207], a[188:191], v[252:255]
v_mfma_f32_16x16x32_bf16 v[252:255], a[228:231], a[184:187], v[252:255]
v_mfma_f32_16x16x32_bf16 v[220:223], a[228:231], a[180:183], v[220:223]
global_load_dwordx4 a[200:203], v0, s[74:75] offset:1024
v_mfma_f32_16x16x32_bf16 v[220:223], a[204:207], a[176:179], v[220:223]
v_mfma_f32_16x16x32_bf16 v[188:191], a[204:207], a[172:175], v[188:191]
v_mfma_f32_16x16x32_bf16 v[188:191], a[228:231], a[168:171], v[188:191]
v_mfma_f32_16x16x32_bf16 v[156:159], a[228:231], a[164:167], v[156:159]
v_mfma_f32_16x16x32_bf16 v[156:159], a[204:207], a[160:163], v[156:159]
v_mfma_f32_16x16x32_bf16 v[124:127], a[204:207], a[156:159], v[124:127]
v_mfma_f32_16x16x32_bf16 v[124:127], a[228:231], a[152:155], v[124:127]
v_mfma_f32_16x16x32_bf16 v[92:95], a[228:231], a[148:151], v[92:95]
v_mfma_f32_16x16x32_bf16 v[92:95], a[204:207], a[144:147], v[92:95]
v_mfma_f32_16x16x32_bf16 v[60:63], a[204:207], a[140:143], v[60:63]
v_mfma_f32_16x16x32_bf16 v[60:63], a[228:231], a[136:139], v[60:63]
v_mfma_f32_16x16x32_bf16 v[28:31], a[228:231], a[132:135], v[28:31]
global_load_dwordx4 a[228:231], v0, s[72:73] offset:2048
v_mfma_f32_16x16x32_bf16 v[28:31], a[204:207], a[128:131], v[28:31]
s_waitcnt vmcnt(7)
v_mfma_f32_16x16x32_bf16 v[32:35], a[196:199], a[128:131], v[32:35]
v_mfma_f32_16x16x32_bf16 v[32:35], a[224:227], a[132:135], v[32:35]
v_mfma_f32_16x16x32_bf16 v[64:67], a[224:227], a[136:139], v[64:67]
global_load_dwordx4 a[204:207], v0, s[74:75] offset:2048
v_mfma_f32_16x16x32_bf16 v[64:67], a[196:199], a[140:143], v[64:67]
v_mfma_f32_16x16x32_bf16 v[96:99], a[196:199], a[144:147], v[96:99]
v_mfma_f32_16x16x32_bf16 v[96:99], a[224:227], a[148:151], v[96:99]
v_mfma_f32_16x16x32_bf16 v[128:131], a[224:227], a[152:155], v[128:131]
v_mfma_f32_16x16x32_bf16 v[128:131], a[196:199], a[156:159], v[128:131]
v_mfma_f32_16x16x32_bf16 v[160:163], a[196:199], a[160:163], v[160:163]
v_mfma_f32_16x16x32_bf16 v[160:163], a[224:227], a[164:167], v[160:163]
v_mfma_f32_16x16x32_bf16 v[192:195], a[224:227], a[168:171], v[192:195]
v_mfma_f32_16x16x32_bf16 v[192:195], a[196:199], a[172:175], v[192:195]
v_mfma_f32_16x16x32_bf16 v[224:227], a[196:199], a[176:179], v[224:227]
v_mfma_f32_16x16x32_bf16 v[224:227], a[224:227], a[180:183], v[224:227]
v_mfma_f32_16x16x32_bf16 a[232:235], a[224:227], a[184:187], a[232:235]
global_load_dwordx4 a[224:227], v0, s[72:73] offset:3072
v_mfma_f32_16x16x32_bf16 a[232:235], a[196:199], a[188:191], a[232:235]
s_waitcnt vmcnt(7)
v_mfma_f32_16x16x32_bf16 a[236:239], a[212:215], a[188:191], a[236:239]
v_mfma_f32_16x16x32_bf16 a[236:239], a[216:219], a[184:187], a[236:239]
v_mfma_f32_16x16x32_bf16 v[228:231], a[216:219], a[180:183], v[228:231]
global_load_dwordx4 a[196:199], v0, s[74:75] offset:3072
v_mfma_f32_16x16x32_bf16 v[228:231], a[212:215], a[176:179], v[228:231]
s_add_u32 s72, s12, 487424
s_addc_u32 s73, s13, 0
v_mfma_f32_16x16x32_bf16 v[196:199], a[212:215], a[172:175], v[196:199]
v_mfma_f32_16x16x32_bf16 v[196:199], a[216:219], a[168:171], v[196:199]
v_mfma_f32_16x16x32_bf16 v[164:167], a[216:219], a[164:167], v[164:167]
s_add_u32 s74, s12, 520192
s_addc_u32 s75, s13, 0
v_mfma_f32_16x16x32_bf16 v[164:167], a[212:215], a[160:163], v[164:167]
v_mfma_f32_16x16x32_bf16 v[132:135], a[212:215], a[156:159], v[132:135]
v_mfma_f32_16x16x32_bf16 v[132:135], a[216:219], a[152:155], v[132:135]
v_mfma_f32_16x16x32_bf16 v[100:103], a[216:219], a[148:151], v[100:103]
v_mfma_f32_16x16x32_bf16 v[100:103], a[212:215], a[144:147], v[100:103]
v_mfma_f32_16x16x32_bf16 v[68:71], a[212:215], a[140:143], v[68:71]
v_mfma_f32_16x16x32_bf16 v[68:71], a[216:219], a[136:139], v[68:71]
v_mfma_f32_16x16x32_bf16 v[36:39], a[216:219], a[132:135], v[36:39]
global_load_dwordx4 a[216:219], v0, s[72:73] offset:-4096
v_mfma_f32_16x16x32_bf16 v[36:39], a[212:215], a[128:131], v[36:39]
s_waitcnt vmcnt(7)
v_mfma_f32_16x16x32_bf16 v[40:43], a[192:195], a[128:131], v[40:43]
v_mfma_f32_16x16x32_bf16 v[40:43], a[208:211], a[132:135], v[40:43]
v_mfma_f32_16x16x32_bf16 v[72:75], a[208:211], a[136:139], v[72:75]
global_load_dwordx4 a[212:215], v0, s[74:75] offset:-4096
v_mfma_f32_16x16x32_bf16 v[72:75], a[192:195], a[140:143], v[72:75]
v_mfma_f32_16x16x32_bf16 v[104:107], a[192:195], a[144:147], v[104:107]
v_mfma_f32_16x16x32_bf16 v[104:107], a[208:211], a[148:151], v[104:107]
v_mfma_f32_16x16x32_bf16 v[136:139], a[208:211], a[152:155], v[136:139]
v_mfma_f32_16x16x32_bf16 v[136:139], a[192:195], a[156:159], v[136:139]
v_mfma_f32_16x16x32_bf16 v[168:171], a[192:195], a[160:163], v[168:171]
v_mfma_f32_16x16x32_bf16 v[168:171], a[208:211], a[164:167], v[168:171]
v_mfma_f32_16x16x32_bf16 v[200:203], a[208:211], a[168:171], v[200:203]
v_mfma_f32_16x16x32_bf16 v[200:203], a[192:195], a[172:175], v[200:203]
v_mfma_f32_16x16x32_bf16 v[232:235], a[192:195], a[176:179], v[232:235]
v_mfma_f32_16x16x32_bf16 v[232:235], a[208:211], a[180:183], v[232:235]
v_mfma_f32_16x16x32_bf16 a[240:243], a[208:211], a[184:187], a[240:243]
global_load_dwordx4 a[208:211], v0, s[72:73] offset:-3072
v_mfma_f32_16x16x32_bf16 a[240:243], a[192:195], a[188:191], a[240:243]
s_waitcnt vmcnt(7)
v_mfma_f32_16x16x32_bf16 a[244:247], a[220:223], a[188:191], a[244:247]
v_mfma_f32_16x16x32_bf16 a[244:247], a[200:203], a[184:187], a[244:247]
v_mfma_f32_16x16x32_bf16 v[236:239], a[200:203], a[180:183], v[236:239]
global_load_dwordx4 a[192:195], v0, s[74:75] offset:-3072
v_mfma_f32_16x16x32_bf16 v[236:239], a[220:223], a[176:179], v[236:239]
v_mfma_f32_16x16x32_bf16 v[204:207], a[220:223], a[172:175], v[204:207]
v_mfma_f32_16x16x32_bf16 v[204:207], a[200:203], a[168:171], v[204:207]
v_mfma_f32_16x16x32_bf16 v[172:175], a[200:203], a[164:167], v[172:175]
v_mfma_f32_16x16x32_bf16 v[172:175], a[220:223], a[160:163], v[172:175]
v_mfma_f32_16x16x32_bf16 v[140:143], a[220:223], a[156:159], v[140:143]
v_mfma_f32_16x16x32_bf16 v[140:143], a[200:203], a[152:155], v[140:143]
v_mfma_f32_16x16x32_bf16 v[108:111], a[200:203], a[148:151], v[108:111]
v_mfma_f32_16x16x32_bf16 v[108:111], a[220:223], a[144:147], v[108:111]
v_mfma_f32_16x16x32_bf16 v[76:79], a[220:223], a[140:143], v[76:79]
v_mfma_f32_16x16x32_bf16 v[76:79], a[200:203], a[136:139], v[76:79]
v_mfma_f32_16x16x32_bf16 v[44:47], a[200:203], a[132:135], v[44:47]
global_load_dwordx4 a[200:203], v0, s[72:73] offset:-2048
v_mfma_f32_16x16x32_bf16 v[44:47], a[220:223], a[128:131], v[44:47]
s_waitcnt vmcnt(7)
v_mfma_f32_16x16x32_bf16 v[48:51], a[228:231], a[128:131], v[48:51]
v_mfma_f32_16x16x32_bf16 v[48:51], a[204:207], a[132:135], v[48:51]
v_mfma_f32_16x16x32_bf16 v[80:83], a[204:207], a[136:139], v[80:83]
global_load_dwordx4 a[220:223], v0, s[74:75] offset:-2048
v_mfma_f32_16x16x32_bf16 v[80:83], a[228:231], a[140:143], v[80:83]
v_mfma_f32_16x16x32_bf16 v[112:115], a[228:231], a[144:147], v[112:115]
v_mfma_f32_16x16x32_bf16 v[112:115], a[204:207], a[148:151], v[112:115]
v_mfma_f32_16x16x32_bf16 v[144:147], a[204:207], a[152:155], v[144:147]
v_mfma_f32_16x16x32_bf16 v[144:147], a[228:231], a[156:159], v[144:147]
v_mfma_f32_16x16x32_bf16 v[176:179], a[228:231], a[160:163], v[176:179]
v_mfma_f32_16x16x32_bf16 v[176:179], a[204:207], a[164:167], v[176:179]
v_mfma_f32_16x16x32_bf16 v[208:211], a[204:207], a[168:171], v[208:211]
v_mfma_f32_16x16x32_bf16 v[208:211], a[228:231], a[172:175], v[208:211]
v_mfma_f32_16x16x32_bf16 v[240:243], a[228:231], a[176:179], v[240:243]
v_mfma_f32_16x16x32_bf16 v[240:243], a[204:207], a[180:183], v[240:243]
v_mfma_f32_16x16x32_bf16 a[248:251], a[204:207], a[184:187], a[248:251]
global_load_dwordx4 a[204:207], v0, s[72:73] offset:-1024
v_mfma_f32_16x16x32_bf16 a[248:251], a[228:231], a[188:191], a[248:251]
s_waitcnt vmcnt(7)
v_mfma_f32_16x16x32_bf16 a[252:255], a[224:227], a[188:191], a[252:255]
ds_read_b128 a[188:191], v2 offset:49152
v_mfma_f32_16x16x32_bf16 a[252:255], a[196:199], a[184:187], a[252:255]
ds_read_b128 a[184:187], v2 offset:57344
v_mfma_f32_16x16x32_bf16 v[244:247], a[196:199], a[180:183], v[244:247]
ds_read_b128 a[180:183], v2 offset:58368
v_mfma_f32_16x16x32_bf16 v[244:247], a[224:227], a[176:179], v[244:247]
ds_read_b128 a[176:179], v2 offset:50176
v_mfma_f32_16x16x32_bf16 v[212:215], a[224:227], a[172:175], v[212:215]
ds_read_b128 a[172:175], v2 offset:51200
v_mfma_f32_16x16x32_bf16 v[212:215], a[196:199], a[168:171], v[212:215]
ds_read_b128 a[168:171], v2 offset:59392
v_mfma_f32_16x16x32_bf16 v[180:183], a[196:199], a[164:167], v[180:183]
ds_read_b128 a[164:167], v2 offset:60416
v_mfma_f32_16x16x32_bf16 v[180:183], a[224:227], a[160:163], v[180:183]
ds_read_b128 a[160:163], v2 offset:52224
v_mfma_f32_16x16x32_bf16 v[148:151], a[224:227], a[156:159], v[148:151]
ds_read_b128 a[156:159], v2 offset:53248
v_mfma_f32_16x16x32_bf16 v[148:151], a[196:199], a[152:155], v[148:151]
ds_read_b128 a[152:155], v2 offset:61440
v_mfma_f32_16x16x32_bf16 v[116:119], a[196:199], a[148:151], v[116:119]
ds_read_b128 a[148:151], v2 offset:62464
v_mfma_f32_16x16x32_bf16 v[116:119], a[224:227], a[144:147], v[116:119]
ds_read_b128 a[144:147], v2 offset:54272
v_mfma_f32_16x16x32_bf16 v[84:87], a[224:227], a[140:143], v[84:87]
ds_read_b128 a[140:143], v2 offset:55296
v_mfma_f32_16x16x32_bf16 v[84:87], a[196:199], a[136:139], v[84:87]
ds_read_b128 a[136:139], v2 offset:63488
v_mfma_f32_16x16x32_bf16 v[52:55], a[196:199], a[132:135], v[52:55]
ds_read_b128 a[132:135], v2 offset:64512
v_mfma_f32_16x16x32_bf16 v[52:55], a[224:227], a[128:131], v[52:55]
ds_read_b128 a[128:131], v2 offset:56320
s_waitcnt vmcnt(5) lgkmcnt(12)
v_mfma_f32_16x16x32_bf16 v[24:27], a[216:219], a[188:191], v[24:27]
global_load_dwordx4 a[228:231], v0, s[74:75] offset:-1024
v_mfma_f32_16x16x32_bf16 v[24:27], a[212:215], a[184:187], v[24:27]
v_mfma_f32_16x16x32_bf16 v[56:59], a[212:215], a[180:183], v[56:59]
v_mfma_f32_16x16x32_bf16 v[56:59], a[216:219], a[176:179], v[56:59]
s_waitcnt lgkmcnt(8)
v_mfma_f32_16x16x32_bf16 v[88:91], a[216:219], a[172:175], v[88:91]
global_load_dwordx4 a[196:199], v0, s[72:73] offset:0
v_mfma_f32_16x16x32_bf16 v[88:91], a[212:215], a[168:171], v[88:91]
v_mfma_f32_16x16x32_bf16 v[120:123], a[212:215], a[164:167], v[120:123]
v_mfma_f32_16x16x32_bf16 v[120:123], a[216:219], a[160:163], v[120:123]
s_waitcnt lgkmcnt(4)
v_mfma_f32_16x16x32_bf16 v[152:155], a[216:219], a[156:159], v[152:155]
global_load_dwordx4 a[224:227], v0, s[74:75] offset:0
v_mfma_f32_16x16x32_bf16 v[152:155], a[212:215], a[152:155], v[152:155]
v_mfma_f32_16x16x32_bf16 v[184:187], a[212:215], a[148:151], v[184:187]
v_mfma_f32_16x16x32_bf16 v[184:187], a[216:219], a[144:147], v[184:187]
s_waitcnt lgkmcnt(0)
v_mfma_f32_16x16x32_bf16 v[216:219], a[216:219], a[140:143], v[216:219]
v_mfma_f32_16x16x32_bf16 v[216:219], a[212:215], a[136:139], v[216:219]
v_mfma_f32_16x16x32_bf16 v[248:251], a[212:215], a[132:135], v[248:251]
global_load_dwordx4 a[212:215], v0, s[72:73] offset:1024
v_mfma_f32_16x16x32_bf16 v[248:251], a[216:219], a[128:131], v[248:251]
s_waitcnt vmcnt(7)
v_mfma_f32_16x16x32_bf16 v[252:255], a[208:211], a[128:131], v[252:255]
v_mfma_f32_16x16x32_bf16 v[252:255], a[192:195], a[132:135], v[252:255]
v_mfma_f32_16x16x32_bf16 v[220:223], a[192:195], a[136:139], v[220:223]
global_load_dwordx4 a[216:219], v0, s[74:75] offset:1024
v_mfma_f32_16x16x32_bf16 v[220:223], a[208:211], a[140:143], v[220:223]
v_mfma_f32_16x16x32_bf16 v[188:191], a[208:211], a[144:147], v[188:191]
v_mfma_f32_16x16x32_bf16 v[188:191], a[192:195], a[148:151], v[188:191]
v_mfma_f32_16x16x32_bf16 v[156:159], a[192:195], a[152:155], v[156:159]
v_mfma_f32_16x16x32_bf16 v[156:159], a[208:211], a[156:159], v[156:159]
v_mfma_f32_16x16x32_bf16 v[124:127], a[208:211], a[160:163], v[124:127]
v_mfma_f32_16x16x32_bf16 v[124:127], a[192:195], a[164:167], v[124:127]
v_mfma_f32_16x16x32_bf16 v[92:95], a[192:195], a[168:171], v[92:95]
v_mfma_f32_16x16x32_bf16 v[92:95], a[208:211], a[172:175], v[92:95]
v_mfma_f32_16x16x32_bf16 v[60:63], a[208:211], a[176:179], v[60:63]
v_mfma_f32_16x16x32_bf16 v[60:63], a[192:195], a[180:183], v[60:63]
v_mfma_f32_16x16x32_bf16 v[28:31], a[192:195], a[184:187], v[28:31]
global_load_dwordx4 a[192:195], v0, s[72:73] offset:2048
v_mfma_f32_16x16x32_bf16 v[28:31], a[208:211], a[188:191], v[28:31]
s_waitcnt vmcnt(7)
v_mfma_f32_16x16x32_bf16 v[32:35], a[200:203], a[188:191], v[32:35]
v_mfma_f32_16x16x32_bf16 v[32:35], a[220:223], a[184:187], v[32:35]
v_mfma_f32_16x16x32_bf16 v[64:67], a[220:223], a[180:183], v[64:67]
global_load_dwordx4 a[208:211], v0, s[74:75] offset:2048
v_mfma_f32_16x16x32_bf16 v[64:67], a[200:203], a[176:179], v[64:67]
v_mfma_f32_16x16x32_bf16 v[96:99], a[200:203], a[172:175], v[96:99]
v_mfma_f32_16x16x32_bf16 v[96:99], a[220:223], a[168:171], v[96:99]
v_mfma_f32_16x16x32_bf16 v[128:131], a[220:223], a[164:167], v[128:131]
v_mfma_f32_16x16x32_bf16 v[128:131], a[200:203], a[160:163], v[128:131]
v_mfma_f32_16x16x32_bf16 v[160:163], a[200:203], a[156:159], v[160:163]
v_mfma_f32_16x16x32_bf16 v[160:163], a[220:223], a[152:155], v[160:163]
v_mfma_f32_16x16x32_bf16 v[192:195], a[220:223], a[148:151], v[192:195]
v_mfma_f32_16x16x32_bf16 v[192:195], a[200:203], a[144:147], v[192:195]
v_mfma_f32_16x16x32_bf16 v[224:227], a[200:203], a[140:143], v[224:227]
v_accvgpr_read_b32 v9, a0
v_accvgpr_read_b32 v11, a1
v_mfma_f32_16x16x32_bf16 v[224:227], a[220:223], a[136:139], v[224:227]
v_lshlrev_b32 v8, 16, v9
v_mfma_f32_16x16x32_bf16 a[232:235], a[220:223], a[132:135], a[232:235]
global_load_dwordx4 a[220:223], v0, s[72:73] offset:3072
v_mfma_f32_16x16x32_bf16 a[232:235], a[200:203], a[128:131], a[232:235]
v_lshlrev_b32 v10, 16, v11
s_waitcnt vmcnt(7)
v_mfma_f32_16x16x32_bf16 a[236:239], a[204:207], a[128:131], a[236:239]
v_and_b32 v9, s53, v9
v_and_b32 v11, s53, v11
v_mfma_f32_16x16x32_bf16 a[236:239], a[228:231], a[132:135], a[236:239]
v_accvgpr_read_b32 v13, a2
v_mfma_f32_16x16x32_bf16 v[228:231], a[228:231], a[136:139], v[228:231]
global_load_dwordx4 a[200:203], v0, s[74:75] offset:3072
v_mfma_f32_16x16x32_bf16 v[228:231], a[204:207], a[140:143], v[228:231]
s_add_u32 s72, s12, 266240
s_addc_u32 s73, s13, 0
v_mfma_f32_16x16x32_bf16 v[196:199], a[204:207], a[144:147], v[196:199]
v_accvgpr_read_b32 v15, a3
v_lshlrev_b32 v12, 16, v13
v_mfma_f32_16x16x32_bf16 v[196:199], a[228:231], a[148:151], v[196:199]
v_lshlrev_b32 v14, 16, v15
v_mfma_f32_16x16x32_bf16 v[164:167], a[228:231], a[152:155], v[164:167]
s_add_u32 s74, s12, 299008
s_addc_u32 s75, s13, 0
v_mfma_f32_16x16x32_bf16 v[164:167], a[204:207], a[156:159], v[164:167]
v_and_b32 v13, s53, v13
v_and_b32 v15, s53, v15
v_mfma_f32_16x16x32_bf16 v[132:135], a[204:207], a[160:163], v[132:135]
s_add_u32 s54, s57, 32768
v_add_u32 v3, s54, v0
v_mfma_f32_16x16x32_bf16 v[132:135], a[228:231], a[164:167], v[132:135]
v_mul_f32 v8, v8, v24
v_mul_f32 v9, v9, v25
v_mfma_f32_16x16x32_bf16 v[100:103], a[228:231], a[168:171], v[100:103]
v_mul_f32 v10, v10, v26
v_mfma_f32_16x16x32_bf16 v[100:103], a[204:207], a[172:175], v[100:103]
v_mul_f32 v11, v11, v27
v_cvt_pk_bf16_f32 v16, v8, v9
v_mfma_f32_16x16x32_bf16 v[68:71], a[204:207], a[176:179], v[68:71]
v_cvt_pk_bf16_f32 v17, v10, v11
v_accvgpr_read_b32 v9, a4
v_mfma_f32_16x16x32_bf16 v[68:71], a[228:231], a[180:183], v[68:71]
v_accvgpr_read_b32 v11, a5
v_mfma_f32_16x16x32_bf16 v[36:39], a[228:231], a[184:187], v[36:39]
global_load_dwordx4 a[228:231], v0, s[72:73] offset:0
v_mfma_f32_16x16x32_bf16 v[36:39], a[204:207], a[188:191], v[36:39]
v_lshlrev_b32 v8, 16, v9
s_waitcnt vmcnt(7)
v_mfma_f32_16x16x32_bf16 v[40:43], a[196:199], a[188:191], v[40:43]
v_lshlrev_b32 v10, 16, v11
v_and_b32 v9, s53, v9
v_mfma_f32_16x16x32_bf16 v[40:43], a[224:227], a[184:187], v[40:43]
v_and_b32 v11, s53, v11
v_mfma_f32_16x16x32_bf16 v[72:75], a[224:227], a[180:183], v[72:75]
global_load_dwordx4 a[204:207], v0, s[74:75] offset:0
v_mfma_f32_16x16x32_bf16 v[72:75], a[196:199], a[176:179], v[72:75]
v_mul_f32 v12, v12, v28
v_mfma_f32_16x16x32_bf16 v[104:107], a[196:199], a[172:175], v[104:107]
v_mul_f32 v13, v13, v29
v_mul_f32 v14, v14, v30
v_mfma_f32_16x16x32_bf16 v[104:107], a[224:227], a[168:171], v[104:107]
v_mul_f32 v15, v15, v31
v_cvt_pk_bf16_f32 v18, v12, v13
v_mfma_f32_16x16x32_bf16 v[136:139], a[224:227], a[164:167], v[136:139]
v_cvt_pk_bf16_f32 v19, v14, v15
v_mfma_f32_16x16x32_bf16 v[136:139], a[196:199], a[160:163], v[136:139]
v_accvgpr_read_b32 v13, a6
v_accvgpr_read_b32 v15, a7
v_mfma_f32_16x16x32_bf16 v[168:171], a[196:199], a[156:159], v[168:171]
v_lshlrev_b32 v12, 16, v13
v_lshlrev_b32 v14, 16, v15
v_mfma_f32_16x16x32_bf16 v[168:171], a[224:227], a[152:155], v[168:171]
v_and_b32 v13, s53, v13
v_mfma_f32_16x16x32_bf16 v[200:203], a[224:227], a[148:151], v[200:203]
v_and_b32 v15, s53, v15
v_mfma_f32_16x16x32_bf16 v[200:203], a[196:199], a[144:147], v[200:203]
ds_write_b128 v3, v[16:19] offset:0
v_mfma_f32_16x16x32_bf16 v[232:235], a[196:199], a[140:143], v[232:235]
v_mul_f32 v8, v8, v56
v_mul_f32 v9, v9, v57
v_mfma_f32_16x16x32_bf16 v[232:235], a[224:227], a[136:139], v[232:235]
v_mul_f32 v10, v10, v58
v_mfma_f32_16x16x32_bf16 a[240:243], a[224:227], a[132:135], a[240:243]
global_load_dwordx4 a[224:227], v0, s[72:73] offset:1024
v_mfma_f32_16x16x32_bf16 a[240:243], a[196:199], a[128:131], a[240:243]
v_mul_f32 v11, v11, v59
v_cvt_pk_bf16_f32 v20, v8, v9
s_waitcnt vmcnt(7)
v_mfma_f32_16x16x32_bf16 a[244:247], a[212:215], a[128:131], a[244:247]
v_cvt_pk_bf16_f32 v21, v10, v11
v_mfma_f32_16x16x32_bf16 a[244:247], a[216:219], a[132:135], a[244:247]
v_accvgpr_read_b32 v9, a8
v_mfma_f32_16x16x32_bf16 v[236:239], a[216:219], a[136:139], v[236:239]
global_load_dwordx4 a[196:199], v0, s[74:75] offset:1024
v_mfma_f32_16x16x32_bf16 v[236:239], a[212:215], a[140:143], v[236:239]
v_accvgpr_read_b32 v11, a9
v_lshlrev_b32 v8, 16, v9
v_mfma_f32_16x16x32_bf16 v[204:207], a[212:215], a[144:147], v[204:207]
v_lshlrev_b32 v10, 16, v11
v_mfma_f32_16x16x32_bf16 v[204:207], a[216:219], a[148:151], v[204:207]
v_and_b32 v9, s53, v9
v_and_b32 v11, s53, v11
v_mfma_f32_16x16x32_bf16 v[172:175], a[216:219], a[152:155], v[172:175]
s_mov_b32 s60, 131072
v_mfma_f32_16x16x32_bf16 v[172:175], a[212:215], a[156:159], v[172:175]
buffer_store_dwordx4 v[16:19], v0, s[24:27], s60 offen offset:0 sc1
v_mfma_f32_16x16x32_bf16 v[140:143], a[212:215], a[160:163], v[140:143]
v_mul_f32 v12, v12, v60
v_mul_f32 v13, v13, v61
v_mfma_f32_16x16x32_bf16 v[140:143], a[216:219], a[164:167], v[140:143]
v_mul_f32 v14, v14, v62
v_mul_f32 v15, v15, v63
v_mfma_f32_16x16x32_bf16 v[108:111], a[216:219], a[168:171], v[108:111]
L_pad13:
s_cbranch_execz L_tret0
v_cvt_pk_bf16_f32 v22, v12, v13
v_cvt_pk_bf16_f32 v23, v14, v15
v_mfma_f32_16x16x32_bf16 v[108:111], a[212:215], a[172:175], v[108:111]
v_accvgpr_read_b32 v13, a10
v_mfma_f32_16x16x32_bf16 v[76:79], a[212:215], a[176:179], v[76:79]
v_accvgpr_read_b32 v15, a11
v_lshlrev_b32 v12, 16, v13
v_mfma_f32_16x16x32_bf16 v[76:79], a[216:219], a[180:183], v[76:79]
v_lshlrev_b32 v14, 16, v15
v_mfma_f32_16x16x32_bf16 v[44:47], a[216:219], a[184:187], v[44:47]
global_load_dwordx4 a[216:219], v0, s[72:73] offset:2048
v_mfma_f32_16x16x32_bf16 v[44:47], a[212:215], a[188:191], v[44:47]
v_and_b32 v13, s53, v13
s_waitcnt vmcnt(8)
v_mfma_f32_16x16x32_bf16 v[48:51], a[192:195], a[188:191], v[48:51]
v_and_b32 v15, s53, v15
v_mfma_f32_16x16x32_bf16 v[48:51], a[208:211], a[184:187], v[48:51]
ds_write_b128 v3, v[20:23] offset:1024
v_mfma_f32_16x16x32_bf16 v[80:83], a[208:211], a[180:183], v[80:83]
global_load_dwordx4 a[212:215], v0, s[74:75] offset:2048
v_mfma_f32_16x16x32_bf16 v[80:83], a[192:195], a[176:179], v[80:83]
v_mul_f32 v8, v8, v88
v_mfma_f32_16x16x32_bf16 v[112:115], a[192:195], a[172:175], v[112:115]
v_mul_f32 v9, v9, v89
v_mul_f32 v10, v10, v90
v_mfma_f32_16x16x32_bf16 v[112:115], a[208:211], a[168:171], v[112:115]
v_mul_f32 v11, v11, v91
v_cvt_pk_bf16_f32 v16, v8, v9
v_mfma_f32_16x16x32_bf16 v[144:147], a[208:211], a[164:167], v[144:147]
v_cvt_pk_bf16_f32 v17, v10, v11
v_mfma_f32_16x16x32_bf16 v[144:147], a[192:195], a[160:163], v[144:147]
v_accvgpr_read_b32 v9, a12
v_accvgpr_read_b32 v11, a13
v_mfma_f32_16x16x32_bf16 v[176:179], a[192:195], a[156:159], v[176:179]
v_lshlrev_b32 v8, 16, v9
v_lshlrev_b32 v10, 16, v11
v_mfma_f32_16x16x32_bf16 v[176:179], a[208:211], a[152:155], v[176:179]
v_and_b32 v9, s53, v9
v_and_b32 v11, s53, v11
v_mfma_f32_16x16x32_bf16 v[208:211], a[208:211], a[148:151], v[208:211]
buffer_store_dwordx4 v[20:23], v0, s[24:27], s60 offen offset:1024 sc1
v_mfma_f32_16x16x32_bf16 v[208:211], a[192:195], a[144:147], v[208:211]
v_mfma_f32_16x16x32_bf16 v[240:243], a[192:195], a[140:143], v[240:243]
v_mul_f32 v12, v12, v92
v_mul_f32 v13, v13, v93
v_mfma_f32_16x16x32_bf16 v[240:243], a[208:211], a[136:139], v[240:243]
v_mul_f32 v14, v14, v94
v_mfma_f32_16x16x32_bf16 a[248:251], a[208:211], a[132:135], a[248:251]
global_load_dwordx4 a[208:211], v0, s[72:73] offset:3072
v_mfma_f32_16x16x32_bf16 a[248:251], a[192:195], a[128:131], a[248:251]
v_mul_f32 v15, v15, v95
s_waitcnt vmcnt(9)
v_mfma_f32_16x16x32_bf16 a[252:255], a[220:223], a[128:131], a[252:255]
ds_read_b128 a[128:131], v2 offset:0
v_cvt_pk_bf16_f32 v18, v12, v13
v_mfma_f32_16x16x32_bf16 a[252:255], a[200:203], a[132:135], a[252:255]
ds_read_b128 a[132:135], v2 offset:8192
v_cvt_pk_bf16_f32 v19, v14, v15
v_mfma_f32_16x16x32_bf16 v[244:247], a[200:203], a[136:139], v[244:247]
ds_read_b128 a[136:139], v2 offset:9216
v_accvgpr_read_b32 v13, a14
v_mfma_f32_16x16x32_bf16 v[244:247], a[220:223], a[140:143], v[244:247]
ds_read_b128 a[140:143], v2 offset:1024
v_accvgpr_read_b32 v15, a15
v_mfma_f32_16x16x32_bf16 v[212:215], a[220:223], a[144:147], v[212:215]
ds_read_b128 a[144:147], v2 offset:2048
v_mfma_f32_16x16x32_bf16 v[212:215], a[200:203], a[148:151], v[212:215]
ds_read_b128 a[148:151], v2 offset:10240
v_lshlrev_b32 v12, 16, v13
v_mfma_f32_16x16x32_bf16 v[180:183], a[200:203], a[152:155], v[180:183]
ds_read_b128 a[152:155], v2 offset:11264
v_lshlrev_b32 v14, 16, v15
v_mfma_f32_16x16x32_bf16 v[180:183], a[220:223], a[156:159], v[180:183]
ds_read_b128 a[156:159], v2 offset:3072
v_and_b32 v13, s53, v13
v_mfma_f32_16x16x32_bf16 v[148:151], a[220:223], a[160:163], v[148:151]
ds_read_b128 a[160:163], v2 offset:4096
v_and_b32 v15, s53, v15
v_mfma_f32_16x16x32_bf16 v[148:151], a[200:203], a[164:167], v[148:151]
ds_read_b128 a[164:167], v2 offset:12288
v_mfma_f32_16x16x32_bf16 v[116:119], a[200:203], a[168:171], v[116:119]
ds_read_b128 a[168:171], v2 offset:13312
v_mfma_f32_16x16x32_bf16 v[116:119], a[220:223], a[172:175], v[116:119]
ds_read_b128 a[172:175], v2 offset:5120
v_mfma_f32_16x16x32_bf16 v[84:87], a[220:223], a[176:179], v[84:87]
ds_read_b128 a[176:179], v2 offset:6144
v_mul_f32 v8, v8, v120
v_mfma_f32_16x16x32_bf16 v[84:87], a[200:203], a[180:183], v[84:87]
ds_read_b128 a[180:183], v2 offset:14336
v_mul_f32 v9, v9, v121
v_mfma_f32_16x16x32_bf16 v[52:55], a[200:203], a[184:187], v[52:55]
ds_read_b128 a[184:187], v2 offset:15360
v_mul_f32 v10, v10, v122
v_mfma_f32_16x16x32_bf16 v[52:55], a[220:223], a[188:191], v[52:55]
ds_read_b128 a[188:191], v2 offset:7168
s_waitcnt vmcnt(7) lgkmcnt(12)
v_mfma_f32_16x16x32_bf16 v[40:43], a[228:231], a[128:131], v[40:43]
global_load_dwordx4 a[192:195], v0, s[74:75] offset:3072
v_mfma_f32_16x16x32_bf16 v[40:43], a[204:207], a[132:135], v[40:43]
s_add_u32 s72, s12, 331776
s_addc_u32 s73, s13, 0
v_mfma_f32_16x16x32_bf16 v[72:75], a[204:207], a[136:139], v[72:75]
s_add_u32 s74, s12, 364544
s_addc_u32 s75, s13, 0
v_mfma_f32_16x16x32_bf16 v[72:75], a[228:231], a[140:143], v[72:75]
s_waitcnt lgkmcnt(8)
v_mfma_f32_16x16x32_bf16 v[104:107], a[228:231], a[144:147], v[104:107]
global_load_dwordx4 a[200:203], v0, s[72:73] offset:0
v_mfma_f32_16x16x32_bf16 v[104:107], a[204:207], a[148:151], v[104:107]
ds_write_b128 v3, v[16:19] offset:2048
v_mfma_f32_16x16x32_bf16 v[136:139], a[204:207], a[152:155], v[136:139]
v_mul_f32 v11, v11, v123
v_cvt_pk_bf16_f32 v20, v8, v9
v_mfma_f32_16x16x32_bf16 v[136:139], a[228:231], a[156:159], v[136:139]
v_cvt_pk_bf16_f32 v21, v10, v11
s_waitcnt lgkmcnt(5)
v_mfma_f32_16x16x32_bf16 v[168:171], a[228:231], a[160:163], v[168:171]
global_load_dwordx4 a[220:223], v0, s[74:75] offset:0
v_mfma_f32_16x16x32_bf16 v[168:171], a[204:207], a[164:167], v[168:171]
v_accvgpr_read_b32 v9, a16
v_accvgpr_read_b32 v11, a17
v_mfma_f32_16x16x32_bf16 v[200:203], a[204:207], a[168:171], v[200:203]
v_lshlrev_b32 v8, 16, v9
v_lshlrev_b32 v10, 16, v11
v_mfma_f32_16x16x32_bf16 v[200:203], a[228:231], a[172:175], v[200:203]
v_and_b32 v9, s53, v9
v_and_b32 v11, s53, v11
s_waitcnt lgkmcnt(1)
v_mfma_f32_16x16x32_bf16 v[232:235], a[228:231], a[176:179], v[232:235]
v_mfma_f32_16x16x32_bf16 v[232:235], a[204:207], a[180:183], v[232:235]
buffer_store_dwordx4 v[16:19], v0, s[24:27], s60 offen offset:2048 sc1
v_mfma_f32_16x16x32_bf16 a[240:243], a[204:207], a[184:187], a[240:243]
global_load_dwordx4 a[204:207], v0, s[72:73] offset:1024
v_mfma_f32_16x16x32_bf16 a[240:243], a[228:231], a[188:191], a[240:243]
v_mul_f32 v12, v12, v124
s_waitcnt vmcnt(10)
v_mfma_f32_16x16x32_bf16 a[244:247], a[224:227], a[188:191], a[244:247]
v_mul_f32 v13, v13, v125
v_mfma_f32_16x16x32_bf16 a[244:247], a[196:199], a[184:187], a[244:247]
v_mul_f32 v14, v14, v126
v_mfma_f32_16x16x32_bf16 v[236:239], a[196:199], a[180:183], v[236:239]
global_load_dwordx4 a[228:231], v0, s[74:75] offset:1024
v_mfma_f32_16x16x32_bf16 v[236:239], a[224:227], a[176:179], v[236:239]
v_mul_f32 v15, v15, v127
v_cvt_pk_bf16_f32 v22, v12, v13
v_mfma_f32_16x16x32_bf16 v[204:207], a[224:227], a[172:175], v[204:207]
v_cvt_pk_bf16_f32 v23, v14, v15
v_accvgpr_read_b32 v13, a18
v_mfma_f32_16x16x32_bf16 v[204:207], a[196:199], a[168:171], v[204:207]
v_accvgpr_read_b32 v15, a19
v_mfma_f32_16x16x32_bf16 v[172:175], a[196:199], a[164:167], v[172:175]
v_lshlrev_b32 v12, 16, v13
v_lshlrev_b32 v14, 16, v15
v_mfma_f32_16x16x32_bf16 v[172:175], a[224:227], a[160:163], v[172:175]
v_and_b32 v13, s53, v13
v_and_b32 v15, s53, v15
v_mfma_f32_16x16x32_bf16 v[140:143], a[224:227], a[156:159], v[140:143]
ds_write_b128 v3, v[20:23] offset:3072
v_mfma_f32_16x16x32_bf16 v[140:143], a[196:199], a[152:155], v[140:143]
v_mul_f32 v8, v8, v152
v_mfma_f32_16x16x32_bf16 v[108:111], a[196:199], a[148:151], v[108:111]
v_mul_f32 v9, v9, v153
v_mul_f32 v10, v10, v154
v_mfma_f32_16x16x32_bf16 v[108:111], a[224:227], a[144:147], v[108:111]
v_mul_f32 v11, v11, v155
v_mfma_f32_16x16x32_bf16 v[76:79], a[224:227], a[140:143], v[76:79]
v_cvt_pk_bf16_f32 v16, v8, v9
v_cvt_pk_bf16_f32 v17, v10, v11
v_mfma_f32_16x16x32_bf16 v[76:79], a[196:199], a[136:139], v[76:79]
v_accvgpr_read_b32 v9, a20
v_mfma_f32_16x16x32_bf16 v[44:47], a[196:199], a[132:135], v[44:47]
global_load_dwordx4 a[196:199], v0, s[72:73] offset:2048
v_mfma_f32_16x16x32_bf16 v[44:47], a[224:227], a[128:131], v[44:47]
v_accvgpr_read_b32 v11, a21
s_waitcnt vmcnt(9)
v_mfma_f32_16x16x32_bf16 v[48:51], a[216:219], a[128:131], v[48:51]
v_lshlrev_b32 v8, 16, v9
v_lshlrev_b32 v10, 16, v11
v_mfma_f32_16x16x32_bf16 v[48:51], a[212:215], a[132:135], v[48:51]
v_and_b32 v9, s53, v9
v_mfma_f32_16x16x32_bf16 v[80:83], a[212:215], a[136:139], v[80:83]
global_load_dwordx4 a[224:227], v0, s[74:75] offset:2048
v_mfma_f32_16x16x32_bf16 v[80:83], a[216:219], a[140:143], v[80:83]
v_and_b32 v11, s53, v11
v_mfma_f32_16x16x32_bf16 v[112:115], a[216:219], a[144:147], v[112:115]
buffer_store_dwordx4 v[20:23], v0, s[24:27], s60 offen offset:3072 sc1
v_mfma_f32_16x16x32_bf16 v[112:115], a[212:215], a[148:151], v[112:115]
v_mul_f32 v12, v12, v156
v_mfma_f32_16x16x32_bf16 v[144:147], a[212:215], a[152:155], v[144:147]
v_mul_f32 v13, v13, v157
v_mul_f32 v14, v14, v158
v_mfma_f32_16x16x32_bf16 v[144:147], a[216:219], a[156:159], v[144:147]
v_mul_f32 v15, v15, v159
v_cvt_pk_bf16_f32 v18, v12, v13
v_mfma_f32_16x16x32_bf16 v[176:179], a[216:219], a[160:163], v[176:179]
v_cvt_pk_bf16_f32 v19, v14, v15
v_mfma_f32_16x16x32_bf16 v[176:179], a[212:215], a[164:167], v[176:179]
v_accvgpr_read_b32 v13, a22
v_accvgpr_read_b32 v15, a23
v_mfma_f32_16x16x32_bf16 v[208:211], a[212:215], a[168:171], v[208:211]
v_lshlrev_b32 v12, 16, v13
v_lshlrev_b32 v14, 16, v15
v_mfma_f32_16x16x32_bf16 v[208:211], a[216:219], a[172:175], v[208:211]
v_and_b32 v13, s53, v13
v_mfma_f32_16x16x32_bf16 v[240:243], a[216:219], a[176:179], v[240:243]
v_and_b32 v15, s53, v15
v_mfma_f32_16x16x32_bf16 v[240:243], a[212:215], a[180:183], v[240:243]
ds_write_b128 v3, v[16:19] offset:4096
v_mfma_f32_16x16x32_bf16 a[248:251], a[212:215], a[184:187], a[248:251]
global_load_dwordx4 a[212:215], v0, s[72:73] offset:3072
v_mfma_f32_16x16x32_bf16 a[248:251], a[216:219], a[188:191], a[248:251]
v_mul_f32 v8, v8, v184
s_waitcnt vmcnt(9)
v_mfma_f32_16x16x32_bf16 a[252:255], a[208:211], a[188:191], a[252:255]
ds_read_b128 a[188:191], v2 offset:16384
v_mul_f32 v9, v9, v185
v_mfma_f32_16x16x32_bf16 a[252:255], a[192:195], a[184:187], a[252:255]
ds_read_b128 a[184:187], v2 offset:24576
v_mul_f32 v10, v10, v186
v_mfma_f32_16x16x32_bf16 v[244:247], a[192:195], a[180:183], v[244:247]
ds_read_b128 a[180:183], v2 offset:25600
v_mul_f32 v11, v11, v187
v_mfma_f32_16x16x32_bf16 v[244:247], a[208:211], a[176:179], v[244:247]
ds_read_b128 a[176:179], v2 offset:17408
v_cvt_pk_bf16_f32 v20, v8, v9
v_mfma_f32_16x16x32_bf16 v[212:215], a[208:211], a[172:175], v[212:215]
ds_read_b128 a[172:175], v2 offset:18432
v_cvt_pk_bf16_f32 v21, v10, v11
v_mfma_f32_16x16x32_bf16 v[212:215], a[192:195], a[168:171], v[212:215]
ds_read_b128 a[168:171], v2 offset:26624
v_mfma_f32_16x16x32_bf16 v[180:183], a[192:195], a[164:167], v[180:183]
ds_read_b128 a[164:167], v2 offset:27648
v_accvgpr_read_b32 v9, a24
v_mfma_f32_16x16x32_bf16 v[180:183], a[208:211], a[160:163], v[180:183]
ds_read_b128 a[160:163], v2 offset:19456
v_accvgpr_read_b32 v11, a25
v_mfma_f32_16x16x32_bf16 v[148:151], a[208:211], a[156:159], v[148:151]
ds_read_b128 a[156:159], v2 offset:20480
v_lshlrev_b32 v8, 16, v9
v_mfma_f32_16x16x32_bf16 v[148:151], a[192:195], a[152:155], v[148:151]
ds_read_b128 a[152:155], v2 offset:28672
v_lshlrev_b32 v10, 16, v11
v_mfma_f32_16x16x32_bf16 v[116:119], a[192:195], a[148:151], v[116:119]
ds_read_b128 a[148:151], v2 offset:29696
v_and_b32 v9, s53, v9
v_mfma_f32_16x16x32_bf16 v[116:119], a[208:211], a[144:147], v[116:119]
ds_read_b128 a[144:147], v2 offset:21504
v_mfma_f32_16x16x32_bf16 v[84:87], a[208:211], a[140:143], v[84:87]
ds_read_b128 a[140:143], v2 offset:22528
v_and_b32 v11, s53, v11
v_mfma_f32_16x16x32_bf16 v[84:87], a[192:195], a[136:139], v[84:87]
ds_read_b128 a[136:139], v2 offset:30720
s_mov_b32 s60, 135168
v_mfma_f32_16x16x32_bf16 v[52:55], a[192:195], a[132:135], v[52:55]
ds_read_b128 a[132:135], v2 offset:31744
v_mfma_f32_16x16x32_bf16 v[52:55], a[208:211], a[128:131], v[52:55]
ds_read_b128 a[128:131], v2 offset:23552
s_waitcnt vmcnt(7) lgkmcnt(12)
v_mfma_f32_16x16x32_bf16 v[40:43], a[200:203], a[188:191], v[40:43]
global_load_dwordx4 a[216:219], v0, s[74:75] offset:3072
v_mfma_f32_16x16x32_bf16 v[40:43], a[220:223], a[184:187], v[40:43]
s_add_u32 s72, s12, 274432
s_addc_u32 s73, s13, 0
v_mfma_f32_16x16x32_bf16 v[72:75], a[220:223], a[180:183], v[72:75]
s_add_u32 s74, s12, 307200
s_addc_u32 s75, s13, 0
v_mfma_f32_16x16x32_bf16 v[72:75], a[200:203], a[176:179], v[72:75]
s_waitcnt lgkmcnt(8)
v_mfma_f32_16x16x32_bf16 v[104:107], a[200:203], a[172:175], v[104:107]
global_load_dwordx4 a[192:195], v0, s[72:73] offset:0
v_mfma_f32_16x16x32_bf16 v[104:107], a[220:223], a[168:171], v[104:107]
buffer_store_dwordx4 v[16:19], v0, s[24:27], s60 offen offset:0 sc1
v_mfma_f32_16x16x32_bf16 v[136:139], a[220:223], a[164:167], v[136:139]
v_mul_f32 v12, v12, v188
v_mul_f32 v13, v13, v189
v_mfma_f32_16x16x32_bf16 v[136:139], a[200:203], a[160:163], v[136:139]
v_mul_f32 v14, v14, v190
s_waitcnt lgkmcnt(4)
v_mfma_f32_16x16x32_bf16 v[168:171], a[200:203], a[156:159], v[168:171]
global_load_dwordx4 a[208:211], v0, s[74:75] offset:0
v_mfma_f32_16x16x32_bf16 v[168:171], a[220:223], a[152:155], v[168:171]
v_mul_f32 v15, v15, v191
v_cvt_pk_bf16_f32 v22, v12, v13
v_mfma_f32_16x16x32_bf16 v[200:203], a[220:223], a[148:151], v[200:203]
v_cvt_pk_bf16_f32 v23, v14, v15
v_accvgpr_read_b32 v13, a26
v_mfma_f32_16x16x32_bf16 v[200:203], a[200:203], a[144:147], v[200:203]
v_accvgpr_read_b32 v15, a27
s_waitcnt lgkmcnt(0)
v_mfma_f32_16x16x32_bf16 v[232:235], a[200:203], a[140:143], v[232:235]
v_lshlrev_b32 v12, 16, v13
s_barrier
v_mfma_f32_16x16x32_bf16 v[232:235], a[220:223], a[136:139], v[232:235]
v_lshlrev_b32 v14, 16, v15
v_mfma_f32_16x16x32_bf16 a[240:243], a[220:223], a[132:135], a[240:243]
global_load_dwordx4 a[220:223], v0, s[72:73] offset:1024
v_mfma_f32_16x16x32_bf16 a[240:243], a[200:203], a[128:131], a[240:243]
v_and_b32 v13, s53, v13
s_waitcnt vmcnt(9)
v_mfma_f32_16x16x32_bf16 a[244:247], a[204:207], a[128:131], a[244:247]
v_and_b32 v15, s53, v15
v_mfma_f32_16x16x32_bf16 a[244:247], a[228:231], a[132:135], a[244:247]
ds_write_b128 v3, v[20:23] offset:5120
v_mfma_f32_16x16x32_bf16 v[236:239], a[228:231], a[136:139], v[236:239]
global_load_dwordx4 a[200:203], v0, s[74:75] offset:1024
v_mfma_f32_16x16x32_bf16 v[236:239], a[204:207], a[140:143], v[236:239]
v_mul_f32 v8, v8, v216
v_mfma_f32_16x16x32_bf16 v[204:207], a[204:207], a[144:147], v[204:207]
v_mul_f32 v9, v9, v217
v_mul_f32 v10, v10, v218
v_mfma_f32_16x16x32_bf16 v[204:207], a[228:231], a[148:151], v[204:207]
v_mul_f32 v11, v11, v219
v_cvt_pk_bf16_f32 v16, v8, v9
v_mfma_f32_16x16x32_bf16 v[172:175], a[228:231], a[152:155], v[172:175]
v_cvt_pk_bf16_f32 v17, v10, v11
v_accvgpr_read_b32 v9, a28
v_mfma_f32_16x16x32_bf16 v[172:175], a[204:207], a[156:159], v[172:175]
v_accvgpr_read_b32 v11, a29
v_mfma_f32_16x16x32_bf16 v[140:143], a[204:207], a[160:163], v[140:143]
v_lshlrev_b32 v8, 16, v9
v_lshlrev_b32 v10, 16, v11
v_mfma_f32_16x16x32_bf16 v[140:143], a[228:231], a[164:167], v[140:143]
v_and_b32 v9, s53, v9
v_and_b32 v11, s53, v11
v_mfma_f32_16x16x32_bf16 v[108:111], a[228:231], a[168:171], v[108:111]
buffer_store_dwordx4 v[20:23], v0, s[24:27], s60 offen offset:1024 sc1
v_mfma_f32_16x16x32_bf16 v[108:111], a[204:207], a[172:175], v[108:111]
v_mul_f32 v12, v12, v220
v_mfma_f32_16x16x32_bf16 v[76:79], a[204:207], a[176:179], v[76:79]
v_mul_f32 v13, v13, v221
v_mfma_f32_16x16x32_bf16 v[76:79], a[228:231], a[180:183], v[76:79]
v_mul_f32 v14, v14, v222
v_mfma_f32_16x16x32_bf16 v[44:47], a[228:231], a[184:187], v[44:47]
global_load_dwordx4 a[228:231], v0, s[72:73] offset:2048
v_mfma_f32_16x16x32_bf16 v[44:47], a[204:207], a[188:191], v[44:47]
v_mul_f32 v15, v15, v223
s_waitcnt vmcnt(10)
v_mfma_f32_16x16x32_bf16 v[48:51], a[196:199], a[188:191], v[48:51]
v_cvt_pk_bf16_f32 v18, v12, v13
v_cvt_pk_bf16_f32 v19, v14, v15
v_mfma_f32_16x16x32_bf16 v[48:51], a[224:227], a[184:187], v[48:51]
v_accvgpr_read_b32 v13, a30
v_mfma_f32_16x16x32_bf16 v[80:83], a[224:227], a[180:183], v[80:83]
global_load_dwordx4 a[204:207], v0, s[74:75] offset:2048
v_mfma_f32_16x16x32_bf16 v[80:83], a[196:199], a[176:179], v[80:83]
v_accvgpr_read_b32 v15, a31
v_lshlrev_b32 v12, 16, v13
v_mfma_f32_16x16x32_bf16 v[112:115], a[196:199], a[172:175], v[112:115]
v_lshlrev_b32 v14, 16, v15
v_mfma_f32_16x16x32_bf16 v[112:115], a[224:227], a[168:171], v[112:115]
v_and_b32 v13, s53, v13
v_and_b32 v15, s53, v15
v_mfma_f32_16x16x32_bf16 v[144:147], a[224:227], a[164:167], v[144:147]
ds_write_b128 v3, v[16:19] offset:6144
v_mfma_f32_16x16x32_bf16 v[144:147], a[196:199], a[160:163], v[144:147]
v_mul_f32 v8, v8, v248
v_mfma_f32_16x16x32_bf16 v[176:179], a[196:199], a[156:159], v[176:179]
v_mul_f32 v9, v9, v249
v_mul_f32 v10, v10, v250
v_mfma_f32_16x16x32_bf16 v[176:179], a[224:227], a[152:155], v[176:179]
v_mul_f32 v11, v11, v251
v_cvt_pk_bf16_f32 v20, v8, v9
v_mfma_f32_16x16x32_bf16 v[208:211], a[224:227], a[148:151], v[208:211]
v_cvt_pk_bf16_f32 v21, v10, v11
v_mfma_f32_16x16x32_bf16 v[208:211], a[196:199], a[144:147], v[208:211]
buffer_store_dwordx4 v[16:19], v0, s[24:27], s60 offen offset:2048 sc1
v_mfma_f32_16x16x32_bf16 v[240:243], a[196:199], a[140:143], v[240:243]
v_mul_f32 v12, v12, v252
v_mfma_f32_16x16x32_bf16 v[240:243], a[224:227], a[136:139], v[240:243]
v_mul_f32 v13, v13, v253
v_mfma_f32_16x16x32_bf16 a[248:251], a[224:227], a[132:135], a[248:251]
global_load_dwordx4 a[224:227], v0, s[72:73] offset:3072
v_mfma_f32_16x16x32_bf16 a[248:251], a[196:199], a[128:131], a[248:251]
v_add_u32 v2, 131072, v0
v_mul_f32 v14, v14, v254
s_waitcnt vmcnt(10)
v_mfma_f32_16x16x32_bf16 a[252:255], a[212:215], a[128:131], a[252:255]
ds_read_b128 a[128:131], v2 offset:0
v_mfma_f32_16x16x32_bf16 a[252:255], a[216:219], a[132:135], a[252:255]
ds_read_b128 a[132:135], v2 offset:8192
v_mul_f32 v15, v15, v255
v_mfma_f32_16x16x32_bf16 v[244:247], a[216:219], a[136:139], v[244:247]
ds_read_b128 a[136:139], v2 offset:9216
v_cvt_pk_bf16_f32 v22, v12, v13
v_mfma_f32_16x16x32_bf16 v[244:247], a[212:215], a[140:143], v[244:247]
ds_read_b128 a[140:143], v2 offset:1024
v_cvt_pk_bf16_f32 v23, v14, v15
v_mfma_f32_16x16x32_bf16 v[212:215], a[212:215], a[144:147], v[212:215]
ds_read_b128 a[144:147], v2 offset:2048
v_mfma_f32_16x16x32_bf16 v[212:215], a[216:219], a[148:151], v[212:215]
ds_read_b128 a[148:151], v2 offset:10240
v_mfma_f32_16x16x32_bf16 v[180:183], a[216:219], a[152:155], v[180:183]
ds_read_b128 a[152:155], v2 offset:11264
v_mfma_f32_16x16x32_bf16 v[180:183], a[212:215], a[156:159], v[180:183]
ds_read_b128 a[156:159], v2 offset:3072
v_mfma_f32_16x16x32_bf16 v[148:151], a[212:215], a[160:163], v[148:151]
ds_read_b128 a[160:163], v2 offset:4096
v_mfma_f32_16x16x32_bf16 v[148:151], a[216:219], a[164:167], v[148:151]
ds_read_b128 a[164:167], v2 offset:12288
v_mfma_f32_16x16x32_bf16 v[116:119], a[216:219], a[168:171], v[116:119]
ds_read_b128 a[168:171], v2 offset:13312
v_accvgpr_read_b32 v9, a32
v_mfma_f32_16x16x32_bf16 v[116:119], a[212:215], a[172:175], v[116:119]
ds_read_b128 a[172:175], v2 offset:5120
v_accvgpr_read_b32 v11, a33
v_mfma_f32_16x16x32_bf16 v[84:87], a[212:215], a[176:179], v[84:87]
ds_read_b128 a[176:179], v2 offset:6144
v_lshlrev_b32 v8, 16, v9
v_mfma_f32_16x16x32_bf16 v[84:87], a[216:219], a[180:183], v[84:87]
ds_read_b128 a[180:183], v2 offset:14336
v_lshlrev_b32 v10, 16, v11
v_mfma_f32_16x16x32_bf16 v[52:55], a[216:219], a[184:187], v[52:55]
ds_read_b128 a[184:187], v2 offset:15360
v_and_b32 v9, s53, v9
v_mfma_f32_16x16x32_bf16 v[52:55], a[212:215], a[188:191], v[52:55]
ds_read_b128 a[188:191], v2 offset:7168
s_waitcnt vmcnt(7) lgkmcnt(12)
v_mfma_f32_16x16x32_bf16 v[40:43], a[192:195], a[128:131], v[40:43]
global_load_dwordx4 a[196:199], v0, s[74:75] offset:3072
v_mfma_f32_16x16x32_bf16 v[40:43], a[208:211], a[132:135], v[40:43]
s_add_u32 s72, s12, 339968
s_addc_u32 s73, s13, 0
v_mfma_f32_16x16x32_bf16 v[72:75], a[208:211], a[136:139], v[72:75]
s_add_u32 s74, s12, 372736
s_addc_u32 s75, s13, 0
v_mfma_f32_16x16x32_bf16 v[72:75], a[192:195], a[140:143], v[72:75]
v_and_b32 v11, s53, v11
s_waitcnt lgkmcnt(8)
v_mfma_f32_16x16x32_bf16 v[104:107], a[192:195], a[144:147], v[104:107]
global_load_dwordx4 a[216:219], v0, s[72:73] offset:0
v_mfma_f32_16x16x32_bf16 v[104:107], a[208:211], a[148:151], v[104:107]
ds_write_b128 v3, v[20:23] offset:7168
v_mfma_f32_16x16x32_bf16 v[136:139], a[208:211], a[152:155], v[136:139]
buffer_store_dwordx4 v[20:23], v0, s[24:27], s60 offen offset:3072 sc1
v_mfma_f32_16x16x32_bf16 v[136:139], a[192:195], a[156:159], v[136:139]
s_waitcnt lgkmcnt(5)
v_mfma_f32_16x16x32_bf16 v[168:171], a[192:195], a[160:163], v[168:171]
global_load_dwordx4 a[212:215], v0, s[74:75] offset:0
v_mfma_f32_16x16x32_bf16 v[168:171], a[208:211], a[164:167], v[168:171]
v_accvgpr_read_b32 v13, a34
v_accvgpr_read_b32 v15, a35
v_mfma_f32_16x16x32_bf16 v[200:203], a[208:211], a[168:171], v[200:203]
v_lshlrev_b32 v12, 16, v13
v_lshlrev_b32 v14, 16, v15
v_mfma_f32_16x16x32_bf16 v[200:203], a[192:195], a[172:175], v[200:203]
v_and_b32 v13, s53, v13
v_and_b32 v15, s53, v15
s_waitcnt lgkmcnt(1)
v_mfma_f32_16x16x32_bf16 v[232:235], a[192:195], a[176:179], v[232:235]
s_add_u32 s54, s57, 98304
v_add_u32 v3, s54, v0
v_mfma_f32_16x16x32_bf16 v[232:235], a[208:211], a[180:183], v[232:235]
v_mul_f32 v8, v8, v32
v_mfma_f32_16x16x32_bf16 a[240:243], a[208:211], a[184:187], a[240:243]
global_load_dwordx4 a[208:211], v0, s[72:73] offset:1024
v_mfma_f32_16x16x32_bf16 a[240:243], a[192:195], a[188:191], a[240:243]
v_mul_f32 v9, v9, v33
s_waitcnt vmcnt(10)
v_mfma_f32_16x16x32_bf16 a[244:247], a[220:223], a[188:191], a[244:247]
v_mul_f32 v10, v10, v34
v_mul_f32 v11, v11, v35
v_mfma_f32_16x16x32_bf16 a[244:247], a[200:203], a[184:187], a[244:247]
v_cvt_pk_bf16_f32 v16, v8, v9
v_mfma_f32_16x16x32_bf16 v[236:239], a[200:203], a[180:183], v[236:239]
global_load_dwordx4 a[192:195], v0, s[74:75] offset:1024
v_mfma_f32_16x16x32_bf16 v[236:239], a[220:223], a[176:179], v[236:239]
v_cvt_pk_bf16_f32 v17, v10, v11
v_accvgpr_read_b32 v9, a36
v_mfma_f32_16x16x32_bf16 v[204:207], a[220:223], a[172:175], v[204:207]
v_accvgpr_read_b32 v11, a37
v_lshlrev_b32 v8, 16, v9
v_mfma_f32_16x16x32_bf16 v[204:207], a[200:203], a[168:171], v[204:207]
v_lshlrev_b32 v10, 16, v11
v_and_b32 v9, s53, v9
v_mfma_f32_16x16x32_bf16 v[172:175], a[200:203], a[164:167], v[172:175]
v_and_b32 v11, s53, v11
v_mul_f32 v12, v12, v36
v_mfma_f32_16x16x32_bf16 v[172:175], a[220:223], a[160:163], v[172:175]
v_mul_f32 v13, v13, v37
v_mul_f32 v14, v14, v38
v_mfma_f32_16x16x32_bf16 v[140:143], a[220:223], a[156:159], v[140:143]
v_mul_f32 v15, v15, v39
v_cvt_pk_bf16_f32 v18, v12, v13
v_mfma_f32_16x16x32_bf16 v[140:143], a[200:203], a[152:155], v[140:143]
v_cvt_pk_bf16_f32 v19, v14, v15
v_accvgpr_read_b32 v13, a38
v_mfma_f32_16x16x32_bf16 v[108:111], a[200:203], a[148:151], v[108:111]
v_accvgpr_read_b32 v15, a39
v_lshlrev_b32 v12, 16, v13
v_mfma_f32_16x16x32_bf16 v[108:111], a[220:223], a[144:147], v[108:111]
v_lshlrev_b32 v14, 16, v15
v_and_b32 v13, s53, v13
v_mfma_f32_16x16x32_bf16 v[76:79], a[220:223], a[140:143], v[76:79]
v_and_b32 v15, s53, v15
v_mfma_f32_16x16x32_bf16 v[76:79], a[200:203], a[136:139], v[76:79]
ds_write_b128 v3, v[16:19] offset:0
v_mfma_f32_16x16x32_bf16 v[44:47], a[200:203], a[132:135], v[44:47]
global_load_dwordx4 a[200:203], v0, s[72:73] offset:2048
v_mfma_f32_16x16x32_bf16 v[44:47], a[220:223], a[128:131], v[44:47]
v_mul_f32 v8, v8, v64
v_mul_f32 v9, v9, v65
s_waitcnt vmcnt(9)
v_mfma_f32_16x16x32_bf16 v[48:51], a[228:231], a[128:131], v[48:51]
v_mul_f32 v10, v10, v66
v_mul_f32 v11, v11, v67
v_mfma_f32_16x16x32_bf16 v[48:51], a[204:207], a[132:135], v[48:51]
v_cvt_pk_bf16_f32 v20, v8, v9
v_mfma_f32_16x16x32_bf16 v[80:83], a[204:207], a[136:139], v[80:83]
global_load_dwordx4 a[220:223], v0, s[74:75] offset:2048
v_mfma_f32_16x16x32_bf16 v[80:83], a[228:231], a[140:143], v[80:83]
v_cvt_pk_bf16_f32 v21, v10, v11
v_accvgpr_read_b32 v9, a40
v_mfma_f32_16x16x32_bf16 v[112:115], a[228:231], a[144:147], v[112:115]
v_accvgpr_read_b32 v11, a41
v_lshlrev_b32 v8, 16, v9
v_mfma_f32_16x16x32_bf16 v[112:115], a[204:207], a[148:151], v[112:115]
v_lshlrev_b32 v10, 16, v11
v_and_b32 v9, s53, v9
v_mfma_f32_16x16x32_bf16 v[144:147], a[204:207], a[152:155], v[144:147]
v_and_b32 v11, s53, v11
s_mov_b32 s60, 163840
v_mfma_f32_16x16x32_bf16 v[144:147], a[228:231], a[156:159], v[144:147]
buffer_store_dwordx4 v[16:19], v0, s[24:27], s60 offen offset:0 sc1
v_mfma_f32_16x16x32_bf16 v[176:179], a[228:231], a[160:163], v[176:179]
v_mul_f32 v12, v12, v68
v_mul_f32 v13, v13, v69
v_mfma_f32_16x16x32_bf16 v[176:179], a[204:207], a[164:167], v[176:179]
v_mul_f32 v14, v14, v70
v_mul_f32 v15, v15, v71
v_mfma_f32_16x16x32_bf16 v[208:211], a[204:207], a[168:171], v[208:211]
v_cvt_pk_bf16_f32 v22, v12, v13
v_cvt_pk_bf16_f32 v23, v14, v15
v_mfma_f32_16x16x32_bf16 v[208:211], a[228:231], a[172:175], v[208:211]
v_accvgpr_read_b32 v13, a42
v_accvgpr_read_b32 v15, a43
v_mfma_f32_16x16x32_bf16 v[240:243], a[228:231], a[176:179], v[240:243]
v_lshlrev_b32 v12, 16, v13
v_lshlrev_b32 v14, 16, v15
v_mfma_f32_16x16x32_bf16 v[240:243], a[204:207], a[180:183], v[240:243]
v_and_b32 v13, s53, v13
v_mfma_f32_16x16x32_bf16 a[248:251], a[204:207], a[184:187], a[248:251]
global_load_dwordx4 a[204:207], v0, s[72:73] offset:3072
v_mfma_f32_16x16x32_bf16 a[248:251], a[228:231], a[188:191], a[248:251]
v_and_b32 v15, s53, v15
s_waitcnt vmcnt(9)
v_mfma_f32_16x16x32_bf16 a[252:255], a[224:227], a[188:191], a[252:255]
ds_read_b128 a[188:191], v2 offset:16384
v_mfma_f32_16x16x32_bf16 a[252:255], a[196:199], a[184:187], a[252:255]
ds_read_b128 a[184:187], v2 offset:24576
v_mfma_f32_16x16x32_bf16 v[244:247], a[196:199], a[180:183], v[244:247]
ds_read_b128 a[180:183], v2 offset:25600
v_mul_f32 v8, v8, v96
v_mfma_f32_16x16x32_bf16 v[244:247], a[224:227], a[176:179], v[244:247]
ds_read_b128 a[176:179], v2 offset:17408
v_mul_f32 v9, v9, v97
v_mfma_f32_16x16x32_bf16 v[212:215], a[224:227], a[172:175], v[212:215]
ds_read_b128 a[172:175], v2 offset:18432
v_mul_f32 v10, v10, v98
v_mfma_f32_16x16x32_bf16 v[212:215], a[196:199], a[168:171], v[212:215]
ds_read_b128 a[168:171], v2 offset:26624
v_mul_f32 v11, v11, v99
v_mfma_f32_16x16x32_bf16 v[180:183], a[196:199], a[164:167], v[180:183]
ds_read_b128 a[164:167], v2 offset:27648
v_cvt_pk_bf16_f32 v16, v8, v9
v_mfma_f32_16x16x32_bf16 v[180:183], a[224:227], a[160:163], v[180:183]
ds_read_b128 a[160:163], v2 offset:19456
v_cvt_pk_bf16_f32 v17, v10, v11
v_mfma_f32_16x16x32_bf16 v[148:151], a[224:227], a[156:159], v[148:151]
ds_read_b128 a[156:159], v2 offset:20480
v_accvgpr_read_b32 v9, a44
v_mfma_f32_16x16x32_bf16 v[148:151], a[196:199], a[152:155], v[148:151]
ds_read_b128 a[152:155], v2 offset:28672
v_accvgpr_read_b32 v11, a45
v_mfma_f32_16x16x32_bf16 v[116:119], a[196:199], a[148:151], v[116:119]
ds_read_b128 a[148:151], v2 offset:29696
s_mov_b32 s38, 516
v_mfma_f32_16x16x32_bf16 v[116:119], a[224:227], a[144:147], v[116:119]
ds_read_b128 a[144:147], v2 offset:21504
s_waitcnt vmcnt(7)
v_mfma_f32_16x16x32_bf16 v[84:87], a[224:227], a[140:143], v[84:87]
ds_read_b128 a[140:143], v2 offset:22528
v_lshlrev_b32 v8, 16, v9
v_mfma_f32_16x16x32_bf16 v[84:87], a[196:199], a[136:139], v[84:87]
ds_read_b128 a[136:139], v2 offset:30720
v_lshlrev_b32 v10, 16, v11
v_mfma_f32_16x16x32_bf16 v[52:55], a[196:199], a[132:135], v[52:55]
ds_read_b128 a[132:135], v2 offset:31744
v_and_b32 v9, s53, v9
v_mfma_f32_16x16x32_bf16 v[52:55], a[224:227], a[128:131], v[52:55]
ds_read_b128 a[128:131], v2 offset:23552
s_waitcnt vmcnt(6) lgkmcnt(12)
v_mfma_f32_16x16x32_bf16 v[40:43], a[216:219], a[188:191], v[40:43]
global_load_dwordx4 a[228:231], v0, s[74:75] offset:3072
v_mfma_f32_16x16x32_bf16 v[40:43], a[212:215], a[184:187], v[40:43]
s_add_u32 s72, s12, 282624
s_addc_u32 s73, s13, 0
buffer_store_dword v6, v0, s[36:39], 0 offen offset:512 sc1
v_mfma_f32_16x16x32_bf16 v[72:75], a[212:215], a[180:183], v[72:75]
L_pad14:
s_cbranch_execz L_tret0
s_add_u32 s74, s12, 315392
s_addc_u32 s75, s13, 0
v_mfma_f32_16x16x32_bf16 v[72:75], a[216:219], a[176:179], v[72:75]
v_and_b32 v11, s53, v11
s_waitcnt lgkmcnt(8)
v_mfma_f32_16x16x32_bf16 v[104:107], a[216:219], a[172:175], v[104:107]
global_load_dwordx4 a[196:199], v0, s[72:73] offset:0
v_mfma_f32_16x16x32_bf16 v[104:107], a[212:215], a[168:171], v[104:107]
ds_write_b128 v3, v[20:23] offset:1024
v_mfma_f32_16x16x32_bf16 v[136:139], a[212:215], a[164:167], v[136:139]
buffer_store_dwordx4 v[20:23], v0, s[24:27], s60 offen offset:1024 sc1
v_mfma_f32_16x16x32_bf16 v[136:139], a[216:219], a[160:163], v[136:139]
v_mul_f32 v12, v12, v100
s_waitcnt lgkmcnt(5)
v_mfma_f32_16x16x32_bf16 v[168:171], a[216:219], a[156:159], v[168:171]
global_load_dwordx4 a[224:227], v0, s[74:75] offset:0
v_mfma_f32_16x16x32_bf16 v[168:171], a[212:215], a[152:155], v[168:171]
v_mul_f32 v13, v13, v101
v_mul_f32 v14, v14, v102
v_mfma_f32_16x16x32_bf16 v[200:203], a[212:215], a[148:151], v[200:203]
v_mul_f32 v15, v15, v103
v_cvt_pk_bf16_f32 v18, v12, v13
v_mfma_f32_16x16x32_bf16 v[200:203], a[216:219], a[144:147], v[200:203]
v_cvt_pk_bf16_f32 v19, v14, v15
v_accvgpr_read_b32 v13, a46
s_waitcnt lgkmcnt(1)
v_mfma_f32_16x16x32_bf16 v[232:235], a[216:219], a[140:143], v[232:235]
v_accvgpr_read_b32 v15, a47
v_lshlrev_b32 v12, 16, v13
v_mfma_f32_16x16x32_bf16 v[232:235], a[212:215], a[136:139], v[232:235]
v_lshlrev_b32 v14, 16, v15
v_mfma_f32_16x16x32_bf16 a[240:243], a[212:215], a[132:135], a[240:243]
global_load_dwordx4 a[212:215], v0, s[72:73] offset:1024
v_mfma_f32_16x16x32_bf16 a[240:243], a[216:219], a[128:131], a[240:243]
v_and_b32 v13, s53, v13
s_waitcnt vmcnt(10)
v_mfma_f32_16x16x32_bf16 a[244:247], a[208:211], a[128:131], a[244:247]
v_and_b32 v15, s53, v15
v_mfma_f32_16x16x32_bf16 a[244:247], a[192:195], a[132:135], a[244:247]
ds_write_b128 v3, v[16:19] offset:2048
v_mfma_f32_16x16x32_bf16 v[236:239], a[192:195], a[136:139], v[236:239]
global_load_dwordx4 a[216:219], v0, s[74:75] offset:1024
v_mfma_f32_16x16x32_bf16 v[236:239], a[208:211], a[140:143], v[236:239]
v_mul_f32 v8, v8, v128
v_mul_f32 v9, v9, v129
v_mfma_f32_16x16x32_bf16 v[204:207], a[208:211], a[144:147], v[204:207]
v_mul_f32 v10, v10, v130
v_mul_f32 v11, v11, v131
v_mfma_f32_16x16x32_bf16 v[204:207], a[192:195], a[148:151], v[204:207]
v_cvt_pk_bf16_f32 v20, v8, v9
v_cvt_pk_bf16_f32 v21, v10, v11
v_mfma_f32_16x16x32_bf16 v[172:175], a[192:195], a[152:155], v[172:175]
v_accvgpr_read_b32 v9, a48
v_accvgpr_read_b32 v11, a49
v_mfma_f32_16x16x32_bf16 v[172:175], a[208:211], a[156:159], v[172:175]
v_lshlrev_b32 v8, 16, v9
v_lshlrev_b32 v10, 16, v11
v_mfma_f32_16x16x32_bf16 v[140:143], a[208:211], a[160:163], v[140:143]
v_and_b32 v9, s53, v9
v_and_b32 v11, s53, v11
v_mfma_f32_16x16x32_bf16 v[140:143], a[192:195], a[164:167], v[140:143]
buffer_store_dwordx4 v[16:19], v0, s[24:27], s60 offen offset:2048 sc1
v_mfma_f32_16x16x32_bf16 v[108:111], a[192:195], a[168:171], v[108:111]
v_mul_f32 v12, v12, v132
v_mul_f32 v13, v13, v133
v_mfma_f32_16x16x32_bf16 v[108:111], a[208:211], a[172:175], v[108:111]
v_mul_f32 v14, v14, v134
v_mul_f32 v15, v15, v135
v_mfma_f32_16x16x32_bf16 v[76:79], a[208:211], a[176:179], v[76:79]
v_cvt_pk_bf16_f32 v22, v12, v13
v_cvt_pk_bf16_f32 v23, v14, v15
v_mfma_f32_16x16x32_bf16 v[76:79], a[192:195], a[180:183], v[76:79]
v_accvgpr_read_b32 v13, a50
v_mfma_f32_16x16x32_bf16 v[44:47], a[192:195], a[184:187], v[44:47]
global_load_dwordx4 a[192:195], v0, s[72:73] offset:2048
v_mfma_f32_16x16x32_bf16 v[44:47], a[208:211], a[188:191], v[44:47]
v_accvgpr_read_b32 v15, a51
s_waitcnt vmcnt(11)
v_mfma_f32_16x16x32_bf16 v[48:51], a[200:203], a[188:191], v[48:51]
v_lshlrev_b32 v12, 16, v13
v_lshlrev_b32 v14, 16, v15
v_mfma_f32_16x16x32_bf16 v[48:51], a[220:223], a[184:187], v[48:51]
v_and_b32 v13, s53, v13
v_mfma_f32_16x16x32_bf16 v[80:83], a[220:223], a[180:183], v[80:83]
global_load_dwordx4 a[208:211], v0, s[74:75] offset:2048
v_mfma_f32_16x16x32_bf16 v[80:83], a[200:203], a[176:179], v[80:83]
v_and_b32 v15, s53, v15
v_mfma_f32_16x16x32_bf16 v[112:115], a[200:203], a[172:175], v[112:115]
ds_write_b128 v3, v[20:23] offset:3072
v_mfma_f32_16x16x32_bf16 v[112:115], a[220:223], a[168:171], v[112:115]
v_mul_f32 v8, v8, v160
v_mul_f32 v9, v9, v161
v_mfma_f32_16x16x32_bf16 v[144:147], a[220:223], a[164:167], v[144:147]
v_mul_f32 v10, v10, v162
v_mul_f32 v11, v11, v163
v_mfma_f32_16x16x32_bf16 v[144:147], a[200:203], a[160:163], v[144:147]
v_cvt_pk_bf16_f32 v16, v8, v9
v_cvt_pk_bf16_f32 v17, v10, v11
v_mfma_f32_16x16x32_bf16 v[176:179], a[200:203], a[156:159], v[176:179]
v_accvgpr_read_b32 v9, a52
v_accvgpr_read_b32 v11, a53
v_mfma_f32_16x16x32_bf16 v[176:179], a[220:223], a[152:155], v[176:179]
v_lshlrev_b32 v8, 16, v9
v_lshlrev_b32 v10, 16, v11
v_mfma_f32_16x16x32_bf16 v[208:211], a[220:223], a[148:151], v[208:211]
v_and_b32 v9, s53, v9
v_and_b32 v11, s53, v11
v_mfma_f32_16x16x32_bf16 v[208:211], a[200:203], a[144:147], v[208:211]
buffer_store_dwordx4 v[20:23], v0, s[24:27], s60 offen offset:3072 sc1
v_mfma_f32_16x16x32_bf16 v[240:243], a[200:203], a[140:143], v[240:243]
v_mul_f32 v12, v12, v164
v_mul_f32 v13, v13, v165
v_mfma_f32_16x16x32_bf16 v[240:243], a[220:223], a[136:139], v[240:243]
v_mul_f32 v14, v14, v166
v_mfma_f32_16x16x32_bf16 a[248:251], a[220:223], a[132:135], a[248:251]
global_load_dwordx4 a[220:223], v0, s[72:73] offset:3072
v_mfma_f32_16x16x32_bf16 a[248:251], a[200:203], a[128:131], a[248:251]
v_add_u32 v2, 0, v0
v_mul_f32 v15, v15, v167
s_waitcnt vmcnt(11)
v_mfma_f32_16x16x32_bf16 a[252:255], a[204:207], a[128:131], a[252:255]
ds_read_b128 a[128:131], v2 offset:0
v_cvt_pk_bf16_f32 v18, v12, v13
v_mfma_f32_16x16x32_bf16 a[252:255], a[228:231], a[132:135], a[252:255]
ds_read_b128 a[132:135], v2 offset:8192
v_cvt_pk_bf16_f32 v19, v14, v15
v_mfma_f32_16x16x32_bf16 v[244:247], a[228:231], a[136:139], v[244:247]
ds_read_b128 a[136:139], v2 offset:9216
v_accvgpr_read_b32 v13, a54
v_mfma_f32_16x16x32_bf16 v[244:247], a[204:207], a[140:143], v[244:247]
ds_read_b128 a[140:143], v2 offset:1024
v_accvgpr_read_b32 v15, a55
v_mfma_f32_16x16x32_bf16 v[212:215], a[204:207], a[144:147], v[212:215]
ds_read_b128 a[144:147], v2 offset:2048
v_lshlrev_b32 v12, 16, v13
v_mfma_f32_16x16x32_bf16 v[212:215], a[228:231], a[148:151], v[212:215]
ds_read_b128 a[148:151], v2 offset:10240
v_lshlrev_b32 v14, 16, v15
v_mfma_f32_16x16x32_bf16 v[180:183], a[228:231], a[152:155], v[180:183]
ds_read_b128 a[152:155], v2 offset:11264
v_and_b32 v13, s53, v13
v_mfma_f32_16x16x32_bf16 v[180:183], a[204:207], a[156:159], v[180:183]
ds_read_b128 a[156:159], v2 offset:3072
v_and_b32 v15, s53, v15
v_mfma_f32_16x16x32_bf16 v[148:151], a[204:207], a[160:163], v[148:151]
ds_read_b128 a[160:163], v2 offset:4096
v_mfma_f32_16x16x32_bf16 v[148:151], a[228:231], a[164:167], v[148:151]
ds_read_b128 a[164:167], v2 offset:12288
v_mfma_f32_16x16x32_bf16 v[116:119], a[228:231], a[168:171], v[116:119]
ds_read_b128 a[168:171], v2 offset:13312
v_mul_f32 v8, v8, v192
v_mfma_f32_16x16x32_bf16 v[116:119], a[204:207], a[172:175], v[116:119]
ds_read_b128 a[172:175], v2 offset:5120
v_mul_f32 v9, v9, v193
v_mfma_f32_16x16x32_bf16 v[84:87], a[204:207], a[176:179], v[84:87]
ds_read_b128 a[176:179], v2 offset:6144
v_mul_f32 v10, v10, v194
v_mfma_f32_16x16x32_bf16 v[84:87], a[228:231], a[180:183], v[84:87]
ds_read_b128 a[180:183], v2 offset:14336
v_mul_f32 v11, v11, v195
v_mfma_f32_16x16x32_bf16 v[52:55], a[228:231], a[184:187], v[52:55]
ds_read_b128 a[184:187], v2 offset:15360
v_cvt_pk_bf16_f32 v20, v8, v9
v_mfma_f32_16x16x32_bf16 v[52:55], a[204:207], a[188:191], v[52:55]
ds_read_b128 a[188:191], v2 offset:7168
s_waitcnt vmcnt(7) lgkmcnt(12)
v_mfma_f32_16x16x32_bf16 v[40:43], a[196:199], a[128:131], v[40:43]
global_load_dwordx4 a[200:203], v0, s[74:75] offset:3072
v_mfma_f32_16x16x32_bf16 v[40:43], a[224:227], a[132:135], v[40:43]
s_add_u32 s72, s12, 348160
s_addc_u32 s73, s13, 0
v_mfma_f32_16x16x32_bf16 v[72:75], a[224:227], a[136:139], v[72:75]
s_add_u32 s74, s12, 380928
s_addc_u32 s75, s13, 0
v_mfma_f32_16x16x32_bf16 v[72:75], a[196:199], a[140:143], v[72:75]
s_waitcnt lgkmcnt(8)
v_mfma_f32_16x16x32_bf16 v[104:107], a[196:199], a[144:147], v[104:107]
global_load_dwordx4 a[228:231], v0, s[72:73] offset:0
v_mfma_f32_16x16x32_bf16 v[104:107], a[224:227], a[148:151], v[104:107]
ds_write_b128 v3, v[16:19] offset:4096
v_mfma_f32_16x16x32_bf16 v[136:139], a[224:227], a[152:155], v[136:139]
v_cvt_pk_bf16_f32 v21, v10, v11
v_accvgpr_read_b32 v9, a56
v_mfma_f32_16x16x32_bf16 v[136:139], a[196:199], a[156:159], v[136:139]
v_accvgpr_read_b32 v11, a57
s_waitcnt lgkmcnt(5)
v_mfma_f32_16x16x32_bf16 v[168:171], a[196:199], a[160:163], v[168:171]
global_load_dwordx4 a[204:207], v0, s[74:75] offset:0
v_mfma_f32_16x16x32_bf16 v[168:171], a[224:227], a[164:167], v[168:171]
v_lshlrev_b32 v8, 16, v9
v_lshlrev_b32 v10, 16, v11
v_mfma_f32_16x16x32_bf16 v[200:203], a[224:227], a[168:171], v[200:203]
v_and_b32 v9, s53, v9
v_and_b32 v11, s53, v11
s_mov_b32 s60, 167936
v_mfma_f32_16x16x32_bf16 v[200:203], a[196:199], a[172:175], v[200:203]
s_waitcnt lgkmcnt(1)
v_mfma_f32_16x16x32_bf16 v[232:235], a[196:199], a[176:179], v[232:235]
v_mul_f32 v12, v12, v196
v_mfma_f32_16x16x32_bf16 v[232:235], a[224:227], a[180:183], v[232:235]
buffer_store_dwordx4 v[16:19], v0, s[24:27], s60 offen offset:0 sc1
v_mfma_f32_16x16x32_bf16 a[240:243], a[224:227], a[184:187], a[240:243]
global_load_dwordx4 a[224:227], v0, s[72:73] offset:1024
v_mfma_f32_16x16x32_bf16 a[240:243], a[196:199], a[188:191], a[240:243]
v_mul_f32 v13, v13, v197
v_mul_f32 v14, v14, v198
s_waitcnt vmcnt(10)
v_mfma_f32_16x16x32_bf16 a[244:247], a[212:215], a[188:191], a[244:247]
v_mul_f32 v15, v15, v199
v_cvt_pk_bf16_f32 v22, v12, v13
v_mfma_f32_16x16x32_bf16 a[244:247], a[216:219], a[184:187], a[244:247]
v_cvt_pk_bf16_f32 v23, v14, v15
v_mfma_f32_16x16x32_bf16 v[236:239], a[216:219], a[180:183], v[236:239]
global_load_dwordx4 a[196:199], v0, s[74:75] offset:1024
v_mfma_f32_16x16x32_bf16 v[236:239], a[212:215], a[176:179], v[236:239]
v_accvgpr_read_b32 v13, a58
v_accvgpr_read_b32 v15, a59
v_mfma_f32_16x16x32_bf16 v[204:207], a[212:215], a[172:175], v[204:207]
v_lshlrev_b32 v12, 16, v13
v_lshlrev_b32 v14, 16, v15
v_mfma_f32_16x16x32_bf16 v[204:207], a[216:219], a[168:171], v[204:207]
v_and_b32 v13, s53, v13
v_and_b32 v15, s53, v15
v_mfma_f32_16x16x32_bf16 v[172:175], a[216:219], a[164:167], v[172:175]
ds_write_b128 v3, v[20:23] offset:5120
v_mfma_f32_16x16x32_bf16 v[172:175], a[212:215], a[160:163], v[172:175]
v_mul_f32 v8, v8, v224
v_mul_f32 v9, v9, v225
v_mfma_f32_16x16x32_bf16 v[140:143], a[212:215], a[156:159], v[140:143]
v_mul_f32 v10, v10, v226
v_mul_f32 v11, v11, v227
v_mfma_f32_16x16x32_bf16 v[140:143], a[216:219], a[152:155], v[140:143]
v_cvt_pk_bf16_f32 v16, v8, v9
v_cvt_pk_bf16_f32 v17, v10, v11
v_mfma_f32_16x16x32_bf16 v[108:111], a[216:219], a[148:151], v[108:111]
v_accvgpr_read_b32 v9, a60
v_accvgpr_read_b32 v11, a61
v_mfma_f32_16x16x32_bf16 v[108:111], a[212:215], a[144:147], v[108:111]
v_lshlrev_b32 v8, 16, v9
v_lshlrev_b32 v10, 16, v11
v_mfma_f32_16x16x32_bf16 v[76:79], a[212:215], a[140:143], v[76:79]
v_and_b32 v9, s53, v9
v_and_b32 v11, s53, v11
v_mfma_f32_16x16x32_bf16 v[76:79], a[216:219], a[136:139], v[76:79]
buffer_store_dwordx4 v[20:23], v0, s[24:27], s60 offen offset:1024 sc1
v_mfma_f32_16x16x32_bf16 v[44:47], a[216:219], a[132:135], v[44:47]
global_load_dwordx4 a[216:219], v0, s[72:73] offset:2048
v_mfma_f32_16x16x32_bf16 v[44:47], a[212:215], a[128:131], v[44:47]
v_mul_f32 v12, v12, v228
s_waitcnt vmcnt(10)
v_mfma_f32_16x16x32_bf16 v[48:51], a[192:195], a[128:131], v[48:51]
v_mul_f32 v13, v13, v229
v_mul_f32 v14, v14, v230
v_mfma_f32_16x16x32_bf16 v[48:51], a[208:211], a[132:135], v[48:51]
v_mul_f32 v15, v15, v231
v_mfma_f32_16x16x32_bf16 v[80:83], a[208:211], a[136:139], v[80:83]
global_load_dwordx4 a[212:215], v0, s[74:75] offset:2048
v_mfma_f32_16x16x32_bf16 v[80:83], a[192:195], a[140:143], v[80:83]
v_cvt_pk_bf16_f32 v18, v12, v13
v_cvt_pk_bf16_f32 v19, v14, v15
v_mfma_f32_16x16x32_bf16 v[112:115], a[192:195], a[144:147], v[112:115]
v_accvgpr_read_b32 v13, a62
v_accvgpr_read_b32 v15, a63
v_mfma_f32_16x16x32_bf16 v[112:115], a[208:211], a[148:151], v[112:115]
v_lshlrev_b32 v12, 16, v13
v_lshlrev_b32 v14, 16, v15
v_mfma_f32_16x16x32_bf16 v[144:147], a[208:211], a[152:155], v[144:147]
v_and_b32 v13, s53, v13
v_and_b32 v15, s53, v15
v_mfma_f32_16x16x32_bf16 v[144:147], a[192:195], a[156:159], v[144:147]
ds_write_b128 v3, v[16:19] offset:6144
v_mfma_f32_16x16x32_bf16 v[176:179], a[192:195], a[160:163], v[176:179]
v_accvgpr_read_b32 v20, a232
v_accvgpr_read_b32 v21, a233
v_mfma_f32_16x16x32_bf16 v[176:179], a[208:211], a[164:167], v[176:179]
v_mul_f32 v8, v8, v20
v_mul_f32 v9, v9, v21
v_mfma_f32_16x16x32_bf16 v[208:211], a[208:211], a[168:171], v[208:211]
v_accvgpr_read_b32 v20, a234
v_accvgpr_read_b32 v21, a235
v_mfma_f32_16x16x32_bf16 v[208:211], a[192:195], a[172:175], v[208:211]
v_mul_f32 v10, v10, v20
v_mul_f32 v11, v11, v21
v_mfma_f32_16x16x32_bf16 v[240:243], a[192:195], a[176:179], v[240:243]
v_cvt_pk_bf16_f32 v20, v8, v9
v_cvt_pk_bf16_f32 v21, v10, v11
v_mfma_f32_16x16x32_bf16 v[240:243], a[208:211], a[180:183], v[240:243]
buffer_store_dwordx4 v[16:19], v0, s[24:27], s60 offen offset:2048 sc1
v_mfma_f32_16x16x32_bf16 a[248:251], a[208:211], a[184:187], a[248:251]
global_load_dwordx4 a[208:211], v0, s[72:73] offset:3072
v_mfma_f32_16x16x32_bf16 a[248:251], a[192:195], a[188:191], a[248:251]
s_waitcnt vmcnt(10)
v_mfma_f32_16x16x32_bf16 a[252:255], a[220:223], a[188:191], a[252:255]
ds_read_b128 a[188:191], v2 offset:16384
v_accvgpr_read_b32 v22, a236
v_mfma_f32_16x16x32_bf16 a[252:255], a[200:203], a[184:187], a[252:255]
ds_read_b128 a[184:187], v2 offset:24576
v_accvgpr_read_b32 v23, a237
v_mfma_f32_16x16x32_bf16 v[244:247], a[200:203], a[180:183], v[244:247]
ds_read_b128 a[180:183], v2 offset:25600
v_mul_f32 v12, v12, v22
v_mfma_f32_16x16x32_bf16 v[244:247], a[220:223], a[176:179], v[244:247]
ds_read_b128 a[176:179], v2 offset:17408
v_mul_f32 v13, v13, v23
v_mfma_f32_16x16x32_bf16 v[212:215], a[220:223], a[172:175], v[212:215]
ds_read_b128 a[172:175], v2 offset:18432
v_accvgpr_read_b32 v22, a238
v_mfma_f32_16x16x32_bf16 v[212:215], a[200:203], a[168:171], v[212:215]
ds_read_b128 a[168:171], v2 offset:26624
v_accvgpr_read_b32 v23, a239
v_mfma_f32_16x16x32_bf16 v[180:183], a[200:203], a[164:167], v[180:183]
ds_read_b128 a[164:167], v2 offset:27648
v_mul_f32 v14, v14, v22
v_mfma_f32_16x16x32_bf16 v[180:183], a[220:223], a[160:163], v[180:183]
ds_read_b128 a[160:163], v2 offset:19456
v_mul_f32 v15, v15, v23
v_mfma_f32_16x16x32_bf16 v[148:151], a[220:223], a[156:159], v[148:151]
ds_read_b128 a[156:159], v2 offset:20480
v_cvt_pk_bf16_f32 v22, v12, v13
v_mfma_f32_16x16x32_bf16 v[148:151], a[200:203], a[152:155], v[148:151]
ds_read_b128 a[152:155], v2 offset:28672
v_cvt_pk_bf16_f32 v23, v14, v15
v_mfma_f32_16x16x32_bf16 v[116:119], a[200:203], a[148:151], v[116:119]
ds_read_b128 a[148:151], v2 offset:29696
v_mfma_f32_16x16x32_bf16 v[116:119], a[220:223], a[144:147], v[116:119]
ds_read_b128 a[144:147], v2 offset:21504
v_mfma_f32_16x16x32_bf16 v[84:87], a[220:223], a[140:143], v[84:87]
ds_read_b128 a[140:143], v2 offset:22528
v_mfma_f32_16x16x32_bf16 v[84:87], a[200:203], a[136:139], v[84:87]
ds_read_b128 a[136:139], v2 offset:30720
v_mfma_f32_16x16x32_bf16 v[52:55], a[200:203], a[132:135], v[52:55]
ds_read_b128 a[132:135], v2 offset:31744
v_mfma_f32_16x16x32_bf16 v[52:55], a[220:223], a[128:131], v[52:55]
ds_read_b128 a[128:131], v2 offset:23552
s_waitcnt vmcnt(8) lgkmcnt(12)
v_mfma_f32_16x16x32_bf16 v[40:43], a[228:231], a[188:191], v[40:43]
global_load_dwordx4 a[192:195], v0, s[74:75] offset:3072
v_mfma_f32_16x16x32_bf16 v[40:43], a[204:207], a[184:187], v[40:43]
s_add_u32 s72, s12, 528384
s_addc_u32 s73, s13, 0
v_mfma_f32_16x16x32_bf16 v[72:75], a[204:207], a[180:183], v[72:75]
s_add_u32 s74, s12, 561152
s_addc_u32 s75, s13, 0
v_mfma_f32_16x16x32_bf16 v[72:75], a[228:231], a[176:179], v[72:75]
s_waitcnt lgkmcnt(8)
v_mfma_f32_16x16x32_bf16 v[104:107], a[228:231], a[172:175], v[104:107]
global_load_dwordx4 a[200:203], v0, s[72:73] offset:-4096
v_mfma_f32_16x16x32_bf16 v[104:107], a[204:207], a[168:171], v[104:107]
ds_write_b128 v3, v[20:23] offset:7168
v_mfma_f32_16x16x32_bf16 v[136:139], a[204:207], a[164:167], v[136:139]
buffer_store_dwordx4 v[20:23], v0, s[24:27], s60 offen offset:3072 sc1
v_mfma_f32_16x16x32_bf16 v[136:139], a[228:231], a[160:163], v[136:139]
s_waitcnt lgkmcnt(5)
v_mfma_f32_16x16x32_bf16 v[168:171], a[228:231], a[156:159], v[168:171]
global_load_dwordx4 a[220:223], v0, s[74:75] offset:-4096
v_mfma_f32_16x16x32_bf16 v[168:171], a[204:207], a[152:155], v[168:171]
v_mfma_f32_16x16x32_bf16 v[200:203], a[204:207], a[148:151], v[200:203]
v_mfma_f32_16x16x32_bf16 v[200:203], a[228:231], a[144:147], v[200:203]
s_waitcnt lgkmcnt(0)
v_mfma_f32_16x16x32_bf16 v[232:235], a[228:231], a[140:143], v[232:235]
s_barrier
v_mfma_f32_16x16x32_bf16 v[232:235], a[204:207], a[136:139], v[232:235]
v_mfma_f32_16x16x32_bf16 a[240:243], a[204:207], a[132:135], a[240:243]
global_load_dwordx4 a[204:207], v0, s[72:73] offset:-3072
v_mfma_f32_16x16x32_bf16 a[240:243], a[228:231], a[128:131], a[240:243]
s_waitcnt vmcnt(10)
v_mfma_f32_16x16x32_bf16 a[244:247], a[224:227], a[128:131], a[244:247]
v_mfma_f32_16x16x32_bf16 a[244:247], a[196:199], a[132:135], a[244:247]
v_mfma_f32_16x16x32_bf16 v[236:239], a[196:199], a[136:139], v[236:239]
global_load_dwordx4 a[228:231], v0, s[74:75] offset:-3072
v_mfma_f32_16x16x32_bf16 v[236:239], a[224:227], a[140:143], v[236:239]
v_mfma_f32_16x16x32_bf16 v[204:207], a[224:227], a[144:147], v[204:207]
v_mfma_f32_16x16x32_bf16 v[204:207], a[196:199], a[148:151], v[204:207]
v_mfma_f32_16x16x32_bf16 v[172:175], a[196:199], a[152:155], v[172:175]
v_mfma_f32_16x16x32_bf16 v[172:175], a[224:227], a[156:159], v[172:175]
v_mfma_f32_16x16x32_bf16 v[140:143], a[224:227], a[160:163], v[140:143]
v_mfma_f32_16x16x32_bf16 v[140:143], a[196:199], a[164:167], v[140:143]
v_mfma_f32_16x16x32_bf16 v[108:111], a[196:199], a[168:171], v[108:111]
v_mfma_f32_16x16x32_bf16 v[108:111], a[224:227], a[172:175], v[108:111]
v_mfma_f32_16x16x32_bf16 v[76:79], a[224:227], a[176:179], v[76:79]
v_mfma_f32_16x16x32_bf16 v[76:79], a[196:199], a[180:183], v[76:79]
v_mfma_f32_16x16x32_bf16 v[44:47], a[196:199], a[184:187], v[44:47]
global_load_dwordx4 a[196:199], v0, s[72:73] offset:-2048
v_mfma_f32_16x16x32_bf16 v[44:47], a[224:227], a[188:191], v[44:47]
s_waitcnt vmcnt(9)
v_mfma_f32_16x16x32_bf16 v[48:51], a[216:219], a[188:191], v[48:51]
v_mfma_f32_16x16x32_bf16 v[48:51], a[212:215], a[184:187], v[48:51]
v_mfma_f32_16x16x32_bf16 v[80:83], a[212:215], a[180:183], v[80:83]
global_load_dwordx4 a[224:227], v0, s[74:75] offset:-2048
v_mfma_f32_16x16x32_bf16 v[80:83], a[216:219], a[176:179], v[80:83]
v_mfma_f32_16x16x32_bf16 v[112:115], a[216:219], a[172:175], v[112:115]
v_mfma_f32_16x16x32_bf16 v[112:115], a[212:215], a[168:171], v[112:115]
v_mfma_f32_16x16x32_bf16 v[144:147], a[212:215], a[164:167], v[144:147]
v_mfma_f32_16x16x32_bf16 v[144:147], a[216:219], a[160:163], v[144:147]
v_mfma_f32_16x16x32_bf16 v[176:179], a[216:219], a[156:159], v[176:179]
v_mfma_f32_16x16x32_bf16 v[176:179], a[212:215], a[152:155], v[176:179]
v_mfma_f32_16x16x32_bf16 v[208:211], a[212:215], a[148:151], v[208:211]
v_mfma_f32_16x16x32_bf16 v[208:211], a[216:219], a[144:147], v[208:211]
v_mfma_f32_16x16x32_bf16 v[240:243], a[216:219], a[140:143], v[240:243]
v_accvgpr_read_b32 v9, a64
v_accvgpr_read_b32 v11, a65
v_mfma_f32_16x16x32_bf16 v[240:243], a[212:215], a[136:139], v[240:243]
v_lshlrev_b32 v8, 16, v9
v_mfma_f32_16x16x32_bf16 a[248:251], a[212:215], a[132:135], a[248:251]
global_load_dwordx4 a[212:215], v0, s[72:73] offset:-1024
v_mfma_f32_16x16x32_bf16 a[248:251], a[216:219], a[128:131], a[248:251]
v_lshlrev_b32 v10, 16, v11
v_and_b32 v9, s53, v9
s_waitcnt vmcnt(8)
v_mfma_f32_16x16x32_bf16 a[252:255], a[208:211], a[128:131], a[252:255]
ds_read_b128 a[128:131], v2 offset:32768
v_and_b32 v11, s53, v11
v_mfma_f32_16x16x32_bf16 a[252:255], a[192:195], a[132:135], a[252:255]
ds_read_b128 a[132:135], v2 offset:40960
v_accvgpr_read_b32 v13, a66
v_mfma_f32_16x16x32_bf16 v[244:247], a[192:195], a[136:139], v[244:247]
ds_read_b128 a[136:139], v2 offset:41984
v_accvgpr_read_b32 v15, a67
v_mfma_f32_16x16x32_bf16 v[244:247], a[208:211], a[140:143], v[244:247]
ds_read_b128 a[140:143], v2 offset:33792
v_lshlrev_b32 v12, 16, v13
v_mfma_f32_16x16x32_bf16 v[212:215], a[208:211], a[144:147], v[212:215]
ds_read_b128 a[144:147], v2 offset:34816
v_lshlrev_b32 v14, 16, v15
v_mfma_f32_16x16x32_bf16 v[212:215], a[192:195], a[148:151], v[212:215]
ds_read_b128 a[148:151], v2 offset:43008
v_and_b32 v13, s53, v13
v_mfma_f32_16x16x32_bf16 v[180:183], a[192:195], a[152:155], v[180:183]
ds_read_b128 a[152:155], v2 offset:44032
v_mfma_f32_16x16x32_bf16 v[180:183], a[208:211], a[156:159], v[180:183]
ds_read_b128 a[156:159], v2 offset:35840
v_and_b32 v15, s53, v15
v_mfma_f32_16x16x32_bf16 v[148:151], a[208:211], a[160:163], v[148:151]
ds_read_b128 a[160:163], v2 offset:36864
s_add_u32 s54, s57, 65536
v_mfma_f32_16x16x32_bf16 v[148:151], a[192:195], a[164:167], v[148:151]
ds_read_b128 a[164:167], v2 offset:45056
v_add_u32 v3, s54, v0
v_mfma_f32_16x16x32_bf16 v[116:119], a[192:195], a[168:171], v[116:119]
ds_read_b128 a[168:171], v2 offset:46080
v_mul_f32 v8, v8, v40
v_mfma_f32_16x16x32_bf16 v[116:119], a[208:211], a[172:175], v[116:119]
ds_read_b128 a[172:175], v2 offset:37888
v_mul_f32 v9, v9, v41
v_mfma_f32_16x16x32_bf16 v[84:87], a[208:211], a[176:179], v[84:87]
ds_read_b128 a[176:179], v2 offset:38912
v_mul_f32 v10, v10, v42
v_mfma_f32_16x16x32_bf16 v[84:87], a[192:195], a[180:183], v[84:87]
ds_read_b128 a[180:183], v2 offset:47104
v_mul_f32 v11, v11, v43
v_mfma_f32_16x16x32_bf16 v[52:55], a[192:195], a[184:187], v[52:55]
ds_read_b128 a[184:187], v2 offset:48128
v_cvt_pk_bf16_f32 v16, v8, v9
v_mfma_f32_16x16x32_bf16 v[52:55], a[208:211], a[188:191], v[52:55]
ds_read_b128 a[188:191], v2 offset:39936
s_waitcnt vmcnt(5) lgkmcnt(12)
v_mfma_f32_16x16x32_bf16 v[24:27], a[200:203], a[128:131], v[24:27]
global_load_dwordx4 a[216:219], v0, s[74:75] offset:-1024
v_mfma_f32_16x16x32_bf16 v[24:27], a[220:223], a[132:135], v[24:27]
s_add_u32 s72, s12, 593920
s_addc_u32 s73, s13, 0
v_mfma_f32_16x16x32_bf16 v[56:59], a[220:223], a[136:139], v[56:59]
s_add_u32 s74, s12, 626688
s_addc_u32 s75, s13, 0
v_mfma_f32_16x16x32_bf16 v[56:59], a[200:203], a[140:143], v[56:59]
v_cvt_pk_bf16_f32 v17, v10, v11
s_waitcnt lgkmcnt(8)
v_mfma_f32_16x16x32_bf16 v[88:91], a[200:203], a[144:147], v[88:91]
global_load_dwordx4 a[192:195], v0, s[72:73] offset:-4096
v_mfma_f32_16x16x32_bf16 v[88:91], a[220:223], a[148:151], v[88:91]
v_accvgpr_read_b32 v9, a68
v_accvgpr_read_b32 v11, a69
v_mfma_f32_16x16x32_bf16 v[120:123], a[220:223], a[152:155], v[120:123]
v_lshlrev_b32 v8, 16, v9
v_lshlrev_b32 v10, 16, v11
v_mfma_f32_16x16x32_bf16 v[120:123], a[200:203], a[156:159], v[120:123]
s_waitcnt lgkmcnt(4)
v_mfma_f32_16x16x32_bf16 v[152:155], a[200:203], a[160:163], v[152:155]
global_load_dwordx4 a[208:211], v0, s[74:75] offset:-4096
v_mfma_f32_16x16x32_bf16 v[152:155], a[220:223], a[164:167], v[152:155]
s_mov_b32 s38, 644
v_and_b32 v9, s53, v9
v_mfma_f32_16x16x32_bf16 v[184:187], a[220:223], a[168:171], v[184:187]
buffer_store_dword v6, v0, s[36:39], 0 offen offset:640 sc1
v_mfma_f32_16x16x32_bf16 v[184:187], a[200:203], a[172:175], v[184:187]
v_and_b32 v11, s53, v11
v_mul_f32 v12, v12, v44
s_waitcnt lgkmcnt(0)
v_mfma_f32_16x16x32_bf16 v[216:219], a[200:203], a[176:179], v[216:219]
v_mul_f32 v13, v13, v45
v_mfma_f32_16x16x32_bf16 v[216:219], a[220:223], a[180:183], v[216:219]
v_mul_f32 v14, v14, v46
v_mfma_f32_16x16x32_bf16 v[248:251], a[220:223], a[184:187], v[248:251]
global_load_dwordx4 a[220:223], v0, s[72:73] offset:-3072
v_mfma_f32_16x16x32_bf16 v[248:251], a[200:203], a[188:191], v[248:251]
v_mul_f32 v15, v15, v47
v_cvt_pk_bf16_f32 v18, v12, v13
s_waitcnt vmcnt(8)
v_mfma_f32_16x16x32_bf16 v[252:255], a[204:207], a[188:191], v[252:255]
v_cvt_pk_bf16_f32 v19, v14, v15
v_mfma_f32_16x16x32_bf16 v[252:255], a[228:231], a[184:187], v[252:255]
v_accvgpr_read_b32 v13, a70
v_mfma_f32_16x16x32_bf16 v[220:223], a[228:231], a[180:183], v[220:223]
global_load_dwordx4 a[200:203], v0, s[74:75] offset:-3072
v_mfma_f32_16x16x32_bf16 v[220:223], a[204:207], a[176:179], v[220:223]
v_accvgpr_read_b32 v15, a71
v_lshlrev_b32 v12, 16, v13
v_mfma_f32_16x16x32_bf16 v[188:191], a[204:207], a[172:175], v[188:191]
v_lshlrev_b32 v14, 16, v15
v_and_b32 v13, s53, v13
v_mfma_f32_16x16x32_bf16 v[188:191], a[228:231], a[168:171], v[188:191]
v_and_b32 v15, s53, v15
v_mfma_f32_16x16x32_bf16 v[156:159], a[228:231], a[164:167], v[156:159]
ds_write_b128 v3, v[16:19] offset:0
v_mfma_f32_16x16x32_bf16 v[156:159], a[204:207], a[160:163], v[156:159]
v_mul_f32 v8, v8, v72
v_mul_f32 v9, v9, v73
v_mfma_f32_16x16x32_bf16 v[124:127], a[204:207], a[156:159], v[124:127]
v_mul_f32 v10, v10, v74
v_mul_f32 v11, v11, v75
v_mfma_f32_16x16x32_bf16 v[124:127], a[228:231], a[152:155], v[124:127]
v_cvt_pk_bf16_f32 v20, v8, v9
v_cvt_pk_bf16_f32 v21, v10, v11
v_mfma_f32_16x16x32_bf16 v[92:95], a[228:231], a[148:151], v[92:95]
v_accvgpr_read_b32 v9, a72
v_accvgpr_read_b32 v11, a73
v_mfma_f32_16x16x32_bf16 v[92:95], a[204:207], a[144:147], v[92:95]
v_lshlrev_b32 v8, 16, v9
v_lshlrev_b32 v10, 16, v11
v_mfma_f32_16x16x32_bf16 v[60:63], a[204:207], a[140:143], v[60:63]
v_and_b32 v9, s53, v9
v_and_b32 v11, s53, v11
s_mov_b32 s60, 196608
v_mfma_f32_16x16x32_bf16 v[60:63], a[228:231], a[136:139], v[60:63]
buffer_store_dwordx4 v[16:19], v0, s[24:27], s60 offen offset:0 sc1
v_mfma_f32_16x16x32_bf16 v[28:31], a[228:231], a[132:135], v[28:31]
global_load_dwordx4 a[228:231], v0, s[72:73] offset:-2048
v_mfma_f32_16x16x32_bf16 v[28:31], a[204:207], a[128:131], v[28:31]
s_waitcnt vmcnt(9)
v_mfma_f32_16x16x32_bf16 v[32:35], a[196:199], a[128:131], v[32:35]
v_mul_f32 v12, v12, v76
v_mul_f32 v13, v13, v77
v_mfma_f32_16x16x32_bf16 v[32:35], a[224:227], a[132:135], v[32:35]
v_mul_f32 v14, v14, v78
v_mfma_f32_16x16x32_bf16 v[64:67], a[224:227], a[136:139], v[64:67]
global_load_dwordx4 a[204:207], v0, s[74:75] offset:-2048
v_mfma_f32_16x16x32_bf16 v[64:67], a[196:199], a[140:143], v[64:67]
v_mul_f32 v15, v15, v79
v_cvt_pk_bf16_f32 v22, v12, v13
v_mfma_f32_16x16x32_bf16 v[96:99], a[196:199], a[144:147], v[96:99]
v_cvt_pk_bf16_f32 v23, v14, v15
v_accvgpr_read_b32 v13, a74
v_mfma_f32_16x16x32_bf16 v[96:99], a[224:227], a[148:151], v[96:99]
v_accvgpr_read_b32 v15, a75
v_mfma_f32_16x16x32_bf16 v[128:131], a[224:227], a[152:155], v[128:131]
v_lshlrev_b32 v12, 16, v13
v_lshlrev_b32 v14, 16, v15
v_mfma_f32_16x16x32_bf16 v[128:131], a[196:199], a[156:159], v[128:131]
v_and_b32 v13, s53, v13
v_and_b32 v15, s53, v15
v_mfma_f32_16x16x32_bf16 v[160:163], a[196:199], a[160:163], v[160:163]
ds_write_b128 v3, v[20:23] offset:1024
v_mfma_f32_16x16x32_bf16 v[160:163], a[224:227], a[164:167], v[160:163]
v_mul_f32 v8, v8, v104
v_mul_f32 v9, v9, v105
v_mfma_f32_16x16x32_bf16 v[192:195], a[224:227], a[168:171], v[192:195]
v_mul_f32 v10, v10, v106
v_mul_f32 v11, v11, v107
v_mfma_f32_16x16x32_bf16 v[192:195], a[196:199], a[172:175], v[192:195]
v_cvt_pk_bf16_f32 v16, v8, v9
v_cvt_pk_bf16_f32 v17, v10, v11
v_mfma_f32_16x16x32_bf16 v[224:227], a[196:199], a[176:179], v[224:227]
v_accvgpr_read_b32 v9, a76
v_accvgpr_read_b32 v11, a77
v_mfma_f32_16x16x32_bf16 v[224:227], a[224:227], a[180:183], v[224:227]
v_lshlrev_b32 v8, 16, v9
v_mfma_f32_16x16x32_bf16 a[232:235], a[224:227], a[184:187], a[232:235]
global_load_dwordx4 a[224:227], v0, s[72:73] offset:-1024
v_mfma_f32_16x16x32_bf16 a[232:235], a[196:199], a[188:191], a[232:235]
v_lshlrev_b32 v10, 16, v11
s_waitcnt vmcnt(9)
v_mfma_f32_16x16x32_bf16 a[236:239], a[212:215], a[188:191], a[236:239]
ds_read_b128 a[188:191], v2 offset:49152
v_and_b32 v9, s53, v9
v_mfma_f32_16x16x32_bf16 a[236:239], a[216:219], a[184:187], a[236:239]
ds_read_b128 a[184:187], v2 offset:57344
v_and_b32 v11, s53, v11
v_mfma_f32_16x16x32_bf16 v[228:231], a[216:219], a[180:183], v[228:231]
ds_read_b128 a[180:183], v2 offset:58368
v_mfma_f32_16x16x32_bf16 v[228:231], a[212:215], a[176:179], v[228:231]
ds_read_b128 a[176:179], v2 offset:50176
v_mfma_f32_16x16x32_bf16 v[196:199], a[212:215], a[172:175], v[196:199]
ds_read_b128 a[172:175], v2 offset:51200
v_mfma_f32_16x16x32_bf16 v[196:199], a[216:219], a[168:171], v[196:199]
L_pad15:
s_cbranch_execz L_tret0
ds_read_b128 a[168:171], v2 offset:59392
v_mul_f32 v12, v12, v108
v_mfma_f32_16x16x32_bf16 v[164:167], a[216:219], a[164:167], v[164:167]
ds_read_b128 a[164:167], v2 offset:60416
v_mul_f32 v13, v13, v109
v_mfma_f32_16x16x32_bf16 v[164:167], a[212:215], a[160:163], v[164:167]
ds_read_b128 a[160:163], v2 offset:52224
v_mul_f32 v14, v14, v110
v_mfma_f32_16x16x32_bf16 v[132:135], a[212:215], a[156:159], v[132:135]
ds_read_b128 a[156:159], v2 offset:53248
v_mul_f32 v15, v15, v111
v_mfma_f32_16x16x32_bf16 v[132:135], a[216:219], a[152:155], v[132:135]
ds_read_b128 a[152:155], v2 offset:61440
v_cvt_pk_bf16_f32 v18, v12, v13
v_mfma_f32_16x16x32_bf16 v[100:103], a[216:219], a[148:151], v[100:103]
ds_read_b128 a[148:151], v2 offset:62464
v_cvt_pk_bf16_f32 v19, v14, v15
v_mfma_f32_16x16x32_bf16 v[100:103], a[212:215], a[144:147], v[100:103]
ds_read_b128 a[144:147], v2 offset:54272
v_accvgpr_read_b32 v13, a78
v_mfma_f32_16x16x32_bf16 v[68:71], a[212:215], a[140:143], v[68:71]
ds_read_b128 a[140:143], v2 offset:55296
v_accvgpr_read_b32 v15, a79
v_mfma_f32_16x16x32_bf16 v[68:71], a[216:219], a[136:139], v[68:71]
ds_read_b128 a[136:139], v2 offset:63488
v_lshlrev_b32 v12, 16, v13
v_mfma_f32_16x16x32_bf16 v[36:39], a[216:219], a[132:135], v[36:39]
ds_read_b128 a[132:135], v2 offset:64512
v_lshlrev_b32 v14, 16, v15
v_mfma_f32_16x16x32_bf16 v[36:39], a[212:215], a[128:131], v[36:39]
ds_read_b128 a[128:131], v2 offset:56320
s_waitcnt vmcnt(7) lgkmcnt(12)
v_mfma_f32_16x16x32_bf16 v[24:27], a[192:195], a[188:191], v[24:27]
global_load_dwordx4 a[196:199], v0, s[74:75] offset:-1024
v_mfma_f32_16x16x32_bf16 v[24:27], a[208:211], a[184:187], v[24:27]
s_add_u32 s72, s12, 536576
s_addc_u32 s73, s13, 0
v_mfma_f32_16x16x32_bf16 v[56:59], a[208:211], a[180:183], v[56:59]
s_add_u32 s74, s12, 569344
s_addc_u32 s75, s13, 0
v_mfma_f32_16x16x32_bf16 v[56:59], a[192:195], a[176:179], v[56:59]
v_and_b32 v13, s53, v13
s_waitcnt lgkmcnt(8)
v_mfma_f32_16x16x32_bf16 v[88:91], a[192:195], a[172:175], v[88:91]
global_load_dwordx4 a[216:219], v0, s[72:73] offset:-4096
v_mfma_f32_16x16x32_bf16 v[88:91], a[208:211], a[168:171], v[88:91]
buffer_store_dwordx4 v[20:23], v0, s[24:27], s60 offen offset:1024 sc1
v_mfma_f32_16x16x32_bf16 v[120:123], a[208:211], a[164:167], v[120:123]
v_and_b32 v15, s53, v15
v_mfma_f32_16x16x32_bf16 v[120:123], a[192:195], a[160:163], v[120:123]
v_mul_f32 v8, v8, v136
s_waitcnt lgkmcnt(4)
v_mfma_f32_16x16x32_bf16 v[152:155], a[192:195], a[156:159], v[152:155]
global_load_dwordx4 a[212:215], v0, s[74:75] offset:-4096
v_mfma_f32_16x16x32_bf16 v[152:155], a[208:211], a[152:155], v[152:155]
ds_write_b128 v3, v[16:19] offset:2048
v_mfma_f32_16x16x32_bf16 v[184:187], a[208:211], a[148:151], v[184:187]
v_mul_f32 v9, v9, v137
v_mul_f32 v10, v10, v138
v_mfma_f32_16x16x32_bf16 v[184:187], a[192:195], a[144:147], v[184:187]
v_mul_f32 v11, v11, v139
v_cvt_pk_bf16_f32 v20, v8, v9
s_waitcnt lgkmcnt(1)
v_mfma_f32_16x16x32_bf16 v[216:219], a[192:195], a[140:143], v[216:219]
v_cvt_pk_bf16_f32 v21, v10, v11
v_accvgpr_read_b32 v9, a80
v_mfma_f32_16x16x32_bf16 v[216:219], a[208:211], a[136:139], v[216:219]
v_accvgpr_read_b32 v11, a81
v_mfma_f32_16x16x32_bf16 v[248:251], a[208:211], a[132:135], v[248:251]
global_load_dwordx4 a[208:211], v0, s[72:73] offset:-3072
v_mfma_f32_16x16x32_bf16 v[248:251], a[192:195], a[128:131], v[248:251]
v_lshlrev_b32 v8, 16, v9
v_lshlrev_b32 v10, 16, v11
s_waitcnt vmcnt(9)
v_mfma_f32_16x16x32_bf16 v[252:255], a[220:223], a[128:131], v[252:255]
v_and_b32 v9, s53, v9
v_and_b32 v11, s53, v11
v_mfma_f32_16x16x32_bf16 v[252:255], a[200:203], a[132:135], v[252:255]
buffer_store_dwordx4 v[16:19], v0, s[24:27], s60 offen offset:2048 sc1
v_mfma_f32_16x16x32_bf16 v[220:223], a[200:203], a[136:139], v[220:223]
global_load_dwordx4 a[192:195], v0, s[74:75] offset:-3072
v_mfma_f32_16x16x32_bf16 v[220:223], a[220:223], a[140:143], v[220:223]
v_mfma_f32_16x16x32_bf16 v[188:191], a[220:223], a[144:147], v[188:191]
v_mul_f32 v12, v12, v140
v_mul_f32 v13, v13, v141
v_mfma_f32_16x16x32_bf16 v[188:191], a[200:203], a[148:151], v[188:191]
v_mul_f32 v14, v14, v142
v_mul_f32 v15, v15, v143
v_mfma_f32_16x16x32_bf16 v[156:159], a[200:203], a[152:155], v[156:159]
v_cvt_pk_bf16_f32 v22, v12, v13
v_cvt_pk_bf16_f32 v23, v14, v15
v_mfma_f32_16x16x32_bf16 v[156:159], a[220:223], a[156:159], v[156:159]
v_accvgpr_read_b32 v13, a82
v_accvgpr_read_b32 v15, a83
v_mfma_f32_16x16x32_bf16 v[124:127], a[220:223], a[160:163], v[124:127]
v_lshlrev_b32 v12, 16, v13
v_lshlrev_b32 v14, 16, v15
v_mfma_f32_16x16x32_bf16 v[124:127], a[200:203], a[164:167], v[124:127]
v_and_b32 v13, s53, v13
v_and_b32 v15, s53, v15
v_mfma_f32_16x16x32_bf16 v[92:95], a[200:203], a[168:171], v[92:95]
ds_write_b128 v3, v[20:23] offset:3072
v_mfma_f32_16x16x32_bf16 v[92:95], a[220:223], a[172:175], v[92:95]
v_mul_f32 v8, v8, v168
v_mfma_f32_16x16x32_bf16 v[60:63], a[220:223], a[176:179], v[60:63]
v_mul_f32 v9, v9, v169
v_mul_f32 v10, v10, v170
v_mfma_f32_16x16x32_bf16 v[60:63], a[200:203], a[180:183], v[60:63]
v_mul_f32 v11, v11, v171
v_mfma_f32_16x16x32_bf16 v[28:31], a[200:203], a[184:187], v[28:31]
global_load_dwordx4 a[200:203], v0, s[72:73] offset:-2048
v_mfma_f32_16x16x32_bf16 v[28:31], a[220:223], a[188:191], v[28:31]
v_cvt_pk_bf16_f32 v16, v8, v9
v_cvt_pk_bf16_f32 v17, v10, v11
s_waitcnt vmcnt(9)
v_mfma_f32_16x16x32_bf16 v[32:35], a[228:231], a[188:191], v[32:35]
v_accvgpr_read_b32 v9, a84
v_accvgpr_read_b32 v11, a85
v_mfma_f32_16x16x32_bf16 v[32:35], a[204:207], a[184:187], v[32:35]
v_lshlrev_b32 v8, 16, v9
v_mfma_f32_16x16x32_bf16 v[64:67], a[204:207], a[180:183], v[64:67]
global_load_dwordx4 a[220:223], v0, s[74:75] offset:-2048
v_mfma_f32_16x16x32_bf16 v[64:67], a[228:231], a[176:179], v[64:67]
v_lshlrev_b32 v10, 16, v11
v_mfma_f32_16x16x32_bf16 v[96:99], a[228:231], a[172:175], v[96:99]
v_and_b32 v9, s53, v9
v_and_b32 v11, s53, v11
v_mfma_f32_16x16x32_bf16 v[96:99], a[204:207], a[168:171], v[96:99]
s_mov_b32 s34, 576
v_mfma_f32_16x16x32_bf16 v[128:131], a[204:207], a[164:167], v[128:131]
buffer_load_dword v5, v0, s[32:35], 0 offen offset:512 sc1
v_mfma_f32_16x16x32_bf16 v[128:131], a[228:231], a[160:163], v[128:131]
buffer_store_dwordx4 v[20:23], v0, s[24:27], s60 offen offset:3072 sc1
v_mfma_f32_16x16x32_bf16 v[160:163], a[228:231], a[156:159], v[160:163]
v_mul_f32 v12, v12, v172
v_mul_f32 v13, v13, v173
v_mfma_f32_16x16x32_bf16 v[160:163], a[204:207], a[152:155], v[160:163]
v_mul_f32 v14, v14, v174
v_mul_f32 v15, v15, v175
v_mfma_f32_16x16x32_bf16 v[192:195], a[204:207], a[148:151], v[192:195]
v_cvt_pk_bf16_f32 v18, v12, v13
v_cvt_pk_bf16_f32 v19, v14, v15
v_mfma_f32_16x16x32_bf16 v[192:195], a[228:231], a[144:147], v[192:195]
v_accvgpr_read_b32 v13, a86
v_accvgpr_read_b32 v15, a87
v_mfma_f32_16x16x32_bf16 v[224:227], a[228:231], a[140:143], v[224:227]
v_lshlrev_b32 v12, 16, v13
v_lshlrev_b32 v14, 16, v15
v_mfma_f32_16x16x32_bf16 v[224:227], a[204:207], a[136:139], v[224:227]
v_and_b32 v13, s53, v13
v_mfma_f32_16x16x32_bf16 a[232:235], a[204:207], a[132:135], a[232:235]
global_load_dwordx4 a[204:207], v0, s[72:73] offset:-1024
v_mfma_f32_16x16x32_bf16 a[232:235], a[228:231], a[128:131], a[232:235]
v_add_u32 v2, 65536, v0
v_and_b32 v15, s53, v15
s_waitcnt vmcnt(11)
v_mfma_f32_16x16x32_bf16 a[236:239], a[224:227], a[128:131], a[236:239]
ds_read_b128 a[128:131], v2 offset:32768
v_mfma_f32_16x16x32_bf16 a[236:239], a[196:199], a[132:135], a[236:239]
ds_read_b128 a[132:135], v2 offset:40960
v_mfma_f32_16x16x32_bf16 v[228:231], a[196:199], a[136:139], v[228:231]
ds_read_b128 a[136:139], v2 offset:41984
v_mul_f32 v8, v8, v200
v_mfma_f32_16x16x32_bf16 v[228:231], a[224:227], a[140:143], v[228:231]
ds_read_b128 a[140:143], v2 offset:33792
v_mul_f32 v9, v9, v201
v_mfma_f32_16x16x32_bf16 v[196:199], a[224:227], a[144:147], v[196:199]
ds_read_b128 a[144:147], v2 offset:34816
v_mfma_f32_16x16x32_bf16 v[196:199], a[196:199], a[148:151], v[196:199]
ds_read_b128 a[148:151], v2 offset:43008
v_mul_f32 v10, v10, v202
v_mfma_f32_16x16x32_bf16 v[164:167], a[196:199], a[152:155], v[164:167]
ds_read_b128 a[152:155], v2 offset:44032
v_mul_f32 v11, v11, v203
v_mfma_f32_16x16x32_bf16 v[164:167], a[224:227], a[156:159], v[164:167]
ds_read_b128 a[156:159], v2 offset:35840
v_cvt_pk_bf16_f32 v20, v8, v9
v_mfma_f32_16x16x32_bf16 v[132:135], a[224:227], a[160:163], v[132:135]
ds_read_b128 a[160:163], v2 offset:36864
v_cvt_pk_bf16_f32 v21, v10, v11
v_mfma_f32_16x16x32_bf16 v[132:135], a[196:199], a[164:167], v[132:135]
ds_read_b128 a[164:167], v2 offset:45056
v_accvgpr_read_b32 v9, a88
v_mfma_f32_16x16x32_bf16 v[100:103], a[196:199], a[168:171], v[100:103]
ds_read_b128 a[168:171], v2 offset:46080
v_accvgpr_read_b32 v11, a89
v_mfma_f32_16x16x32_bf16 v[100:103], a[224:227], a[172:175], v[100:103]
ds_read_b128 a[172:175], v2 offset:37888
v_lshlrev_b32 v8, 16, v9
v_mfma_f32_16x16x32_bf16 v[68:71], a[224:227], a[176:179], v[68:71]
ds_read_b128 a[176:179], v2 offset:38912
v_lshlrev_b32 v10, 16, v11
v_mfma_f32_16x16x32_bf16 v[68:71], a[196:199], a[180:183], v[68:71]
ds_read_b128 a[180:183], v2 offset:47104
v_and_b32 v9, s53, v9
v_mfma_f32_16x16x32_bf16 v[36:39], a[196:199], a[184:187], v[36:39]
ds_read_b128 a[184:187], v2 offset:48128
v_and_b32 v11, s53, v11
v_mfma_f32_16x16x32_bf16 v[36:39], a[224:227], a[188:191], v[36:39]
ds_read_b128 a[188:191], v2 offset:39936
s_waitcnt vmcnt(8) lgkmcnt(12)
v_mfma_f32_16x16x32_bf16 v[24:27], a[216:219], a[128:131], v[24:27]
global_load_dwordx4 a[228:231], v0, s[74:75] offset:-1024
v_mfma_f32_16x16x32_bf16 v[24:27], a[212:215], a[132:135], v[24:27]
s_add_u32 s72, s12, 602112
s_addc_u32 s73, s13, 0
v_mfma_f32_16x16x32_bf16 v[56:59], a[212:215], a[136:139], v[56:59]
s_add_u32 s74, s12, 634880
s_addc_u32 s75, s13, 0
v_mfma_f32_16x16x32_bf16 v[56:59], a[216:219], a[140:143], v[56:59]
s_waitcnt lgkmcnt(8)
v_mfma_f32_16x16x32_bf16 v[88:91], a[216:219], a[144:147], v[88:91]
global_load_dwordx4 a[196:199], v0, s[72:73] offset:-4096
v_mfma_f32_16x16x32_bf16 v[88:91], a[212:215], a[148:151], v[88:91]
ds_write_b128 v3, v[16:19] offset:4096
v_mfma_f32_16x16x32_bf16 v[120:123], a[212:215], a[152:155], v[120:123]
s_mov_b32 s60, 200704
v_mul_f32 v12, v12, v204
v_mfma_f32_16x16x32_bf16 v[120:123], a[216:219], a[156:159], v[120:123]
v_mul_f32 v13, v13, v205
s_waitcnt lgkmcnt(5)
v_mfma_f32_16x16x32_bf16 v[152:155], a[216:219], a[160:163], v[152:155]
global_load_dwordx4 a[224:227], v0, s[74:75] offset:-4096
v_mfma_f32_16x16x32_bf16 v[152:155], a[212:215], a[164:167], v[152:155]
buffer_store_dwordx4 v[16:19], v0, s[24:27], s60 offen offset:0 sc1
v_mfma_f32_16x16x32_bf16 v[184:187], a[212:215], a[168:171], v[184:187]
v_mul_f32 v14, v14, v206
v_mul_f32 v15, v15, v207
v_mfma_f32_16x16x32_bf16 v[184:187], a[216:219], a[172:175], v[184:187]
v_cvt_pk_bf16_f32 v22, v12, v13
v_cvt_pk_bf16_f32 v23, v14, v15
s_waitcnt lgkmcnt(1)
v_mfma_f32_16x16x32_bf16 v[216:219], a[216:219], a[176:179], v[216:219]
v_accvgpr_read_b32 v13, a90
v_accvgpr_read_b32 v15, a91
v_mfma_f32_16x16x32_bf16 v[216:219], a[212:215], a[180:183], v[216:219]
v_lshlrev_b32 v12, 16, v13
v_mfma_f32_16x16x32_bf16 v[248:251], a[212:215], a[184:187], v[248:251]
global_load_dwordx4 a[212:215], v0, s[72:73] offset:-3072
v_mfma_f32_16x16x32_bf16 v[248:251], a[216:219], a[188:191], v[248:251]
v_lshlrev_b32 v14, 16, v15
v_and_b32 v13, s53, v13
s_waitcnt vmcnt(10)
v_mfma_f32_16x16x32_bf16 v[252:255], a[208:211], a[188:191], v[252:255]
v_and_b32 v15, s53, v15
v_mfma_f32_16x16x32_bf16 v[252:255], a[192:195], a[184:187], v[252:255]
ds_write_b128 v3, v[20:23] offset:5120
v_mfma_f32_16x16x32_bf16 v[220:223], a[192:195], a[180:183], v[220:223]
global_load_dwordx4 a[216:219], v0, s[74:75] offset:-3072
v_mfma_f32_16x16x32_bf16 v[220:223], a[208:211], a[176:179], v[220:223]
v_mul_f32 v8, v8, v232
v_mul_f32 v9, v9, v233
v_mfma_f32_16x16x32_bf16 v[188:191], a[208:211], a[172:175], v[188:191]
v_mul_f32 v10, v10, v234
v_mul_f32 v11, v11, v235
v_mfma_f32_16x16x32_bf16 v[188:191], a[192:195], a[168:171], v[188:191]
v_cvt_pk_bf16_f32 v16, v8, v9
v_mfma_f32_16x16x32_bf16 v[156:159], a[192:195], a[164:167], v[156:159]
v_cvt_pk_bf16_f32 v17, v10, v11
v_accvgpr_read_b32 v9, a92
v_mfma_f32_16x16x32_bf16 v[156:159], a[208:211], a[160:163], v[156:159]
v_accvgpr_read_b32 v11, a93
v_lshlrev_b32 v8, 16, v9
v_mfma_f32_16x16x32_bf16 v[124:127], a[208:211], a[156:159], v[124:127]
v_lshlrev_b32 v10, 16, v11
v_and_b32 v9, s53, v9
v_mfma_f32_16x16x32_bf16 v[124:127], a[192:195], a[152:155], v[124:127]
v_and_b32 v11, s53, v11
v_mfma_f32_16x16x32_bf16 v[92:95], a[192:195], a[148:151], v[92:95]
buffer_store_dwordx4 v[20:23], v0, s[24:27], s60 offen offset:1024 sc1
v_mfma_f32_16x16x32_bf16 v[92:95], a[208:211], a[144:147], v[92:95]
v_mul_f32 v12, v12, v236
v_mul_f32 v13, v13, v237
v_mfma_f32_16x16x32_bf16 v[60:63], a[208:211], a[140:143], v[60:63]
v_mul_f32 v14, v14, v238
v_mul_f32 v15, v15, v239
v_mfma_f32_16x16x32_bf16 v[60:63], a[192:195], a[136:139], v[60:63]
v_cvt_pk_bf16_f32 v18, v12, v13
v_mfma_f32_16x16x32_bf16 v[28:31], a[192:195], a[132:135], v[28:31]
global_load_dwordx4 a[192:195], v0, s[72:73] offset:-2048
v_mfma_f32_16x16x32_bf16 v[28:31], a[208:211], a[128:131], v[28:31]
v_cvt_pk_bf16_f32 v19, v14, v15
v_accvgpr_read_b32 v13, a94
s_waitcnt vmcnt(11)
v_mfma_f32_16x16x32_bf16 v[32:35], a[200:203], a[128:131], v[32:35]
v_accvgpr_read_b32 v15, a95
v_lshlrev_b32 v12, 16, v13
v_mfma_f32_16x16x32_bf16 v[32:35], a[220:223], a[132:135], v[32:35]
v_lshlrev_b32 v14, 16, v15
v_mfma_f32_16x16x32_bf16 v[64:67], a[220:223], a[136:139], v[64:67]
global_load_dwordx4 a[208:211], v0, s[74:75] offset:-2048
v_mfma_f32_16x16x32_bf16 v[64:67], a[200:203], a[140:143], v[64:67]
v_and_b32 v13, s53, v13
v_mfma_f32_16x16x32_bf16 v[96:99], a[200:203], a[144:147], v[96:99]
v_and_b32 v15, s53, v15
v_mfma_f32_16x16x32_bf16 v[96:99], a[220:223], a[148:151], v[96:99]
s_waitcnt vmcnt(11)
v_accvgpr_read_b32 v20, a240
v_mfma_f32_16x16x32_bf16 v[128:131], a[220:223], a[152:155], v[128:131]
v_cmp_ne_u32 vcc, 16256, v5
v_accvgpr_read_b32 v21, a241
v_mfma_f32_16x16x32_bf16 v[128:131], a[200:203], a[156:159], v[128:131]
ds_write_b128 v3, v[16:19] offset:6144
v_mfma_f32_16x16x32_bf16 v[160:163], a[200:203], a[160:163], v[160:163]
v_mul_f32 v8, v8, v20
v_mul_f32 v9, v9, v21
v_mfma_f32_16x16x32_bf16 v[160:163], a[220:223], a[164:167], v[160:163]
v_accvgpr_read_b32 v20, a242
v_accvgpr_read_b32 v21, a243
v_mfma_f32_16x16x32_bf16 v[192:195], a[220:223], a[168:171], v[192:195]
s_and_b32 s3, vcc_lo, 15
s_cbranch_scc1 L_slow6
L_back6:
v_mfma_f32_16x16x32_bf16 v[192:195], a[200:203], a[172:175], v[192:195]
v_mul_f32 v10, v10, v20
v_mul_f32 v11, v11, v21
v_mfma_f32_16x16x32_bf16 v[224:227], a[200:203], a[176:179], v[224:227]
v_cvt_pk_bf16_f32 v20, v8, v9
v_cvt_pk_bf16_f32 v21, v10, v11
v_mfma_f32_16x16x32_bf16 v[224:227], a[220:223], a[180:183], v[224:227]
buffer_store_dwordx4 v[16:19], v0, s[24:27], s60 offen offset:2048 sc1
v_mfma_f32_16x16x32_bf16 a[232:235], a[220:223], a[184:187], a[232:235]
global_load_dwordx4 a[220:223], v0, s[72:73] offset:-1024
v_mfma_f32_16x16x32_bf16 a[232:235], a[200:203], a[188:191], a[232:235]
s_add_u32 m0, s56, 0
v_accvgpr_read_b32 v22, a244
s_waitcnt vmcnt(10)
v_mfma_f32_16x16x32_bf16 a[236:239], a[204:207], a[188:191], a[236:239]
ds_read_b128 a[188:191], v2 offset:49152
v_accvgpr_read_b32 v23, a245
v_mfma_f32_16x16x32_bf16 a[236:239], a[228:231], a[184:187], a[236:239]
ds_read_b128 a[184:187], v2 offset:57344
v_mul_f32 v12, v12, v22
v_mfma_f32_16x16x32_bf16 v[228:231], a[228:231], a[180:183], v[228:231]
ds_read_b128 a[180:183], v2 offset:58368
v_mul_f32 v13, v13, v23
v_mfma_f32_16x16x32_bf16 v[228:231], a[204:207], a[176:179], v[228:231]
ds_read_b128 a[176:179], v2 offset:50176
v_accvgpr_read_b32 v22, a246
v_mfma_f32_16x16x32_bf16 v[196:199], a[204:207], a[172:175], v[196:199]
ds_read_b128 a[172:175], v2 offset:51200
v_mfma_f32_16x16x32_bf16 v[196:199], a[228:231], a[168:171], v[196:199]
ds_read_b128 a[168:171], v2 offset:59392
v_accvgpr_read_b32 v23, a247
v_mfma_f32_16x16x32_bf16 v[164:167], a[228:231], a[164:167], v[164:167]
ds_read_b128 a[164:167], v2 offset:60416
v_mul_f32 v14, v14, v22
v_mfma_f32_16x16x32_bf16 v[164:167], a[204:207], a[160:163], v[164:167]
ds_read_b128 a[160:163], v2 offset:52224
v_mul_f32 v15, v15, v23
v_mfma_f32_16x16x32_bf16 v[132:135], a[204:207], a[156:159], v[132:135]
ds_read_b128 a[156:159], v2 offset:53248
v_cvt_pk_bf16_f32 v22, v12, v13
v_mfma_f32_16x16x32_bf16 v[132:135], a[228:231], a[152:155], v[132:135]
ds_read_b128 a[152:155], v2 offset:61440
v_cvt_pk_bf16_f32 v23, v14, v15
v_mfma_f32_16x16x32_bf16 v[100:103], a[228:231], a[148:151], v[100:103]
ds_read_b128 a[148:151], v2 offset:62464
v_mfma_f32_16x16x32_bf16 v[100:103], a[204:207], a[144:147], v[100:103]
ds_read_b128 a[144:147], v2 offset:54272
v_mfma_f32_16x16x32_bf16 v[68:71], a[204:207], a[140:143], v[68:71]
ds_read_b128 a[140:143], v2 offset:55296
v_mfma_f32_16x16x32_bf16 v[68:71], a[228:231], a[136:139], v[68:71]
ds_read_b128 a[136:139], v2 offset:63488
v_mfma_f32_16x16x32_bf16 v[36:39], a[228:231], a[132:135], v[36:39]
ds_read_b128 a[132:135], v2 offset:64512
v_mfma_f32_16x16x32_bf16 v[36:39], a[204:207], a[128:131], v[36:39]
ds_read_b128 a[128:131], v2 offset:56320
s_waitcnt vmcnt(8) lgkmcnt(12)
v_mfma_f32_16x16x32_bf16 v[24:27], a[196:199], a[188:191], v[24:27]
global_load_dwordx4 a[200:203], v0, s[74:75] offset:-1024
v_mfma_f32_16x16x32_bf16 v[24:27], a[224:227], a[184:187], v[24:27]
s_add_u32 s72, s12, 544768
s_addc_u32 s73, s13, 0
v_mfma_f32_16x16x32_bf16 v[56:59], a[224:227], a[180:183], v[56:59]
s_add_u32 s74, s12, 577536
s_addc_u32 s75, s13, 0
v_mfma_f32_16x16x32_bf16 v[56:59], a[196:199], a[176:179], v[56:59]
v_accvgpr_read_b32 v9, a96
s_waitcnt lgkmcnt(8)
v_mfma_f32_16x16x32_bf16 v[88:91], a[196:199], a[172:175], v[88:91]
global_load_dwordx4 a[228:231], v0, s[72:73] offset:-4096
v_mfma_f32_16x16x32_bf16 v[88:91], a[224:227], a[168:171], v[88:91]
s_add_u32 s30, s28, 131072
s_addc_u32 s31, s29, 0
v_mfma_f32_16x16x32_bf16 v[120:123], a[224:227], a[164:167], v[120:123]
global_load_lds_dwordx4 v0, s[30:31] nt
v_mfma_f32_16x16x32_bf16 v[120:123], a[196:199], a[160:163], v[120:123]
s_waitcnt lgkmcnt(4)
v_mfma_f32_16x16x32_bf16 v[152:155], a[196:199], a[156:159], v[152:155]
global_load_dwordx4 a[204:207], v0, s[74:75] offset:-4096
ds_write_b128 v3, v[20:23] offset:7168
buffer_store_dwordx4 v[20:23], v0, s[24:27], s60 offen offset:3072 sc1
v_mfma_f32_16x16x32_bf16 v[152:155], a[224:227], a[152:155], v[152:155]
v_accvgpr_read_b32 v11, a97
v_mfma_f32_16x16x32_bf16 v[184:187], a[224:227], a[148:151], v[184:187]
v_lshlrev_b32 v8, 16, v9
v_mfma_f32_16x16x32_bf16 v[184:187], a[196:199], a[144:147], v[184:187]
v_lshlrev_b32 v10, 16, v11
s_waitcnt lgkmcnt(0)
v_mfma_f32_16x16x32_bf16 v[216:219], a[196:199], a[140:143], v[216:219]
v_and_b32 v9, s53, v9
s_barrier
v_mfma_f32_16x16x32_bf16 v[216:219], a[224:227], a[136:139], v[216:219]
v_and_b32 v11, s53, v11
v_mfma_f32_16x16x32_bf16 v[248:251], a[224:227], a[132:135], v[248:251]
global_load_dwordx4 a[224:227], v0, s[72:73] offset:-3072
v_mfma_f32_16x16x32_bf16 v[248:251], a[196:199], a[128:131], v[248:251]
s_waitcnt vmcnt(11)
v_mfma_f32_16x16x32_bf16 v[252:255], a[212:215], a[128:131], v[252:255]
global_load_lds_dwordx4 v0, s[30:31] offset:1024 nt
v_mfma_f32_16x16x32_bf16 v[252:255], a[216:219], a[132:135], v[252:255]
v_mfma_f32_16x16x32_bf16 v[220:223], a[216:219], a[136:139], v[220:223]
global_load_dwordx4 a[196:199], v0, s[74:75] offset:-3072
v_mfma_f32_16x16x32_bf16 v[220:223], a[212:215], a[140:143], v[220:223]
v_accvgpr_read_b32 v13, a98
v_accvgpr_read_b32 v15, a99
v_mfma_f32_16x16x32_bf16 v[188:191], a[212:215], a[144:147], v[188:191]
v_lshlrev_b32 v12, 16, v13
v_mfma_f32_16x16x32_bf16 v[188:191], a[216:219], a[148:151], v[188:191]
v_lshlrev_b32 v14, 16, v15
v_mfma_f32_16x16x32_bf16 v[156:159], a[216:219], a[152:155], v[156:159]
v_and_b32 v13, s53, v13
v_mfma_f32_16x16x32_bf16 v[156:159], a[212:215], a[156:159], v[156:159]
v_and_b32 v15, s53, v15
v_mfma_f32_16x16x32_bf16 v[124:127], a[212:215], a[160:163], v[124:127]
s_add_u32 s54, s57, 131072
v_add_u32 v3, s54, v0
v_mfma_f32_16x16x32_bf16 v[124:127], a[216:219], a[164:167], v[124:127]
v_mul_f32 v8, v8, v48
v_mfma_f32_16x16x32_bf16 v[92:95], a[216:219], a[168:171], v[92:95]
s_add_u32 m0, s56, 8192
v_mul_f32 v9, v9, v49
v_mfma_f32_16x16x32_bf16 v[92:95], a[212:215], a[172:175], v[92:95]
v_mul_f32 v10, v10, v50
v_mfma_f32_16x16x32_bf16 v[60:63], a[212:215], a[176:179], v[60:63]
s_add_u32 s30, s28, 139264
s_addc_u32 s31, s29, 0
v_mfma_f32_16x16x32_bf16 v[60:63], a[216:219], a[180:183], v[60:63]
v_mul_f32 v11, v11, v51
v_mfma_f32_16x16x32_bf16 v[28:31], a[216:219], a[184:187], v[28:31]
global_load_dwordx4 a[216:219], v0, s[72:73] offset:-2048
v_mfma_f32_16x16x32_bf16 v[28:31], a[212:215], a[188:191], v[28:31]
v_cvt_pk_bf16_f32 v16, v8, v9
s_waitcnt vmcnt(11)
v_mfma_f32_16x16x32_bf16 v[32:35], a[192:195], a[188:191], v[32:35]
v_cvt_pk_bf16_f32 v17, v10, v11
v_mfma_f32_16x16x32_bf16 v[32:35], a[208:211], a[184:187], v[32:35]
v_mfma_f32_16x16x32_bf16 v[64:67], a[208:211], a[180:183], v[64:67]
global_load_dwordx4 a[212:215], v0, s[74:75] offset:-2048
v_mfma_f32_16x16x32_bf16 v[64:67], a[192:195], a[176:179], v[64:67]
global_load_lds_dwordx4 v0, s[30:31] nt
v_mfma_f32_16x16x32_bf16 v[96:99], a[192:195], a[172:175], v[96:99]
v_accvgpr_read_b32 v9, a100
v_mfma_f32_16x16x32_bf16 v[96:99], a[208:211], a[168:171], v[96:99]
v_accvgpr_read_b32 v11, a101
v_lshlrev_b32 v8, 16, v9
v_mfma_f32_16x16x32_bf16 v[128:131], a[208:211], a[164:167], v[128:131]
v_lshlrev_b32 v10, 16, v11
v_mfma_f32_16x16x32_bf16 v[128:131], a[192:195], a[160:163], v[128:131]
v_and_b32 v9, s53, v9
v_mfma_f32_16x16x32_bf16 v[160:163], a[192:195], a[156:159], v[160:163]
v_and_b32 v11, s53, v11
v_mfma_f32_16x16x32_bf16 v[160:163], a[208:211], a[152:155], v[160:163]
v_mul_f32 v12, v12, v52
v_mfma_f32_16x16x32_bf16 v[192:195], a[208:211], a[148:151], v[192:195]
v_mul_f32 v13, v13, v53
v_mfma_f32_16x16x32_bf16 v[192:195], a[192:195], a[144:147], v[192:195]
v_mul_f32 v14, v14, v54
v_mfma_f32_16x16x32_bf16 v[224:227], a[192:195], a[140:143], v[224:227]
global_load_lds_dwordx4 v0, s[30:31] offset:1024 nt
v_mfma_f32_16x16x32_bf16 v[224:227], a[208:211], a[136:139], v[224:227]
v_mfma_f32_16x16x32_bf16 a[232:235], a[208:211], a[132:135], a[232:235]
global_load_dwordx4 a[208:211], v0, s[72:73] offset:-1024
v_mfma_f32_16x16x32_bf16 a[232:235], a[192:195], a[128:131], a[232:235]
v_mul_f32 v15, v15, v55
s_waitcnt vmcnt(12)
v_mfma_f32_16x16x32_bf16 a[236:239], a[220:223], a[128:131], a[236:239]
ds_read_b128 a[128:131], v2 offset:0
v_cvt_pk_bf16_f32 v18, v12, v13
v_mfma_f32_16x16x32_bf16 a[236:239], a[200:203], a[132:135], a[236:239]
ds_read_b128 a[132:135], v2 offset:8192
v_mfma_f32_16x16x32_bf16 v[228:231], a[200:203], a[136:139], v[228:231]
ds_read_b128 a[136:139], v2 offset:9216
v_cvt_pk_bf16_f32 v19, v14, v15
v_mfma_f32_16x16x32_bf16 v[228:231], a[220:223], a[140:143], v[228:231]
ds_read_b128 a[140:143], v2 offset:1024
v_accvgpr_read_b32 v13, a102
v_mfma_f32_16x16x32_bf16 v[196:199], a[220:223], a[144:147], v[196:199]
ds_read_b128 a[144:147], v2 offset:2048
v_mfma_f32_16x16x32_bf16 v[196:199], a[200:203], a[148:151], v[196:199]
ds_read_b128 a[148:151], v2 offset:10240
v_accvgpr_read_b32 v15, a103
v_mfma_f32_16x16x32_bf16 v[164:167], a[200:203], a[152:155], v[164:167]
ds_read_b128 a[152:155], v2 offset:11264
v_mfma_f32_16x16x32_bf16 v[164:167], a[220:223], a[156:159], v[164:167]
ds_read_b128 a[156:159], v2 offset:3072
v_lshlrev_b32 v12, 16, v13
v_mfma_f32_16x16x32_bf16 v[132:135], a[220:223], a[160:163], v[132:135]
ds_read_b128 a[160:163], v2 offset:4096
v_mfma_f32_16x16x32_bf16 v[132:135], a[200:203], a[164:167], v[132:135]
ds_read_b128 a[164:167], v2 offset:12288
v_lshlrev_b32 v14, 16, v15
v_mfma_f32_16x16x32_bf16 v[100:103], a[200:203], a[168:171], v[100:103]
ds_read_b128 a[168:171], v2 offset:13312
v_mfma_f32_16x16x32_bf16 v[100:103], a[220:223], a[172:175], v[100:103]
ds_read_b128 a[172:175], v2 offset:5120
v_and_b32 v13, s53, v13
v_mfma_f32_16x16x32_bf16 v[68:71], a[220:223], a[176:179], v[68:71]
ds_read_b128 a[176:179], v2 offset:6144
v_and_b32 v15, s53, v15
v_mfma_f32_16x16x32_bf16 v[68:71], a[200:203], a[180:183], v[68:71]
ds_read_b128 a[180:183], v2 offset:14336
v_mfma_f32_16x16x32_bf16 v[36:39], a[200:203], a[184:187], v[36:39]
ds_read_b128 a[184:187], v2 offset:15360
v_mfma_f32_16x16x32_bf16 v[36:39], a[220:223], a[188:191], v[36:39]
ds_read_b128 a[188:191], v2 offset:7168
s_waitcnt vmcnt(9) lgkmcnt(12)
v_mfma_f32_16x16x32_bf16 v[24:27], a[228:231], a[128:131], v[24:27]
global_load_dwordx4 a[192:195], v0, s[74:75] offset:-1024
v_mfma_f32_16x16x32_bf16 v[24:27], a[204:207], a[132:135], v[24:27]
ds_write_b128 v3, v[16:19] offset:0
v_mfma_f32_16x16x32_bf16 v[56:59], a[204:207], a[136:139], v[56:59]
v_mul_f32 v8, v8, v80
v_mfma_f32_16x16x32_bf16 v[56:59], a[228:231], a[140:143], v[56:59]
s_waitcnt lgkmcnt(9)
v_mfma_f32_16x16x32_bf16 v[88:91], a[228:231], a[144:147], v[88:91]
global_load_dwordx4 a[200:203], v0, s[72:73] offset:0
v_mfma_f32_16x16x32_bf16 v[88:91], a[204:207], a[148:151], v[88:91]
v_mul_f32 v9, v9, v81
v_mfma_f32_16x16x32_bf16 v[120:123], a[204:207], a[152:155], v[120:123]
v_mul_f32 v10, v10, v82
v_mul_f32 v11, v11, v83
v_mfma_f32_16x16x32_bf16 v[120:123], a[228:231], a[156:159], v[120:123]
s_waitcnt lgkmcnt(5)
v_mfma_f32_16x16x32_bf16 v[152:155], a[228:231], a[160:163], v[152:155]
global_load_dwordx4 a[220:223], v0, s[74:75] offset:0
v_mfma_f32_16x16x32_bf16 v[152:155], a[204:207], a[164:167], v[152:155]
s_mov_b32 s38, 772
s_waitcnt vmcnt(11)
v_mfma_f32_16x16x32_bf16 v[184:187], a[204:207], a[168:171], v[184:187]
buffer_store_dword v6, v0, s[36:39], 0 offen offset:768 sc1
v_mfma_f32_16x16x32_bf16 v[184:187], a[228:231], a[172:175], v[184:187]
v_cvt_pk_bf16_f32 v20, v8, v9
s_waitcnt lgkmcnt(1)
v_mfma_f32_16x16x32_bf16 v[216:219], a[228:231], a[176:179], v[216:219]
v_cvt_pk_bf16_f32 v21, v10, v11
v_mfma_f32_16x16x32_bf16 v[216:219], a[204:207], a[180:183], v[216:219]
v_mfma_f32_16x16x32_bf16 v[248:251], a[204:207], a[184:187], v[248:251]
global_load_dwordx4 a[204:207], v0, s[72:73] offset:1024
v_mfma_f32_16x16x32_bf16 v[248:251], a[228:231], a[188:191], v[248:251]
v_accvgpr_read_b32 v9, a104
s_waitcnt vmcnt(10)
v_mfma_f32_16x16x32_bf16 v[252:255], a[224:227], a[188:191], v[252:255]
v_accvgpr_read_b32 v11, a105
v_mfma_f32_16x16x32_bf16 v[252:255], a[196:199], a[184:187], v[252:255]
v_lshlrev_b32 v8, 16, v9
v_mfma_f32_16x16x32_bf16 v[220:223], a[196:199], a[180:183], v[220:223]
global_load_dwordx4 a[228:231], v0, s[74:75] offset:1024
v_mfma_f32_16x16x32_bf16 v[220:223], a[224:227], a[176:179], v[220:223]
s_add_u32 s72, s12, 610304
s_addc_u32 s73, s13, 0
v_mfma_f32_16x16x32_bf16 v[188:191], a[224:227], a[172:175], v[188:191]
v_lshlrev_b32 v10, 16, v11
v_mfma_f32_16x16x32_bf16 v[188:191], a[196:199], a[168:171], v[188:191]
v_and_b32 v9, s53, v9
v_mfma_f32_16x16x32_bf16 v[156:159], a[196:199], a[164:167], v[156:159]
s_add_u32 s74, s12, 643072
s_addc_u32 s75, s13, 0
v_mfma_f32_16x16x32_bf16 v[156:159], a[224:227], a[160:163], v[156:159]
v_and_b32 v11, s53, v11
v_mfma_f32_16x16x32_bf16 v[124:127], a[224:227], a[156:159], v[124:127]
s_mov_b32 s60, 229376
v_mfma_f32_16x16x32_bf16 v[124:127], a[196:199], a[152:155], v[124:127]
buffer_store_dwordx4 v[16:19], v0, s[24:27], s60 offen offset:0 sc1
v_mfma_f32_16x16x32_bf16 v[92:95], a[196:199], a[148:151], v[92:95]
v_mul_f32 v12, v12, v84
v_mfma_f32_16x16x32_bf16 v[92:95], a[224:227], a[144:147], v[92:95]
v_mul_f32 v13, v13, v85
v_mfma_f32_16x16x32_bf16 v[60:63], a[224:227], a[140:143], v[60:63]
v_mul_f32 v14, v14, v86
v_mfma_f32_16x16x32_bf16 v[60:63], a[196:199], a[136:139], v[60:63]
v_mfma_f32_16x16x32_bf16 v[28:31], a[196:199], a[132:135], v[28:31]
global_load_dwordx4 a[196:199], v0, s[72:73] offset:-4096
v_mfma_f32_16x16x32_bf16 v[28:31], a[224:227], a[128:131], v[28:31]
v_mul_f32 v15, v15, v87
s_waitcnt vmcnt(11)
v_mfma_f32_16x16x32_bf16 v[32:35], a[216:219], a[128:131], v[32:35]
v_cvt_pk_bf16_f32 v22, v12, v13
v_mfma_f32_16x16x32_bf16 v[32:35], a[212:215], a[132:135], v[32:35]
v_cvt_pk_bf16_f32 v23, v14, v15
v_mfma_f32_16x16x32_bf16 v[64:67], a[212:215], a[136:139], v[64:67]
global_load_dwordx4 a[224:227], v0, s[74:75] offset:-4096
L_pad16:
s_cbranch_execz L_tret0
v_mfma_f32_16x16x32_bf16 v[64:67], a[216:219], a[140:143], v[64:67]
v_accvgpr_read_b32 v13, a106
v_mfma_f32_16x16x32_bf16 v[96:99], a[216:219], a[144:147], v[96:99]
v_accvgpr_read_b32 v15, a107
v_mfma_f32_16x16x32_bf16 v[96:99], a[212:215], a[148:151], v[96:99]
v_lshlrev_b32 v12, 16, v13
v_mfma_f32_16x16x32_bf16 v[128:131], a[212:215], a[152:155], v[128:131]
v_lshlrev_b32 v14, 16, v15
v_mfma_f32_16x16x32_bf16 v[128:131], a[216:219], a[156:159], v[128:131]
v_and_b32 v13, s53, v13
v_and_b32 v15, s53, v15
v_mfma_f32_16x16x32_bf16 v[160:163], a[216:219], a[160:163], v[160:163]
ds_write_b128 v3, v[20:23] offset:1024
v_mfma_f32_16x16x32_bf16 v[160:163], a[212:215], a[164:167], v[160:163]
v_mfma_f32_16x16x32_bf16 v[192:195], a[212:215], a[168:171], v[192:195]
v_mul_f32 v8, v8, v112
v_mfma_f32_16x16x32_bf16 v[192:195], a[216:219], a[172:175], v[192:195]
v_mul_f32 v9, v9, v113
v_mfma_f32_16x16x32_bf16 v[224:227], a[216:219], a[176:179], v[224:227]
v_mul_f32 v10, v10, v114
v_mfma_f32_16x16x32_bf16 v[224:227], a[212:215], a[180:183], v[224:227]
v_mul_f32 v11, v11, v115
v_mfma_f32_16x16x32_bf16 a[232:235], a[212:215], a[184:187], a[232:235]
global_load_dwordx4 a[212:215], v0, s[72:73] offset:-3072
v_mfma_f32_16x16x32_bf16 a[232:235], a[216:219], a[188:191], a[232:235]
v_cvt_pk_bf16_f32 v16, v8, v9
s_waitcnt vmcnt(9)
v_mfma_f32_16x16x32_bf16 a[236:239], a[208:211], a[188:191], a[236:239]
v_cvt_pk_bf16_f32 v17, v10, v11
v_mfma_f32_16x16x32_bf16 a[236:239], a[192:195], a[184:187], a[236:239]
v_mfma_f32_16x16x32_bf16 v[228:231], a[192:195], a[180:183], v[228:231]
global_load_dwordx4 a[216:219], v0, s[74:75] offset:-3072
v_mfma_f32_16x16x32_bf16 v[228:231], a[208:211], a[176:179], v[228:231]
v_accvgpr_read_b32 v9, a108
v_accvgpr_read_b32 v11, a109
v_mfma_f32_16x16x32_bf16 v[196:199], a[208:211], a[172:175], v[196:199]
v_lshlrev_b32 v8, 16, v9
v_mfma_f32_16x16x32_bf16 v[196:199], a[192:195], a[168:171], v[196:199]
v_lshlrev_b32 v10, 16, v11
v_mfma_f32_16x16x32_bf16 v[164:167], a[192:195], a[164:167], v[164:167]
v_and_b32 v9, s53, v9
v_mfma_f32_16x16x32_bf16 v[164:167], a[208:211], a[160:163], v[164:167]
s_add_u32 m0, s56, 16384
v_and_b32 v11, s53, v11
v_mfma_f32_16x16x32_bf16 v[132:135], a[208:211], a[156:159], v[132:135]
buffer_store_dwordx4 v[20:23], v0, s[24:27], s60 offen offset:1024 sc1
v_mfma_f32_16x16x32_bf16 v[132:135], a[192:195], a[152:155], v[132:135]
s_add_u32 s30, s28, 147456
s_addc_u32 s31, s29, 0
v_mfma_f32_16x16x32_bf16 v[100:103], a[192:195], a[148:151], v[100:103]
v_mfma_f32_16x16x32_bf16 v[100:103], a[208:211], a[144:147], v[100:103]
v_mul_f32 v12, v12, v116
v_mfma_f32_16x16x32_bf16 v[68:71], a[208:211], a[140:143], v[68:71]
v_mul_f32 v13, v13, v117
v_mfma_f32_16x16x32_bf16 v[68:71], a[192:195], a[136:139], v[68:71]
v_mul_f32 v14, v14, v118
v_mfma_f32_16x16x32_bf16 v[36:39], a[192:195], a[132:135], v[36:39]
global_load_dwordx4 a[192:195], v0, s[72:73] offset:-2048
v_mfma_f32_16x16x32_bf16 v[36:39], a[208:211], a[128:131], v[36:39]
s_waitcnt vmcnt(10)
v_mfma_f32_16x16x32_bf16 v[40:43], a[200:203], a[128:131], v[40:43]
global_load_lds_dwordx4 v0, s[30:31] nt
v_mfma_f32_16x16x32_bf16 v[40:43], a[220:223], a[132:135], v[40:43]
v_mul_f32 v15, v15, v119
v_mfma_f32_16x16x32_bf16 v[72:75], a[220:223], a[136:139], v[72:75]
global_load_dwordx4 a[208:211], v0, s[74:75] offset:-2048
v_mfma_f32_16x16x32_bf16 v[72:75], a[200:203], a[140:143], v[72:75]
v_cvt_pk_bf16_f32 v18, v12, v13
v_mfma_f32_16x16x32_bf16 v[104:107], a[200:203], a[144:147], v[104:107]
v_cvt_pk_bf16_f32 v19, v14, v15
v_mfma_f32_16x16x32_bf16 v[104:107], a[220:223], a[148:151], v[104:107]
v_accvgpr_read_b32 v13, a110
v_mfma_f32_16x16x32_bf16 v[136:139], a[220:223], a[152:155], v[136:139]
v_accvgpr_read_b32 v15, a111
v_mfma_f32_16x16x32_bf16 v[136:139], a[200:203], a[156:159], v[136:139]
v_lshlrev_b32 v12, 16, v13
v_mfma_f32_16x16x32_bf16 v[168:171], a[200:203], a[160:163], v[168:171]
v_lshlrev_b32 v14, 16, v15
v_mfma_f32_16x16x32_bf16 v[168:171], a[220:223], a[164:167], v[168:171]
v_and_b32 v13, s53, v13
v_mfma_f32_16x16x32_bf16 v[200:203], a[220:223], a[168:171], v[200:203]
v_and_b32 v15, s53, v15
v_mfma_f32_16x16x32_bf16 v[200:203], a[200:203], a[172:175], v[200:203]
ds_write_b128 v3, v[16:19] offset:2048
v_mfma_f32_16x16x32_bf16 v[232:235], a[200:203], a[176:179], v[232:235]
global_load_lds_dwordx4 v0, s[30:31] offset:1024 nt
v_mfma_f32_16x16x32_bf16 v[232:235], a[220:223], a[180:183], v[232:235]
v_mfma_f32_16x16x32_bf16 a[240:243], a[220:223], a[184:187], a[240:243]
global_load_dwordx4 a[220:223], v0, s[72:73] offset:-1024
v_mfma_f32_16x16x32_bf16 a[240:243], a[200:203], a[188:191], a[240:243]
v_mul_f32 v8, v8, v144
s_waitcnt vmcnt(11)
v_mfma_f32_16x16x32_bf16 a[244:247], a[204:207], a[188:191], a[244:247]
ds_read_b128 a[188:191], v2 offset:16384
v_mfma_f32_16x16x32_bf16 a[244:247], a[228:231], a[184:187], a[244:247]
ds_read_b128 a[184:187], v2 offset:24576
v_mul_f32 v9, v9, v145
v_mfma_f32_16x16x32_bf16 v[236:239], a[228:231], a[180:183], v[236:239]
ds_read_b128 a[180:183], v2 offset:25600
v_mfma_f32_16x16x32_bf16 v[236:239], a[204:207], a[176:179], v[236:239]
ds_read_b128 a[176:179], v2 offset:17408
v_mul_f32 v10, v10, v146
v_mfma_f32_16x16x32_bf16 v[204:207], a[204:207], a[172:175], v[204:207]
ds_read_b128 a[172:175], v2 offset:18432
v_mfma_f32_16x16x32_bf16 v[204:207], a[228:231], a[168:171], v[204:207]
ds_read_b128 a[168:171], v2 offset:26624
v_mul_f32 v11, v11, v147
v_mfma_f32_16x16x32_bf16 v[172:175], a[228:231], a[164:167], v[172:175]
ds_read_b128 a[164:167], v2 offset:27648
v_cvt_pk_bf16_f32 v20, v8, v9
v_mfma_f32_16x16x32_bf16 v[172:175], a[204:207], a[160:163], v[172:175]
ds_read_b128 a[160:163], v2 offset:19456
v_mfma_f32_16x16x32_bf16 v[140:143], a[204:207], a[156:159], v[140:143]
ds_read_b128 a[156:159], v2 offset:20480
v_cvt_pk_bf16_f32 v21, v10, v11
v_mfma_f32_16x16x32_bf16 v[140:143], a[228:231], a[152:155], v[140:143]
ds_read_b128 a[152:155], v2 offset:28672
v_mfma_f32_16x16x32_bf16 v[108:111], a[228:231], a[148:151], v[108:111]
ds_read_b128 a[148:151], v2 offset:29696
v_accvgpr_read_b32 v9, a112
v_mfma_f32_16x16x32_bf16 v[108:111], a[204:207], a[144:147], v[108:111]
ds_read_b128 a[144:147], v2 offset:21504
v_mfma_f32_16x16x32_bf16 v[76:79], a[204:207], a[140:143], v[76:79]
ds_read_b128 a[140:143], v2 offset:22528
v_accvgpr_read_b32 v11, a113
v_mfma_f32_16x16x32_bf16 v[76:79], a[228:231], a[136:139], v[76:79]
ds_read_b128 a[136:139], v2 offset:30720
v_lshlrev_b32 v8, 16, v9
v_mfma_f32_16x16x32_bf16 v[44:47], a[228:231], a[132:135], v[44:47]
ds_read_b128 a[132:135], v2 offset:31744
v_mfma_f32_16x16x32_bf16 v[44:47], a[204:207], a[128:131], v[44:47]
ds_read_b128 a[128:131], v2 offset:23552
s_waitcnt vmcnt(8) lgkmcnt(12)
v_mfma_f32_16x16x32_bf16 v[24:27], a[196:199], a[188:191], v[24:27]
global_load_dwordx4 a[200:203], v0, s[74:75] offset:-1024
v_mfma_f32_16x16x32_bf16 v[24:27], a[224:227], a[184:187], v[24:27]
v_lshlrev_b32 v10, 16, v11
v_mfma_f32_16x16x32_bf16 v[56:59], a[224:227], a[180:183], v[56:59]
v_and_b32 v9, s53, v9
v_mfma_f32_16x16x32_bf16 v[56:59], a[196:199], a[176:179], v[56:59]
v_and_b32 v11, s53, v11
s_waitcnt lgkmcnt(8)
v_mfma_f32_16x16x32_bf16 v[88:91], a[196:199], a[172:175], v[88:91]
global_load_dwordx4 a[228:231], v0, s[72:73] offset:0
v_mfma_f32_16x16x32_bf16 v[88:91], a[224:227], a[168:171], v[88:91]
s_add_u32 m0, s56, 24576
v_mfma_f32_16x16x32_bf16 v[120:123], a[224:227], a[164:167], v[120:123]
buffer_store_dwordx4 v[16:19], v0, s[24:27], s60 offen offset:2048 sc1
v_mfma_f32_16x16x32_bf16 v[120:123], a[196:199], a[160:163], v[120:123]
s_waitcnt lgkmcnt(4)
v_mfma_f32_16x16x32_bf16 v[152:155], a[196:199], a[156:159], v[152:155]
global_load_dwordx4 a[204:207], v0, s[74:75] offset:0
v_mfma_f32_16x16x32_bf16 v[152:155], a[224:227], a[152:155], v[152:155]
s_add_u32 s30, s28, 155648
s_addc_u32 s31, s29, 0
v_mfma_f32_16x16x32_bf16 v[184:187], a[224:227], a[148:151], v[184:187]
v_mul_f32 v12, v12, v148
v_mfma_f32_16x16x32_bf16 v[184:187], a[196:199], a[144:147], v[184:187]
v_mul_f32 v13, v13, v149
s_waitcnt lgkmcnt(0)
v_mfma_f32_16x16x32_bf16 v[216:219], a[196:199], a[140:143], v[216:219]
v_mul_f32 v14, v14, v150
s_barrier
v_mfma_f32_16x16x32_bf16 v[216:219], a[224:227], a[136:139], v[216:219]
v_mfma_f32_16x16x32_bf16 v[248:251], a[224:227], a[132:135], v[248:251]
global_load_dwordx4 a[224:227], v0, s[72:73] offset:1024
v_mfma_f32_16x16x32_bf16 v[248:251], a[196:199], a[128:131], v[248:251]
s_waitcnt vmcnt(11)
v_mfma_f32_16x16x32_bf16 v[252:255], a[212:215], a[128:131], v[252:255]
global_load_lds_dwordx4 v0, s[30:31] nt
v_mfma_f32_16x16x32_bf16 v[252:255], a[216:219], a[132:135], v[252:255]
v_mul_f32 v15, v15, v151
v_mfma_f32_16x16x32_bf16 v[220:223], a[216:219], a[136:139], v[220:223]
global_load_dwordx4 a[196:199], v0, s[74:75] offset:1024
v_mfma_f32_16x16x32_bf16 v[220:223], a[212:215], a[140:143], v[220:223]
s_add_u32 s72, s12, 659456
s_addc_u32 s73, s13, 0
v_mfma_f32_16x16x32_bf16 v[188:191], a[212:215], a[144:147], v[188:191]
v_cvt_pk_bf16_f32 v22, v12, v13
v_mfma_f32_16x16x32_bf16 v[188:191], a[216:219], a[148:151], v[188:191]
v_cvt_pk_bf16_f32 v23, v14, v15
v_mfma_f32_16x16x32_bf16 v[156:159], a[216:219], a[152:155], v[156:159]
s_add_u32 s74, s12, 692224
s_addc_u32 s75, s13, 0
v_mfma_f32_16x16x32_bf16 v[156:159], a[212:215], a[156:159], v[156:159]
v_accvgpr_read_b32 v13, a114
v_mfma_f32_16x16x32_bf16 v[124:127], a[212:215], a[160:163], v[124:127]
v_accvgpr_read_b32 v15, a115
v_lshlrev_b32 v12, 16, v13
v_mfma_f32_16x16x32_bf16 v[124:127], a[216:219], a[164:167], v[124:127]
v_lshlrev_b32 v14, 16, v15
v_mfma_f32_16x16x32_bf16 v[92:95], a[216:219], a[168:171], v[92:95]
v_and_b32 v13, s53, v13
v_mfma_f32_16x16x32_bf16 v[92:95], a[212:215], a[172:175], v[92:95]
v_and_b32 v15, s53, v15
v_mfma_f32_16x16x32_bf16 v[60:63], a[212:215], a[176:179], v[60:63]
ds_write_b128 v3, v[20:23] offset:3072
v_mfma_f32_16x16x32_bf16 v[60:63], a[216:219], a[180:183], v[60:63]
v_mfma_f32_16x16x32_bf16 v[28:31], a[216:219], a[184:187], v[28:31]
global_load_dwordx4 a[216:219], v0, s[72:73] offset:-4096
v_mfma_f32_16x16x32_bf16 v[28:31], a[212:215], a[188:191], v[28:31]
s_waitcnt vmcnt(10)
v_mfma_f32_16x16x32_bf16 v[32:35], a[192:195], a[188:191], v[32:35]
global_load_lds_dwordx4 v0, s[30:31] offset:1024 nt
v_mfma_f32_16x16x32_bf16 v[32:35], a[208:211], a[184:187], v[32:35]
v_mfma_f32_16x16x32_bf16 v[64:67], a[208:211], a[180:183], v[64:67]
global_load_dwordx4 a[212:215], v0, s[74:75] offset:-4096
v_mfma_f32_16x16x32_bf16 v[64:67], a[192:195], a[176:179], v[64:67]
v_mul_f32 v8, v8, v176
v_mul_f32 v9, v9, v177
v_mfma_f32_16x16x32_bf16 v[96:99], a[192:195], a[172:175], v[96:99]
v_mul_f32 v10, v10, v178
v_mfma_f32_16x16x32_bf16 v[96:99], a[208:211], a[168:171], v[96:99]
v_mul_f32 v11, v11, v179
v_mfma_f32_16x16x32_bf16 v[128:131], a[208:211], a[164:167], v[128:131]
v_cvt_pk_bf16_f32 v16, v8, v9
v_mfma_f32_16x16x32_bf16 v[128:131], a[192:195], a[160:163], v[128:131]
v_cvt_pk_bf16_f32 v17, v10, v11
v_mfma_f32_16x16x32_bf16 v[160:163], a[192:195], a[156:159], v[160:163]
v_accvgpr_read_b32 v9, a116
v_mfma_f32_16x16x32_bf16 v[160:163], a[208:211], a[152:155], v[160:163]
v_accvgpr_read_b32 v11, a117
v_mfma_f32_16x16x32_bf16 v[192:195], a[208:211], a[148:151], v[192:195]
v_lshlrev_b32 v8, 16, v9
v_lshlrev_b32 v10, 16, v11
v_mfma_f32_16x16x32_bf16 v[192:195], a[192:195], a[144:147], v[192:195]
v_and_b32 v9, s53, v9
v_mfma_f32_16x16x32_bf16 v[224:227], a[192:195], a[140:143], v[224:227]
v_and_b32 v11, s53, v11
v_mfma_f32_16x16x32_bf16 v[224:227], a[208:211], a[136:139], v[224:227]
s_mov_b32 s34, 704
v_mfma_f32_16x16x32_bf16 a[232:235], a[208:211], a[132:135], a[232:235]
global_load_dwordx4 a[208:211], v0, s[72:73] offset:-3072
v_mfma_f32_16x16x32_bf16 a[232:235], a[192:195], a[128:131], a[232:235]
s_waitcnt vmcnt(10)
v_mfma_f32_16x16x32_bf16 a[236:239], a[220:223], a[128:131], a[236:239]
buffer_load_dword v5, v0, s[32:35], 0 offen offset:640 sc1
v_mfma_f32_16x16x32_bf16 a[236:239], a[200:203], a[132:135], a[236:239]
buffer_store_dwordx4 v[20:23], v0, s[24:27], s60 offen offset:3072 sc1
v_mfma_f32_16x16x32_bf16 v[228:231], a[200:203], a[136:139], v[228:231]
global_load_dwordx4 a[192:195], v0, s[74:75] offset:-3072
v_mfma_f32_16x16x32_bf16 v[228:231], a[220:223], a[140:143], v[228:231]
v_mfma_f32_16x16x32_bf16 v[196:199], a[220:223], a[144:147], v[196:199]
v_mul_f32 v12, v12, v180
v_mfma_f32_16x16x32_bf16 v[196:199], a[200:203], a[148:151], v[196:199]
v_mul_f32 v13, v13, v181
s_mov_b64 exec, 0
s_cmp_eq_u32 s55, 0
s_cbranch_scc1 L_pad17
s_cmp_eq_u32 s55, 1
s_cbranch_scc1 L_pad18
s_cmp_eq_u32 s55, 2
s_cbranch_scc1 L_pad19
s_branch L_pad20
L_tret1:
s_mov_b64 exec, -1

v_mfma_f32_16x16x32_bf16 v[164:167], a[200:203], a[152:155], v[164:167]
v_mul_f32 v14, v14, v182
v_mfma_f32_16x16x32_bf16 v[164:167], a[220:223], a[156:159], v[164:167]
v_mul_f32 v15, v15, v183
v_mfma_f32_16x16x32_bf16 v[132:135], a[220:223], a[160:163], v[132:135]
v_cvt_pk_bf16_f32 v18, v12, v13
v_cvt_pk_bf16_f32 v19, v14, v15
v_mfma_f32_16x16x32_bf16 v[132:135], a[200:203], a[164:167], v[132:135]
v_accvgpr_read_b32 v13, a118
v_mfma_f32_16x16x32_bf16 v[100:103], a[200:203], a[168:171], v[100:103]
v_accvgpr_read_b32 v15, a119
v_mfma_f32_16x16x32_bf16 v[100:103], a[220:223], a[172:175], v[100:103]
v_lshlrev_b32 v12, 16, v13
v_mfma_f32_16x16x32_bf16 v[68:71], a[220:223], a[176:179], v[68:71]
v_lshlrev_b32 v14, 16, v15
v_mfma_f32_16x16x32_bf16 v[68:71], a[200:203], a[180:183], v[68:71]
v_and_b32 v13, s53, v13
v_mfma_f32_16x16x32_bf16 v[36:39], a[200:203], a[184:187], v[36:39]
global_load_dwordx4 a[200:203], v0, s[72:73] offset:-2048
v_mfma_f32_16x16x32_bf16 v[36:39], a[220:223], a[188:191], v[36:39]
v_and_b32 v15, s53, v15
s_waitcnt vmcnt(11)
v_mfma_f32_16x16x32_bf16 v[40:43], a[228:231], a[188:191], v[40:43]
ds_write_b128 v3, v[16:19] offset:4096
v_mfma_f32_16x16x32_bf16 v[40:43], a[204:207], a[184:187], v[40:43]
v_mfma_f32_16x16x32_bf16 v[72:75], a[204:207], a[180:183], v[72:75]
global_load_dwordx4 a[220:223], v0, s[74:75] offset:-2048
v_mfma_f32_16x16x32_bf16 v[72:75], a[228:231], a[176:179], v[72:75]
v_mfma_f32_16x16x32_bf16 v[104:107], a[228:231], a[172:175], v[104:107]
v_mul_f32 v8, v8, v208
v_mul_f32 v9, v9, v209
v_mfma_f32_16x16x32_bf16 v[104:107], a[204:207], a[168:171], v[104:107]
v_mul_f32 v10, v10, v210
v_mfma_f32_16x16x32_bf16 v[136:139], a[204:207], a[164:167], v[136:139]
v_mul_f32 v11, v11, v211
v_mfma_f32_16x16x32_bf16 v[136:139], a[228:231], a[160:163], v[136:139]
v_cvt_pk_bf16_f32 v20, v8, v9
v_mfma_f32_16x16x32_bf16 v[168:171], a[228:231], a[156:159], v[168:171]
v_cvt_pk_bf16_f32 v21, v10, v11
v_mfma_f32_16x16x32_bf16 v[168:171], a[204:207], a[152:155], v[168:171]
v_accvgpr_read_b32 v9, a120
v_mfma_f32_16x16x32_bf16 v[200:203], a[204:207], a[148:151], v[200:203]
v_accvgpr_read_b32 v11, a121
v_mfma_f32_16x16x32_bf16 v[200:203], a[228:231], a[144:147], v[200:203]
v_lshlrev_b32 v8, 16, v9
v_mfma_f32_16x16x32_bf16 v[232:235], a[228:231], a[140:143], v[232:235]
v_lshlrev_b32 v10, 16, v11
v_and_b32 v9, s53, v9
v_mfma_f32_16x16x32_bf16 v[232:235], a[204:207], a[136:139], v[232:235]
v_mfma_f32_16x16x32_bf16 a[240:243], a[204:207], a[132:135], a[240:243]
global_load_dwordx4 a[204:207], v0, s[72:73] offset:-1024
v_mfma_f32_16x16x32_bf16 a[240:243], a[228:231], a[128:131], a[240:243]
v_add_u32 v2, 0, v0
s_waitcnt vmcnt(10)
v_mfma_f32_16x16x32_bf16 a[244:247], a[224:227], a[128:131], a[244:247]
ds_read_b128 a[128:131], v2 offset:0
v_and_b32 v11, s53, v11
v_mfma_f32_16x16x32_bf16 a[244:247], a[196:199], a[132:135], a[244:247]
ds_read_b128 a[132:135], v2 offset:8192
s_mov_b32 s60, 233472
v_mfma_f32_16x16x32_bf16 v[236:239], a[196:199], a[136:139], v[236:239]
ds_read_b128 a[136:139], v2 offset:9216
v_mfma_f32_16x16x32_bf16 v[236:239], a[224:227], a[140:143], v[236:239]
ds_read_b128 a[140:143], v2 offset:1024
v_mfma_f32_16x16x32_bf16 v[204:207], a[224:227], a[144:147], v[204:207]
ds_read_b128 a[144:147], v2 offset:2048
v_mfma_f32_16x16x32_bf16 v[204:207], a[196:199], a[148:151], v[204:207]
ds_read_b128 a[148:151], v2 offset:10240
v_mfma_f32_16x16x32_bf16 v[172:175], a[196:199], a[152:155], v[172:175]
ds_read_b128 a[152:155], v2 offset:11264
v_mfma_f32_16x16x32_bf16 v[172:175], a[224:227], a[156:159], v[172:175]
ds_read_b128 a[156:159], v2 offset:3072
v_mul_f32 v12, v12, v212
v_mfma_f32_16x16x32_bf16 v[140:143], a[224:227], a[160:163], v[140:143]
ds_read_b128 a[160:163], v2 offset:4096
v_mul_f32 v13, v13, v213
v_mfma_f32_16x16x32_bf16 v[140:143], a[196:199], a[164:167], v[140:143]
ds_read_b128 a[164:167], v2 offset:12288
v_mfma_f32_16x16x32_bf16 v[108:111], a[196:199], a[168:171], v[108:111]
ds_read_b128 a[168:171], v2 offset:13312
v_mul_f32 v14, v14, v214
v_mfma_f32_16x16x32_bf16 v[108:111], a[224:227], a[172:175], v[108:111]
ds_read_b128 a[172:175], v2 offset:5120
v_mfma_f32_16x16x32_bf16 v[76:79], a[224:227], a[176:179], v[76:79]
ds_read_b128 a[176:179], v2 offset:6144
v_mul_f32 v15, v15, v215
v_mfma_f32_16x16x32_bf16 v[76:79], a[196:199], a[180:183], v[76:79]
ds_read_b128 a[180:183], v2 offset:14336
v_mfma_f32_16x16x32_bf16 v[44:47], a[196:199], a[184:187], v[44:47]
ds_read_b128 a[184:187], v2 offset:15360
v_cvt_pk_bf16_f32 v22, v12, v13
v_mfma_f32_16x16x32_bf16 v[44:47], a[224:227], a[188:191], v[44:47]
ds_read_b128 a[188:191], v2 offset:7168
s_waitcnt vmcnt(7) lgkmcnt(12)
v_mfma_f32_16x16x32_bf16 v[24:27], a[216:219], a[128:131], v[24:27]
global_load_dwordx4 a[228:231], v0, s[74:75] offset:-1024
v_mfma_f32_16x16x32_bf16 v[24:27], a[212:215], a[132:135], v[24:27]
buffer_store_dwordx4 v[16:19], v0, s[24:27], s60 offen offset:0 sc1
v_mfma_f32_16x16x32_bf16 v[56:59], a[212:215], a[136:139], v[56:59]
v_cvt_pk_bf16_f32 v23, v14, v15
v_accvgpr_read_b32 v13, a122
v_mfma_f32_16x16x32_bf16 v[56:59], a[216:219], a[140:143], v[56:59]
v_accvgpr_read_b32 v15, a123
s_waitcnt lgkmcnt(8)
v_mfma_f32_16x16x32_bf16 v[88:91], a[216:219], a[144:147], v[88:91]
global_load_dwordx4 a[196:199], v0, s[72:73] offset:0
v_mfma_f32_16x16x32_bf16 v[88:91], a[212:215], a[148:151], v[88:91]
v_lshlrev_b32 v12, 16, v13
v_mfma_f32_16x16x32_bf16 v[120:123], a[212:215], a[152:155], v[120:123]
v_lshlrev_b32 v14, 16, v15
v_mfma_f32_16x16x32_bf16 v[120:123], a[216:219], a[156:159], v[120:123]
s_waitcnt lgkmcnt(4)
v_mfma_f32_16x16x32_bf16 v[152:155], a[216:219], a[160:163], v[152:155]
global_load_dwordx4 a[224:227], v0, s[74:75] offset:0
v_mfma_f32_16x16x32_bf16 v[152:155], a[212:215], a[164:167], v[152:155]
v_and_b32 v13, s53, v13
v_mfma_f32_16x16x32_bf16 v[184:187], a[212:215], a[168:171], v[184:187]
v_and_b32 v15, s53, v15
v_mfma_f32_16x16x32_bf16 v[184:187], a[216:219], a[172:175], v[184:187]
s_waitcnt lgkmcnt(0)
v_mfma_f32_16x16x32_bf16 v[216:219], a[216:219], a[176:179], v[216:219]
s_barrier
v_mfma_f32_16x16x32_bf16 v[216:219], a[212:215], a[180:183], v[216:219]
s_waitcnt vmcnt(9)
v_mul_f32 v8, v8, v240
v_mfma_f32_16x16x32_bf16 v[248:251], a[212:215], a[184:187], v[248:251]
global_load_dwordx4 a[212:215], v0, s[72:73] offset:1024
v_mfma_f32_16x16x32_bf16 v[248:251], a[216:219], a[188:191], v[248:251]
s_waitcnt vmcnt(8)
v_mfma_f32_16x16x32_bf16 v[252:255], a[208:211], a[188:191], v[252:255]
v_cmp_ne_u32 vcc, 16256, v5
v_mul_f32 v9, v9, v241
v_mfma_f32_16x16x32_bf16 v[252:255], a[192:195], a[184:187], v[252:255]
ds_write_b128 v3, v[20:23] offset:5120
v_mfma_f32_16x16x32_bf16 v[220:223], a[192:195], a[180:183], v[220:223]
global_load_dwordx4 a[216:219], v0, s[74:75] offset:1024
v_mfma_f32_16x16x32_bf16 v[220:223], a[208:211], a[176:179], v[220:223]
v_mul_f32 v10, v10, v242
v_mul_f32 v11, v11, v243
v_mfma_f32_16x16x32_bf16 v[188:191], a[208:211], a[172:175], v[188:191]
s_and_b32 s3, vcc_lo, 15
s_cbranch_scc1 L_slow7
L_back7:
v_mfma_f32_16x16x32_bf16 v[188:191], a[192:195], a[168:171], v[188:191]
v_cvt_pk_bf16_f32 v16, v8, v9
v_mfma_f32_16x16x32_bf16 v[156:159], a[192:195], a[164:167], v[156:159]
v_cvt_pk_bf16_f32 v17, v10, v11
v_mfma_f32_16x16x32_bf16 v[156:159], a[208:211], a[160:163], v[156:159]
s_add_u32 m0, s56, 0
v_accvgpr_read_b32 v9, a124
v_mfma_f32_16x16x32_bf16 v[124:127], a[208:211], a[156:159], v[124:127]
s_add_u32 s30, s28, 163840
s_addc_u32 s31, s29, 0
v_mfma_f32_16x16x32_bf16 v[124:127], a[192:195], a[152:155], v[124:127]
v_accvgpr_read_b32 v11, a125
v_mfma_f32_16x16x32_bf16 v[92:95], a[192:195], a[148:151], v[92:95]
v_lshlrev_b32 v8, 16, v9
v_mfma_f32_16x16x32_bf16 v[92:95], a[208:211], a[144:147], v[92:95]
global_load_lds_dwordx4 v0, s[30:31] nt
v_mfma_f32_16x16x32_bf16 v[60:63], a[208:211], a[140:143], v[60:63]
v_lshlrev_b32 v10, 16, v11
v_mfma_f32_16x16x32_bf16 v[60:63], a[192:195], a[136:139], v[60:63]
v_and_b32 v9, s53, v9
v_mfma_f32_16x16x32_bf16 v[28:31], a[192:195], a[132:135], v[28:31]
global_load_dwordx4 a[192:195], v0, s[72:73] offset:2048
v_mfma_f32_16x16x32_bf16 v[28:31], a[208:211], a[128:131], v[28:31]
s_waitcnt vmcnt(9)
v_mfma_f32_16x16x32_bf16 v[32:35], a[200:203], a[128:131], v[32:35]
v_and_b32 v11, s53, v11
v_mfma_f32_16x16x32_bf16 v[32:35], a[220:223], a[132:135], v[32:35]
buffer_store_dwordx4 v[20:23], v0, s[24:27], s60 offen offset:1024 sc1
v_mfma_f32_16x16x32_bf16 v[64:67], a[220:223], a[136:139], v[64:67]
global_load_dwordx4 a[208:211], v0, s[74:75] offset:2048
v_mfma_f32_16x16x32_bf16 v[64:67], a[200:203], a[140:143], v[64:67]
v_mfma_f32_16x16x32_bf16 v[96:99], a[200:203], a[144:147], v[96:99]
v_mul_f32 v12, v12, v244
v_mfma_f32_16x16x32_bf16 v[96:99], a[220:223], a[148:151], v[96:99]
v_mfma_f32_16x16x32_bf16 v[128:131], a[220:223], a[152:155], v[128:131]
global_load_lds_dwordx4 v0, s[30:31] offset:1024 nt
v_mfma_f32_16x16x32_bf16 v[128:131], a[200:203], a[156:159], v[128:131]
v_mul_f32 v13, v13, v245
v_mul_f32 v14, v14, v246
v_mfma_f32_16x16x32_bf16 v[160:163], a[200:203], a[160:163], v[160:163]
v_mul_f32 v15, v15, v247
v_mfma_f32_16x16x32_bf16 v[160:163], a[220:223], a[164:167], v[160:163]
v_cvt_pk_bf16_f32 v18, v12, v13
v_mfma_f32_16x16x32_bf16 v[192:195], a[220:223], a[168:171], v[192:195]
v_cvt_pk_bf16_f32 v19, v14, v15
v_mfma_f32_16x16x32_bf16 v[192:195], a[200:203], a[172:175], v[192:195]
v_accvgpr_read_b32 v13, a126
v_mfma_f32_16x16x32_bf16 v[224:227], a[200:203], a[176:179], v[224:227]
v_accvgpr_read_b32 v15, a127
v_mfma_f32_16x16x32_bf16 v[224:227], a[220:223], a[180:183], v[224:227]
v_lshlrev_b32 v12, 16, v13
v_mfma_f32_16x16x32_bf16 a[232:235], a[220:223], a[184:187], a[232:235]
global_load_dwordx4 a[220:223], v0, s[72:73] offset:3072
v_mfma_f32_16x16x32_bf16 a[232:235], a[200:203], a[188:191], a[232:235]
s_add_u32 m0, s56, 8192
s_waitcnt vmcnt(11)
v_mfma_f32_16x16x32_bf16 a[236:239], a[204:207], a[188:191], a[236:239]
s_add_u32 s30, s28, 172032
s_addc_u32 s31, s29, 0
v_mfma_f32_16x16x32_bf16 a[236:239], a[228:231], a[184:187], a[236:239]
v_lshlrev_b32 v14, 16, v15
v_mfma_f32_16x16x32_bf16 v[228:231], a[228:231], a[180:183], v[228:231]
global_load_dwordx4 a[200:203], v0, s[74:75] offset:3072
v_mfma_f32_16x16x32_bf16 v[228:231], a[204:207], a[176:179], v[228:231]
s_add_u32 s72, s12, 724992
s_addc_u32 s73, s13, 0
v_mfma_f32_16x16x32_bf16 v[196:199], a[204:207], a[172:175], v[196:199]
v_and_b32 v13, s53, v13
v_mfma_f32_16x16x32_bf16 v[196:199], a[228:231], a[168:171], v[196:199]
v_and_b32 v15, s53, v15
v_mfma_f32_16x16x32_bf16 v[164:167], a[228:231], a[164:167], v[164:167]
s_add_u32 s74, s12, 757760
s_addc_u32 s75, s13, 0
v_mfma_f32_16x16x32_bf16 v[164:167], a[204:207], a[160:163], v[164:167]
global_load_lds_dwordx4 v0, s[30:31] nt
v_mfma_f32_16x16x32_bf16 v[132:135], a[204:207], a[156:159], v[132:135]
ds_write_b128 v3, v[16:19] offset:6144
v_mfma_f32_16x16x32_bf16 v[132:135], a[228:231], a[152:155], v[132:135]
v_mfma_f32_16x16x32_bf16 v[100:103], a[228:231], a[148:151], v[100:103]
v_accvgpr_read_b32 v20, a248
v_mfma_f32_16x16x32_bf16 v[100:103], a[204:207], a[144:147], v[100:103]
v_accvgpr_read_b32 v21, a249
v_mul_f32 v8, v8, v20
v_mfma_f32_16x16x32_bf16 v[68:71], a[204:207], a[140:143], v[68:71]
v_mul_f32 v9, v9, v21
v_mfma_f32_16x16x32_bf16 v[68:71], a[228:231], a[136:139], v[68:71]
v_mfma_f32_16x16x32_bf16 v[36:39], a[228:231], a[132:135], v[36:39]
global_load_dwordx4 a[228:231], v0, s[72:73] offset:-4096
v_mfma_f32_16x16x32_bf16 v[36:39], a[204:207], a[128:131], v[36:39]
v_accvgpr_read_b32 v20, a250
s_waitcnt vmcnt(11)
v_mfma_f32_16x16x32_bf16 v[40:43], a[196:199], a[128:131], v[40:43]
global_load_lds_dwordx4 v0, s[30:31] offset:1024 nt
v_mfma_f32_16x16x32_bf16 v[40:43], a[224:227], a[132:135], v[40:43]
v_mfma_f32_16x16x32_bf16 v[72:75], a[224:227], a[136:139], v[72:75]
global_load_dwordx4 a[204:207], v0, s[74:75] offset:-4096
v_mfma_f32_16x16x32_bf16 v[72:75], a[196:199], a[140:143], v[72:75]
v_accvgpr_read_b32 v21, a251
v_mfma_f32_16x16x32_bf16 v[104:107], a[196:199], a[144:147], v[104:107]
v_mul_f32 v10, v10, v20
v_mfma_f32_16x16x32_bf16 v[104:107], a[224:227], a[148:151], v[104:107]
v_mul_f32 v11, v11, v21
v_mfma_f32_16x16x32_bf16 v[136:139], a[224:227], a[152:155], v[136:139]
v_cvt_pk_bf16_f32 v20, v8, v9
v_cvt_pk_bf16_f32 v21, v10, v11
v_mfma_f32_16x16x32_bf16 v[136:139], a[196:199], a[156:159], v[136:139]
buffer_store_dwordx4 v[16:19], v0, s[24:27], s60 offen offset:2048 sc1
v_mfma_f32_16x16x32_bf16 v[168:171], a[196:199], a[160:163], v[168:171]
v_mfma_f32_16x16x32_bf16 v[168:171], a[224:227], a[164:167], v[168:171]
v_accvgpr_read_b32 v22, a252
v_mfma_f32_16x16x32_bf16 v[200:203], a[224:227], a[168:171], v[200:203]
v_accvgpr_read_b32 v23, a253
v_mfma_f32_16x16x32_bf16 v[200:203], a[196:199], a[172:175], v[200:203]
v_mul_f32 v12, v12, v22
v_mfma_f32_16x16x32_bf16 v[232:235], a[196:199], a[176:179], v[232:235]
v_mul_f32 v13, v13, v23
v_mfma_f32_16x16x32_bf16 v[232:235], a[224:227], a[180:183], v[232:235]
v_mfma_f32_16x16x32_bf16 a[240:243], a[224:227], a[184:187], a[240:243]
global_load_dwordx4 a[224:227], v0, s[72:73] offset:-3072
v_mfma_f32_16x16x32_bf16 a[240:243], a[196:199], a[188:191], a[240:243]
v_accvgpr_read_b32 v22, a254
s_waitcnt vmcnt(13)
v_mfma_f32_16x16x32_bf16 a[244:247], a[212:215], a[188:191], a[244:247]
v_accvgpr_read_b32 v23, a255
v_mfma_f32_16x16x32_bf16 a[244:247], a[216:219], a[184:187], a[244:247]
v_mul_f32 v14, v14, v22
v_mfma_f32_16x16x32_bf16 v[236:239], a[216:219], a[180:183], v[236:239]
global_load_dwordx4 a[196:199], v0, s[74:75] offset:-3072
v_mfma_f32_16x16x32_bf16 v[236:239], a[212:215], a[176:179], v[236:239]
v_mul_f32 v15, v15, v23
v_mfma_f32_16x16x32_bf16 v[204:207], a[212:215], a[172:175], v[204:207]
v_cvt_pk_bf16_f32 v22, v12, v13
v_mfma_f32_16x16x32_bf16 v[204:207], a[216:219], a[168:171], v[204:207]
v_cvt_pk_bf16_f32 v23, v14, v15
v_mfma_f32_16x16x32_bf16 v[172:175], a[216:219], a[164:167], v[172:175]
ds_write_b128 v3, v[20:23] offset:7168
v_mfma_f32_16x16x32_bf16 v[172:175], a[212:215], a[160:163], v[172:175]
buffer_store_dwordx4 v[20:23], v0, s[24:27], s60 offen offset:3072 sc1
v_mfma_f32_16x16x32_bf16 v[140:143], a[212:215], a[156:159], v[140:143]
v_mfma_f32_16x16x32_bf16 v[140:143], a[216:219], a[152:155], v[140:143]
v_mfma_f32_16x16x32_bf16 v[108:111], a[216:219], a[148:151], v[108:111]
v_mfma_f32_16x16x32_bf16 v[108:111], a[212:215], a[144:147], v[108:111]
v_mfma_f32_16x16x32_bf16 v[76:79], a[212:215], a[140:143], v[76:79]
v_mfma_f32_16x16x32_bf16 v[76:79], a[216:219], a[136:139], v[76:79]
v_mfma_f32_16x16x32_bf16 v[44:47], a[216:219], a[132:135], v[44:47]
global_load_dwordx4 a[216:219], v0, s[72:73] offset:-2048
v_mfma_f32_16x16x32_bf16 v[44:47], a[212:215], a[128:131], v[44:47]
s_waitcnt vmcnt(12)
v_mfma_f32_16x16x32_bf16 v[48:51], a[192:195], a[128:131], v[48:51]
v_mfma_f32_16x16x32_bf16 v[48:51], a[208:211], a[132:135], v[48:51]
v_mfma_f32_16x16x32_bf16 v[80:83], a[208:211], a[136:139], v[80:83]
global_load_dwordx4 a[212:215], v0, s[74:75] offset:-2048
v_mfma_f32_16x16x32_bf16 v[80:83], a[192:195], a[140:143], v[80:83]
v_mfma_f32_16x16x32_bf16 v[112:115], a[192:195], a[144:147], v[112:115]
v_mfma_f32_16x16x32_bf16 v[112:115], a[208:211], a[148:151], v[112:115]
v_mfma_f32_16x16x32_bf16 v[144:147], a[208:211], a[152:155], v[144:147]
v_mfma_f32_16x16x32_bf16 v[144:147], a[192:195], a[156:159], v[144:147]
v_mfma_f32_16x16x32_bf16 v[176:179], a[192:195], a[160:163], v[176:179]
v_mfma_f32_16x16x32_bf16 v[176:179], a[208:211], a[164:167], v[176:179]
v_mfma_f32_16x16x32_bf16 v[208:211], a[208:211], a[168:171], v[208:211]
v_mfma_f32_16x16x32_bf16 v[208:211], a[192:195], a[172:175], v[208:211]
v_mfma_f32_16x16x32_bf16 v[240:243], a[192:195], a[176:179], v[240:243]
v_mfma_f32_16x16x32_bf16 v[240:243], a[208:211], a[180:183], v[240:243]
v_mfma_f32_16x16x32_bf16 a[248:251], a[208:211], a[184:187], a[248:251]
global_load_dwordx4 a[208:211], v0, s[72:73] offset:-1024
v_mfma_f32_16x16x32_bf16 a[248:251], a[192:195], a[188:191], a[248:251]
s_waitcnt vmcnt(11)
v_mfma_f32_16x16x32_bf16 a[252:255], a[220:223], a[188:191], a[252:255]
ds_read_b128 a[188:191], v2 offset:16384
v_mfma_f32_16x16x32_bf16 a[252:255], a[200:203], a[184:187], a[252:255]
ds_read_b128 a[184:187], v2 offset:24576
v_mfma_f32_16x16x32_bf16 v[244:247], a[200:203], a[180:183], v[244:247]
ds_read_b128 a[180:183], v2 offset:25600
v_mfma_f32_16x16x32_bf16 v[244:247], a[220:223], a[176:179], v[244:247]
ds_read_b128 a[176:179], v2 offset:17408
v_mfma_f32_16x16x32_bf16 v[212:215], a[220:223], a[172:175], v[212:215]
ds_read_b128 a[172:175], v2 offset:18432
v_mfma_f32_16x16x32_bf16 v[212:215], a[200:203], a[168:171], v[212:215]
ds_read_b128 a[168:171], v2 offset:26624
v_mfma_f32_16x16x32_bf16 v[180:183], a[200:203], a[164:167], v[180:183]
ds_read_b128 a[164:167], v2 offset:27648
v_mfma_f32_16x16x32_bf16 v[180:183], a[220:223], a[160:163], v[180:183]
ds_read_b128 a[160:163], v2 offset:19456
v_mfma_f32_16x16x32_bf16 v[148:151], a[220:223], a[156:159], v[148:151]
L_pad17:
s_cbranch_execz L_pad21
ds_read_b128 a[156:159], v2 offset:20480
v_mfma_f32_16x16x32_bf16 v[148:151], a[200:203], a[152:155], v[148:151]
ds_read_b128 a[152:155], v2 offset:28672
v_mfma_f32_16x16x32_bf16 v[116:119], a[200:203], a[148:151], v[116:119]
ds_read_b128 a[148:151], v2 offset:29696
v_mfma_f32_16x16x32_bf16 v[116:119], a[220:223], a[144:147], v[116:119]
ds_read_b128 a[144:147], v2 offset:21504
v_mfma_f32_16x16x32_bf16 v[84:87], a[220:223], a[140:143], v[84:87]
ds_read_b128 a[140:143], v2 offset:22528
v_mfma_f32_16x16x32_bf16 v[84:87], a[200:203], a[136:139], v[84:87]
ds_read_b128 a[136:139], v2 offset:30720
v_mfma_f32_16x16x32_bf16 v[52:55], a[200:203], a[132:135], v[52:55]
ds_read_b128 a[132:135], v2 offset:31744
v_mfma_f32_16x16x32_bf16 v[52:55], a[220:223], a[128:131], v[52:55]
ds_read_b128 a[128:131], v2 offset:23552
s_waitcnt vmcnt(7) lgkmcnt(12)
v_mfma_f32_16x16x32_bf16 v[24:27], a[228:231], a[188:191], v[24:27]
global_load_dwordx4 a[192:195], v0, s[74:75] offset:-1024
v_mfma_f32_16x16x32_bf16 v[24:27], a[204:207], a[184:187], v[24:27]
v_lshrrev_b32 v16, 4, v0
v_and_b32 v16, 48, v16
v_mfma_f32_16x16x32_bf16 v[56:59], a[204:207], a[180:183], v[56:59]
s_add_u32 s67, s66, 4096
v_mfma_f32_16x16x32_bf16 v[56:59], a[228:231], a[176:179], v[56:59]
s_waitcnt lgkmcnt(8)
v_mfma_f32_16x16x32_bf16 v[88:91], a[228:231], a[172:175], v[88:91]
global_load_dwordx4 a[200:203], v0, s[72:73] offset:0
v_mfma_f32_16x16x32_bf16 v[88:91], a[204:207], a[168:171], v[88:91]
buffer_load_dwordx4 v[16:19], v16, s[16:19], s67 offen offset:0
v_mfma_f32_16x16x32_bf16 v[120:123], a[204:207], a[164:167], v[120:123]
v_mfma_f32_16x16x32_bf16 v[120:123], a[228:231], a[160:163], v[120:123]
s_waitcnt lgkmcnt(4)
v_mfma_f32_16x16x32_bf16 v[152:155], a[228:231], a[156:159], v[152:155]
global_load_dwordx4 a[220:223], v0, s[74:75] offset:0
v_mfma_f32_16x16x32_bf16 v[152:155], a[204:207], a[152:155], v[152:155]
v_mfma_f32_16x16x32_bf16 v[184:187], a[204:207], a[148:151], v[184:187]
v_mfma_f32_16x16x32_bf16 v[184:187], a[228:231], a[144:147], v[184:187]
s_waitcnt lgkmcnt(0)
v_mfma_f32_16x16x32_bf16 v[216:219], a[228:231], a[140:143], v[216:219]
s_barrier
v_mfma_f32_16x16x32_bf16 v[216:219], a[204:207], a[136:139], v[216:219]
s_add_u32 m0, s56, 16384
v_mfma_f32_16x16x32_bf16 v[248:251], a[204:207], a[132:135], v[248:251]
global_load_dwordx4 a[204:207], v0, s[72:73] offset:1024
v_mfma_f32_16x16x32_bf16 v[248:251], a[228:231], a[128:131], v[248:251]
s_waitcnt vmcnt(9)
v_mfma_f32_16x16x32_bf16 v[252:255], a[224:227], a[128:131], v[252:255]
s_add_u32 s30, s28, 180224
s_addc_u32 s31, s29, 0
v_mfma_f32_16x16x32_bf16 v[252:255], a[196:199], a[132:135], v[252:255]
v_mfma_f32_16x16x32_bf16 v[220:223], a[196:199], a[136:139], v[220:223]
global_load_dwordx4 a[228:231], v0, s[74:75] offset:1024
v_mfma_f32_16x16x32_bf16 v[220:223], a[224:227], a[140:143], v[220:223]
v_mfma_f32_16x16x32_bf16 v[188:191], a[224:227], a[144:147], v[188:191]
v_mfma_f32_16x16x32_bf16 v[188:191], a[196:199], a[148:151], v[188:191]
global_load_lds_dwordx4 v0, s[30:31] nt
v_mfma_f32_16x16x32_bf16 v[156:159], a[196:199], a[152:155], v[156:159]
v_mfma_f32_16x16x32_bf16 v[156:159], a[224:227], a[156:159], v[156:159]
v_mfma_f32_16x16x32_bf16 v[124:127], a[224:227], a[160:163], v[124:127]
v_mfma_f32_16x16x32_bf16 v[124:127], a[196:199], a[164:167], v[124:127]
v_mfma_f32_16x16x32_bf16 v[92:95], a[196:199], a[168:171], v[92:95]
s_mov_b32 s38, 900
s_waitcnt vmcnt(10)
v_mfma_f32_16x16x32_bf16 v[92:95], a[224:227], a[172:175], v[92:95]
buffer_store_dword v6, v0, s[36:39], 0 offen offset:896 sc1
v_mfma_f32_16x16x32_bf16 v[60:63], a[224:227], a[176:179], v[60:63]
v_mfma_f32_16x16x32_bf16 v[60:63], a[196:199], a[180:183], v[60:63]
v_mfma_f32_16x16x32_bf16 v[28:31], a[196:199], a[184:187], v[28:31]
global_load_dwordx4 a[196:199], v0, s[72:73] offset:2048
v_mfma_f32_16x16x32_bf16 v[28:31], a[224:227], a[188:191], v[28:31]
s_waitcnt vmcnt(10)
v_mfma_f32_16x16x32_bf16 v[32:35], a[216:219], a[188:191], v[32:35]
global_load_lds_dwordx4 v0, s[30:31] offset:1024 nt
v_mfma_f32_16x16x32_bf16 v[32:35], a[212:215], a[184:187], v[32:35]
v_mfma_f32_16x16x32_bf16 v[64:67], a[212:215], a[180:183], v[64:67]
global_load_dwordx4 a[224:227], v0, s[74:75] offset:2048
v_mfma_f32_16x16x32_bf16 v[64:67], a[216:219], a[176:179], v[64:67]
v_mfma_f32_16x16x32_bf16 v[96:99], a[216:219], a[172:175], v[96:99]
v_mfma_f32_16x16x32_bf16 v[96:99], a[212:215], a[168:171], v[96:99]
v_mfma_f32_16x16x32_bf16 v[128:131], a[212:215], a[164:167], v[128:131]
v_mfma_f32_16x16x32_bf16 v[128:131], a[216:219], a[160:163], v[128:131]
v_mfma_f32_16x16x32_bf16 v[160:163], a[216:219], a[156:159], v[160:163]
v_mfma_f32_16x16x32_bf16 v[160:163], a[212:215], a[152:155], v[160:163]
v_mfma_f32_16x16x32_bf16 v[192:195], a[212:215], a[148:151], v[192:195]
s_add_u32 m0, s56, 24576
v_mfma_f32_16x16x32_bf16 v[192:195], a[216:219], a[144:147], v[192:195]
s_add_u32 s30, s28, 188416
s_addc_u32 s31, s29, 0
v_mfma_f32_16x16x32_bf16 v[224:227], a[216:219], a[140:143], v[224:227]
v_mfma_f32_16x16x32_bf16 v[224:227], a[212:215], a[136:139], v[224:227]
v_mfma_f32_16x16x32_bf16 a[232:235], a[212:215], a[132:135], a[232:235]
global_load_dwordx4 a[212:215], v0, s[72:73] offset:3072
v_mfma_f32_16x16x32_bf16 a[232:235], a[216:219], a[128:131], a[232:235]
s_waitcnt vmcnt(11)
v_mfma_f32_16x16x32_bf16 a[236:239], a[208:211], a[128:131], a[236:239]
global_load_lds_dwordx4 v0, s[30:31] nt
v_mfma_f32_16x16x32_bf16 a[236:239], a[192:195], a[132:135], a[236:239]
v_mfma_f32_16x16x32_bf16 v[228:231], a[192:195], a[136:139], v[228:231]
global_load_dwordx4 a[216:219], v0, s[74:75] offset:3072
v_mfma_f32_16x16x32_bf16 v[228:231], a[208:211], a[140:143], v[228:231]
s_add_u32 s72, s12, 667648
s_addc_u32 s73, s13, 0
v_mfma_f32_16x16x32_bf16 v[196:199], a[208:211], a[144:147], v[196:199]
v_mfma_f32_16x16x32_bf16 v[196:199], a[192:195], a[148:151], v[196:199]
v_mfma_f32_16x16x32_bf16 v[164:167], a[192:195], a[152:155], v[164:167]
s_add_u32 s74, s12, 700416
s_addc_u32 s75, s13, 0
v_mfma_f32_16x16x32_bf16 v[164:167], a[208:211], a[156:159], v[164:167]
v_mfma_f32_16x16x32_bf16 v[132:135], a[208:211], a[160:163], v[132:135]
v_mfma_f32_16x16x32_bf16 v[132:135], a[192:195], a[164:167], v[132:135]
v_mfma_f32_16x16x32_bf16 v[100:103], a[192:195], a[168:171], v[100:103]
v_mfma_f32_16x16x32_bf16 v[100:103], a[208:211], a[172:175], v[100:103]
v_mfma_f32_16x16x32_bf16 v[68:71], a[208:211], a[176:179], v[68:71]
v_mfma_f32_16x16x32_bf16 v[68:71], a[192:195], a[180:183], v[68:71]
global_load_lds_dwordx4 v0, s[30:31] offset:1024 nt
v_mfma_f32_16x16x32_bf16 v[36:39], a[192:195], a[184:187], v[36:39]
global_load_dwordx4 a[192:195], v0, s[72:73] offset:-4096
v_mfma_f32_16x16x32_bf16 v[36:39], a[208:211], a[188:191], v[36:39]
s_waitcnt vmcnt(12)
v_mfma_f32_16x16x32_bf16 v[40:43], a[200:203], a[188:191], v[40:43]
v_mfma_f32_16x16x32_bf16 v[40:43], a[220:223], a[184:187], v[40:43]
v_mfma_f32_16x16x32_bf16 v[72:75], a[220:223], a[180:183], v[72:75]
global_load_dwordx4 a[208:211], v0, s[74:75] offset:-4096
v_mfma_f32_16x16x32_bf16 v[72:75], a[200:203], a[176:179], v[72:75]
v_mfma_f32_16x16x32_bf16 v[104:107], a[200:203], a[172:175], v[104:107]
v_mfma_f32_16x16x32_bf16 v[104:107], a[220:223], a[168:171], v[104:107]
v_mfma_f32_16x16x32_bf16 v[136:139], a[220:223], a[164:167], v[136:139]
v_mfma_f32_16x16x32_bf16 v[136:139], a[200:203], a[160:163], v[136:139]
v_mfma_f32_16x16x32_bf16 v[168:171], a[200:203], a[156:159], v[168:171]
v_mfma_f32_16x16x32_bf16 v[168:171], a[220:223], a[152:155], v[168:171]
v_mfma_f32_16x16x32_bf16 v[200:203], a[220:223], a[148:151], v[200:203]
v_mfma_f32_16x16x32_bf16 v[200:203], a[200:203], a[144:147], v[200:203]
v_mfma_f32_16x16x32_bf16 v[232:235], a[200:203], a[140:143], v[232:235]
v_mfma_f32_16x16x32_bf16 v[232:235], a[220:223], a[136:139], v[232:235]
s_mov_b32 s34, 832
v_mfma_f32_16x16x32_bf16 a[240:243], a[220:223], a[132:135], a[240:243]
global_load_dwordx4 a[220:223], v0, s[72:73] offset:-3072
v_mfma_f32_16x16x32_bf16 a[240:243], a[200:203], a[128:131], a[240:243]
s_waitcnt vmcnt(12)
v_mfma_f32_16x16x32_bf16 a[244:247], a[204:207], a[128:131], a[244:247]
buffer_load_dword v5, v0, s[32:35], 0 offen offset:768 sc1
v_mfma_f32_16x16x32_bf16 a[244:247], a[228:231], a[132:135], a[244:247]
v_mfma_f32_16x16x32_bf16 v[236:239], a[228:231], a[136:139], v[236:239]
global_load_dwordx4 a[200:203], v0, s[74:75] offset:-3072
v_mfma_f32_16x16x32_bf16 v[236:239], a[204:207], a[140:143], v[236:239]
v_mfma_f32_16x16x32_bf16 v[204:207], a[204:207], a[144:147], v[204:207]
v_mfma_f32_16x16x32_bf16 v[204:207], a[228:231], a[148:151], v[204:207]
v_mfma_f32_16x16x32_bf16 v[172:175], a[228:231], a[152:155], v[172:175]
v_mfma_f32_16x16x32_bf16 v[172:175], a[204:207], a[156:159], v[172:175]
v_mfma_f32_16x16x32_bf16 v[140:143], a[204:207], a[160:163], v[140:143]
v_mfma_f32_16x16x32_bf16 v[140:143], a[228:231], a[164:167], v[140:143]
v_mfma_f32_16x16x32_bf16 v[108:111], a[228:231], a[168:171], v[108:111]
v_mfma_f32_16x16x32_bf16 v[108:111], a[204:207], a[172:175], v[108:111]
v_mfma_f32_16x16x32_bf16 v[76:79], a[204:207], a[176:179], v[76:79]
v_mfma_f32_16x16x32_bf16 v[76:79], a[228:231], a[180:183], v[76:79]
v_mfma_f32_16x16x32_bf16 v[44:47], a[228:231], a[184:187], v[44:47]
global_load_dwordx4 a[228:231], v0, s[72:73] offset:-2048
v_mfma_f32_16x16x32_bf16 v[44:47], a[204:207], a[188:191], v[44:47]
s_waitcnt vmcnt(10)
v_mfma_f32_16x16x32_bf16 v[48:51], a[196:199], a[188:191], v[48:51]
v_mfma_f32_16x16x32_bf16 v[48:51], a[224:227], a[184:187], v[48:51]
v_mfma_f32_16x16x32_bf16 v[80:83], a[224:227], a[180:183], v[80:83]
global_load_dwordx4 a[204:207], v0, s[74:75] offset:-2048
v_mfma_f32_16x16x32_bf16 v[80:83], a[196:199], a[176:179], v[80:83]
v_mfma_f32_16x16x32_bf16 v[112:115], a[196:199], a[172:175], v[112:115]
v_mfma_f32_16x16x32_bf16 v[112:115], a[224:227], a[168:171], v[112:115]
v_mfma_f32_16x16x32_bf16 v[144:147], a[224:227], a[164:167], v[144:147]
v_mfma_f32_16x16x32_bf16 v[144:147], a[196:199], a[160:163], v[144:147]
v_mfma_f32_16x16x32_bf16 v[176:179], a[196:199], a[156:159], v[176:179]
v_mfma_f32_16x16x32_bf16 v[176:179], a[224:227], a[152:155], v[176:179]
v_mfma_f32_16x16x32_bf16 v[208:211], a[224:227], a[148:151], v[208:211]
v_mfma_f32_16x16x32_bf16 v[208:211], a[196:199], a[144:147], v[208:211]
v_mfma_f32_16x16x32_bf16 v[240:243], a[196:199], a[140:143], v[240:243]
v_mfma_f32_16x16x32_bf16 v[240:243], a[224:227], a[136:139], v[240:243]
v_mfma_f32_16x16x32_bf16 a[248:251], a[224:227], a[132:135], a[248:251]
global_load_dwordx4 a[224:227], v0, s[72:73] offset:-1024
v_mfma_f32_16x16x32_bf16 a[248:251], a[196:199], a[128:131], a[248:251]
s_waitcnt vmcnt(9)
v_mfma_f32_16x16x32_bf16 a[252:255], a[212:215], a[128:131], a[252:255]
ds_read_b128 a[128:131], v2 offset:0
v_mfma_f32_16x16x32_bf16 a[252:255], a[216:219], a[132:135], a[252:255]
ds_read_b128 a[132:135], v2 offset:8192
v_mfma_f32_16x16x32_bf16 v[244:247], a[216:219], a[136:139], v[244:247]
ds_read_b128 a[136:139], v2 offset:9216
v_mfma_f32_16x16x32_bf16 v[244:247], a[212:215], a[140:143], v[244:247]
ds_read_b128 a[140:143], v2 offset:1024
v_mfma_f32_16x16x32_bf16 v[212:215], a[212:215], a[144:147], v[212:215]
ds_read_b128 a[144:147], v2 offset:2048
v_mfma_f32_16x16x32_bf16 v[212:215], a[216:219], a[148:151], v[212:215]
ds_read_b128 a[148:151], v2 offset:10240
v_mfma_f32_16x16x32_bf16 v[180:183], a[216:219], a[152:155], v[180:183]
ds_read_b128 a[152:155], v2 offset:11264
v_mfma_f32_16x16x32_bf16 v[180:183], a[212:215], a[156:159], v[180:183]
ds_read_b128 a[156:159], v2 offset:3072
v_mfma_f32_16x16x32_bf16 v[148:151], a[212:215], a[160:163], v[148:151]
ds_read_b128 a[160:163], v2 offset:4096
v_mfma_f32_16x16x32_bf16 v[148:151], a[216:219], a[164:167], v[148:151]
ds_read_b128 a[164:167], v2 offset:12288
v_mfma_f32_16x16x32_bf16 v[116:119], a[216:219], a[168:171], v[116:119]
ds_read_b128 a[168:171], v2 offset:13312
v_mfma_f32_16x16x32_bf16 v[116:119], a[212:215], a[172:175], v[116:119]
ds_read_b128 a[172:175], v2 offset:5120
v_mfma_f32_16x16x32_bf16 v[84:87], a[212:215], a[176:179], v[84:87]
ds_read_b128 a[176:179], v2 offset:6144
v_mfma_f32_16x16x32_bf16 v[84:87], a[216:219], a[180:183], v[84:87]
ds_read_b128 a[180:183], v2 offset:14336
v_mfma_f32_16x16x32_bf16 v[52:55], a[216:219], a[184:187], v[52:55]
ds_read_b128 a[184:187], v2 offset:15360
v_mfma_f32_16x16x32_bf16 v[52:55], a[212:215], a[188:191], v[52:55]
ds_read_b128 a[188:191], v2 offset:7168
s_waitcnt vmcnt(6) lgkmcnt(12)
v_mfma_f32_16x16x32_bf16 v[24:27], a[192:195], a[128:131], v[24:27]
global_load_dwordx4 a[196:199], v0, s[74:75] offset:-1024
v_mfma_f32_16x16x32_bf16 v[24:27], a[208:211], a[132:135], v[24:27]
v_mfma_f32_16x16x32_bf16 v[56:59], a[208:211], a[136:139], v[56:59]
v_mfma_f32_16x16x32_bf16 v[56:59], a[192:195], a[140:143], v[56:59]
s_waitcnt lgkmcnt(8)
v_mfma_f32_16x16x32_bf16 v[88:91], a[192:195], a[144:147], v[88:91]
global_load_dwordx4 a[216:219], v0, s[72:73] offset:0
v_mfma_f32_16x16x32_bf16 v[88:91], a[208:211], a[148:151], v[88:91]
v_mfma_f32_16x16x32_bf16 v[120:123], a[208:211], a[152:155], v[120:123]
v_mfma_f32_16x16x32_bf16 v[120:123], a[192:195], a[156:159], v[120:123]
s_waitcnt lgkmcnt(4)
v_mfma_f32_16x16x32_bf16 v[152:155], a[192:195], a[160:163], v[152:155]
global_load_dwordx4 a[212:215], v0, s[74:75] offset:0
v_mfma_f32_16x16x32_bf16 v[152:155], a[208:211], a[164:167], v[152:155]
v_mfma_f32_16x16x32_bf16 v[184:187], a[208:211], a[168:171], v[184:187]
v_mfma_f32_16x16x32_bf16 v[184:187], a[192:195], a[172:175], v[184:187]
s_waitcnt lgkmcnt(0)
v_mfma_f32_16x16x32_bf16 v[216:219], a[192:195], a[176:179], v[216:219]
s_barrier
v_mfma_f32_16x16x32_bf16 v[216:219], a[208:211], a[180:183], v[216:219]
s_waitcnt vmcnt(7)
v_mfma_f32_16x16x32_bf16 v[248:251], a[208:211], a[184:187], v[248:251]
global_load_dwordx4 a[208:211], v0, s[72:73] offset:1024
v_mfma_f32_16x16x32_bf16 v[248:251], a[192:195], a[188:191], v[248:251]
s_waitcnt vmcnt(7)
v_mfma_f32_16x16x32_bf16 v[252:255], a[220:223], a[188:191], v[252:255]
v_cmp_ne_u32 vcc, 16256, v5
v_mfma_f32_16x16x32_bf16 v[252:255], a[200:203], a[184:187], v[252:255]
v_mfma_f32_16x16x32_bf16 v[220:223], a[200:203], a[180:183], v[220:223]
global_load_dwordx4 a[192:195], v0, s[74:75] offset:1024
v_mfma_f32_16x16x32_bf16 v[220:223], a[220:223], a[176:179], v[220:223]
v_mfma_f32_16x16x32_bf16 v[188:191], a[220:223], a[172:175], v[188:191]
s_and_b32 s3, vcc_lo, 15
s_cbranch_scc1 L_slow8
L_back8:
v_mfma_f32_16x16x32_bf16 v[188:191], a[200:203], a[168:171], v[188:191]
v_mfma_f32_16x16x32_bf16 v[156:159], a[200:203], a[164:167], v[156:159]
v_mfma_f32_16x16x32_bf16 v[156:159], a[220:223], a[160:163], v[156:159]
s_add_u32 m0, s56, 0
v_mfma_f32_16x16x32_bf16 v[124:127], a[220:223], a[156:159], v[124:127]
s_add_u32 s30, s28, 196608
s_addc_u32 s31, s29, 0
v_mfma_f32_16x16x32_bf16 v[124:127], a[200:203], a[152:155], v[124:127]
v_mfma_f32_16x16x32_bf16 v[92:95], a[200:203], a[148:151], v[92:95]
v_mfma_f32_16x16x32_bf16 v[92:95], a[220:223], a[144:147], v[92:95]
global_load_lds_dwordx4 v0, s[30:31] nt
v_mfma_f32_16x16x32_bf16 v[60:63], a[220:223], a[140:143], v[60:63]
v_mfma_f32_16x16x32_bf16 v[60:63], a[200:203], a[136:139], v[60:63]
v_mfma_f32_4x4x4_16b_bf16 v[8:11], v[6:7], v[16:17], 0
v_mfma_f32_4x4x4_16b_bf16 v[12:15], v[6:7], v[18:19], 0
v_mfma_f32_16x16x32_bf16 v[28:31], a[200:203], a[132:135], v[28:31]
global_load_dwordx4 a[200:203], v0, s[72:73] offset:2048
v_mfma_f32_16x16x32_bf16 v[28:31], a[220:223], a[128:131], v[28:31]
s_waitcnt vmcnt(8)
v_mfma_f32_16x16x32_bf16 v[32:35], a[228:231], a[128:131], v[32:35]
v_mfma_f32_16x16x32_bf16 v[32:35], a[204:207], a[132:135], v[32:35]
v_mfma_f32_16x16x32_bf16 v[64:67], a[204:207], a[136:139], v[64:67]
global_load_dwordx4 a[220:223], v0, s[74:75] offset:2048
v_mfma_f32_16x16x32_bf16 v[64:67], a[228:231], a[140:143], v[64:67]
v_mfma_f32_16x16x32_bf16 v[96:99], a[228:231], a[144:147], v[96:99]
v_mfma_f32_16x16x32_bf16 v[96:99], a[204:207], a[148:151], v[96:99]
v_add_f32 v24, v24, v8
v_mfma_f32_16x16x32_bf16 v[128:131], a[204:207], a[152:155], v[128:131]
global_load_lds_dwordx4 v0, s[30:31] offset:1024 nt
v_mfma_f32_16x16x32_bf16 v[128:131], a[228:231], a[156:159], v[128:131]
v_add_f32 v25, v25, v9
v_mfma_f32_16x16x32_bf16 v[160:163], a[228:231], a[160:163], v[160:163]
v_add_f32 v26, v26, v10
v_mfma_f32_16x16x32_bf16 v[160:163], a[204:207], a[164:167], v[160:163]
v_add_f32 v27, v27, v11
v_mfma_f32_16x16x32_bf16 v[192:195], a[204:207], a[168:171], v[192:195]
v_add_f32 v28, v28, v12
v_add_f32 v29, v29, v13
v_mfma_f32_16x16x32_bf16 v[192:195], a[228:231], a[172:175], v[192:195]
v_add_f32 v30, v30, v14
v_mfma_f32_16x16x32_bf16 v[224:227], a[228:231], a[176:179], v[224:227]
v_add_f32 v31, v31, v15
v_mfma_f32_16x16x32_bf16 v[224:227], a[204:207], a[180:183], v[224:227]
v_mfma_f32_16x16x32_bf16 a[232:235], a[204:207], a[184:187], a[232:235]
global_load_dwordx4 a[204:207], v0, s[72:73] offset:3072
v_mfma_f32_16x16x32_bf16 a[232:235], a[228:231], a[188:191], a[232:235]
s_add_u32 m0, s56, 8192
v_add_f32 v56, v56, v8
s_waitcnt vmcnt(9)
v_mfma_f32_16x16x32_bf16 a[236:239], a[224:227], a[188:191], a[236:239]
s_add_u32 s30, s28, 204800
s_addc_u32 s31, s29, 0
v_mfma_f32_16x16x32_bf16 a[236:239], a[196:199], a[184:187], a[236:239]
v_mfma_f32_16x16x32_bf16 v[228:231], a[196:199], a[180:183], v[228:231]
global_load_dwordx4 a[228:231], v0, s[74:75] offset:3072
v_mfma_f32_16x16x32_bf16 v[228:231], a[224:227], a[176:179], v[228:231]
s_add_u32 s72, s12, 733184
s_addc_u32 s73, s13, 0
v_mfma_f32_16x16x32_bf16 v[196:199], a[224:227], a[172:175], v[196:199]
v_add_f32 v57, v57, v9
v_mfma_f32_16x16x32_bf16 v[196:199], a[196:199], a[168:171], v[196:199]
v_add_f32 v58, v58, v10
v_add_f32 v59, v59, v11
v_mfma_f32_16x16x32_bf16 v[164:167], a[196:199], a[164:167], v[164:167]
s_add_u32 s74, s12, 765952
s_addc_u32 s75, s13, 0
v_mfma_f32_16x16x32_bf16 v[164:167], a[224:227], a[160:163], v[164:167]
global_load_lds_dwordx4 v0, s[30:31] nt
v_mfma_f32_16x16x32_bf16 v[132:135], a[224:227], a[156:159], v[132:135]
v_add_f32 v60, v60, v12
v_mfma_f32_16x16x32_bf16 v[132:135], a[196:199], a[152:155], v[132:135]
v_add_f32 v61, v61, v13
v_mfma_f32_16x16x32_bf16 v[100:103], a[196:199], a[148:151], v[100:103]
v_add_f32 v62, v62, v14
v_mfma_f32_16x16x32_bf16 v[100:103], a[224:227], a[144:147], v[100:103]
v_add_f32 v63, v63, v15
v_mfma_f32_16x16x32_bf16 v[68:71], a[224:227], a[140:143], v[68:71]
v_add_f32 v88, v88, v8
v_mfma_f32_16x16x32_bf16 v[68:71], a[196:199], a[136:139], v[68:71]
v_add_f32 v89, v89, v9
v_mfma_f32_16x16x32_bf16 v[36:39], a[196:199], a[132:135], v[36:39]
global_load_dwordx4 a[196:199], v0, s[72:73] offset:-4096
v_mfma_f32_16x16x32_bf16 v[36:39], a[224:227], a[128:131], v[36:39]
s_waitcnt vmcnt(10)
v_mfma_f32_16x16x32_bf16 v[40:43], a[216:219], a[128:131], v[40:43]
global_load_lds_dwordx4 v0, s[30:31] offset:1024 nt
v_mfma_f32_16x16x32_bf16 v[40:43], a[212:215], a[132:135], v[40:43]
v_add_f32 v90, v90, v10
v_mfma_f32_16x16x32_bf16 v[72:75], a[212:215], a[136:139], v[72:75]
global_load_dwordx4 a[224:227], v0, s[74:75] offset:-4096
v_mfma_f32_16x16x32_bf16 v[72:75], a[216:219], a[140:143], v[72:75]
v_add_f32 v91, v91, v11
v_mfma_f32_16x16x32_bf16 v[104:107], a[216:219], a[144:147], v[104:107]
v_add_f32 v92, v92, v12
v_mfma_f32_16x16x32_bf16 v[104:107], a[212:215], a[148:151], v[104:107]
v_add_f32 v93, v93, v13
v_mfma_f32_16x16x32_bf16 v[136:139], a[212:215], a[152:155], v[136:139]
v_add_f32 v94, v94, v14
v_mfma_f32_16x16x32_bf16 v[136:139], a[216:219], a[156:159], v[136:139]
v_add_f32 v95, v95, v15
v_mfma_f32_16x16x32_bf16 v[168:171], a[216:219], a[160:163], v[168:171]
v_add_f32 v120, v120, v8
v_add_f32 v121, v121, v9
v_mfma_f32_16x16x32_bf16 v[168:171], a[212:215], a[164:167], v[168:171]
v_add_f32 v122, v122, v10
v_mfma_f32_16x16x32_bf16 v[200:203], a[212:215], a[168:171], v[200:203]
v_add_f32 v123, v123, v11
v_mfma_f32_16x16x32_bf16 v[200:203], a[216:219], a[172:175], v[200:203]
v_add_f32 v124, v124, v12
v_mfma_f32_16x16x32_bf16 v[232:235], a[216:219], a[176:179], v[232:235]
v_add_f32 v125, v125, v13
v_mfma_f32_16x16x32_bf16 v[232:235], a[212:215], a[180:183], v[232:235]
v_add_f32 v126, v126, v14
v_mfma_f32_16x16x32_bf16 a[240:243], a[212:215], a[184:187], a[240:243]
global_load_dwordx4 a[212:215], v0, s[72:73] offset:-3072
v_mfma_f32_16x16x32_bf16 a[240:243], a[216:219], a[188:191], a[240:243]
v_add_f32 v127, v127, v15
s_waitcnt vmcnt(11)
v_mfma_f32_16x16x32_bf16 a[244:247], a[208:211], a[188:191], a[244:247]
v_add_f32 v152, v152, v8
v_mfma_f32_16x16x32_bf16 a[244:247], a[192:195], a[184:187], a[244:247]
v_mfma_f32_16x16x32_bf16 v[236:239], a[192:195], a[180:183], v[236:239]
global_load_dwordx4 a[216:219], v0, s[74:75] offset:-3072
v_mfma_f32_16x16x32_bf16 v[236:239], a[208:211], a[176:179], v[236:239]
v_add_f32 v153, v153, v9
v_mfma_f32_16x16x32_bf16 v[204:207], a[208:211], a[172:175], v[204:207]
v_add_f32 v154, v154, v10
v_mfma_f32_16x16x32_bf16 v[204:207], a[192:195], a[168:171], v[204:207]
v_add_f32 v155, v155, v11
v_add_f32 v156, v156, v12
v_mfma_f32_16x16x32_bf16 v[172:175], a[192:195], a[164:167], v[172:175]
v_add_f32 v157, v157, v13
v_mfma_f32_16x16x32_bf16 v[172:175], a[208:211], a[160:163], v[172:175]
v_add_f32 v158, v158, v14
v_mfma_f32_16x16x32_bf16 v[140:143], a[208:211], a[156:159], v[140:143]
v_add_f32 v159, v159, v15
v_mfma_f32_16x16x32_bf16 v[140:143], a[192:195], a[152:155], v[140:143]
v_add_f32 v184, v184, v8
v_mfma_f32_16x16x32_bf16 v[108:111], a[192:195], a[148:151], v[108:111]
v_add_f32 v185, v185, v9
v_mfma_f32_16x16x32_bf16 v[108:111], a[208:211], a[144:147], v[108:111]
v_add_f32 v186, v186, v10
v_mfma_f32_16x16x32_bf16 v[76:79], a[208:211], a[140:143], v[76:79]
v_add_f32 v187, v187, v11
v_add_f32 v188, v188, v12
v_mfma_f32_16x16x32_bf16 v[76:79], a[192:195], a[136:139], v[76:79]
v_mfma_f32_16x16x32_bf16 v[44:47], a[192:195], a[132:135], v[44:47]
global_load_dwordx4 a[192:195], v0, s[72:73] offset:-2048
v_mfma_f32_16x16x32_bf16 v[44:47], a[208:211], a[128:131], v[44:47]
v_add_f32 v189, v189, v13
s_waitcnt vmcnt(10)
v_mfma_f32_16x16x32_bf16 v[48:51], a[200:203], a[128:131], v[48:51]
v_add_f32 v190, v190, v14
v_mfma_f32_16x16x32_bf16 v[48:51], a[220:223], a[132:135], v[48:51]
v_add_f32 v191, v191, v15
v_mfma_f32_16x16x32_bf16 v[80:83], a[220:223], a[136:139], v[80:83]
global_load_dwordx4 a[208:211], v0, s[74:75] offset:-2048
v_mfma_f32_16x16x32_bf16 v[80:83], a[200:203], a[140:143], v[80:83]
v_add_f32 v216, v216, v8
v_mfma_f32_16x16x32_bf16 v[112:115], a[200:203], a[144:147], v[112:115]
v_add_f32 v217, v217, v9
v_lshlrev_b32 v3, 10, v0
v_mfma_f32_16x16x32_bf16 v[112:115], a[220:223], a[148:151], v[112:115]
v_add_f32 v218, v218, v10
v_mfma_f32_16x16x32_bf16 v[144:147], a[220:223], a[152:155], v[144:147]
v_add_f32 v219, v219, v11
v_mfma_f32_16x16x32_bf16 v[144:147], a[200:203], a[156:159], v[144:147]
v_add_f32 v220, v220, v12
v_mfma_f32_16x16x32_bf16 v[176:179], a[200:203], a[160:163], v[176:179]
v_add_f32 v221, v221, v13
v_add_f32 v222, v222, v14
v_mfma_f32_16x16x32_bf16 v[176:179], a[220:223], a[164:167], v[176:179]
v_add_f32 v223, v223, v15
v_mfma_f32_16x16x32_bf16 v[208:211], a[220:223], a[168:171], v[208:211]
v_add_f32 v248, v248, v8
v_mfma_f32_16x16x32_bf16 v[208:211], a[200:203], a[172:175], v[208:211]
v_add_f32 v249, v249, v9
buffer_load_dword v3, v3, s[40:43], s63 offen
v_mfma_f32_16x16x32_bf16 v[240:243], a[200:203], a[176:179], v[240:243]
v_add_f32 v250, v250, v10
v_mfma_f32_16x16x32_bf16 v[240:243], a[220:223], a[180:183], v[240:243]
v_add_f32 v251, v251, v11
v_mfma_f32_16x16x32_bf16 a[248:251], a[220:223], a[184:187], a[248:251]
global_load_dwordx4 a[220:223], v0, s[72:73] offset:-1024
v_mfma_f32_16x16x32_bf16 a[248:251], a[200:203], a[188:191], a[248:251]
v_add_f32 v252, v252, v12
s_waitcnt vmcnt(10)
v_mfma_f32_16x16x32_bf16 a[252:255], a[204:207], a[188:191], a[252:255]
ds_read_b128 a[188:191], v2 offset:16384
v_mfma_f32_16x16x32_bf16 a[252:255], a[228:231], a[184:187], a[252:255]
ds_read_b128 a[184:187], v2 offset:24576
v_add_f32 v253, v253, v13
v_mfma_f32_16x16x32_bf16 v[244:247], a[228:231], a[180:183], v[244:247]
ds_read_b128 a[180:183], v2 offset:25600
v_mfma_f32_16x16x32_bf16 v[244:247], a[204:207], a[176:179], v[244:247]
ds_read_b128 a[176:179], v2 offset:17408
v_add_f32 v254, v254, v14
v_mfma_f32_16x16x32_bf16 v[212:215], a[204:207], a[172:175], v[212:215]
ds_read_b128 a[172:175], v2 offset:18432
v_mfma_f32_16x16x32_bf16 v[212:215], a[228:231], a[168:171], v[212:215]
ds_read_b128 a[168:171], v2 offset:26624
v_add_f32 v255, v255, v15
v_mfma_f32_16x16x32_bf16 v[180:183], a[228:231], a[164:167], v[180:183]
ds_read_b128 a[164:167], v2 offset:27648
v_mfma_f32_16x16x32_bf16 v[180:183], a[204:207], a[160:163], v[180:183]
ds_read_b128 a[160:163], v2 offset:19456
v_mfma_f32_16x16x32_bf16 v[148:151], a[204:207], a[156:159], v[148:151]
ds_read_b128 a[156:159], v2 offset:20480
v_mfma_f32_16x16x32_bf16 v[148:151], a[228:231], a[152:155], v[148:151]
ds_read_b128 a[152:155], v2 offset:28672
v_lshrrev_b32 v16, 4, v0
v_mfma_f32_16x16x32_bf16 v[116:119], a[228:231], a[148:151], v[116:119]
ds_read_b128 a[148:151], v2 offset:29696
v_and_b32 v16, 48, v16
v_mfma_f32_16x16x32_bf16 v[116:119], a[204:207], a[144:147], v[116:119]
ds_read_b128 a[144:147], v2 offset:21504
s_add_u32 s67, s66, 4096
v_mfma_f32_16x16x32_bf16 v[84:87], a[204:207], a[140:143], v[84:87]
ds_read_b128 a[140:143], v2 offset:22528
v_mfma_f32_16x16x32_bf16 v[84:87], a[228:231], a[136:139], v[84:87]
ds_read_b128 a[136:139], v2 offset:30720
v_mfma_f32_16x16x32_bf16 v[52:55], a[228:231], a[132:135], v[52:55]
ds_read_b128 a[132:135], v2 offset:31744
v_mfma_f32_16x16x32_bf16 v[52:55], a[204:207], a[128:131], v[52:55]
ds_read_b128 a[128:131], v2 offset:23552
s_waitcnt vmcnt(6) lgkmcnt(12)
v_mfma_f32_16x16x32_bf16 v[24:27], a[196:199], a[188:191], v[24:27]
global_load_dwordx4 a[200:203], v0, s[74:75] offset:-1024
buffer_load_dwordx4 v[16:19], v16, s[16:19], s67 offen offset:64
v_mfma_f32_16x16x32_bf16 v[24:27], a[224:227], a[184:187], v[24:27]
v_mfma_f32_16x16x32_bf16 v[56:59], a[224:227], a[180:183], v[56:59]
v_mfma_f32_16x16x32_bf16 v[56:59], a[196:199], a[176:179], v[56:59]
s_waitcnt lgkmcnt(8)
v_mfma_f32_16x16x32_bf16 v[88:91], a[196:199], a[172:175], v[88:91]
global_load_dwordx4 a[228:231], v0, s[72:73] offset:0
v_mfma_f32_16x16x32_bf16 v[88:91], a[224:227], a[168:171], v[88:91]
v_mfma_f32_16x16x32_bf16 v[120:123], a[224:227], a[164:167], v[120:123]
v_mfma_f32_16x16x32_bf16 v[120:123], a[196:199], a[160:163], v[120:123]
s_waitcnt lgkmcnt(4)
v_mfma_f32_16x16x32_bf16 v[152:155], a[196:199], a[156:159], v[152:155]
global_load_dwordx4 a[204:207], v0, s[74:75] offset:0
v_mfma_f32_16x16x32_bf16 v[152:155], a[224:227], a[152:155], v[152:155]
v_mfma_f32_16x16x32_bf16 v[184:187], a[224:227], a[148:151], v[184:187]
v_mfma_f32_16x16x32_bf16 v[184:187], a[196:199], a[144:147], v[184:187]
s_waitcnt lgkmcnt(0)
v_mfma_f32_16x16x32_bf16 v[216:219], a[196:199], a[140:143], v[216:219]
v_mfma_f32_16x16x32_bf16 v[216:219], a[224:227], a[136:139], v[216:219]
v_mfma_f32_16x16x32_bf16 v[248:251], a[224:227], a[132:135], v[248:251]
global_load_dwordx4 a[224:227], v0, s[72:73] offset:1024
v_mfma_f32_16x16x32_bf16 v[248:251], a[196:199], a[128:131], v[248:251]
s_waitcnt vmcnt(9)
v_mfma_f32_16x16x32_bf16 v[252:255], a[212:215], a[128:131], v[252:255]
v_mfma_f32_16x16x32_bf16 v[252:255], a[216:219], a[132:135], v[252:255]
v_mfma_f32_16x16x32_bf16 v[220:223], a[216:219], a[136:139], v[220:223]
global_load_dwordx4 a[196:199], v0, s[74:75] offset:1024
v_mfma_f32_16x16x32_bf16 v[220:223], a[212:215], a[140:143], v[220:223]
v_mfma_f32_16x16x32_bf16 v[188:191], a[212:215], a[144:147], v[188:191]
v_mfma_f32_16x16x32_bf16 v[188:191], a[216:219], a[148:151], v[188:191]
v_mfma_f32_16x16x32_bf16 v[156:159], a[216:219], a[152:155], v[156:159]
v_mfma_f32_16x16x32_bf16 v[156:159], a[212:215], a[156:159], v[156:159]
v_mfma_f32_16x16x32_bf16 v[124:127], a[212:215], a[160:163], v[124:127]
v_mfma_f32_16x16x32_bf16 v[124:127], a[216:219], a[164:167], v[124:127]
v_mfma_f32_16x16x32_bf16 v[92:95], a[216:219], a[168:171], v[92:95]
v_mfma_f32_16x16x32_bf16 v[92:95], a[212:215], a[172:175], v[92:95]
v_mfma_f32_16x16x32_bf16 v[60:63], a[212:215], a[176:179], v[60:63]
v_mfma_f32_16x16x32_bf16 v[60:63], a[216:219], a[180:183], v[60:63]
v_mfma_f32_16x16x32_bf16 v[28:31], a[216:219], a[184:187], v[28:31]
global_load_dwordx4 a[216:219], v0, s[72:73] offset:2048
v_mfma_f32_16x16x32_bf16 v[28:31], a[212:215], a[188:191], v[28:31]
s_waitcnt vmcnt(9)
v_mfma_f32_16x16x32_bf16 v[32:35], a[192:195], a[188:191], v[32:35]
v_mfma_f32_16x16x32_bf16 v[32:35], a[208:211], a[184:187], v[32:35]
v_mfma_f32_16x16x32_bf16 v[64:67], a[208:211], a[180:183], v[64:67]
global_load_dwordx4 a[212:215], v0, s[74:75] offset:2048
v_mfma_f32_16x16x32_bf16 v[64:67], a[192:195], a[176:179], v[64:67]
v_mfma_f32_16x16x32_bf16 v[96:99], a[192:195], a[172:175], v[96:99]
v_mfma_f32_16x16x32_bf16 v[96:99], a[208:211], a[168:171], v[96:99]
v_mfma_f32_16x16x32_bf16 v[128:131], a[208:211], a[164:167], v[128:131]
v_mfma_f32_16x16x32_bf16 v[128:131], a[192:195], a[160:163], v[128:131]
v_mfma_f32_16x16x32_bf16 v[160:163], a[192:195], a[156:159], v[160:163]
v_mfma_f32_16x16x32_bf16 v[160:163], a[208:211], a[152:155], v[160:163]
v_mfma_f32_16x16x32_bf16 v[192:195], a[208:211], a[148:151], v[192:195]
v_mfma_f32_16x16x32_bf16 v[192:195], a[192:195], a[144:147], v[192:195]
v_mfma_f32_16x16x32_bf16 v[224:227], a[192:195], a[140:143], v[224:227]
v_mfma_f32_16x16x32_bf16 v[224:227], a[208:211], a[136:139], v[224:227]
v_mfma_f32_16x16x32_bf16 a[232:235], a[208:211], a[132:135], a[232:235]
global_load_dwordx4 a[208:211], v0, s[72:73] offset:3072
v_mfma_f32_16x16x32_bf16 a[232:235], a[192:195], a[128:131], a[232:235]
s_waitcnt vmcnt(8)
v_mfma_f32_16x16x32_bf16 a[236:239], a[220:223], a[128:131], a[236:239]
v_mfma_f32_16x16x32_bf16 a[236:239], a[200:203], a[132:135], a[236:239]
v_mfma_f32_16x16x32_bf16 v[228:231], a[200:203], a[136:139], v[228:231]
global_load_dwordx4 a[192:195], v0, s[74:75] offset:3072
v_mfma_f32_16x16x32_bf16 v[228:231], a[220:223], a[140:143], v[228:231]
s_add_u32 s72, s12, 552960
s_addc_u32 s73, s13, 0
v_mfma_f32_16x16x32_bf16 v[196:199], a[220:223], a[144:147], v[196:199]
v_mfma_f32_16x16x32_bf16 v[196:199], a[200:203], a[148:151], v[196:199]
v_mfma_f32_16x16x32_bf16 v[164:167], a[200:203], a[152:155], v[164:167]
s_add_u32 s74, s12, 585728
s_addc_u32 s75, s13, 0
v_mfma_f32_16x16x32_bf16 v[164:167], a[220:223], a[156:159], v[164:167]
v_mfma_f32_16x16x32_bf16 v[132:135], a[220:223], a[160:163], v[132:135]
v_mfma_f32_16x16x32_bf16 v[132:135], a[200:203], a[164:167], v[132:135]
v_mfma_f32_16x16x32_bf16 v[100:103], a[200:203], a[168:171], v[100:103]
v_mfma_f32_16x16x32_bf16 v[100:103], a[220:223], a[172:175], v[100:103]
s_waitcnt vmcnt(8)
v_mfma_f32_16x16x32_bf16 v[68:71], a[220:223], a[176:179], v[68:71]
v_mfma_f32_16x16x32_bf16 v[68:71], a[200:203], a[180:183], v[68:71]
v_mfma_f32_4x4x4_16b_bf16 v[8:11], v[6:7], v[16:17], 0
v_mfma_f32_4x4x4_16b_bf16 v[12:15], v[6:7], v[18:19], 0
v_mfma_f32_16x16x32_bf16 v[36:39], a[200:203], a[184:187], v[36:39]
global_load_dwordx4 a[200:203], v0, s[72:73] offset:-4096
v_mfma_f32_16x16x32_bf16 v[36:39], a[220:223], a[188:191], v[36:39]
s_waitcnt vmcnt(7)
v_mfma_f32_16x16x32_bf16 v[40:43], a[228:231], a[188:191], v[40:43]
v_mfma_f32_16x16x32_bf16 v[40:43], a[204:207], a[184:187], v[40:43]
v_mfma_f32_16x16x32_bf16 v[72:75], a[204:207], a[180:183], v[72:75]
global_load_dwordx4 a[220:223], v0, s[74:75] offset:-4096
v_mfma_f32_16x16x32_bf16 v[72:75], a[228:231], a[176:179], v[72:75]
v_mfma_f32_16x16x32_bf16 v[104:107], a[228:231], a[172:175], v[104:107]
v_mfma_f32_16x16x32_bf16 v[104:107], a[204:207], a[168:171], v[104:107]
v_add_f32 v32, v32, v8
v_add_f32 v33, v33, v9
v_mfma_f32_16x16x32_bf16 v[136:139], a[204:207], a[164:167], v[136:139]
L_pad18:
s_cbranch_execz L_pad22
v_add_f32 v34, v34, v10
v_mfma_f32_16x16x32_bf16 v[136:139], a[228:231], a[160:163], v[136:139]
v_add_f32 v35, v35, v11
v_mfma_f32_16x16x32_bf16 v[168:171], a[228:231], a[156:159], v[168:171]
v_add_f32 v36, v36, v12
v_mfma_f32_16x16x32_bf16 v[168:171], a[204:207], a[152:155], v[168:171]
v_add_f32 v37, v37, v13
v_mfma_f32_16x16x32_bf16 v[200:203], a[204:207], a[148:151], v[200:203]
v_add_f32 v38, v38, v14
v_mfma_f32_16x16x32_bf16 v[200:203], a[228:231], a[144:147], v[200:203]
v_add_f32 v39, v39, v15
v_mfma_f32_16x16x32_bf16 v[232:235], a[228:231], a[140:143], v[232:235]
v_add_f32 v64, v64, v8
v_mfma_f32_16x16x32_bf16 v[232:235], a[204:207], a[136:139], v[232:235]
v_mfma_f32_16x16x32_bf16 a[240:243], a[204:207], a[132:135], a[240:243]
global_load_dwordx4 a[204:207], v0, s[72:73] offset:-3072
v_mfma_f32_16x16x32_bf16 a[240:243], a[228:231], a[128:131], a[240:243]
v_add_f32 v65, v65, v9
s_waitcnt vmcnt(7)
v_mfma_f32_16x16x32_bf16 a[244:247], a[224:227], a[128:131], a[244:247]
v_add_f32 v66, v66, v10
v_mfma_f32_16x16x32_bf16 a[244:247], a[196:199], a[132:135], a[244:247]
v_add_f32 v67, v67, v11
v_mfma_f32_16x16x32_bf16 v[236:239], a[196:199], a[136:139], v[236:239]
global_load_dwordx4 a[228:231], v0, s[74:75] offset:-3072
v_mfma_f32_16x16x32_bf16 v[236:239], a[224:227], a[140:143], v[236:239]
v_add_f32 v68, v68, v12
v_mfma_f32_16x16x32_bf16 v[204:207], a[224:227], a[144:147], v[204:207]
v_add_f32 v69, v69, v13
v_mfma_f32_16x16x32_bf16 v[204:207], a[196:199], a[148:151], v[204:207]
v_add_f32 v70, v70, v14
v_mfma_f32_16x16x32_bf16 v[172:175], a[196:199], a[152:155], v[172:175]
v_add_f32 v71, v71, v15
v_mfma_f32_16x16x32_bf16 v[172:175], a[224:227], a[156:159], v[172:175]
v_add_f32 v96, v96, v8
v_mfma_f32_16x16x32_bf16 v[140:143], a[224:227], a[160:163], v[140:143]
v_add_f32 v97, v97, v9
v_mfma_f32_16x16x32_bf16 v[140:143], a[196:199], a[164:167], v[140:143]
v_add_f32 v98, v98, v10
v_mfma_f32_16x16x32_bf16 v[108:111], a[196:199], a[168:171], v[108:111]
v_add_f32 v99, v99, v11
v_mfma_f32_16x16x32_bf16 v[108:111], a[224:227], a[172:175], v[108:111]
v_add_f32 v100, v100, v12
v_mfma_f32_16x16x32_bf16 v[76:79], a[224:227], a[176:179], v[76:79]
v_add_f32 v101, v101, v13
v_mfma_f32_16x16x32_bf16 v[76:79], a[196:199], a[180:183], v[76:79]
v_add_f32 v102, v102, v14
v_mfma_f32_16x16x32_bf16 v[44:47], a[196:199], a[184:187], v[44:47]
global_load_dwordx4 a[196:199], v0, s[72:73] offset:-2048
v_mfma_f32_16x16x32_bf16 v[44:47], a[224:227], a[188:191], v[44:47]
v_add_f32 v103, v103, v15
s_waitcnt vmcnt(7)
v_mfma_f32_16x16x32_bf16 v[48:51], a[216:219], a[188:191], v[48:51]
v_add_f32 v128, v128, v8
v_mfma_f32_16x16x32_bf16 v[48:51], a[212:215], a[184:187], v[48:51]
v_mfma_f32_16x16x32_bf16 v[80:83], a[212:215], a[180:183], v[80:83]
global_load_dwordx4 a[224:227], v0, s[74:75] offset:-2048
v_mfma_f32_16x16x32_bf16 v[80:83], a[216:219], a[176:179], v[80:83]
v_add_f32 v129, v129, v9
v_mfma_f32_16x16x32_bf16 v[112:115], a[216:219], a[172:175], v[112:115]
v_add_f32 v130, v130, v10
v_mfma_f32_16x16x32_bf16 v[112:115], a[212:215], a[168:171], v[112:115]
v_add_f32 v131, v131, v11
v_mfma_f32_16x16x32_bf16 v[144:147], a[212:215], a[164:167], v[144:147]
v_add_f32 v132, v132, v12
v_mfma_f32_16x16x32_bf16 v[144:147], a[216:219], a[160:163], v[144:147]
v_add_f32 v133, v133, v13
v_mfma_f32_16x16x32_bf16 v[176:179], a[216:219], a[156:159], v[176:179]
v_add_f32 v134, v134, v14
v_mfma_f32_16x16x32_bf16 v[176:179], a[212:215], a[152:155], v[176:179]
v_add_f32 v135, v135, v15
v_mfma_f32_16x16x32_bf16 v[208:211], a[212:215], a[148:151], v[208:211]
v_add_f32 v160, v160, v8
v_mfma_f32_16x16x32_bf16 v[208:211], a[216:219], a[144:147], v[208:211]
v_add_f32 v161, v161, v9
v_mfma_f32_16x16x32_bf16 v[240:243], a[216:219], a[140:143], v[240:243]
v_add_f32 v162, v162, v10
v_add_f32 v163, v163, v11
v_mfma_f32_16x16x32_bf16 v[240:243], a[212:215], a[136:139], v[240:243]
v_mfma_f32_16x16x32_bf16 a[248:251], a[212:215], a[132:135], a[248:251]
global_load_dwordx4 a[212:215], v0, s[72:73] offset:-1024
v_mfma_f32_16x16x32_bf16 a[248:251], a[216:219], a[128:131], a[248:251]
v_add_u32 v2, 131072, v0
s_waitcnt vmcnt(7)
v_mfma_f32_16x16x32_bf16 a[252:255], a[208:211], a[128:131], a[252:255]
ds_read_b128 a[128:131], v2 offset:0
v_add_f32 v164, v164, v12
v_mfma_f32_16x16x32_bf16 a[252:255], a[192:195], a[132:135], a[252:255]
ds_read_b128 a[132:135], v2 offset:8192
v_mfma_f32_16x16x32_bf16 v[244:247], a[192:195], a[136:139], v[244:247]
ds_read_b128 a[136:139], v2 offset:9216
v_add_f32 v165, v165, v13
v_mfma_f32_16x16x32_bf16 v[244:247], a[208:211], a[140:143], v[244:247]
ds_read_b128 a[140:143], v2 offset:1024
v_mfma_f32_16x16x32_bf16 v[212:215], a[208:211], a[144:147], v[212:215]
ds_read_b128 a[144:147], v2 offset:2048
v_add_f32 v166, v166, v14
v_mfma_f32_16x16x32_bf16 v[212:215], a[192:195], a[148:151], v[212:215]
ds_read_b128 a[148:151], v2 offset:10240
v_mfma_f32_16x16x32_bf16 v[180:183], a[192:195], a[152:155], v[180:183]
ds_read_b128 a[152:155], v2 offset:11264
v_add_f32 v167, v167, v15
v_mfma_f32_16x16x32_bf16 v[180:183], a[208:211], a[156:159], v[180:183]
ds_read_b128 a[156:159], v2 offset:3072
v_add_f32 v192, v192, v8
v_mfma_f32_16x16x32_bf16 v[148:151], a[208:211], a[160:163], v[148:151]
ds_read_b128 a[160:163], v2 offset:4096
v_mfma_f32_16x16x32_bf16 v[148:151], a[192:195], a[164:167], v[148:151]
ds_read_b128 a[164:167], v2 offset:12288
v_add_f32 v193, v193, v9
v_mfma_f32_16x16x32_bf16 v[116:119], a[192:195], a[168:171], v[116:119]
ds_read_b128 a[168:171], v2 offset:13312
v_mfma_f32_16x16x32_bf16 v[116:119], a[208:211], a[172:175], v[116:119]
ds_read_b128 a[172:175], v2 offset:5120
v_add_f32 v194, v194, v10
v_mfma_f32_16x16x32_bf16 v[84:87], a[208:211], a[176:179], v[84:87]
ds_read_b128 a[176:179], v2 offset:6144
v_mfma_f32_16x16x32_bf16 v[84:87], a[192:195], a[180:183], v[84:87]
ds_read_b128 a[180:183], v2 offset:14336
v_add_f32 v195, v195, v11
v_mfma_f32_16x16x32_bf16 v[52:55], a[192:195], a[184:187], v[52:55]
ds_read_b128 a[184:187], v2 offset:15360
v_mfma_f32_16x16x32_bf16 v[52:55], a[208:211], a[188:191], v[52:55]
ds_read_b128 a[188:191], v2 offset:7168
s_waitcnt vmcnt(5) lgkmcnt(12)
v_mfma_f32_16x16x32_bf16 v[24:27], a[200:203], a[128:131], v[24:27]
global_load_dwordx4 a[216:219], v0, s[74:75] offset:-1024
v_mfma_f32_16x16x32_bf16 v[24:27], a[220:223], a[132:135], v[24:27]
v_add_f32 v196, v196, v12
v_mfma_f32_16x16x32_bf16 v[56:59], a[220:223], a[136:139], v[56:59]
v_add_f32 v197, v197, v13
v_mfma_f32_16x16x32_bf16 v[56:59], a[200:203], a[140:143], v[56:59]
v_add_f32 v198, v198, v14
s_waitcnt lgkmcnt(8)
v_mfma_f32_16x16x32_bf16 v[88:91], a[200:203], a[144:147], v[88:91]
global_load_dwordx4 a[192:195], v0, s[72:73] offset:0
v_mfma_f32_16x16x32_bf16 v[88:91], a[220:223], a[148:151], v[88:91]
v_add_f32 v199, v199, v15
v_mfma_f32_16x16x32_bf16 v[120:123], a[220:223], a[152:155], v[120:123]
v_add_f32 v224, v224, v8
v_mfma_f32_16x16x32_bf16 v[120:123], a[200:203], a[156:159], v[120:123]
s_waitcnt lgkmcnt(4)
v_mfma_f32_16x16x32_bf16 v[152:155], a[200:203], a[160:163], v[152:155]
global_load_dwordx4 a[208:211], v0, s[74:75] offset:0
v_mfma_f32_16x16x32_bf16 v[152:155], a[220:223], a[164:167], v[152:155]
v_add_f32 v225, v225, v9
v_mfma_f32_16x16x32_bf16 v[184:187], a[220:223], a[168:171], v[184:187]
v_add_f32 v226, v226, v10
v_mfma_f32_16x16x32_bf16 v[184:187], a[200:203], a[172:175], v[184:187]
v_add_f32 v227, v227, v11
s_waitcnt lgkmcnt(0)
v_mfma_f32_16x16x32_bf16 v[216:219], a[200:203], a[176:179], v[216:219]
v_add_f32 v228, v228, v12
v_mfma_f32_16x16x32_bf16 v[216:219], a[220:223], a[180:183], v[216:219]
v_mfma_f32_16x16x32_bf16 v[248:251], a[220:223], a[184:187], v[248:251]
global_load_dwordx4 a[220:223], v0, s[72:73] offset:1024
v_mfma_f32_16x16x32_bf16 v[248:251], a[200:203], a[188:191], v[248:251]
v_add_f32 v229, v229, v13
s_waitcnt vmcnt(7)
v_mfma_f32_16x16x32_bf16 v[252:255], a[204:207], a[188:191], v[252:255]
v_add_f32 v230, v230, v14
v_mfma_f32_16x16x32_bf16 v[252:255], a[228:231], a[184:187], v[252:255]
v_mfma_f32_16x16x32_bf16 v[220:223], a[228:231], a[180:183], v[220:223]
global_load_dwordx4 a[200:203], v0, s[74:75] offset:1024
v_mfma_f32_16x16x32_bf16 v[220:223], a[204:207], a[176:179], v[220:223]
s_add_u32 s72, s12, 618496
s_addc_u32 s73, s13, 0
v_mfma_f32_16x16x32_bf16 v[188:191], a[204:207], a[172:175], v[188:191]
v_add_f32 v231, v231, v15
v_mfma_f32_16x16x32_bf16 v[188:191], a[228:231], a[168:171], v[188:191]
v_mfma_f32_4x4x4_16b_bf16 a[232:235], v[6:7], v[16:17], a[232:235]
v_mfma_f32_4x4x4_16b_bf16 a[236:239], v[6:7], v[18:19], a[236:239]
v_mfma_f32_16x16x32_bf16 v[156:159], a[228:231], a[164:167], v[156:159]
s_add_u32 s74, s12, 651264
s_addc_u32 s75, s13, 0
v_mfma_f32_16x16x32_bf16 v[156:159], a[204:207], a[160:163], v[156:159]
v_mfma_f32_16x16x32_bf16 v[124:127], a[204:207], a[156:159], v[124:127]
v_mfma_f32_16x16x32_bf16 v[124:127], a[228:231], a[152:155], v[124:127]
v_lshrrev_b32 v16, 4, v0
v_mfma_f32_16x16x32_bf16 v[92:95], a[228:231], a[148:151], v[92:95]
v_and_b32 v16, 48, v16
v_mfma_f32_16x16x32_bf16 v[92:95], a[204:207], a[144:147], v[92:95]
s_add_u32 s67, s66, 4096
v_mfma_f32_16x16x32_bf16 v[60:63], a[204:207], a[140:143], v[60:63]
buffer_load_dwordx4 v[16:19], v16, s[16:19], s67 offen offset:128
v_mfma_f32_16x16x32_bf16 v[60:63], a[228:231], a[136:139], v[60:63]
v_mfma_f32_16x16x32_bf16 v[28:31], a[228:231], a[132:135], v[28:31]
global_load_dwordx4 a[228:231], v0, s[72:73] offset:-4096
v_mfma_f32_16x16x32_bf16 v[28:31], a[204:207], a[128:131], v[28:31]
s_waitcnt vmcnt(8)
v_mfma_f32_16x16x32_bf16 v[32:35], a[196:199], a[128:131], v[32:35]
v_mfma_f32_16x16x32_bf16 v[32:35], a[224:227], a[132:135], v[32:35]
v_mfma_f32_16x16x32_bf16 v[64:67], a[224:227], a[136:139], v[64:67]
global_load_dwordx4 a[204:207], v0, s[74:75] offset:-4096
v_mfma_f32_16x16x32_bf16 v[64:67], a[196:199], a[140:143], v[64:67]
v_mfma_f32_16x16x32_bf16 v[96:99], a[196:199], a[144:147], v[96:99]
v_mfma_f32_16x16x32_bf16 v[96:99], a[224:227], a[148:151], v[96:99]
v_mfma_f32_16x16x32_bf16 v[128:131], a[224:227], a[152:155], v[128:131]
v_mfma_f32_16x16x32_bf16 v[128:131], a[196:199], a[156:159], v[128:131]
v_mfma_f32_16x16x32_bf16 v[160:163], a[196:199], a[160:163], v[160:163]
v_mfma_f32_16x16x32_bf16 v[160:163], a[224:227], a[164:167], v[160:163]
v_mfma_f32_16x16x32_bf16 v[192:195], a[224:227], a[168:171], v[192:195]
v_mfma_f32_16x16x32_bf16 v[192:195], a[196:199], a[172:175], v[192:195]
v_mfma_f32_16x16x32_bf16 v[224:227], a[196:199], a[176:179], v[224:227]
v_mfma_f32_16x16x32_bf16 v[224:227], a[224:227], a[180:183], v[224:227]
v_mfma_f32_16x16x32_bf16 a[232:235], a[224:227], a[184:187], a[232:235]
global_load_dwordx4 a[224:227], v0, s[72:73] offset:-3072
v_mfma_f32_16x16x32_bf16 a[232:235], a[196:199], a[188:191], a[232:235]
s_waitcnt vmcnt(8)
v_mfma_f32_16x16x32_bf16 a[236:239], a[212:215], a[188:191], a[236:239]
v_mfma_f32_16x16x32_bf16 a[236:239], a[216:219], a[184:187], a[236:239]
v_mfma_f32_16x16x32_bf16 v[228:231], a[216:219], a[180:183], v[228:231]
global_load_dwordx4 a[196:199], v0, s[74:75] offset:-3072
v_mfma_f32_16x16x32_bf16 v[228:231], a[212:215], a[176:179], v[228:231]
v_mfma_f32_16x16x32_bf16 v[196:199], a[212:215], a[172:175], v[196:199]
v_mfma_f32_16x16x32_bf16 v[196:199], a[216:219], a[168:171], v[196:199]
v_mfma_f32_16x16x32_bf16 v[164:167], a[216:219], a[164:167], v[164:167]
v_mfma_f32_16x16x32_bf16 v[164:167], a[212:215], a[160:163], v[164:167]
v_mfma_f32_16x16x32_bf16 v[132:135], a[212:215], a[156:159], v[132:135]
v_mfma_f32_16x16x32_bf16 v[132:135], a[216:219], a[152:155], v[132:135]
v_mfma_f32_16x16x32_bf16 v[100:103], a[216:219], a[148:151], v[100:103]
v_mfma_f32_16x16x32_bf16 v[100:103], a[212:215], a[144:147], v[100:103]
v_mfma_f32_16x16x32_bf16 v[68:71], a[212:215], a[140:143], v[68:71]
v_mfma_f32_16x16x32_bf16 v[68:71], a[216:219], a[136:139], v[68:71]
v_mfma_f32_16x16x32_bf16 v[36:39], a[216:219], a[132:135], v[36:39]
global_load_dwordx4 a[216:219], v0, s[72:73] offset:-2048
v_mfma_f32_16x16x32_bf16 v[36:39], a[212:215], a[128:131], v[36:39]
s_waitcnt vmcnt(8)
v_mfma_f32_16x16x32_bf16 v[40:43], a[192:195], a[128:131], v[40:43]
v_mfma_f32_16x16x32_bf16 v[40:43], a[208:211], a[132:135], v[40:43]
v_mfma_f32_16x16x32_bf16 v[72:75], a[208:211], a[136:139], v[72:75]
global_load_dwordx4 a[212:215], v0, s[74:75] offset:-2048
v_mfma_f32_16x16x32_bf16 v[72:75], a[192:195], a[140:143], v[72:75]
v_mfma_f32_16x16x32_bf16 v[104:107], a[192:195], a[144:147], v[104:107]
v_mfma_f32_16x16x32_bf16 v[104:107], a[208:211], a[148:151], v[104:107]
v_mfma_f32_16x16x32_bf16 v[136:139], a[208:211], a[152:155], v[136:139]
v_mfma_f32_16x16x32_bf16 v[136:139], a[192:195], a[156:159], v[136:139]
v_mfma_f32_16x16x32_bf16 v[168:171], a[192:195], a[160:163], v[168:171]
v_mfma_f32_16x16x32_bf16 v[168:171], a[208:211], a[164:167], v[168:171]
v_mfma_f32_16x16x32_bf16 v[200:203], a[208:211], a[168:171], v[200:203]
v_mfma_f32_16x16x32_bf16 v[200:203], a[192:195], a[172:175], v[200:203]
v_mfma_f32_16x16x32_bf16 v[232:235], a[192:195], a[176:179], v[232:235]
v_mfma_f32_16x16x32_bf16 v[232:235], a[208:211], a[180:183], v[232:235]
v_mfma_f32_16x16x32_bf16 a[240:243], a[208:211], a[184:187], a[240:243]
global_load_dwordx4 a[208:211], v0, s[72:73] offset:-1024
v_mfma_f32_16x16x32_bf16 a[240:243], a[192:195], a[188:191], a[240:243]
s_waitcnt vmcnt(8)
v_mfma_f32_16x16x32_bf16 a[244:247], a[220:223], a[188:191], a[244:247]
ds_read_b128 a[188:191], v2 offset:16384
v_mfma_f32_16x16x32_bf16 a[244:247], a[200:203], a[184:187], a[244:247]
ds_read_b128 a[184:187], v2 offset:24576
v_mfma_f32_16x16x32_bf16 v[236:239], a[200:203], a[180:183], v[236:239]
ds_read_b128 a[180:183], v2 offset:25600
v_mfma_f32_16x16x32_bf16 v[236:239], a[220:223], a[176:179], v[236:239]
ds_read_b128 a[176:179], v2 offset:17408
v_mfma_f32_16x16x32_bf16 v[204:207], a[220:223], a[172:175], v[204:207]
ds_read_b128 a[172:175], v2 offset:18432
v_mfma_f32_16x16x32_bf16 v[204:207], a[200:203], a[168:171], v[204:207]
ds_read_b128 a[168:171], v2 offset:26624
v_mfma_f32_16x16x32_bf16 v[172:175], a[200:203], a[164:167], v[172:175]
ds_read_b128 a[164:167], v2 offset:27648
v_mfma_f32_16x16x32_bf16 v[172:175], a[220:223], a[160:163], v[172:175]
ds_read_b128 a[160:163], v2 offset:19456
v_mfma_f32_16x16x32_bf16 v[140:143], a[220:223], a[156:159], v[140:143]
ds_read_b128 a[156:159], v2 offset:20480
v_mfma_f32_16x16x32_bf16 v[140:143], a[200:203], a[152:155], v[140:143]
ds_read_b128 a[152:155], v2 offset:28672
v_mfma_f32_16x16x32_bf16 v[108:111], a[200:203], a[148:151], v[108:111]
ds_read_b128 a[148:151], v2 offset:29696
v_mfma_f32_16x16x32_bf16 v[108:111], a[220:223], a[144:147], v[108:111]
ds_read_b128 a[144:147], v2 offset:21504
v_mfma_f32_16x16x32_bf16 v[76:79], a[220:223], a[140:143], v[76:79]
ds_read_b128 a[140:143], v2 offset:22528
v_mfma_f32_16x16x32_bf16 v[76:79], a[200:203], a[136:139], v[76:79]
ds_read_b128 a[136:139], v2 offset:30720
v_mfma_f32_16x16x32_bf16 v[44:47], a[200:203], a[132:135], v[44:47]
ds_read_b128 a[132:135], v2 offset:31744
v_mfma_f32_16x16x32_bf16 v[44:47], a[220:223], a[128:131], v[44:47]
ds_read_b128 a[128:131], v2 offset:23552
s_waitcnt vmcnt(5) lgkmcnt(12)
v_mfma_f32_16x16x32_bf16 v[24:27], a[228:231], a[188:191], v[24:27]
global_load_dwordx4 a[192:195], v0, s[74:75] offset:-1024
v_mfma_f32_16x16x32_bf16 v[24:27], a[204:207], a[184:187], v[24:27]
v_mfma_f32_16x16x32_bf16 v[56:59], a[204:207], a[180:183], v[56:59]
v_mfma_f32_16x16x32_bf16 v[56:59], a[228:231], a[176:179], v[56:59]
s_waitcnt lgkmcnt(8)
v_mfma_f32_16x16x32_bf16 v[88:91], a[228:231], a[172:175], v[88:91]
global_load_dwordx4 a[200:203], v0, s[72:73] offset:0
v_mfma_f32_16x16x32_bf16 v[88:91], a[204:207], a[168:171], v[88:91]
v_mfma_f32_16x16x32_bf16 v[120:123], a[204:207], a[164:167], v[120:123]
v_mfma_f32_16x16x32_bf16 v[120:123], a[228:231], a[160:163], v[120:123]
s_waitcnt lgkmcnt(4)
v_mfma_f32_16x16x32_bf16 v[152:155], a[228:231], a[156:159], v[152:155]
global_load_dwordx4 a[220:223], v0, s[74:75] offset:0
v_mfma_f32_16x16x32_bf16 v[152:155], a[204:207], a[152:155], v[152:155]
v_mfma_f32_16x16x32_bf16 v[184:187], a[204:207], a[148:151], v[184:187]
v_mfma_f32_16x16x32_bf16 v[184:187], a[228:231], a[144:147], v[184:187]
s_waitcnt lgkmcnt(0)
v_mfma_f32_16x16x32_bf16 v[216:219], a[228:231], a[140:143], v[216:219]
s_barrier
v_mfma_f32_16x16x32_bf16 v[216:219], a[204:207], a[136:139], v[216:219]
s_add_u32 m0, s56, 16384
v_mfma_f32_16x16x32_bf16 v[248:251], a[204:207], a[132:135], v[248:251]
global_load_dwordx4 a[204:207], v0, s[72:73] offset:1024
v_mfma_f32_16x16x32_bf16 v[248:251], a[228:231], a[128:131], v[248:251]
s_waitcnt vmcnt(7)
v_mfma_f32_16x16x32_bf16 v[252:255], a[224:227], a[128:131], v[252:255]
s_add_u32 s30, s28, 212992
s_addc_u32 s31, s29, 0
v_mfma_f32_16x16x32_bf16 v[252:255], a[196:199], a[132:135], v[252:255]
v_mfma_f32_16x16x32_bf16 v[220:223], a[196:199], a[136:139], v[220:223]
global_load_dwordx4 a[228:231], v0, s[74:75] offset:1024
v_mfma_f32_16x16x32_bf16 v[220:223], a[224:227], a[140:143], v[220:223]
s_add_u32 s72, s12, 675840
s_addc_u32 s73, s13, 0
v_mfma_f32_16x16x32_bf16 v[188:191], a[224:227], a[144:147], v[188:191]
v_mfma_f32_16x16x32_bf16 v[188:191], a[196:199], a[148:151], v[188:191]
v_mfma_f32_16x16x32_bf16 v[156:159], a[196:199], a[152:155], v[156:159]
s_add_u32 s74, s12, 708608
s_addc_u32 s75, s13, 0
v_mfma_f32_16x16x32_bf16 v[156:159], a[224:227], a[156:159], v[156:159]
global_load_lds_dwordx4 v0, s[30:31] nt
v_mfma_f32_16x16x32_bf16 v[124:127], a[224:227], a[160:163], v[124:127]
v_mfma_f32_16x16x32_bf16 v[124:127], a[196:199], a[164:167], v[124:127]
v_mfma_f32_16x16x32_bf16 v[92:95], a[196:199], a[168:171], v[92:95]
v_mfma_f32_16x16x32_bf16 v[92:95], a[224:227], a[172:175], v[92:95]
v_mfma_f32_16x16x32_bf16 v[60:63], a[224:227], a[176:179], v[60:63]
v_mfma_f32_16x16x32_bf16 v[60:63], a[196:199], a[180:183], v[60:63]
v_mfma_f32_16x16x32_bf16 v[28:31], a[196:199], a[184:187], v[28:31]
global_load_dwordx4 a[196:199], v0, s[72:73] offset:-4096
v_mfma_f32_16x16x32_bf16 v[28:31], a[224:227], a[188:191], v[28:31]
s_waitcnt vmcnt(8)
v_mfma_f32_16x16x32_bf16 v[32:35], a[216:219], a[188:191], v[32:35]
v_mfma_f32_16x16x32_bf16 v[32:35], a[212:215], a[184:187], v[32:35]
v_mfma_f32_16x16x32_bf16 v[64:67], a[212:215], a[180:183], v[64:67]
global_load_dwordx4 a[224:227], v0, s[74:75] offset:-4096
v_mfma_f32_16x16x32_bf16 v[64:67], a[216:219], a[176:179], v[64:67]
global_load_lds_dwordx4 v0, s[30:31] offset:1024 nt
v_mfma_f32_16x16x32_bf16 v[96:99], a[216:219], a[172:175], v[96:99]
v_mfma_f32_16x16x32_bf16 v[96:99], a[212:215], a[168:171], v[96:99]
v_mfma_f32_16x16x32_bf16 v[128:131], a[212:215], a[164:167], v[128:131]
v_mfma_f32_16x16x32_bf16 v[128:131], a[216:219], a[160:163], v[128:131]
v_mfma_f32_16x16x32_bf16 v[160:163], a[216:219], a[156:159], v[160:163]
v_mfma_f32_16x16x32_bf16 v[160:163], a[212:215], a[152:155], v[160:163]
v_mfma_f32_16x16x32_bf16 v[192:195], a[212:215], a[148:151], v[192:195]
v_mfma_f32_16x16x32_bf16 v[192:195], a[216:219], a[144:147], v[192:195]
v_mfma_f32_16x16x32_bf16 v[224:227], a[216:219], a[140:143], v[224:227]
s_add_u32 m0, s56, 24576
v_mfma_f32_16x16x32_bf16 v[224:227], a[212:215], a[136:139], v[224:227]
s_mov_b32 s34, 960
v_mfma_f32_16x16x32_bf16 a[232:235], a[212:215], a[132:135], a[232:235]
global_load_dwordx4 a[212:215], v0, s[72:73] offset:-3072
v_mfma_f32_16x16x32_bf16 a[232:235], a[216:219], a[128:131], a[232:235]
s_add_u32 s30, s28, 221184
s_addc_u32 s31, s29, 0
s_waitcnt vmcnt(9)
v_mfma_f32_16x16x32_bf16 a[236:239], a[208:211], a[128:131], a[236:239]
buffer_load_dword v5, v0, s[32:35], 0 offen offset:896 sc1
v_mfma_f32_16x16x32_bf16 a[236:239], a[192:195], a[132:135], a[236:239]
v_mfma_f32_16x16x32_bf16 v[228:231], a[192:195], a[136:139], v[228:231]
global_load_dwordx4 a[216:219], v0, s[74:75] offset:-3072
v_mfma_f32_16x16x32_bf16 v[228:231], a[208:211], a[140:143], v[228:231]
v_mfma_f32_16x16x32_bf16 v[196:199], a[208:211], a[144:147], v[196:199]
global_load_lds_dwordx4 v0, s[30:31] nt
v_mfma_f32_16x16x32_bf16 v[196:199], a[192:195], a[148:151], v[196:199]
v_mfma_f32_16x16x32_bf16 v[164:167], a[192:195], a[152:155], v[164:167]
v_mfma_f32_16x16x32_bf16 v[164:167], a[208:211], a[156:159], v[164:167]
v_mfma_f32_16x16x32_bf16 v[132:135], a[208:211], a[160:163], v[132:135]
v_mfma_f32_16x16x32_bf16 v[132:135], a[192:195], a[164:167], v[132:135]
v_mfma_f32_16x16x32_bf16 v[100:103], a[192:195], a[168:171], v[100:103]
v_mfma_f32_16x16x32_bf16 v[100:103], a[208:211], a[172:175], v[100:103]
v_mfma_f32_16x16x32_bf16 v[68:71], a[208:211], a[176:179], v[68:71]
v_mfma_f32_16x16x32_bf16 v[68:71], a[192:195], a[180:183], v[68:71]
global_load_lds_dwordx4 v0, s[30:31] offset:1024 nt
v_mfma_f32_16x16x32_bf16 v[36:39], a[192:195], a[184:187], v[36:39]
global_load_dwordx4 a[192:195], v0, s[72:73] offset:-2048
v_mfma_f32_16x16x32_bf16 v[36:39], a[208:211], a[188:191], v[36:39]
s_waitcnt vmcnt(12)
v_mfma_f32_16x16x32_bf16 v[40:43], a[200:203], a[188:191], v[40:43]
v_mfma_f32_16x16x32_bf16 v[40:43], a[220:223], a[184:187], v[40:43]
v_mfma_f32_16x16x32_bf16 v[72:75], a[220:223], a[180:183], v[72:75]
global_load_dwordx4 a[208:211], v0, s[74:75] offset:-2048
v_mfma_f32_16x16x32_bf16 v[72:75], a[200:203], a[176:179], v[72:75]
v_mfma_f32_16x16x32_bf16 v[104:107], a[200:203], a[172:175], v[104:107]
v_mfma_f32_16x16x32_bf16 v[104:107], a[220:223], a[168:171], v[104:107]
v_mfma_f32_16x16x32_bf16 v[136:139], a[220:223], a[164:167], v[136:139]
v_mfma_f32_16x16x32_bf16 v[136:139], a[200:203], a[160:163], v[136:139]
v_mfma_f32_16x16x32_bf16 v[168:171], a[200:203], a[156:159], v[168:171]
v_mfma_f32_16x16x32_bf16 v[168:171], a[220:223], a[152:155], v[168:171]
v_mfma_f32_16x16x32_bf16 v[200:203], a[220:223], a[148:151], v[200:203]
v_mfma_f32_16x16x32_bf16 v[200:203], a[200:203], a[144:147], v[200:203]
v_mfma_f32_16x16x32_bf16 v[232:235], a[200:203], a[140:143], v[232:235]
v_mfma_f32_16x16x32_bf16 v[232:235], a[220:223], a[136:139], v[232:235]
v_mfma_f32_16x16x32_bf16 a[240:243], a[220:223], a[132:135], a[240:243]
global_load_dwordx4 a[220:223], v0, s[72:73] offset:-1024
v_mfma_f32_16x16x32_bf16 a[240:243], a[200:203], a[128:131], a[240:243]
v_add_u32 v2, 0, v0
s_waitcnt vmcnt(12)
v_mfma_f32_16x16x32_bf16 a[244:247], a[204:207], a[128:131], a[244:247]
ds_read_b128 a[128:131], v2 offset:0
v_mfma_f32_16x16x32_bf16 a[244:247], a[228:231], a[132:135], a[244:247]
ds_read_b128 a[132:135], v2 offset:8192
v_mfma_f32_16x16x32_bf16 v[236:239], a[228:231], a[136:139], v[236:239]
ds_read_b128 a[136:139], v2 offset:9216
v_mfma_f32_16x16x32_bf16 v[236:239], a[204:207], a[140:143], v[236:239]
ds_read_b128 a[140:143], v2 offset:1024
v_mfma_f32_16x16x32_bf16 v[204:207], a[204:207], a[144:147], v[204:207]
ds_read_b128 a[144:147], v2 offset:2048
v_mfma_f32_16x16x32_bf16 v[204:207], a[228:231], a[148:151], v[204:207]
ds_read_b128 a[148:151], v2 offset:10240
v_mfma_f32_16x16x32_bf16 v[172:175], a[228:231], a[152:155], v[172:175]
ds_read_b128 a[152:155], v2 offset:11264
v_mfma_f32_16x16x32_bf16 v[172:175], a[204:207], a[156:159], v[172:175]
ds_read_b128 a[156:159], v2 offset:3072
v_mfma_f32_16x16x32_bf16 v[140:143], a[204:207], a[160:163], v[140:143]
ds_read_b128 a[160:163], v2 offset:4096
v_mfma_f32_16x16x32_bf16 v[140:143], a[228:231], a[164:167], v[140:143]
ds_read_b128 a[164:167], v2 offset:12288
v_mfma_f32_16x16x32_bf16 v[108:111], a[228:231], a[168:171], v[108:111]
ds_read_b128 a[168:171], v2 offset:13312
v_mfma_f32_16x16x32_bf16 v[108:111], a[204:207], a[172:175], v[108:111]
ds_read_b128 a[172:175], v2 offset:5120
v_mfma_f32_16x16x32_bf16 v[76:79], a[204:207], a[176:179], v[76:79]
ds_read_b128 a[176:179], v2 offset:6144
v_mfma_f32_16x16x32_bf16 v[76:79], a[228:231], a[180:183], v[76:79]
ds_read_b128 a[180:183], v2 offset:14336
v_mfma_f32_16x16x32_bf16 v[44:47], a[228:231], a[184:187], v[44:47]
ds_read_b128 a[184:187], v2 offset:15360
v_mfma_f32_16x16x32_bf16 v[44:47], a[204:207], a[188:191], v[44:47]
ds_read_b128 a[188:191], v2 offset:7168
s_waitcnt vmcnt(9) lgkmcnt(12)
v_mfma_f32_16x16x32_bf16 v[24:27], a[196:199], a[128:131], v[24:27]
global_load_dwordx4 a[200:203], v0, s[74:75] offset:-1024
v_mfma_f32_16x16x32_bf16 v[24:27], a[224:227], a[132:135], v[24:27]
v_mfma_f32_16x16x32_bf16 v[56:59], a[224:227], a[136:139], v[56:59]
v_mfma_f32_16x16x32_bf16 v[56:59], a[196:199], a[140:143], v[56:59]
s_waitcnt lgkmcnt(8)
v_mfma_f32_16x16x32_bf16 v[88:91], a[196:199], a[144:147], v[88:91]
global_load_dwordx4 a[228:231], v0, s[72:73] offset:0
v_mfma_f32_16x16x32_bf16 v[88:91], a[224:227], a[148:151], v[88:91]
v_mfma_f32_16x16x32_bf16 v[120:123], a[224:227], a[152:155], v[120:123]
v_mfma_f32_16x16x32_bf16 v[120:123], a[196:199], a[156:159], v[120:123]
s_waitcnt lgkmcnt(4)
v_mfma_f32_16x16x32_bf16 v[152:155], a[196:199], a[160:163], v[152:155]
global_load_dwordx4 a[204:207], v0, s[74:75] offset:0
v_mfma_f32_16x16x32_bf16 v[152:155], a[224:227], a[164:167], v[152:155]
v_mfma_f32_16x16x32_bf16 v[184:187], a[224:227], a[168:171], v[184:187]
v_mfma_f32_16x16x32_bf16 v[184:187], a[196:199], a[172:175], v[184:187]
s_waitcnt vmcnt(6) lgkmcnt(0)
v_mfma_f32_16x16x32_bf16 v[216:219], a[196:199], a[176:179], v[216:219]
s_barrier
v_mfma_f32_16x16x32_bf16 v[216:219], a[224:227], a[180:183], v[216:219]
v_cmp_ne_u32 vcc, 16256, v5
v_mfma_f32_16x16x32_bf16 v[248:251], a[224:227], a[184:187], v[248:251]
global_load_dwordx4 a[224:227], v0, s[72:73] offset:1024
v_mfma_f32_16x16x32_bf16 v[248:251], a[196:199], a[188:191], v[248:251]
v_mfma_f32_16x16x32_bf16 v[252:255], a[212:215], a[188:191], v[252:255]
v_mfma_f32_16x16x32_bf16 v[252:255], a[216:219], a[184:187], v[252:255]
v_mfma_f32_16x16x32_bf16 v[220:223], a[216:219], a[180:183], v[220:223]
global_load_dwordx4 a[196:199], v0, s[74:75] offset:1024
v_mfma_f32_16x16x32_bf16 v[220:223], a[212:215], a[176:179], v[220:223]
s_and_b32 s3, vcc_lo, 15
s_cbranch_scc1 L_slow9
L_back9:
v_mfma_f32_16x16x32_bf16 v[188:191], a[212:215], a[172:175], v[188:191]
v_mfma_f32_16x16x32_bf16 v[188:191], a[216:219], a[168:171], v[188:191]
v_mfma_f32_16x16x32_bf16 v[156:159], a[216:219], a[164:167], v[156:159]
s_add_u32 m0, s56, 0
v_mfma_f32_16x16x32_bf16 v[156:159], a[212:215], a[160:163], v[156:159]
s_add_u32 s30, s28, 229376
s_addc_u32 s31, s29, 0
v_mfma_f32_16x16x32_bf16 v[124:127], a[212:215], a[156:159], v[124:127]
v_mfma_f32_16x16x32_bf16 v[124:127], a[216:219], a[152:155], v[124:127]
v_mfma_f32_16x16x32_bf16 v[92:95], a[216:219], a[148:151], v[92:95]
global_load_lds_dwordx4 v0, s[30:31] nt
v_mfma_f32_16x16x32_bf16 v[92:95], a[212:215], a[144:147], v[92:95]
v_mfma_f32_16x16x32_bf16 v[60:63], a[212:215], a[140:143], v[60:63]
v_mfma_f32_16x16x32_bf16 v[60:63], a[216:219], a[136:139], v[60:63]
v_mfma_f32_16x16x32_bf16 v[28:31], a[216:219], a[132:135], v[28:31]
global_load_dwordx4 a[216:219], v0, s[72:73] offset:2048
v_mfma_f32_16x16x32_bf16 v[28:31], a[212:215], a[128:131], v[28:31]
s_waitcnt vmcnt(8)
v_mfma_f32_16x16x32_bf16 v[32:35], a[192:195], a[128:131], v[32:35]
v_mfma_f32_16x16x32_bf16 v[32:35], a[208:211], a[132:135], v[32:35]
v_mfma_f32_16x16x32_bf16 v[64:67], a[208:211], a[136:139], v[64:67]
global_load_dwordx4 a[212:215], v0, s[74:75] offset:2048
v_mfma_f32_16x16x32_bf16 v[64:67], a[192:195], a[140:143], v[64:67]
v_mfma_f32_16x16x32_bf16 v[96:99], a[192:195], a[144:147], v[96:99]
v_mfma_f32_16x16x32_bf16 v[96:99], a[208:211], a[148:151], v[96:99]
global_load_lds_dwordx4 v0, s[30:31] offset:1024 nt
v_mfma_f32_16x16x32_bf16 v[128:131], a[208:211], a[152:155], v[128:131]
v_mfma_f32_16x16x32_bf16 v[128:131], a[192:195], a[156:159], v[128:131]
v_mfma_f32_16x16x32_bf16 v[160:163], a[192:195], a[160:163], v[160:163]
v_mfma_f32_16x16x32_bf16 v[160:163], a[208:211], a[164:167], v[160:163]
v_mfma_f32_16x16x32_bf16 v[192:195], a[208:211], a[168:171], v[192:195]
v_mfma_f32_16x16x32_bf16 v[192:195], a[192:195], a[172:175], v[192:195]
v_mfma_f32_16x16x32_bf16 v[224:227], a[192:195], a[176:179], v[224:227]
v_mfma_f32_16x16x32_bf16 v[224:227], a[208:211], a[180:183], v[224:227]
s_add_u32 m0, s56, 8192
v_mfma_f32_16x16x32_bf16 a[232:235], a[208:211], a[184:187], a[232:235]
global_load_dwordx4 a[208:211], v0, s[72:73] offset:3072
v_mfma_f32_16x16x32_bf16 a[232:235], a[192:195], a[188:191], a[232:235]
s_waitcnt vmcnt(9)
v_mfma_f32_16x16x32_bf16 a[236:239], a[220:223], a[188:191], a[236:239]
s_add_u32 s30, s28, 237568
s_addc_u32 s31, s29, 0
v_mfma_f32_16x16x32_bf16 a[236:239], a[200:203], a[184:187], a[236:239]
v_mfma_f32_16x16x32_bf16 v[228:231], a[200:203], a[180:183], v[228:231]
global_load_dwordx4 a[192:195], v0, s[74:75] offset:3072
v_mfma_f32_16x16x32_bf16 v[228:231], a[220:223], a[176:179], v[228:231]
s_add_u32 s72, s12, 741376
s_addc_u32 s73, s13, 0
v_mfma_f32_16x16x32_bf16 v[196:199], a[220:223], a[172:175], v[196:199]
v_mfma_f32_16x16x32_bf16 v[196:199], a[200:203], a[168:171], v[196:199]
global_load_lds_dwordx4 v0, s[30:31] nt
v_mfma_f32_16x16x32_bf16 v[164:167], a[200:203], a[164:167], v[164:167]
s_add_u32 s74, s12, 774144
s_addc_u32 s75, s13, 0
v_mfma_f32_16x16x32_bf16 v[164:167], a[220:223], a[160:163], v[164:167]
v_mfma_f32_16x16x32_bf16 v[132:135], a[220:223], a[156:159], v[132:135]
v_mfma_f32_16x16x32_bf16 v[132:135], a[200:203], a[152:155], v[132:135]
v_mfma_f32_16x16x32_bf16 v[100:103], a[200:203], a[148:151], v[100:103]
v_mfma_f32_16x16x32_bf16 v[100:103], a[220:223], a[144:147], v[100:103]
v_mfma_f32_16x16x32_bf16 v[68:71], a[220:223], a[140:143], v[68:71]
v_mfma_f32_16x16x32_bf16 v[68:71], a[200:203], a[136:139], v[68:71]
v_mfma_f32_16x16x32_bf16 v[36:39], a[200:203], a[132:135], v[36:39]
global_load_dwordx4 a[200:203], v0, s[72:73] offset:-4096
v_mfma_f32_16x16x32_bf16 v[36:39], a[220:223], a[128:131], v[36:39]
s_waitcnt vmcnt(10)
v_mfma_f32_16x16x32_bf16 v[40:43], a[228:231], a[128:131], v[40:43]
global_load_lds_dwordx4 v0, s[30:31] offset:1024 nt
v_mfma_f32_16x16x32_bf16 v[40:43], a[204:207], a[132:135], v[40:43]
v_mfma_f32_16x16x32_bf16 v[72:75], a[204:207], a[136:139], v[72:75]
global_load_dwordx4 a[220:223], v0, s[74:75] offset:-4096
v_mfma_f32_16x16x32_bf16 v[72:75], a[228:231], a[140:143], v[72:75]
v_mfma_f32_16x16x32_bf16 v[104:107], a[228:231], a[144:147], v[104:107]
v_mfma_f32_16x16x32_bf16 v[104:107], a[204:207], a[148:151], v[104:107]
v_mfma_f32_16x16x32_bf16 v[136:139], a[204:207], a[152:155], v[136:139]
v_mfma_f32_16x16x32_bf16 v[136:139], a[228:231], a[156:159], v[136:139]
v_mfma_f32_16x16x32_bf16 v[168:171], a[228:231], a[160:163], v[168:171]
v_mfma_f32_16x16x32_bf16 v[168:171], a[204:207], a[164:167], v[168:171]
v_mfma_f32_16x16x32_bf16 v[200:203], a[204:207], a[168:171], v[200:203]
v_mfma_f32_16x16x32_bf16 v[200:203], a[228:231], a[172:175], v[200:203]
v_mfma_f32_16x16x32_bf16 v[232:235], a[228:231], a[176:179], v[232:235]
v_mfma_f32_16x16x32_bf16 v[232:235], a[204:207], a[180:183], v[232:235]
v_mfma_f32_16x16x32_bf16 a[240:243], a[204:207], a[184:187], a[240:243]
global_load_dwordx4 a[204:207], v0, s[72:73] offset:-3072
v_mfma_f32_16x16x32_bf16 a[240:243], a[228:231], a[188:191], a[240:243]
s_waitcnt vmcnt(11)
v_mfma_f32_16x16x32_bf16 a[244:247], a[224:227], a[188:191], a[244:247]
v_mfma_f32_16x16x32_bf16 a[244:247], a[196:199], a[184:187], a[244:247]
v_mfma_f32_16x16x32_bf16 v[236:239], a[196:199], a[180:183], v[236:239]
global_load_dwordx4 a[228:231], v0, s[74:75] offset:-3072
v_mfma_f32_16x16x32_bf16 v[236:239], a[224:227], a[176:179], v[236:239]
v_mfma_f32_16x16x32_bf16 v[204:207], a[224:227], a[172:175], v[204:207]
v_mfma_f32_16x16x32_bf16 v[204:207], a[196:199], a[168:171], v[204:207]
v_mfma_f32_16x16x32_bf16 v[172:175], a[196:199], a[164:167], v[172:175]
v_mfma_f32_16x16x32_bf16 v[172:175], a[224:227], a[160:163], v[172:175]
v_mfma_f32_16x16x32_bf16 v[140:143], a[224:227], a[156:159], v[140:143]
v_mfma_f32_16x16x32_bf16 v[140:143], a[196:199], a[152:155], v[140:143]
v_mfma_f32_16x16x32_bf16 v[108:111], a[196:199], a[148:151], v[108:111]
v_mfma_f32_16x16x32_bf16 v[108:111], a[224:227], a[144:147], v[108:111]
v_mfma_f32_16x16x32_bf16 v[76:79], a[224:227], a[140:143], v[76:79]
L_pad19:
s_cbranch_execz L_tret1
v_mfma_f32_16x16x32_bf16 v[76:79], a[196:199], a[136:139], v[76:79]
v_mfma_f32_4x4x4_16b_bf16 v[8:11], v[6:7], v[16:17], 0
v_mfma_f32_4x4x4_16b_bf16 v[12:15], v[6:7], v[18:19], 0
v_mfma_f32_16x16x32_bf16 v[44:47], a[196:199], a[132:135], v[44:47]
global_load_dwordx4 a[196:199], v0, s[72:73] offset:-2048
v_mfma_f32_16x16x32_bf16 v[44:47], a[224:227], a[128:131], v[44:47]
s_waitcnt vmcnt(10)
v_mfma_f32_16x16x32_bf16 v[48:51], a[216:219], a[128:131], v[48:51]
v_mfma_f32_16x16x32_bf16 v[48:51], a[212:215], a[132:135], v[48:51]
v_mfma_f32_16x16x32_bf16 v[80:83], a[212:215], a[136:139], v[80:83]
global_load_dwordx4 a[224:227], v0, s[74:75] offset:-2048
v_mfma_f32_16x16x32_bf16 v[80:83], a[216:219], a[140:143], v[80:83]
v_mfma_f32_16x16x32_bf16 v[112:115], a[216:219], a[144:147], v[112:115]
v_mfma_f32_16x16x32_bf16 v[112:115], a[212:215], a[148:151], v[112:115]
v_add_f32 v40, v40, v8
v_add_f32 v41, v41, v9
v_mfma_f32_16x16x32_bf16 v[144:147], a[212:215], a[152:155], v[144:147]
v_add_f32 v42, v42, v10
v_mfma_f32_16x16x32_bf16 v[144:147], a[216:219], a[156:159], v[144:147]
v_add_f32 v43, v43, v11
v_mfma_f32_16x16x32_bf16 v[176:179], a[216:219], a[160:163], v[176:179]
v_add_f32 v44, v44, v12
v_mfma_f32_16x16x32_bf16 v[176:179], a[212:215], a[164:167], v[176:179]
v_add_f32 v45, v45, v13
v_mfma_f32_16x16x32_bf16 v[208:211], a[212:215], a[168:171], v[208:211]
v_add_f32 v46, v46, v14
v_add_f32 v47, v47, v15
v_mfma_f32_16x16x32_bf16 v[208:211], a[216:219], a[172:175], v[208:211]
v_add_f32 v72, v72, v8
v_mfma_f32_16x16x32_bf16 v[240:243], a[216:219], a[176:179], v[240:243]
v_add_f32 v73, v73, v9
v_mfma_f32_16x16x32_bf16 v[240:243], a[212:215], a[180:183], v[240:243]
v_mfma_f32_16x16x32_bf16 a[248:251], a[212:215], a[184:187], a[248:251]
global_load_dwordx4 a[212:215], v0, s[72:73] offset:-1024
v_mfma_f32_16x16x32_bf16 a[248:251], a[216:219], a[188:191], a[248:251]
v_add_f32 v74, v74, v10
s_waitcnt vmcnt(9)
v_mfma_f32_16x16x32_bf16 a[252:255], a[208:211], a[188:191], a[252:255]
ds_read_b128 a[188:191], v2 offset:16384
v_add_f32 v75, v75, v11
v_mfma_f32_16x16x32_bf16 a[252:255], a[192:195], a[184:187], a[252:255]
ds_read_b128 a[184:187], v2 offset:24576
v_add_f32 v76, v76, v12
v_mfma_f32_16x16x32_bf16 v[244:247], a[192:195], a[180:183], v[244:247]
ds_read_b128 a[180:183], v2 offset:25600
v_mfma_f32_16x16x32_bf16 v[244:247], a[208:211], a[176:179], v[244:247]
ds_read_b128 a[176:179], v2 offset:17408
v_add_f32 v77, v77, v13
v_mfma_f32_16x16x32_bf16 v[212:215], a[208:211], a[172:175], v[212:215]
ds_read_b128 a[172:175], v2 offset:18432
v_mfma_f32_16x16x32_bf16 v[212:215], a[192:195], a[168:171], v[212:215]
ds_read_b128 a[168:171], v2 offset:26624
v_add_f32 v78, v78, v14
v_mfma_f32_16x16x32_bf16 v[180:183], a[192:195], a[164:167], v[180:183]
ds_read_b128 a[164:167], v2 offset:27648
v_mfma_f32_16x16x32_bf16 v[180:183], a[208:211], a[160:163], v[180:183]
ds_read_b128 a[160:163], v2 offset:19456
v_add_f32 v79, v79, v15
v_mfma_f32_16x16x32_bf16 v[148:151], a[208:211], a[156:159], v[148:151]
ds_read_b128 a[156:159], v2 offset:20480
v_add_f32 v104, v104, v8
v_mfma_f32_16x16x32_bf16 v[148:151], a[192:195], a[152:155], v[148:151]
ds_read_b128 a[152:155], v2 offset:28672
v_mfma_f32_16x16x32_bf16 v[116:119], a[192:195], a[148:151], v[116:119]
ds_read_b128 a[148:151], v2 offset:29696
v_add_f32 v105, v105, v9
v_mfma_f32_16x16x32_bf16 v[116:119], a[208:211], a[144:147], v[116:119]
ds_read_b128 a[144:147], v2 offset:21504
v_mfma_f32_16x16x32_bf16 v[84:87], a[208:211], a[140:143], v[84:87]
ds_read_b128 a[140:143], v2 offset:22528
v_add_f32 v106, v106, v10
v_mfma_f32_16x16x32_bf16 v[84:87], a[192:195], a[136:139], v[84:87]
ds_read_b128 a[136:139], v2 offset:30720
v_add_f32 v107, v107, v11
v_mfma_f32_16x16x32_bf16 v[52:55], a[192:195], a[132:135], v[52:55]
ds_read_b128 a[132:135], v2 offset:31744
v_mfma_f32_16x16x32_bf16 v[52:55], a[208:211], a[128:131], v[52:55]
ds_read_b128 a[128:131], v2 offset:23552
s_waitcnt vmcnt(5) lgkmcnt(12)
v_mfma_f32_16x16x32_bf16 v[24:27], a[200:203], a[188:191], v[24:27]
global_load_dwordx4 a[216:219], v0, s[74:75] offset:-1024
v_mfma_f32_16x16x32_bf16 v[24:27], a[220:223], a[184:187], v[24:27]
v_add_f32 v108, v108, v12
v_mfma_f32_16x16x32_bf16 v[56:59], a[220:223], a[180:183], v[56:59]
v_add_f32 v109, v109, v13
v_add_f32 v110, v110, v14
v_mfma_f32_16x16x32_bf16 v[56:59], a[200:203], a[176:179], v[56:59]
s_waitcnt lgkmcnt(8)
v_mfma_f32_16x16x32_bf16 v[88:91], a[200:203], a[172:175], v[88:91]
global_load_dwordx4 a[192:195], v0, s[72:73] offset:0
v_mfma_f32_16x16x32_bf16 v[88:91], a[220:223], a[168:171], v[88:91]
v_add_f32 v111, v111, v15
v_mfma_f32_16x16x32_bf16 v[120:123], a[220:223], a[164:167], v[120:123]
v_add_f32 v136, v136, v8
v_mfma_f32_16x16x32_bf16 v[120:123], a[200:203], a[160:163], v[120:123]
s_waitcnt lgkmcnt(4)
v_mfma_f32_16x16x32_bf16 v[152:155], a[200:203], a[156:159], v[152:155]
global_load_dwordx4 a[208:211], v0, s[74:75] offset:0
v_mfma_f32_16x16x32_bf16 v[152:155], a[220:223], a[152:155], v[152:155]
v_add_f32 v137, v137, v9
v_add_f32 v138, v138, v10
v_mfma_f32_16x16x32_bf16 v[184:187], a[220:223], a[148:151], v[184:187]
v_add_f32 v139, v139, v11
v_mfma_f32_16x16x32_bf16 v[184:187], a[200:203], a[144:147], v[184:187]
v_add_f32 v140, v140, v12
s_waitcnt lgkmcnt(0)
v_mfma_f32_16x16x32_bf16 v[216:219], a[200:203], a[140:143], v[216:219]
v_add_f32 v141, v141, v13
s_barrier
v_mfma_f32_16x16x32_bf16 v[216:219], a[220:223], a[136:139], v[216:219]
s_add_u32 m0, s56, 16384
v_mfma_f32_16x16x32_bf16 v[248:251], a[220:223], a[132:135], v[248:251]
global_load_dwordx4 a[220:223], v0, s[72:73] offset:1024
v_mfma_f32_16x16x32_bf16 v[248:251], a[200:203], a[128:131], v[248:251]
v_add_f32 v142, v142, v14
s_waitcnt vmcnt(7)
v_mfma_f32_16x16x32_bf16 v[252:255], a[204:207], a[128:131], v[252:255]
s_add_u32 s30, s28, 245760
s_addc_u32 s31, s29, 0
v_mfma_f32_16x16x32_bf16 v[252:255], a[228:231], a[132:135], v[252:255]
v_add_f32 v143, v143, v15
v_mfma_f32_16x16x32_bf16 v[220:223], a[228:231], a[136:139], v[220:223]
global_load_dwordx4 a[200:203], v0, s[74:75] offset:1024
v_mfma_f32_16x16x32_bf16 v[220:223], a[204:207], a[140:143], v[220:223]
v_add_f32 v168, v168, v8
v_mfma_f32_16x16x32_bf16 v[188:191], a[204:207], a[144:147], v[188:191]
v_mfma_f32_16x16x32_bf16 v[188:191], a[228:231], a[148:151], v[188:191]
global_load_lds_dwordx4 v0, s[30:31] nt
v_mfma_f32_16x16x32_bf16 v[156:159], a[228:231], a[152:155], v[156:159]
v_add_f32 v169, v169, v9
v_add_f32 v170, v170, v10
v_mfma_f32_16x16x32_bf16 v[156:159], a[204:207], a[156:159], v[156:159]
v_add_f32 v171, v171, v11
v_mfma_f32_16x16x32_bf16 v[124:127], a[204:207], a[160:163], v[124:127]
v_add_f32 v172, v172, v12
v_mfma_f32_16x16x32_bf16 v[124:127], a[228:231], a[164:167], v[124:127]
v_add_f32 v173, v173, v13
v_mfma_f32_16x16x32_bf16 v[92:95], a[228:231], a[168:171], v[92:95]
v_add_f32 v174, v174, v14
v_mfma_f32_16x16x32_bf16 v[92:95], a[204:207], a[172:175], v[92:95]
v_add_f32 v175, v175, v15
v_mfma_f32_16x16x32_bf16 v[60:63], a[204:207], a[176:179], v[60:63]
v_add_f32 v200, v200, v8
v_add_f32 v201, v201, v9
v_mfma_f32_16x16x32_bf16 v[60:63], a[228:231], a[180:183], v[60:63]
v_mfma_f32_16x16x32_bf16 v[28:31], a[228:231], a[184:187], v[28:31]
global_load_dwordx4 a[228:231], v0, s[72:73] offset:2048
v_mfma_f32_16x16x32_bf16 v[28:31], a[204:207], a[188:191], v[28:31]
v_add_f32 v202, v202, v10
s_waitcnt vmcnt(8)
v_mfma_f32_16x16x32_bf16 v[32:35], a[196:199], a[188:191], v[32:35]
global_load_lds_dwordx4 v0, s[30:31] offset:1024 nt
v_mfma_f32_16x16x32_bf16 v[32:35], a[224:227], a[184:187], v[32:35]
v_mfma_f32_16x16x32_bf16 v[64:67], a[224:227], a[180:183], v[64:67]
global_load_dwordx4 a[204:207], v0, s[74:75] offset:2048
v_mfma_f32_16x16x32_bf16 v[64:67], a[196:199], a[176:179], v[64:67]
v_add_f32 v203, v203, v11
v_mfma_f32_16x16x32_bf16 v[96:99], a[196:199], a[172:175], v[96:99]
v_add_f32 v204, v204, v12
v_mfma_f32_16x16x32_bf16 v[96:99], a[224:227], a[168:171], v[96:99]
v_add_f32 v205, v205, v13
v_add_f32 v206, v206, v14
v_mfma_f32_16x16x32_bf16 v[128:131], a[224:227], a[164:167], v[128:131]
v_add_f32 v207, v207, v15
v_mfma_f32_16x16x32_bf16 v[128:131], a[196:199], a[160:163], v[128:131]
v_add_f32 v232, v232, v8
v_mfma_f32_16x16x32_bf16 v[160:163], a[196:199], a[156:159], v[160:163]
v_add_f32 v233, v233, v9
v_mfma_f32_16x16x32_bf16 v[160:163], a[224:227], a[152:155], v[160:163]
v_add_f32 v234, v234, v10
v_mfma_f32_16x16x32_bf16 v[192:195], a[224:227], a[148:151], v[192:195]
s_add_u32 m0, s56, 24576
v_add_f32 v235, v235, v11
v_add_f32 v236, v236, v12
v_mfma_f32_16x16x32_bf16 v[192:195], a[196:199], a[144:147], v[192:195]
s_add_u32 s30, s28, 253952
s_addc_u32 s31, s29, 0
v_mfma_f32_16x16x32_bf16 v[224:227], a[196:199], a[140:143], v[224:227]
v_add_f32 v237, v237, v13
v_mfma_f32_16x16x32_bf16 v[224:227], a[224:227], a[136:139], v[224:227]
v_mfma_f32_16x16x32_bf16 a[232:235], a[224:227], a[132:135], a[232:235]
global_load_dwordx4 a[224:227], v0, s[72:73] offset:3072
v_mfma_f32_16x16x32_bf16 a[232:235], a[196:199], a[128:131], a[232:235]
v_add_f32 v238, v238, v14
s_waitcnt vmcnt(9)
v_mfma_f32_16x16x32_bf16 a[236:239], a[212:215], a[128:131], a[236:239]
global_load_lds_dwordx4 v0, s[30:31] nt
v_mfma_f32_16x16x32_bf16 a[236:239], a[216:219], a[132:135], a[236:239]
v_mfma_f32_16x16x32_bf16 v[228:231], a[216:219], a[136:139], v[228:231]
global_load_dwordx4 a[196:199], v0, s[74:75] offset:3072
v_mfma_f32_16x16x32_bf16 v[228:231], a[212:215], a[140:143], v[228:231]
s_add_u32 s72, s12, 684032
s_addc_u32 s73, s13, 0
v_mfma_f32_16x16x32_bf16 v[196:199], a[212:215], a[144:147], v[196:199]
v_add_f32 v239, v239, v15
v_mfma_f32_16x16x32_bf16 v[196:199], a[216:219], a[148:151], v[196:199]
v_mfma_f32_4x4x4_16b_bf16 a[240:243], v[6:7], v[16:17], a[240:243]
v_mfma_f32_4x4x4_16b_bf16 a[244:247], v[6:7], v[18:19], a[244:247]
v_mfma_f32_16x16x32_bf16 v[164:167], a[216:219], a[152:155], v[164:167]
s_add_u32 s74, s12, 716800
s_addc_u32 s75, s13, 0
v_mfma_f32_16x16x32_bf16 v[164:167], a[212:215], a[156:159], v[164:167]
v_mfma_f32_16x16x32_bf16 v[132:135], a[212:215], a[160:163], v[132:135]
v_mfma_f32_16x16x32_bf16 v[132:135], a[216:219], a[164:167], v[132:135]
v_lshrrev_b32 v16, 4, v0
v_mfma_f32_16x16x32_bf16 v[100:103], a[216:219], a[168:171], v[100:103]
v_and_b32 v16, 48, v16
v_mfma_f32_16x16x32_bf16 v[100:103], a[212:215], a[172:175], v[100:103]
s_add_u32 s67, s66, 4096
v_mfma_f32_16x16x32_bf16 v[68:71], a[212:215], a[176:179], v[68:71]
buffer_load_dwordx4 v[16:19], v16, s[16:19], s67 offen offset:192
v_mfma_f32_16x16x32_bf16 v[68:71], a[216:219], a[180:183], v[68:71]
global_load_lds_dwordx4 v0, s[30:31] offset:1024 nt
v_mfma_f32_16x16x32_bf16 v[36:39], a[216:219], a[184:187], v[36:39]
global_load_dwordx4 a[216:219], v0, s[72:73] offset:-4096
v_mfma_f32_16x16x32_bf16 v[36:39], a[212:215], a[188:191], v[36:39]
s_waitcnt vmcnt(12)
v_mfma_f32_16x16x32_bf16 v[40:43], a[192:195], a[188:191], v[40:43]
v_mfma_f32_16x16x32_bf16 v[40:43], a[208:211], a[184:187], v[40:43]
v_mfma_f32_16x16x32_bf16 v[72:75], a[208:211], a[180:183], v[72:75]
global_load_dwordx4 a[212:215], v0, s[74:75] offset:-4096
v_mfma_f32_16x16x32_bf16 v[72:75], a[192:195], a[176:179], v[72:75]
v_mfma_f32_16x16x32_bf16 v[104:107], a[192:195], a[172:175], v[104:107]
v_mfma_f32_16x16x32_bf16 v[104:107], a[208:211], a[168:171], v[104:107]
v_mfma_f32_16x16x32_bf16 v[136:139], a[208:211], a[164:167], v[136:139]
v_mfma_f32_16x16x32_bf16 v[136:139], a[192:195], a[160:163], v[136:139]
v_mfma_f32_16x16x32_bf16 v[168:171], a[192:195], a[156:159], v[168:171]
v_mfma_f32_16x16x32_bf16 v[168:171], a[208:211], a[152:155], v[168:171]
v_mfma_f32_16x16x32_bf16 v[200:203], a[208:211], a[148:151], v[200:203]
v_mfma_f32_16x16x32_bf16 v[200:203], a[192:195], a[144:147], v[200:203]
v_mfma_f32_16x16x32_bf16 v[232:235], a[192:195], a[140:143], v[232:235]
v_mfma_f32_16x16x32_bf16 v[232:235], a[208:211], a[136:139], v[232:235]
v_mfma_f32_16x16x32_bf16 a[240:243], a[208:211], a[132:135], a[240:243]
global_load_dwordx4 a[208:211], v0, s[72:73] offset:-3072
v_mfma_f32_16x16x32_bf16 a[240:243], a[192:195], a[128:131], a[240:243]
s_waitcnt vmcnt(12)
v_mfma_f32_16x16x32_bf16 a[244:247], a[220:223], a[128:131], a[244:247]
v_mfma_f32_16x16x32_bf16 a[244:247], a[200:203], a[132:135], a[244:247]
v_mfma_f32_16x16x32_bf16 v[236:239], a[200:203], a[136:139], v[236:239]
global_load_dwordx4 a[192:195], v0, s[74:75] offset:-3072
v_mfma_f32_16x16x32_bf16 v[236:239], a[220:223], a[140:143], v[236:239]
v_mfma_f32_16x16x32_bf16 v[204:207], a[220:223], a[144:147], v[204:207]
v_mfma_f32_16x16x32_bf16 v[204:207], a[200:203], a[148:151], v[204:207]
v_mfma_f32_16x16x32_bf16 v[172:175], a[200:203], a[152:155], v[172:175]
v_mfma_f32_16x16x32_bf16 v[172:175], a[220:223], a[156:159], v[172:175]
v_mfma_f32_16x16x32_bf16 v[140:143], a[220:223], a[160:163], v[140:143]
v_mfma_f32_16x16x32_bf16 v[140:143], a[200:203], a[164:167], v[140:143]
v_mfma_f32_16x16x32_bf16 v[108:111], a[200:203], a[168:171], v[108:111]
v_mfma_f32_16x16x32_bf16 v[108:111], a[220:223], a[172:175], v[108:111]
v_mfma_f32_16x16x32_bf16 v[76:79], a[220:223], a[176:179], v[76:79]
v_mfma_f32_16x16x32_bf16 v[76:79], a[200:203], a[180:183], v[76:79]
v_mfma_f32_16x16x32_bf16 v[44:47], a[200:203], a[184:187], v[44:47]
global_load_dwordx4 a[200:203], v0, s[72:73] offset:-2048
v_mfma_f32_16x16x32_bf16 v[44:47], a[220:223], a[188:191], v[44:47]
s_waitcnt vmcnt(10)
v_mfma_f32_16x16x32_bf16 v[48:51], a[228:231], a[188:191], v[48:51]
v_mfma_f32_16x16x32_bf16 v[48:51], a[204:207], a[184:187], v[48:51]
v_mfma_f32_16x16x32_bf16 v[80:83], a[204:207], a[180:183], v[80:83]
global_load_dwordx4 a[220:223], v0, s[74:75] offset:-2048
v_mfma_f32_16x16x32_bf16 v[80:83], a[228:231], a[176:179], v[80:83]
v_mfma_f32_16x16x32_bf16 v[112:115], a[228:231], a[172:175], v[112:115]
v_mfma_f32_16x16x32_bf16 v[112:115], a[204:207], a[168:171], v[112:115]
v_mfma_f32_16x16x32_bf16 v[144:147], a[204:207], a[164:167], v[144:147]
v_mfma_f32_16x16x32_bf16 v[144:147], a[228:231], a[160:163], v[144:147]
v_mfma_f32_16x16x32_bf16 v[176:179], a[228:231], a[156:159], v[176:179]
v_mfma_f32_16x16x32_bf16 v[176:179], a[204:207], a[152:155], v[176:179]
v_mfma_f32_16x16x32_bf16 v[208:211], a[204:207], a[148:151], v[208:211]
v_mfma_f32_16x16x32_bf16 v[208:211], a[228:231], a[144:147], v[208:211]
v_mfma_f32_16x16x32_bf16 v[240:243], a[228:231], a[140:143], v[240:243]
v_mfma_f32_16x16x32_bf16 v[240:243], a[204:207], a[136:139], v[240:243]
v_mfma_f32_16x16x32_bf16 a[248:251], a[204:207], a[132:135], a[248:251]
global_load_dwordx4 a[204:207], v0, s[72:73] offset:-1024
v_mfma_f32_16x16x32_bf16 a[248:251], a[228:231], a[128:131], a[248:251]
s_waitcnt vmcnt(9)
v_mfma_f32_16x16x32_bf16 a[252:255], a[224:227], a[128:131], a[252:255]
ds_read_b128 a[128:131], v2 offset:0
v_mfma_f32_16x16x32_bf16 a[252:255], a[196:199], a[132:135], a[252:255]
ds_read_b128 a[132:135], v2 offset:8192
v_mfma_f32_16x16x32_bf16 v[244:247], a[196:199], a[136:139], v[244:247]
ds_read_b128 a[136:139], v2 offset:9216
v_mfma_f32_16x16x32_bf16 v[244:247], a[224:227], a[140:143], v[244:247]
ds_read_b128 a[140:143], v2 offset:1024
v_mfma_f32_16x16x32_bf16 v[212:215], a[224:227], a[144:147], v[212:215]
ds_read_b128 a[144:147], v2 offset:2048
v_mfma_f32_16x16x32_bf16 v[212:215], a[196:199], a[148:151], v[212:215]
ds_read_b128 a[148:151], v2 offset:10240
v_mfma_f32_16x16x32_bf16 v[180:183], a[196:199], a[152:155], v[180:183]
ds_read_b128 a[152:155], v2 offset:11264
v_mfma_f32_16x16x32_bf16 v[180:183], a[224:227], a[156:159], v[180:183]
ds_read_b128 a[156:159], v2 offset:3072
v_mfma_f32_16x16x32_bf16 v[148:151], a[224:227], a[160:163], v[148:151]
ds_read_b128 a[160:163], v2 offset:4096
v_mfma_f32_16x16x32_bf16 v[148:151], a[196:199], a[164:167], v[148:151]
ds_read_b128 a[164:167], v2 offset:12288
v_mfma_f32_16x16x32_bf16 v[116:119], a[196:199], a[168:171], v[116:119]
ds_read_b128 a[168:171], v2 offset:13312
v_mfma_f32_16x16x32_bf16 v[116:119], a[224:227], a[172:175], v[116:119]
ds_read_b128 a[172:175], v2 offset:5120
s_waitcnt vmcnt(8)
v_mfma_f32_16x16x32_bf16 v[84:87], a[224:227], a[176:179], v[84:87]
ds_read_b128 a[176:179], v2 offset:6144
v_mfma_f32_16x16x32_bf16 v[84:87], a[196:199], a[180:183], v[84:87]
ds_read_b128 a[180:183], v2 offset:14336
v_mfma_f32_4x4x4_16b_bf16 v[8:11], v[6:7], v[16:17], 0
v_mfma_f32_4x4x4_16b_bf16 v[12:15], v[6:7], v[18:19], 0
v_mfma_f32_16x16x32_bf16 v[52:55], a[196:199], a[184:187], v[52:55]
ds_read_b128 a[184:187], v2 offset:15360
v_mfma_f32_16x16x32_bf16 v[52:55], a[224:227], a[188:191], v[52:55]
ds_read_b128 a[188:191], v2 offset:7168
s_waitcnt vmcnt(5) lgkmcnt(12)
v_mfma_f32_16x16x32_bf16 v[24:27], a[216:219], a[128:131], v[24:27]
global_load_dwordx4 a[228:231], v0, s[74:75] offset:-1024
v_mfma_f32_16x16x32_bf16 v[24:27], a[212:215], a[132:135], v[24:27]
v_mfma_f32_16x16x32_bf16 v[56:59], a[212:215], a[136:139], v[56:59]
v_mfma_f32_16x16x32_bf16 v[56:59], a[216:219], a[140:143], v[56:59]
s_waitcnt lgkmcnt(8)
v_mfma_f32_16x16x32_bf16 v[88:91], a[216:219], a[144:147], v[88:91]
global_load_dwordx4 a[196:199], v0, s[72:73] offset:0
v_mfma_f32_16x16x32_bf16 v[88:91], a[212:215], a[148:151], v[88:91]
v_add_f32 v48, v48, v8
v_mfma_f32_16x16x32_bf16 v[120:123], a[212:215], a[152:155], v[120:123]
v_add_f32 v49, v49, v9
v_mfma_f32_16x16x32_bf16 v[120:123], a[216:219], a[156:159], v[120:123]
v_add_f32 v50, v50, v10
s_waitcnt lgkmcnt(4)
v_mfma_f32_16x16x32_bf16 v[152:155], a[216:219], a[160:163], v[152:155]
global_load_dwordx4 a[224:227], v0, s[74:75] offset:0
v_mfma_f32_16x16x32_bf16 v[152:155], a[212:215], a[164:167], v[152:155]
v_add_f32 v51, v51, v11
v_mfma_f32_16x16x32_bf16 v[184:187], a[212:215], a[168:171], v[184:187]
v_mfma_f32_16x16x32_bf16 v[184:187], a[216:219], a[172:175], v[184:187]
v_add_f32 v52, v52, v12
s_waitcnt lgkmcnt(0)
v_mfma_f32_16x16x32_bf16 v[216:219], a[216:219], a[176:179], v[216:219]
v_add_f32 v53, v53, v13
s_barrier
v_mfma_f32_16x16x32_bf16 v[216:219], a[212:215], a[180:183], v[216:219]
v_mfma_f32_16x16x32_bf16 v[248:251], a[212:215], a[184:187], v[248:251]
global_load_dwordx4 a[212:215], v0, s[72:73] offset:1024
v_mfma_f32_16x16x32_bf16 v[248:251], a[216:219], a[188:191], v[248:251]
v_add_f32 v54, v54, v14
s_waitcnt vmcnt(7)
v_mfma_f32_16x16x32_bf16 v[252:255], a[208:211], a[188:191], v[252:255]
v_add_f32 v55, v55, v15
v_mfma_f32_16x16x32_bf16 v[252:255], a[192:195], a[184:187], v[252:255]
v_mfma_f32_16x16x32_bf16 v[220:223], a[192:195], a[180:183], v[220:223]
global_load_dwordx4 a[216:219], v0, s[74:75] offset:1024
v_mfma_f32_16x16x32_bf16 v[220:223], a[208:211], a[176:179], v[220:223]
v_add_f32 v80, v80, v8
v_mfma_f32_16x16x32_bf16 v[188:191], a[208:211], a[172:175], v[188:191]
v_add_f32 v81, v81, v9
v_mfma_f32_16x16x32_bf16 v[188:191], a[192:195], a[168:171], v[188:191]
v_add_f32 v82, v82, v10
v_mfma_f32_16x16x32_bf16 v[156:159], a[192:195], a[164:167], v[156:159]
v_add_f32 v83, v83, v11
v_mfma_f32_16x16x32_bf16 v[156:159], a[208:211], a[160:163], v[156:159]
v_add_f32 v84, v84, v12
v_mfma_f32_16x16x32_bf16 v[124:127], a[208:211], a[156:159], v[124:127]
v_add_f32 v85, v85, v13
v_mfma_f32_16x16x32_bf16 v[124:127], a[192:195], a[152:155], v[124:127]
v_add_f32 v86, v86, v14
v_mfma_f32_16x16x32_bf16 v[92:95], a[192:195], a[148:151], v[92:95]
v_add_f32 v87, v87, v15
v_mfma_f32_16x16x32_bf16 v[92:95], a[208:211], a[144:147], v[92:95]
v_add_f32 v112, v112, v8
v_mfma_f32_16x16x32_bf16 v[60:63], a[208:211], a[140:143], v[60:63]
v_add_f32 v113, v113, v9
v_mfma_f32_16x16x32_bf16 v[60:63], a[192:195], a[136:139], v[60:63]
v_mfma_f32_16x16x32_bf16 v[28:31], a[192:195], a[132:135], v[28:31]
global_load_dwordx4 a[192:195], v0, s[72:73] offset:2048
v_mfma_f32_16x16x32_bf16 v[28:31], a[208:211], a[128:131], v[28:31]
v_add_f32 v114, v114, v10
s_waitcnt vmcnt(7)
v_mfma_f32_16x16x32_bf16 v[32:35], a[200:203], a[128:131], v[32:35]
v_add_f32 v115, v115, v11
v_mfma_f32_16x16x32_bf16 v[32:35], a[220:223], a[132:135], v[32:35]
v_mfma_f32_16x16x32_bf16 v[64:67], a[220:223], a[136:139], v[64:67]
global_load_dwordx4 a[208:211], v0, s[74:75] offset:2048
v_mfma_f32_16x16x32_bf16 v[64:67], a[200:203], a[140:143], v[64:67]
v_add_f32 v116, v116, v12
v_mfma_f32_16x16x32_bf16 v[96:99], a[200:203], a[144:147], v[96:99]
v_add_f32 v117, v117, v13
v_mfma_f32_16x16x32_bf16 v[96:99], a[220:223], a[148:151], v[96:99]
v_add_f32 v118, v118, v14
v_mfma_f32_16x16x32_bf16 v[128:131], a[220:223], a[152:155], v[128:131]
v_add_f32 v119, v119, v15
v_mfma_f32_16x16x32_bf16 v[128:131], a[200:203], a[156:159], v[128:131]
v_add_f32 v144, v144, v8
v_mfma_f32_16x16x32_bf16 v[160:163], a[200:203], a[160:163], v[160:163]
v_add_f32 v145, v145, v9
v_mfma_f32_16x16x32_bf16 v[160:163], a[220:223], a[164:167], v[160:163]
v_add_f32 v146, v146, v10
v_mfma_f32_16x16x32_bf16 v[192:195], a[220:223], a[168:171], v[192:195]
v_add_f32 v147, v147, v11
v_mfma_f32_16x16x32_bf16 v[192:195], a[200:203], a[172:175], v[192:195]
v_add_f32 v148, v148, v12
v_mfma_f32_16x16x32_bf16 v[224:227], a[200:203], a[176:179], v[224:227]
v_mfma_f32_16x16x32_bf16 v[224:227], a[220:223], a[180:183], v[224:227]
v_add_f32 v149, v149, v13
v_mfma_f32_16x16x32_bf16 a[232:235], a[220:223], a[184:187], a[232:235]
global_load_dwordx4 a[220:223], v0, s[72:73] offset:3072
v_mfma_f32_16x16x32_bf16 a[232:235], a[200:203], a[188:191], a[232:235]
v_add_f32 v150, v150, v14
s_waitcnt vmcnt(7)
v_mfma_f32_16x16x32_bf16 a[236:239], a[204:207], a[188:191], a[236:239]
v_add_f32 v151, v151, v15
v_mfma_f32_16x16x32_bf16 a[236:239], a[228:231], a[184:187], a[236:239]
v_mfma_f32_16x16x32_bf16 v[228:231], a[228:231], a[180:183], v[228:231]
global_load_dwordx4 a[200:203], v0, s[74:75] offset:3072
v_mfma_f32_16x16x32_bf16 v[228:231], a[204:207], a[176:179], v[228:231]
s_add_u32 s72, s12, 749568
s_addc_u32 s73, s13, 0
v_mfma_f32_16x16x32_bf16 v[196:199], a[204:207], a[172:175], v[196:199]
v_add_f32 v176, v176, v8
v_mfma_f32_16x16x32_bf16 v[196:199], a[228:231], a[168:171], v[196:199]
v_add_f32 v177, v177, v9
v_mfma_f32_16x16x32_bf16 v[164:167], a[228:231], a[164:167], v[164:167]
s_add_u32 s74, s12, 782336
s_addc_u32 s75, s13, 0
v_mfma_f32_16x16x32_bf16 v[164:167], a[204:207], a[160:163], v[164:167]
v_add_f32 v178, v178, v10
v_mfma_f32_16x16x32_bf16 v[132:135], a[204:207], a[156:159], v[132:135]
v_add_f32 v179, v179, v11
v_mfma_f32_16x16x32_bf16 v[132:135], a[228:231], a[152:155], v[132:135]
v_add_f32 v180, v180, v12
v_mfma_f32_16x16x32_bf16 v[100:103], a[228:231], a[148:151], v[100:103]
v_add_f32 v181, v181, v13
v_mfma_f32_16x16x32_bf16 v[100:103], a[204:207], a[144:147], v[100:103]
v_mfma_f32_16x16x32_bf16 v[68:71], a[204:207], a[140:143], v[68:71]
v_add_f32 v182, v182, v14
v_mfma_f32_16x16x32_bf16 v[68:71], a[228:231], a[136:139], v[68:71]
v_add_f32 v183, v183, v15
v_mfma_f32_16x16x32_bf16 v[36:39], a[228:231], a[132:135], v[36:39]
global_load_dwordx4 a[228:231], v0, s[72:73] offset:-4096
v_mfma_f32_16x16x32_bf16 v[36:39], a[204:207], a[128:131], v[36:39]
v_add_f32 v208, v208, v8
s_waitcnt vmcnt(7)
v_mfma_f32_16x16x32_bf16 v[40:43], a[196:199], a[128:131], v[40:43]
v_add_f32 v209, v209, v9
v_mfma_f32_16x16x32_bf16 v[40:43], a[224:227], a[132:135], v[40:43]
v_mfma_f32_16x16x32_bf16 v[72:75], a[224:227], a[136:139], v[72:75]
global_load_dwordx4 a[204:207], v0, s[74:75] offset:-4096
v_mfma_f32_16x16x32_bf16 v[72:75], a[196:199], a[140:143], v[72:75]
v_add_f32 v210, v210, v10
v_mfma_f32_16x16x32_bf16 v[104:107], a[196:199], a[144:147], v[104:107]
v_add_f32 v211, v211, v11
v_mfma_f32_16x16x32_bf16 v[104:107], a[224:227], a[148:151], v[104:107]
v_add_f32 v212, v212, v12
v_mfma_f32_16x16x32_bf16 v[136:139], a[224:227], a[152:155], v[136:139]
v_add_f32 v213, v213, v13
v_mfma_f32_16x16x32_bf16 v[136:139], a[196:199], a[156:159], v[136:139]
v_add_f32 v214, v214, v14
v_mfma_f32_16x16x32_bf16 v[168:171], a[196:199], a[160:163], v[168:171]
v_add_f32 v215, v215, v15
v_mfma_f32_16x16x32_bf16 v[168:171], a[224:227], a[164:167], v[168:171]
v_mfma_f32_16x16x32_bf16 v[200:203], a[224:227], a[168:171], v[200:203]
v_add_f32 v240, v240, v8
v_mfma_f32_16x16x32_bf16 v[200:203], a[196:199], a[172:175], v[200:203]
v_add_f32 v241, v241, v9
v_mfma_f32_16x16x32_bf16 v[232:235], a[196:199], a[176:179], v[232:235]
v_add_f32 v242, v242, v10
v_mfma_f32_16x16x32_bf16 v[232:235], a[224:227], a[180:183], v[232:235]
v_add_f32 v243, v243, v11
v_mfma_f32_16x16x32_bf16 a[240:243], a[224:227], a[184:187], a[240:243]
global_load_dwordx4 a[224:227], v0, s[72:73] offset:-3072
v_mfma_f32_16x16x32_bf16 a[240:243], a[196:199], a[188:191], a[240:243]
s_waitcnt vmcnt(7)
v_mfma_f32_16x16x32_bf16 a[244:247], a[212:215], a[188:191], a[244:247]
v_add_f32 v244, v244, v12
v_mfma_f32_16x16x32_bf16 a[244:247], a[216:219], a[184:187], a[244:247]
v_add_f32 v245, v245, v13
v_mfma_f32_16x16x32_bf16 v[236:239], a[216:219], a[180:183], v[236:239]
global_load_dwordx4 a[196:199], v0, s[74:75] offset:-3072
v_mfma_f32_16x16x32_bf16 v[236:239], a[212:215], a[176:179], v[236:239]
v_add_f32 v246, v246, v14
v_mfma_f32_16x16x32_bf16 v[204:207], a[212:215], a[172:175], v[204:207]
v_add_f32 v247, v247, v15
v_mfma_f32_16x16x32_bf16 v[204:207], a[216:219], a[168:171], v[204:207]
v_mfma_f32_4x4x4_16b_bf16 a[248:251], v[6:7], v[16:17], a[248:251]
v_mfma_f32_16x16x32_bf16 v[172:175], a[216:219], a[164:167], v[172:175]
v_mfma_f32_4x4x4_16b_bf16 a[252:255], v[6:7], v[18:19], a[252:255]
v_mfma_f32_16x16x32_bf16 v[172:175], a[212:215], a[160:163], v[172:175]
v_mfma_f32_16x16x32_bf16 v[140:143], a[212:215], a[156:159], v[140:143]
v_mfma_f32_16x16x32_bf16 v[140:143], a[216:219], a[152:155], v[140:143]
v_mfma_f32_16x16x32_bf16 v[108:111], a[216:219], a[148:151], v[108:111]
v_mfma_f32_16x16x32_bf16 v[108:111], a[212:215], a[144:147], v[108:111]
v_mfma_f32_16x16x32_bf16 v[76:79], a[212:215], a[140:143], v[76:79]
v_mfma_f32_16x16x32_bf16 v[76:79], a[216:219], a[136:139], v[76:79]
v_mfma_f32_16x16x32_bf16 v[44:47], a[216:219], a[132:135], v[44:47]
global_load_dwordx4 a[216:219], v0, s[72:73] offset:-2048
v_mfma_f32_16x16x32_bf16 v[44:47], a[212:215], a[128:131], v[44:47]
s_waitcnt vmcnt(7)
v_mfma_f32_16x16x32_bf16 v[48:51], a[192:195], a[128:131], v[48:51]
v_mfma_f32_16x16x32_bf16 v[48:51], a[208:211], a[132:135], v[48:51]
v_mfma_f32_16x16x32_bf16 v[80:83], a[208:211], a[136:139], v[80:83]
global_load_dwordx4 a[212:215], v0, s[74:75] offset:-2048
v_mfma_f32_16x16x32_bf16 v[80:83], a[192:195], a[140:143], v[80:83]
v_mfma_f32_16x16x32_bf16 v[112:115], a[192:195], a[144:147], v[112:115]
v_mfma_f32_16x16x32_bf16 v[112:115], a[208:211], a[148:151], v[112:115]
v_mfma_f32_16x16x32_bf16 v[144:147], a[208:211], a[152:155], v[144:147]
v_mfma_f32_16x16x32_bf16 v[144:147], a[192:195], a[156:159], v[144:147]
v_mfma_f32_16x16x32_bf16 v[176:179], a[192:195], a[160:163], v[176:179]
v_mfma_f32_16x16x32_bf16 v[176:179], a[208:211], a[164:167], v[176:179]
v_mfma_f32_16x16x32_bf16 v[208:211], a[208:211], a[168:171], v[208:211]
v_mfma_f32_16x16x32_bf16 v[208:211], a[192:195], a[172:175], v[208:211]
v_mfma_f32_16x16x32_bf16 v[240:243], a[192:195], a[176:179], v[240:243]
v_mfma_f32_16x16x32_bf16 v[240:243], a[208:211], a[180:183], v[240:243]
v_mfma_f32_16x16x32_bf16 a[248:251], a[208:211], a[184:187], a[248:251]
global_load_dwordx4 a[208:211], v0, s[72:73] offset:-1024
v_mfma_f32_16x16x32_bf16 a[248:251], a[192:195], a[188:191], a[248:251]
s_waitcnt vmcnt(7)
v_mfma_f32_16x16x32_bf16 a[252:255], a[220:223], a[188:191], a[252:255]
ds_read_b128 a[188:191], v2 offset:16384
v_mfma_f32_16x16x32_bf16 a[252:255], a[200:203], a[184:187], a[252:255]
ds_read_b128 a[184:187], v2 offset:24576
v_mfma_f32_16x16x32_bf16 v[244:247], a[200:203], a[180:183], v[244:247]
ds_read_b128 a[180:183], v2 offset:25600
v_mfma_f32_16x16x32_bf16 v[244:247], a[220:223], a[176:179], v[244:247]
ds_read_b128 a[176:179], v2 offset:17408
v_mfma_f32_16x16x32_bf16 v[212:215], a[220:223], a[172:175], v[212:215]
ds_read_b128 a[172:175], v2 offset:18432
v_mfma_f32_16x16x32_bf16 v[212:215], a[200:203], a[168:171], v[212:215]
ds_read_b128 a[168:171], v2 offset:26624
v_mfma_f32_16x16x32_bf16 v[180:183], a[200:203], a[164:167], v[180:183]
ds_read_b128 a[164:167], v2 offset:27648
v_mfma_f32_16x16x32_bf16 v[180:183], a[220:223], a[160:163], v[180:183]
ds_read_b128 a[160:163], v2 offset:19456
v_mfma_f32_16x16x32_bf16 v[148:151], a[220:223], a[156:159], v[148:151]
ds_read_b128 a[156:159], v2 offset:20480
v_mfma_f32_16x16x32_bf16 v[148:151], a[200:203], a[152:155], v[148:151]
ds_read_b128 a[152:155], v2 offset:28672
v_mfma_f32_16x16x32_bf16 v[116:119], a[200:203], a[148:151], v[116:119]
ds_read_b128 a[148:151], v2 offset:29696
v_mfma_f32_16x16x32_bf16 v[116:119], a[220:223], a[144:147], v[116:119]
ds_read_b128 a[144:147], v2 offset:21504
v_mfma_f32_16x16x32_bf16 v[84:87], a[220:223], a[140:143], v[84:87]
ds_read_b128 a[140:143], v2 offset:22528
v_mfma_f32_16x16x32_bf16 v[84:87], a[200:203], a[136:139], v[84:87]
ds_read_b128 a[136:139], v2 offset:30720
v_mfma_f32_16x16x32_bf16 v[52:55], a[200:203], a[132:135], v[52:55]
ds_read_b128 a[132:135], v2 offset:31744
v_mfma_f32_16x16x32_bf16 v[52:55], a[220:223], a[128:131], v[52:55]
ds_read_b128 a[128:131], v2 offset:23552
s_waitcnt vmcnt(5) lgkmcnt(12)
v_mfma_f32_16x16x32_bf16 v[24:27], a[228:231], a[188:191], v[24:27]
global_load_dwordx4 a[192:195], v0, s[74:75] offset:-1024
v_mfma_f32_16x16x32_bf16 v[24:27], a[204:207], a[184:187], v[24:27]
v_mfma_f32_16x16x32_bf16 v[56:59], a[204:207], a[180:183], v[56:59]
v_mfma_f32_16x16x32_bf16 v[56:59], a[228:231], a[176:179], v[56:59]
s_waitcnt lgkmcnt(8)
v_mfma_f32_16x16x32_bf16 v[88:91], a[228:231], a[172:175], v[88:91]
global_load_dwordx4 a[200:203], v0, s[72:73] offset:0
v_mfma_f32_16x16x32_bf16 v[88:91], a[204:207], a[168:171], v[88:91]
v_mfma_f32_16x16x32_bf16 v[120:123], a[204:207], a[164:167], v[120:123]
v_mfma_f32_16x16x32_bf16 v[120:123], a[228:231], a[160:163], v[120:123]
s_waitcnt lgkmcnt(4)
v_mfma_f32_16x16x32_bf16 v[152:155], a[228:231], a[156:159], v[152:155]
global_load_dwordx4 a[220:223], v0, s[74:75] offset:0
v_mfma_f32_16x16x32_bf16 v[152:155], a[204:207], a[152:155], v[152:155]
v_lshrrev_b32 v4, 3, v0
v_mfma_f32_16x16x32_bf16 v[184:187], a[204:207], a[148:151], v[184:187]
v_xor_b32 v4, v4, v0
v_mfma_f32_16x16x32_bf16 v[184:187], a[228:231], a[144:147], v[184:187]
s_waitcnt lgkmcnt(0)
v_mfma_f32_16x16x32_bf16 v[216:219], a[228:231], a[140:143], v[216:219]
v_and_b32 v4, 48, v4
s_barrier
v_mfma_f32_16x16x32_bf16 v[216:219], a[204:207], a[136:139], v[216:219]
v_mfma_f32_16x16x32_bf16 v[248:251], a[204:207], a[132:135], v[248:251]
global_load_dwordx4 a[204:207], v0, s[72:73] offset:1024
v_mfma_f32_16x16x32_bf16 v[248:251], a[228:231], a[128:131], v[248:251]
v_and_b32 v1, 0x3c0, v0
s_waitcnt vmcnt(7)
v_mfma_f32_16x16x32_bf16 v[252:255], a[224:227], a[128:131], v[252:255]
v_lshl_add_u32 v4, v1, 5, v4
v_mfma_f32_16x16x32_bf16 v[252:255], a[196:199], a[132:135], v[252:255]
v_mfma_f32_16x16x32_bf16 v[220:223], a[196:199], a[136:139], v[220:223]
global_load_dwordx4 a[228:231], v0, s[74:75] offset:1024
v_mfma_f32_16x16x32_bf16 v[220:223], a[224:227], a[140:143], v[220:223]
v_add_u32 v4, s66, v4
v_mfma_f32_16x16x32_bf16 v[188:191], a[224:227], a[144:147], v[188:191]
v_mfma_f32_16x16x32_bf16 v[188:191], a[196:199], a[148:151], v[188:191]
v_lshrrev_b32 v1, 4, v0
v_mfma_f32_16x16x32_bf16 v[156:159], a[196:199], a[152:155], v[156:159]
v_lshrrev_b32 v3, 1, v0
v_mfma_f32_16x16x32_bf16 v[156:159], a[224:227], a[156:159], v[156:159]
v_xor_b32 v1, v1, v3
v_mfma_f32_16x16x32_bf16 v[124:127], a[224:227], a[160:163], v[124:127]
v_mfma_f32_16x16x32_bf16 v[124:127], a[196:199], a[164:167], v[124:127]
v_and_b32 v1, 48, v1
v_mfma_f32_16x16x32_bf16 v[92:95], a[196:199], a[168:171], v[92:95]
v_and_b32 v3, 0xf0, v0
L_pad20:
s_cbranch_execz L_tret1
v_mfma_f32_16x16x32_bf16 v[92:95], a[224:227], a[172:175], v[92:95]
v_mfma_f32_16x16x32_bf16 v[60:63], a[224:227], a[176:179], v[60:63]
v_lshl_add_u32 v1, v3, 2, v1
v_mfma_f32_16x16x32_bf16 v[60:63], a[196:199], a[180:183], v[60:63]
v_mfma_f32_16x16x32_bf16 v[28:31], a[196:199], a[184:187], v[28:31]
global_load_dwordx4 a[196:199], v0, s[72:73] offset:2048
v_mfma_f32_16x16x32_bf16 v[28:31], a[224:227], a[188:191], v[28:31]
s_add_u32 s67, s57, 0
s_waitcnt vmcnt(7)
v_mfma_f32_16x16x32_bf16 v[32:35], a[216:219], a[188:191], v[32:35]
v_add_u32 v1, s67, v1
v_mfma_f32_16x16x32_bf16 v[32:35], a[212:215], a[184:187], v[32:35]
v_add_u32 v3, s67, v0
v_mfma_f32_16x16x32_bf16 v[64:67], a[212:215], a[180:183], v[64:67]
global_load_dwordx4 a[224:227], v0, s[74:75] offset:2048
v_mfma_f32_16x16x32_bf16 v[64:67], a[216:219], a[176:179], v[64:67]
v_mfma_f32_16x16x32_bf16 v[96:99], a[216:219], a[172:175], v[96:99]
s_mov_b32 s44, 0
v_mfma_f32_16x16x32_bf16 v[96:99], a[212:215], a[168:171], v[96:99]
s_mov_b32 s45, 32768
s_mov_b32 s46, 65536
v_mfma_f32_16x16x32_bf16 v[128:131], a[212:215], a[164:167], v[128:131]
s_mov_b32 s47, 98304
v_mfma_f32_16x16x32_bf16 v[128:131], a[216:219], a[160:163], v[128:131]
s_mov_b32 s48, 131072
s_mov_b32 s49, 163840
v_mfma_f32_16x16x32_bf16 v[160:163], a[216:219], a[156:159], v[160:163]
s_mov_b32 s50, 196608
v_mfma_f32_16x16x32_bf16 v[160:163], a[212:215], a[152:155], v[160:163]
s_mov_b32 s51, 229376
v_mfma_f32_16x16x32_bf16 v[192:195], a[212:215], a[148:151], v[192:195]
v_mfma_f32_16x16x32_bf16 v[192:195], a[216:219], a[144:147], v[192:195]
v_mfma_f32_16x16x32_bf16 v[224:227], a[216:219], a[140:143], v[224:227]
v_mfma_f32_16x16x32_bf16 v[224:227], a[212:215], a[136:139], v[224:227]
v_mfma_f32_4x4x4_16b_bf16 v[8:11], v[6:7], a[0:1], 0
v_mfma_f32_4x4x4_16b_bf16 v[12:15], v[6:7], a[2:3], 0
v_mfma_f32_16x16x32_bf16 a[232:235], a[212:215], a[132:135], a[232:235]
global_load_dwordx4 a[212:215], v0, s[72:73] offset:3072
v_mfma_f32_16x16x32_bf16 a[232:235], a[216:219], a[128:131], a[232:235]
s_nop 0
v_mul_f32 v8, v8, v24
s_waitcnt vmcnt(7)
v_mfma_f32_16x16x32_bf16 a[236:239], a[208:211], a[128:131], a[236:239]
v_mul_f32 v9, v9, v25
v_mul_f32 v10, v10, v26
v_mfma_f32_16x16x32_bf16 a[236:239], a[192:195], a[132:135], a[236:239]
v_mul_f32 v11, v11, v27
v_mfma_f32_16x16x32_bf16 v[228:231], a[192:195], a[136:139], v[228:231]
global_load_dwordx4 a[216:219], v0, s[74:75] offset:3072
v_mfma_f32_16x16x32_bf16 v[228:231], a[208:211], a[140:143], v[228:231]
s_add_u32 s72, s12, 528384
s_addc_u32 s73, s13, 0
v_mfma_f32_16x16x32_bf16 v[196:199], a[208:211], a[144:147], v[196:199]
v_cvt_pk_bf16_f32 v16, v8, v9
v_mfma_f32_16x16x32_bf16 v[196:199], a[192:195], a[148:151], v[196:199]
v_cvt_pk_bf16_f32 v17, v10, v11
v_mul_f32 v12, v12, v28
v_mfma_f32_16x16x32_bf16 v[164:167], a[192:195], a[152:155], v[164:167]
s_add_u32 s74, s12, 561152
s_addc_u32 s75, s13, 0
v_mfma_f32_16x16x32_bf16 v[164:167], a[208:211], a[156:159], v[164:167]
v_mul_f32 v13, v13, v29
v_mfma_f32_16x16x32_bf16 v[132:135], a[208:211], a[160:163], v[132:135]
v_mul_f32 v14, v14, v30
v_mul_f32 v15, v15, v31
v_mfma_f32_16x16x32_bf16 v[132:135], a[192:195], a[164:167], v[132:135]
v_cvt_pk_bf16_f32 v18, v12, v13
v_mfma_f32_16x16x32_bf16 v[100:103], a[192:195], a[168:171], v[100:103]
v_cvt_pk_bf16_f32 v19, v14, v15
v_mfma_f32_16x16x32_bf16 v[100:103], a[208:211], a[172:175], v[100:103]
v_mfma_f32_4x4x4_16b_bf16 v[8:11], v[6:7], a[4:5], 0
v_mfma_f32_4x4x4_16b_bf16 v[12:15], v[6:7], a[6:7], 0
v_mfma_f32_16x16x32_bf16 v[68:71], a[208:211], a[176:179], v[68:71]
ds_write_b128 v1, v[16:19] offset:0
v_mfma_f32_16x16x32_bf16 v[68:71], a[192:195], a[180:183], v[68:71]
s_nop 0
v_mul_f32 v8, v8, v56
v_mfma_f32_16x16x32_bf16 v[36:39], a[192:195], a[184:187], v[36:39]
global_load_dwordx4 a[192:195], v0, s[72:73] offset:0
v_mfma_f32_16x16x32_bf16 v[36:39], a[208:211], a[188:191], v[36:39]
v_mul_f32 v9, v9, v57
v_mul_f32 v10, v10, v58
s_waitcnt vmcnt(7)
v_mfma_f32_16x16x32_bf16 v[40:43], a[200:203], a[188:191], v[40:43]
v_mul_f32 v11, v11, v59
v_mfma_f32_16x16x32_bf16 v[40:43], a[220:223], a[184:187], v[40:43]
v_cvt_pk_bf16_f32 v20, v8, v9
v_mfma_f32_16x16x32_bf16 v[72:75], a[220:223], a[180:183], v[72:75]
global_load_dwordx4 a[208:211], v0, s[74:75] offset:0
v_mfma_f32_16x16x32_bf16 v[72:75], a[200:203], a[176:179], v[72:75]
v_cvt_pk_bf16_f32 v21, v10, v11
v_mfma_f32_16x16x32_bf16 v[104:107], a[200:203], a[172:175], v[104:107]
ds_read_b128 a[0:3], v3 offset:0
v_mul_f32 v12, v12, v60
v_mfma_f32_16x16x32_bf16 v[104:107], a[220:223], a[168:171], v[104:107]
v_mul_f32 v13, v13, v61
v_mfma_f32_16x16x32_bf16 v[136:139], a[220:223], a[164:167], v[136:139]
v_mul_f32 v14, v14, v62
v_mul_f32 v15, v15, v63
v_mfma_f32_16x16x32_bf16 v[136:139], a[200:203], a[160:163], v[136:139]
v_cvt_pk_bf16_f32 v22, v12, v13
v_mfma_f32_16x16x32_bf16 v[168:171], a[200:203], a[156:159], v[168:171]
v_cvt_pk_bf16_f32 v23, v14, v15
v_mfma_f32_16x16x32_bf16 v[168:171], a[220:223], a[152:155], v[168:171]
v_mfma_f32_4x4x4_16b_bf16 v[8:11], v[6:7], a[8:9], 0
v_mfma_f32_4x4x4_16b_bf16 v[12:15], v[6:7], a[10:11], 0
v_mfma_f32_16x16x32_bf16 v[200:203], a[220:223], a[148:151], v[200:203]
ds_write_b128 v1, v[20:23] offset:1024
v_mfma_f32_16x16x32_bf16 v[200:203], a[200:203], a[144:147], v[200:203]
s_nop 0
v_mul_f32 v8, v8, v88
v_mfma_f32_16x16x32_bf16 v[232:235], a[200:203], a[140:143], v[232:235]
v_mul_f32 v9, v9, v89
v_mul_f32 v10, v10, v90
v_mfma_f32_16x16x32_bf16 v[232:235], a[220:223], a[136:139], v[232:235]
v_mul_f32 v11, v11, v91
v_mfma_f32_16x16x32_bf16 a[240:243], a[220:223], a[132:135], a[240:243]
global_load_dwordx4 a[220:223], v0, s[72:73] offset:1024
v_mfma_f32_16x16x32_bf16 a[240:243], a[200:203], a[128:131], a[240:243]
v_cvt_pk_bf16_f32 v16, v8, v9
s_waitcnt vmcnt(7)
v_mfma_f32_16x16x32_bf16 a[244:247], a[204:207], a[128:131], a[244:247]
v_cvt_pk_bf16_f32 v17, v10, v11
v_mfma_f32_16x16x32_bf16 a[244:247], a[228:231], a[132:135], a[244:247]
ds_read_b128 a[4:7], v3 offset:1024
v_mfma_f32_16x16x32_bf16 v[236:239], a[228:231], a[136:139], v[236:239]
global_load_dwordx4 a[200:203], v0, s[74:75] offset:1024
v_mfma_f32_16x16x32_bf16 v[236:239], a[204:207], a[140:143], v[236:239]
s_waitcnt lgkmcnt(2)
v_mfma_f32_16x16x32_bf16 v[204:207], a[204:207], a[144:147], v[204:207]
buffer_store_dwordx4 a[0:3], v4, s[20:23], s44 offen offset:0 sc1
v_mfma_f32_16x16x32_bf16 v[204:207], a[228:231], a[148:151], v[204:207]
v_mul_f32 v12, v12, v92
v_mfma_f32_16x16x32_bf16 v[172:175], a[228:231], a[152:155], v[172:175]
v_mul_f32 v13, v13, v93
v_mul_f32 v14, v14, v94
v_mfma_f32_16x16x32_bf16 v[172:175], a[204:207], a[156:159], v[172:175]
v_mul_f32 v15, v15, v95
v_mfma_f32_16x16x32_bf16 v[140:143], a[204:207], a[160:163], v[140:143]
v_cvt_pk_bf16_f32 v18, v12, v13
v_cvt_pk_bf16_f32 v19, v14, v15
v_mfma_f32_16x16x32_bf16 v[140:143], a[228:231], a[164:167], v[140:143]
v_mfma_f32_4x4x4_16b_bf16 v[8:11], v[6:7], a[12:13], 0
v_mfma_f32_4x4x4_16b_bf16 v[12:15], v[6:7], a[14:15], 0
v_mfma_f32_16x16x32_bf16 v[108:111], a[228:231], a[168:171], v[108:111]
ds_write_b128 v1, v[16:19] offset:2048
v_mfma_f32_16x16x32_bf16 v[108:111], a[204:207], a[172:175], v[108:111]
s_nop 0
v_mul_f32 v8, v8, v120
v_mfma_f32_16x16x32_bf16 v[76:79], a[204:207], a[176:179], v[76:79]
v_mul_f32 v9, v9, v121
v_mfma_f32_16x16x32_bf16 v[76:79], a[228:231], a[180:183], v[76:79]
v_mul_f32 v10, v10, v122
v_mfma_f32_16x16x32_bf16 v[44:47], a[228:231], a[184:187], v[44:47]
global_load_dwordx4 a[228:231], v0, s[72:73] offset:2048
v_mfma_f32_16x16x32_bf16 v[44:47], a[204:207], a[188:191], v[44:47]
v_mul_f32 v11, v11, v123
s_waitcnt vmcnt(8)
v_mfma_f32_16x16x32_bf16 v[48:51], a[196:199], a[188:191], v[48:51]
v_cvt_pk_bf16_f32 v20, v8, v9
v_mfma_f32_16x16x32_bf16 v[48:51], a[224:227], a[184:187], v[48:51]
v_cvt_pk_bf16_f32 v21, v10, v11
v_mfma_f32_16x16x32_bf16 v[80:83], a[224:227], a[180:183], v[80:83]
global_load_dwordx4 a[204:207], v0, s[74:75] offset:2048
v_mfma_f32_16x16x32_bf16 v[80:83], a[196:199], a[176:179], v[80:83]
ds_read_b128 a[8:11], v3 offset:2048
v_mfma_f32_16x16x32_bf16 v[112:115], a[196:199], a[172:175], v[112:115]
s_waitcnt lgkmcnt(2)
v_mfma_f32_16x16x32_bf16 v[112:115], a[224:227], a[168:171], v[112:115]
buffer_store_dwordx4 a[4:7], v4, s[20:23], s45 offen offset:0 sc1
v_mfma_f32_16x16x32_bf16 v[144:147], a[224:227], a[164:167], v[144:147]
v_mul_f32 v12, v12, v124
v_mul_f32 v13, v13, v125
v_mfma_f32_16x16x32_bf16 v[144:147], a[196:199], a[160:163], v[144:147]
v_mul_f32 v14, v14, v126
v_mfma_f32_16x16x32_bf16 v[176:179], a[196:199], a[156:159], v[176:179]
v_mul_f32 v15, v15, v127
v_cvt_pk_bf16_f32 v22, v12, v13
v_mfma_f32_16x16x32_bf16 v[176:179], a[224:227], a[152:155], v[176:179]
v_cvt_pk_bf16_f32 v23, v14, v15
v_mfma_f32_16x16x32_bf16 v[208:211], a[224:227], a[148:151], v[208:211]
v_mfma_f32_16x16x32_bf16 v[208:211], a[196:199], a[144:147], v[208:211]
v_mfma_f32_4x4x4_16b_bf16 v[8:11], v[6:7], a[16:17], 0
v_mfma_f32_4x4x4_16b_bf16 v[12:15], v[6:7], a[18:19], 0
v_mfma_f32_16x16x32_bf16 v[240:243], a[196:199], a[140:143], v[240:243]
ds_write_b128 v1, v[20:23] offset:3072
v_mfma_f32_16x16x32_bf16 v[240:243], a[224:227], a[136:139], v[240:243]
s_nop 0
v_mul_f32 v8, v8, v152
v_mfma_f32_16x16x32_bf16 a[248:251], a[224:227], a[132:135], a[248:251]
global_load_dwordx4 a[224:227], v0, s[72:73] offset:3072
v_mfma_f32_16x16x32_bf16 a[248:251], a[196:199], a[128:131], a[248:251]
v_mul_f32 v9, v9, v153
v_mul_f32 v10, v10, v154
s_waitcnt vmcnt(9)
v_mfma_f32_16x16x32_bf16 a[252:255], a[212:215], a[128:131], a[252:255]
ds_read_b128 a[128:131], v2 offset:32768
v_mul_f32 v11, v11, v155
v_mfma_f32_16x16x32_bf16 a[252:255], a[216:219], a[132:135], a[252:255]
ds_read_b128 a[132:135], v2 offset:40960
v_cvt_pk_bf16_f32 v16, v8, v9
v_mfma_f32_16x16x32_bf16 v[244:247], a[216:219], a[136:139], v[244:247]
ds_read_b128 a[136:139], v2 offset:41984
v_cvt_pk_bf16_f32 v17, v10, v11
v_mfma_f32_16x16x32_bf16 v[244:247], a[212:215], a[140:143], v[244:247]
ds_read_b128 a[140:143], v2 offset:33792
v_mfma_f32_16x16x32_bf16 v[212:215], a[212:215], a[144:147], v[212:215]
ds_read_b128 a[144:147], v2 offset:34816
v_mfma_f32_16x16x32_bf16 v[212:215], a[216:219], a[148:151], v[212:215]
ds_read_b128 a[148:151], v2 offset:43008
v_mfma_f32_16x16x32_bf16 v[180:183], a[216:219], a[152:155], v[180:183]
ds_read_b128 a[152:155], v2 offset:44032
v_mfma_f32_16x16x32_bf16 v[180:183], a[212:215], a[156:159], v[180:183]
ds_read_b128 a[156:159], v2 offset:35840
v_mfma_f32_16x16x32_bf16 v[148:151], a[212:215], a[160:163], v[148:151]
ds_read_b128 a[160:163], v2 offset:36864
v_mul_f32 v12, v12, v156
v_mfma_f32_16x16x32_bf16 v[148:151], a[216:219], a[164:167], v[148:151]
ds_read_b128 a[164:167], v2 offset:45056
v_mfma_f32_16x16x32_bf16 v[116:119], a[216:219], a[168:171], v[116:119]
ds_read_b128 a[168:171], v2 offset:46080
v_mul_f32 v13, v13, v157
v_mfma_f32_16x16x32_bf16 v[116:119], a[212:215], a[172:175], v[116:119]
ds_read_b128 a[172:175], v2 offset:37888
v_mul_f32 v14, v14, v158
v_mfma_f32_16x16x32_bf16 v[84:87], a[212:215], a[176:179], v[84:87]
ds_read_b128 a[176:179], v2 offset:38912
v_mfma_f32_16x16x32_bf16 v[84:87], a[216:219], a[180:183], v[84:87]
ds_read_b128 a[180:183], v2 offset:47104
v_mul_f32 v15, v15, v159
v_mfma_f32_16x16x32_bf16 v[52:55], a[216:219], a[184:187], v[52:55]
ds_read_b128 a[184:187], v2 offset:48128
v_cvt_pk_bf16_f32 v18, v12, v13
v_mfma_f32_16x16x32_bf16 v[52:55], a[212:215], a[188:191], v[52:55]
ds_read_b128 a[188:191], v2 offset:39936
s_waitcnt vmcnt(7) lgkmcnt(12)
v_mfma_f32_16x16x32_bf16 v[40:43], a[192:195], a[128:131], v[40:43]
global_load_dwordx4 a[196:199], v0, s[74:75] offset:3072
v_mfma_f32_16x16x32_bf16 v[40:43], a[208:211], a[132:135], v[40:43]
s_add_u32 s72, s12, 593920
s_addc_u32 s73, s13, 0
v_mfma_f32_16x16x32_bf16 v[72:75], a[208:211], a[136:139], v[72:75]
s_add_u32 s74, s12, 626688
s_addc_u32 s75, s13, 0
v_mfma_f32_16x16x32_bf16 v[72:75], a[192:195], a[140:143], v[72:75]
s_waitcnt lgkmcnt(8)
v_mfma_f32_16x16x32_bf16 v[104:107], a[192:195], a[144:147], v[104:107]
global_load_dwordx4 a[216:219], v0, s[72:73] offset:0
v_mfma_f32_16x16x32_bf16 v[104:107], a[208:211], a[148:151], v[104:107]
ds_read_b128 a[12:15], v3 offset:3072
v_mfma_f32_16x16x32_bf16 v[136:139], a[208:211], a[152:155], v[136:139]
buffer_store_dwordx4 a[8:11], v4, s[20:23], s46 offen offset:0 sc1
v_mfma_f32_16x16x32_bf16 v[136:139], a[192:195], a[156:159], v[136:139]
v_cvt_pk_bf16_f32 v19, v14, v15
v_mfma_f32_4x4x4_16b_bf16 v[8:11], v[6:7], a[20:21], 0
v_mfma_f32_4x4x4_16b_bf16 v[12:15], v[6:7], a[22:23], 0
s_waitcnt lgkmcnt(5)
v_mfma_f32_16x16x32_bf16 v[168:171], a[192:195], a[160:163], v[168:171]
global_load_dwordx4 a[212:215], v0, s[74:75] offset:0
v_mfma_f32_16x16x32_bf16 v[168:171], a[208:211], a[164:167], v[168:171]
ds_write_b128 v1, v[16:19] offset:4096
v_mfma_f32_16x16x32_bf16 v[200:203], a[208:211], a[168:171], v[200:203]
v_mul_f32 v8, v8, v184
v_mfma_f32_16x16x32_bf16 v[200:203], a[192:195], a[172:175], v[200:203]
v_mul_f32 v9, v9, v185
v_mul_f32 v10, v10, v186
s_waitcnt lgkmcnt(2)
v_mfma_f32_16x16x32_bf16 v[232:235], a[192:195], a[176:179], v[232:235]
v_mul_f32 v11, v11, v187
v_mfma_f32_16x16x32_bf16 v[232:235], a[208:211], a[180:183], v[232:235]
v_cvt_pk_bf16_f32 v20, v8, v9
v_mfma_f32_16x16x32_bf16 a[240:243], a[208:211], a[184:187], a[240:243]
global_load_dwordx4 a[208:211], v0, s[72:73] offset:1024
v_mfma_f32_16x16x32_bf16 a[240:243], a[192:195], a[188:191], a[240:243]
v_cvt_pk_bf16_f32 v21, v10, v11
s_waitcnt vmcnt(10)
v_mfma_f32_16x16x32_bf16 a[244:247], a[220:223], a[188:191], a[244:247]
ds_read_b128 a[16:19], v3 offset:4096
v_mfma_f32_16x16x32_bf16 a[244:247], a[200:203], a[184:187], a[244:247]
s_waitcnt lgkmcnt(2)
v_mfma_f32_16x16x32_bf16 v[236:239], a[200:203], a[180:183], v[236:239]
global_load_dwordx4 a[192:195], v0, s[74:75] offset:1024
v_mfma_f32_16x16x32_bf16 v[236:239], a[220:223], a[176:179], v[236:239]
buffer_store_dwordx4 a[12:15], v4, s[20:23], s47 offen offset:0 sc1
v_mfma_f32_16x16x32_bf16 v[204:207], a[220:223], a[172:175], v[204:207]
v_mul_f32 v12, v12, v188
v_mfma_f32_16x16x32_bf16 v[204:207], a[200:203], a[168:171], v[204:207]
v_mul_f32 v13, v13, v189
v_mfma_f32_16x16x32_bf16 v[172:175], a[200:203], a[164:167], v[172:175]
v_mul_f32 v14, v14, v190
v_mul_f32 v15, v15, v191
v_mfma_f32_16x16x32_bf16 v[172:175], a[220:223], a[160:163], v[172:175]
v_cvt_pk_bf16_f32 v22, v12, v13
v_mfma_f32_16x16x32_bf16 v[140:143], a[220:223], a[156:159], v[140:143]
v_cvt_pk_bf16_f32 v23, v14, v15
v_mfma_f32_16x16x32_bf16 v[140:143], a[200:203], a[152:155], v[140:143]
v_mfma_f32_4x4x4_16b_bf16 v[8:11], v[6:7], a[24:25], 0
v_mfma_f32_4x4x4_16b_bf16 v[12:15], v[6:7], a[26:27], 0
v_mfma_f32_16x16x32_bf16 v[108:111], a[200:203], a[148:151], v[108:111]
ds_write_b128 v1, v[20:23] offset:5120
v_mfma_f32_16x16x32_bf16 v[108:111], a[220:223], a[144:147], v[108:111]
s_nop 0
v_mul_f32 v8, v8, v216
v_mfma_f32_16x16x32_bf16 v[76:79], a[220:223], a[140:143], v[76:79]
v_mul_f32 v9, v9, v217
v_mul_f32 v10, v10, v218
v_mfma_f32_16x16x32_bf16 v[76:79], a[200:203], a[136:139], v[76:79]
v_mul_f32 v11, v11, v219
v_mfma_f32_16x16x32_bf16 v[44:47], a[200:203], a[132:135], v[44:47]
global_load_dwordx4 a[200:203], v0, s[72:73] offset:2048
v_mfma_f32_16x16x32_bf16 v[44:47], a[220:223], a[128:131], v[44:47]
v_cvt_pk_bf16_f32 v16, v8, v9
s_waitcnt vmcnt(10)
v_mfma_f32_16x16x32_bf16 v[48:51], a[228:231], a[128:131], v[48:51]
v_cvt_pk_bf16_f32 v17, v10, v11
v_mfma_f32_16x16x32_bf16 v[48:51], a[204:207], a[132:135], v[48:51]
ds_read_b128 a[20:23], v3 offset:5120
v_mfma_f32_16x16x32_bf16 v[80:83], a[204:207], a[136:139], v[80:83]
global_load_dwordx4 a[220:223], v0, s[74:75] offset:2048
v_mfma_f32_16x16x32_bf16 v[80:83], a[228:231], a[140:143], v[80:83]
s_waitcnt lgkmcnt(2)
v_mfma_f32_16x16x32_bf16 v[112:115], a[228:231], a[144:147], v[112:115]
buffer_store_dwordx4 a[16:19], v4, s[20:23], s48 offen offset:0 sc1
v_mfma_f32_16x16x32_bf16 v[112:115], a[204:207], a[148:151], v[112:115]
v_mul_f32 v12, v12, v220
v_mfma_f32_16x16x32_bf16 v[144:147], a[204:207], a[152:155], v[144:147]
v_mul_f32 v13, v13, v221
v_mul_f32 v14, v14, v222
v_mfma_f32_16x16x32_bf16 v[144:147], a[228:231], a[156:159], v[144:147]
v_mul_f32 v15, v15, v223
v_mfma_f32_16x16x32_bf16 v[176:179], a[228:231], a[160:163], v[176:179]
v_cvt_pk_bf16_f32 v18, v12, v13
v_cvt_pk_bf16_f32 v19, v14, v15
v_mfma_f32_16x16x32_bf16 v[176:179], a[204:207], a[164:167], v[176:179]
v_mfma_f32_4x4x4_16b_bf16 v[8:11], v[6:7], a[28:29], 0
v_mfma_f32_4x4x4_16b_bf16 v[12:15], v[6:7], a[30:31], 0
v_mfma_f32_16x16x32_bf16 v[208:211], a[204:207], a[168:171], v[208:211]
ds_write_b128 v1, v[16:19] offset:6144
v_mfma_f32_16x16x32_bf16 v[208:211], a[228:231], a[172:175], v[208:211]
s_nop 0
v_mul_f32 v8, v8, v248
v_mfma_f32_16x16x32_bf16 v[240:243], a[228:231], a[176:179], v[240:243]
v_mul_f32 v9, v9, v249
v_mfma_f32_16x16x32_bf16 v[240:243], a[204:207], a[180:183], v[240:243]
v_mul_f32 v10, v10, v250
v_mfma_f32_16x16x32_bf16 a[248:251], a[204:207], a[184:187], a[248:251]
global_load_dwordx4 a[204:207], v0, s[72:73] offset:3072
v_mfma_f32_16x16x32_bf16 a[248:251], a[228:231], a[188:191], a[248:251]
v_mul_f32 v11, v11, v251
s_waitcnt vmcnt(10)
v_mfma_f32_16x16x32_bf16 a[252:255], a[224:227], a[188:191], a[252:255]
ds_read_b128 a[188:191], v2 offset:49152
v_mfma_f32_16x16x32_bf16 a[252:255], a[196:199], a[184:187], a[252:255]
ds_read_b128 a[184:187], v2 offset:57344
v_cvt_pk_bf16_f32 v20, v8, v9
v_mfma_f32_16x16x32_bf16 v[244:247], a[196:199], a[180:183], v[244:247]
ds_read_b128 a[180:183], v2 offset:58368
v_cvt_pk_bf16_f32 v21, v10, v11
v_mfma_f32_16x16x32_bf16 v[244:247], a[224:227], a[176:179], v[244:247]
ds_read_b128 a[176:179], v2 offset:50176
v_mfma_f32_16x16x32_bf16 v[212:215], a[224:227], a[172:175], v[212:215]
ds_read_b128 a[172:175], v2 offset:51200
v_mfma_f32_16x16x32_bf16 v[212:215], a[196:199], a[168:171], v[212:215]
ds_read_b128 a[168:171], v2 offset:59392
v_mfma_f32_16x16x32_bf16 v[180:183], a[196:199], a[164:167], v[180:183]
ds_read_b128 a[164:167], v2 offset:60416
v_mfma_f32_16x16x32_bf16 v[180:183], a[224:227], a[160:163], v[180:183]
ds_read_b128 a[160:163], v2 offset:52224
v_mfma_f32_16x16x32_bf16 v[148:151], a[224:227], a[156:159], v[148:151]
ds_read_b128 a[156:159], v2 offset:53248
v_mul_f32 v12, v12, v252
v_mfma_f32_16x16x32_bf16 v[148:151], a[196:199], a[152:155], v[148:151]
ds_read_b128 a[152:155], v2 offset:61440
v_mfma_f32_16x16x32_bf16 v[116:119], a[196:199], a[148:151], v[116:119]
ds_read_b128 a[148:151], v2 offset:62464
v_mul_f32 v13, v13, v253
v_mfma_f32_16x16x32_bf16 v[116:119], a[224:227], a[144:147], v[116:119]
ds_read_b128 a[144:147], v2 offset:54272
v_mul_f32 v14, v14, v254
v_mfma_f32_16x16x32_bf16 v[84:87], a[224:227], a[140:143], v[84:87]
ds_read_b128 a[140:143], v2 offset:55296
v_mul_f32 v15, v15, v255
v_mfma_f32_16x16x32_bf16 v[84:87], a[196:199], a[136:139], v[84:87]
ds_read_b128 a[136:139], v2 offset:63488
v_mfma_f32_16x16x32_bf16 v[52:55], a[196:199], a[132:135], v[52:55]
ds_read_b128 a[132:135], v2 offset:64512
v_cvt_pk_bf16_f32 v22, v12, v13
v_mfma_f32_16x16x32_bf16 v[52:55], a[224:227], a[128:131], v[52:55]
ds_read_b128 a[128:131], v2 offset:56320
s_waitcnt vmcnt(7) lgkmcnt(12)
v_mfma_f32_16x16x32_bf16 v[40:43], a[216:219], a[188:191], v[40:43]
global_load_dwordx4 a[228:231], v0, s[74:75] offset:3072
v_mfma_f32_16x16x32_bf16 v[40:43], a[212:215], a[184:187], v[40:43]
s_add_u32 s72, s12, 536576
s_addc_u32 s73, s13, 0
v_mfma_f32_16x16x32_bf16 v[72:75], a[212:215], a[180:183], v[72:75]
s_add_u32 s74, s12, 569344
s_addc_u32 s75, s13, 0
v_mfma_f32_16x16x32_bf16 v[72:75], a[216:219], a[176:179], v[72:75]
s_waitcnt lgkmcnt(8)
v_mfma_f32_16x16x32_bf16 v[104:107], a[216:219], a[172:175], v[104:107]
global_load_dwordx4 a[196:199], v0, s[72:73] offset:0
v_mfma_f32_16x16x32_bf16 v[104:107], a[212:215], a[168:171], v[104:107]
ds_read_b128 a[24:27], v3 offset:6144
v_mfma_f32_16x16x32_bf16 v[136:139], a[212:215], a[164:167], v[136:139]
buffer_store_dwordx4 a[20:23], v4, s[20:23], s49 offen offset:0 sc1
v_mfma_f32_16x16x32_bf16 v[136:139], a[216:219], a[160:163], v[136:139]
v_cvt_pk_bf16_f32 v23, v14, v15
s_waitcnt lgkmcnt(5)
v_mfma_f32_16x16x32_bf16 v[168:171], a[216:219], a[156:159], v[168:171]
global_load_dwordx4 a[224:227], v0, s[74:75] offset:0
v_mfma_f32_16x16x32_bf16 v[168:171], a[212:215], a[152:155], v[168:171]
ds_write_b128 v1, v[20:23] offset:7168
v_mfma_f32_16x16x32_bf16 v[200:203], a[212:215], a[148:151], v[200:203]
ds_read_b128 a[28:31], v3 offset:7168
s_waitcnt lgkmcnt(2)
v_mfma_f32_16x16x32_bf16 v[200:203], a[216:219], a[144:147], v[200:203]
v_mfma_f32_16x16x32_bf16 v[232:235], a[216:219], a[140:143], v[232:235]
v_mfma_f32_16x16x32_bf16 v[232:235], a[212:215], a[136:139], v[232:235]
buffer_store_dwordx4 a[24:27], v4, s[20:23], s50 offen offset:0 sc1
v_mfma_f32_16x16x32_bf16 a[240:243], a[212:215], a[132:135], a[240:243]
global_load_dwordx4 a[212:215], v0, s[72:73] offset:1024
v_mfma_f32_16x16x32_bf16 a[240:243], a[216:219], a[128:131], a[240:243]
v_mfma_f32_4x4x4_16b_bf16 v[8:11], v[6:7], a[32:33], 0
v_mfma_f32_4x4x4_16b_bf16 v[12:15], v[6:7], a[34:35], 0
s_nop 3
v_mul_f32 v8, v8, v32
s_waitcnt vmcnt(11)
v_mfma_f32_16x16x32_bf16 a[244:247], a[208:211], a[128:131], a[244:247]
v_mul_f32 v9, v9, v33
v_mfma_f32_16x16x32_bf16 a[244:247], a[192:195], a[132:135], a[244:247]
v_mfma_f32_16x16x32_bf16 v[236:239], a[192:195], a[136:139], v[236:239]
global_load_dwordx4 a[216:219], v0, s[74:75] offset:1024
v_mfma_f32_16x16x32_bf16 v[236:239], a[208:211], a[140:143], v[236:239]
v_mul_f32 v10, v10, v34
v_mul_f32 v11, v11, v35
v_mfma_f32_16x16x32_bf16 v[204:207], a[208:211], a[144:147], v[204:207]
v_cvt_pk_bf16_f32 v16, v8, v9
v_cvt_pk_bf16_f32 v17, v10, v11
v_mfma_f32_16x16x32_bf16 v[204:207], a[192:195], a[148:151], v[204:207]
v_mul_f32 v12, v12, v36
v_mfma_f32_16x16x32_bf16 v[172:175], a[192:195], a[152:155], v[172:175]
v_mul_f32 v13, v13, v37
v_mul_f32 v14, v14, v38
v_mfma_f32_16x16x32_bf16 v[172:175], a[208:211], a[156:159], v[172:175]
v_mul_f32 v15, v15, v39
v_mfma_f32_16x16x32_bf16 v[140:143], a[208:211], a[160:163], v[140:143]
v_cvt_pk_bf16_f32 v18, v12, v13
v_cvt_pk_bf16_f32 v19, v14, v15
v_mfma_f32_16x16x32_bf16 v[140:143], a[192:195], a[164:167], v[140:143]
v_mfma_f32_4x4x4_16b_bf16 v[8:11], v[6:7], a[36:37], 0
v_mfma_f32_4x4x4_16b_bf16 v[12:15], v[6:7], a[38:39], 0
v_mfma_f32_16x16x32_bf16 v[108:111], a[192:195], a[168:171], v[108:111]
ds_write_b128 v1, v[16:19] offset:0
v_mfma_f32_16x16x32_bf16 v[108:111], a[208:211], a[172:175], v[108:111]
s_nop 0
v_mul_f32 v8, v8, v64
v_mfma_f32_16x16x32_bf16 v[76:79], a[208:211], a[176:179], v[76:79]
v_mul_f32 v9, v9, v65
v_mul_f32 v10, v10, v66
v_mfma_f32_16x16x32_bf16 v[76:79], a[192:195], a[180:183], v[76:79]
v_mfma_f32_16x16x32_bf16 v[44:47], a[192:195], a[184:187], v[44:47]
global_load_dwordx4 a[192:195], v0, s[72:73] offset:2048
v_mfma_f32_16x16x32_bf16 v[44:47], a[208:211], a[188:191], v[44:47]
v_mul_f32 v11, v11, v67
v_cvt_pk_bf16_f32 v20, v8, v9
s_waitcnt vmcnt(10)
v_mfma_f32_16x16x32_bf16 v[48:51], a[200:203], a[188:191], v[48:51]
v_cvt_pk_bf16_f32 v21, v10, v11
v_mfma_f32_16x16x32_bf16 v[48:51], a[220:223], a[184:187], v[48:51]
ds_read_b128 a[32:35], v3 offset:0
v_mfma_f32_16x16x32_bf16 v[80:83], a[220:223], a[180:183], v[80:83]
global_load_dwordx4 a[208:211], v0, s[74:75] offset:2048
v_mfma_f32_16x16x32_bf16 v[80:83], a[200:203], a[176:179], v[80:83]
s_waitcnt lgkmcnt(2)
v_mfma_f32_16x16x32_bf16 v[112:115], a[200:203], a[172:175], v[112:115]
buffer_store_dwordx4 a[28:31], v4, s[20:23], s51 offen offset:0 sc1
v_mfma_f32_16x16x32_bf16 v[112:115], a[220:223], a[168:171], v[112:115]
v_mul_f32 v12, v12, v68
v_mul_f32 v13, v13, v69
v_mfma_f32_16x16x32_bf16 v[144:147], a[220:223], a[164:167], v[144:147]
v_mul_f32 v14, v14, v70
v_mfma_f32_16x16x32_bf16 v[144:147], a[200:203], a[160:163], v[144:147]
v_mul_f32 v15, v15, v71
v_cvt_pk_bf16_f32 v22, v12, v13
v_mfma_f32_16x16x32_bf16 v[176:179], a[200:203], a[156:159], v[176:179]
v_cvt_pk_bf16_f32 v23, v14, v15
v_mfma_f32_16x16x32_bf16 v[176:179], a[220:223], a[152:155], v[176:179]
v_mfma_f32_4x4x4_16b_bf16 v[8:11], v[6:7], a[40:41], 0
v_mfma_f32_4x4x4_16b_bf16 v[12:15], v[6:7], a[42:43], 0
v_mfma_f32_16x16x32_bf16 v[208:211], a[220:223], a[148:151], v[208:211]
ds_write_b128 v1, v[20:23] offset:1024
v_mfma_f32_16x16x32_bf16 v[208:211], a[200:203], a[144:147], v[208:211]
s_nop 0
v_mul_f32 v8, v8, v96
v_mfma_f32_16x16x32_bf16 v[240:243], a[200:203], a[140:143], v[240:243]
v_mul_f32 v9, v9, v97
v_mul_f32 v10, v10, v98
v_mfma_f32_16x16x32_bf16 v[240:243], a[220:223], a[136:139], v[240:243]
v_mul_f32 v11, v11, v99
v_mfma_f32_16x16x32_bf16 a[248:251], a[220:223], a[132:135], a[248:251]
global_load_dwordx4 a[220:223], v0, s[72:73] offset:3072
v_mfma_f32_16x16x32_bf16 a[248:251], a[200:203], a[128:131], a[248:251]
v_add_u32 v2, 65536, v0
s_waitcnt vmcnt(10)
v_mfma_f32_16x16x32_bf16 a[252:255], a[204:207], a[128:131], a[252:255]
ds_read_b128 a[128:131], v2 offset:32768
v_cvt_pk_bf16_f32 v16, v8, v9
v_mfma_f32_16x16x32_bf16 a[252:255], a[228:231], a[132:135], a[252:255]
ds_read_b128 a[132:135], v2 offset:40960
v_cvt_pk_bf16_f32 v17, v10, v11
v_mfma_f32_16x16x32_bf16 v[244:247], a[228:231], a[136:139], v[244:247]
ds_read_b128 a[136:139], v2 offset:41984
v_mfma_f32_16x16x32_bf16 v[244:247], a[204:207], a[140:143], v[244:247]
ds_read_b128 a[140:143], v2 offset:33792
v_mfma_f32_16x16x32_bf16 v[212:215], a[204:207], a[144:147], v[212:215]
ds_read_b128 a[144:147], v2 offset:34816
v_mfma_f32_16x16x32_bf16 v[212:215], a[228:231], a[148:151], v[212:215]
ds_read_b128 a[148:151], v2 offset:43008
v_mfma_f32_16x16x32_bf16 v[180:183], a[228:231], a[152:155], v[180:183]
ds_read_b128 a[152:155], v2 offset:44032
v_mfma_f32_16x16x32_bf16 v[180:183], a[204:207], a[156:159], v[180:183]
ds_read_b128 a[156:159], v2 offset:35840
v_mul_f32 v12, v12, v100
v_mfma_f32_16x16x32_bf16 v[148:151], a[204:207], a[160:163], v[148:151]
ds_read_b128 a[160:163], v2 offset:36864
v_mul_f32 v13, v13, v101
v_mfma_f32_16x16x32_bf16 v[148:151], a[228:231], a[164:167], v[148:151]
ds_read_b128 a[164:167], v2 offset:45056
v_mul_f32 v14, v14, v102
v_mfma_f32_16x16x32_bf16 v[116:119], a[228:231], a[168:171], v[116:119]
ds_read_b128 a[168:171], v2 offset:46080
v_mfma_f32_16x16x32_bf16 v[116:119], a[204:207], a[172:175], v[116:119]
ds_read_b128 a[172:175], v2 offset:37888
v_mul_f32 v15, v15, v103
v_mfma_f32_16x16x32_bf16 v[84:87], a[204:207], a[176:179], v[84:87]
ds_read_b128 a[176:179], v2 offset:38912
v_cvt_pk_bf16_f32 v18, v12, v13
v_mfma_f32_16x16x32_bf16 v[84:87], a[228:231], a[180:183], v[84:87]
ds_read_b128 a[180:183], v2 offset:47104
v_cvt_pk_bf16_f32 v19, v14, v15
v_mfma_f32_16x16x32_bf16 v[52:55], a[228:231], a[184:187], v[52:55]
ds_read_b128 a[184:187], v2 offset:48128
v_mfma_f32_16x16x32_bf16 v[52:55], a[204:207], a[188:191], v[52:55]
ds_read_b128 a[188:191], v2 offset:39936
v_mfma_f32_4x4x4_16b_bf16 v[8:11], v[6:7], a[44:45], 0
v_mfma_f32_4x4x4_16b_bf16 v[12:15], v[6:7], a[46:47], 0
s_waitcnt vmcnt(7) lgkmcnt(12)
v_mfma_f32_16x16x32_bf16 v[40:43], a[196:199], a[128:131], v[40:43]
global_load_dwordx4 a[200:203], v0, s[74:75] offset:3072
v_mfma_f32_16x16x32_bf16 v[40:43], a[224:227], a[132:135], v[40:43]
s_add_u32 s72, s12, 602112
s_addc_u32 s73, s13, 0
v_mfma_f32_16x16x32_bf16 v[72:75], a[224:227], a[136:139], v[72:75]
s_add_u32 s74, s12, 634880
s_addc_u32 s75, s13, 0
v_mfma_f32_16x16x32_bf16 v[72:75], a[196:199], a[140:143], v[72:75]
s_waitcnt lgkmcnt(8)
v_mfma_f32_16x16x32_bf16 v[104:107], a[196:199], a[144:147], v[104:107]
global_load_dwordx4 a[228:231], v0, s[72:73] offset:0
v_mfma_f32_16x16x32_bf16 v[104:107], a[224:227], a[148:151], v[104:107]
ds_read_b128 a[36:39], v3 offset:1024
v_mfma_f32_16x16x32_bf16 v[136:139], a[224:227], a[152:155], v[136:139]
buffer_store_dwordx4 a[32:35], v4, s[20:23], s44 offen offset:64 sc1
v_mfma_f32_16x16x32_bf16 v[136:139], a[196:199], a[156:159], v[136:139]
v_mul_f32 v8, v8, v128
s_waitcnt lgkmcnt(5)
v_mfma_f32_16x16x32_bf16 v[168:171], a[196:199], a[160:163], v[168:171]
global_load_dwordx4 a[204:207], v0, s[74:75] offset:0
v_mfma_f32_16x16x32_bf16 v[168:171], a[224:227], a[164:167], v[168:171]
ds_write_b128 v1, v[16:19] offset:2048
v_mfma_f32_16x16x32_bf16 v[200:203], a[224:227], a[168:171], v[200:203]
v_mul_f32 v9, v9, v129
v_mul_f32 v10, v10, v130
v_mfma_f32_16x16x32_bf16 v[200:203], a[196:199], a[172:175], v[200:203]
v_mul_f32 v11, v11, v131
v_cvt_pk_bf16_f32 v20, v8, v9
s_waitcnt lgkmcnt(2)
v_mfma_f32_16x16x32_bf16 v[232:235], a[196:199], a[176:179], v[232:235]
v_cvt_pk_bf16_f32 v21, v10, v11
v_mfma_f32_16x16x32_bf16 v[232:235], a[224:227], a[180:183], v[232:235]
ds_read_b128 a[40:43], v3 offset:2048
v_mfma_f32_16x16x32_bf16 a[240:243], a[224:227], a[184:187], a[240:243]
L_pad21:
s_cbranch_execz L_tret1
global_load_dwordx4 a[224:227], v0, s[72:73] offset:1024
v_mfma_f32_16x16x32_bf16 a[240:243], a[196:199], a[188:191], a[240:243]
s_waitcnt lgkmcnt(2)
s_waitcnt vmcnt(9)
v_mfma_f32_16x16x32_bf16 a[244:247], a[212:215], a[188:191], a[244:247]
buffer_store_dwordx4 a[36:39], v4, s[20:23], s45 offen offset:64 sc1
v_mfma_f32_16x16x32_bf16 a[244:247], a[216:219], a[184:187], a[244:247]
v_mul_f32 v12, v12, v132
v_mfma_f32_16x16x32_bf16 v[236:239], a[216:219], a[180:183], v[236:239]
global_load_dwordx4 a[196:199], v0, s[74:75] offset:1024
v_mfma_f32_16x16x32_bf16 v[236:239], a[212:215], a[176:179], v[236:239]
v_mul_f32 v13, v13, v133
v_mul_f32 v14, v14, v134
v_mfma_f32_16x16x32_bf16 v[204:207], a[212:215], a[172:175], v[204:207]
v_mul_f32 v15, v15, v135
v_cvt_pk_bf16_f32 v22, v12, v13
v_mfma_f32_16x16x32_bf16 v[204:207], a[216:219], a[168:171], v[204:207]
v_cvt_pk_bf16_f32 v23, v14, v15
v_mfma_f32_4x4x4_16b_bf16 v[8:11], v[6:7], a[48:49], 0
v_mfma_f32_4x4x4_16b_bf16 v[12:15], v[6:7], a[50:51], 0
v_mfma_f32_16x16x32_bf16 v[172:175], a[216:219], a[164:167], v[172:175]
ds_write_b128 v1, v[20:23] offset:3072
v_mfma_f32_16x16x32_bf16 v[172:175], a[212:215], a[160:163], v[172:175]
s_nop 0
v_mul_f32 v8, v8, v160
v_mfma_f32_16x16x32_bf16 v[140:143], a[212:215], a[156:159], v[140:143]
v_mul_f32 v9, v9, v161
v_mfma_f32_16x16x32_bf16 v[140:143], a[216:219], a[152:155], v[140:143]
v_mul_f32 v10, v10, v162
v_mfma_f32_16x16x32_bf16 v[108:111], a[216:219], a[148:151], v[108:111]
v_mul_f32 v11, v11, v163
v_cvt_pk_bf16_f32 v16, v8, v9
v_mfma_f32_16x16x32_bf16 v[108:111], a[212:215], a[144:147], v[108:111]
v_cvt_pk_bf16_f32 v17, v10, v11
v_mfma_f32_16x16x32_bf16 v[76:79], a[212:215], a[140:143], v[76:79]
ds_read_b128 a[44:47], v3 offset:3072
s_waitcnt lgkmcnt(2)
v_mfma_f32_16x16x32_bf16 v[76:79], a[216:219], a[136:139], v[76:79]
buffer_store_dwordx4 a[40:43], v4, s[20:23], s46 offen offset:64 sc1
v_mfma_f32_16x16x32_bf16 v[44:47], a[216:219], a[132:135], v[44:47]
global_load_dwordx4 a[216:219], v0, s[72:73] offset:2048
v_mfma_f32_16x16x32_bf16 v[44:47], a[212:215], a[128:131], v[44:47]
s_waitcnt vmcnt(11)
v_mfma_f32_16x16x32_bf16 v[48:51], a[192:195], a[128:131], v[48:51]
v_mul_f32 v12, v12, v164
v_mul_f32 v13, v13, v165
v_mfma_f32_16x16x32_bf16 v[48:51], a[208:211], a[132:135], v[48:51]
v_mfma_f32_16x16x32_bf16 v[80:83], a[208:211], a[136:139], v[80:83]
global_load_dwordx4 a[212:215], v0, s[74:75] offset:2048
v_mfma_f32_16x16x32_bf16 v[80:83], a[192:195], a[140:143], v[80:83]
v_mul_f32 v14, v14, v166
v_mul_f32 v15, v15, v167
v_mfma_f32_16x16x32_bf16 v[112:115], a[192:195], a[144:147], v[112:115]
v_cvt_pk_bf16_f32 v18, v12, v13
v_cvt_pk_bf16_f32 v19, v14, v15
v_mfma_f32_16x16x32_bf16 v[112:115], a[208:211], a[148:151], v[112:115]
v_mfma_f32_4x4x4_16b_bf16 v[8:11], v[6:7], a[52:53], 0
v_mfma_f32_4x4x4_16b_bf16 v[12:15], v[6:7], a[54:55], 0
v_mfma_f32_16x16x32_bf16 v[144:147], a[208:211], a[152:155], v[144:147]
ds_write_b128 v1, v[16:19] offset:4096
v_mfma_f32_16x16x32_bf16 v[144:147], a[192:195], a[156:159], v[144:147]
s_nop 0
v_mul_f32 v8, v8, v192
v_mfma_f32_16x16x32_bf16 v[176:179], a[192:195], a[160:163], v[176:179]
v_mul_f32 v9, v9, v193
v_mfma_f32_16x16x32_bf16 v[176:179], a[208:211], a[164:167], v[176:179]
v_mul_f32 v10, v10, v194
v_mul_f32 v11, v11, v195
v_mfma_f32_16x16x32_bf16 v[208:211], a[208:211], a[168:171], v[208:211]
v_cvt_pk_bf16_f32 v20, v8, v9
v_mfma_f32_16x16x32_bf16 v[208:211], a[192:195], a[172:175], v[208:211]
v_cvt_pk_bf16_f32 v21, v10, v11
v_mfma_f32_16x16x32_bf16 v[240:243], a[192:195], a[176:179], v[240:243]
ds_read_b128 a[48:51], v3 offset:4096
s_waitcnt lgkmcnt(2)
v_mfma_f32_16x16x32_bf16 v[240:243], a[208:211], a[180:183], v[240:243]
buffer_store_dwordx4 a[44:47], v4, s[20:23], s47 offen offset:64 sc1
v_mfma_f32_16x16x32_bf16 a[248:251], a[208:211], a[184:187], a[248:251]
global_load_dwordx4 a[208:211], v0, s[72:73] offset:3072
v_mfma_f32_16x16x32_bf16 a[248:251], a[192:195], a[188:191], a[248:251]
v_mul_f32 v12, v12, v196
s_waitcnt vmcnt(11)
v_mfma_f32_16x16x32_bf16 a[252:255], a[220:223], a[188:191], a[252:255]
ds_read_b128 a[188:191], v2 offset:49152
v_mfma_f32_16x16x32_bf16 a[252:255], a[200:203], a[184:187], a[252:255]
ds_read_b128 a[184:187], v2 offset:57344
v_mul_f32 v13, v13, v197
v_mfma_f32_16x16x32_bf16 v[244:247], a[200:203], a[180:183], v[244:247]
ds_read_b128 a[180:183], v2 offset:58368
v_mul_f32 v14, v14, v198
v_mfma_f32_16x16x32_bf16 v[244:247], a[220:223], a[176:179], v[244:247]
ds_read_b128 a[176:179], v2 offset:50176
v_mul_f32 v15, v15, v199
v_mfma_f32_16x16x32_bf16 v[212:215], a[220:223], a[172:175], v[212:215]
ds_read_b128 a[172:175], v2 offset:51200
v_mfma_f32_16x16x32_bf16 v[212:215], a[200:203], a[168:171], v[212:215]
ds_read_b128 a[168:171], v2 offset:59392
v_cvt_pk_bf16_f32 v22, v12, v13
v_mfma_f32_16x16x32_bf16 v[180:183], a[200:203], a[164:167], v[180:183]
ds_read_b128 a[164:167], v2 offset:60416
v_cvt_pk_bf16_f32 v23, v14, v15
v_mfma_f32_16x16x32_bf16 v[180:183], a[220:223], a[160:163], v[180:183]
ds_read_b128 a[160:163], v2 offset:52224
v_mfma_f32_4x4x4_16b_bf16 v[8:11], v[6:7], a[56:57], 0
v_mfma_f32_4x4x4_16b_bf16 v[12:15], v[6:7], a[58:59], 0
v_mfma_f32_16x16x32_bf16 v[148:151], a[220:223], a[156:159], v[148:151]
ds_read_b128 a[156:159], v2 offset:53248
v_mfma_f32_16x16x32_bf16 v[148:151], a[200:203], a[152:155], v[148:151]
ds_read_b128 a[152:155], v2 offset:61440
v_mfma_f32_16x16x32_bf16 v[116:119], a[200:203], a[148:151], v[116:119]
ds_read_b128 a[148:151], v2 offset:62464
v_mul_f32 v8, v8, v224
v_mfma_f32_16x16x32_bf16 v[116:119], a[220:223], a[144:147], v[116:119]
ds_read_b128 a[144:147], v2 offset:54272
v_mfma_f32_16x16x32_bf16 v[84:87], a[220:223], a[140:143], v[84:87]
ds_read_b128 a[140:143], v2 offset:55296
v_mul_f32 v9, v9, v225
v_mfma_f32_16x16x32_bf16 v[84:87], a[200:203], a[136:139], v[84:87]
ds_read_b128 a[136:139], v2 offset:63488
v_mul_f32 v10, v10, v226
v_mfma_f32_16x16x32_bf16 v[52:55], a[200:203], a[132:135], v[52:55]
ds_read_b128 a[132:135], v2 offset:64512
v_mul_f32 v11, v11, v227
v_mfma_f32_16x16x32_bf16 v[52:55], a[220:223], a[128:131], v[52:55]
ds_read_b128 a[128:131], v2 offset:56320
s_waitcnt vmcnt(8) lgkmcnt(12)
v_mfma_f32_16x16x32_bf16 v[40:43], a[228:231], a[188:191], v[40:43]
global_load_dwordx4 a[192:195], v0, s[74:75] offset:3072
v_mfma_f32_16x16x32_bf16 v[40:43], a[204:207], a[184:187], v[40:43]
s_add_u32 s72, s12, 544768
s_addc_u32 s73, s13, 0
v_mfma_f32_16x16x32_bf16 v[72:75], a[204:207], a[180:183], v[72:75]
s_add_u32 s74, s12, 577536
s_addc_u32 s75, s13, 0
v_mfma_f32_16x16x32_bf16 v[72:75], a[228:231], a[176:179], v[72:75]
s_waitcnt lgkmcnt(8)
v_mfma_f32_16x16x32_bf16 v[104:107], a[228:231], a[172:175], v[104:107]
global_load_dwordx4 a[200:203], v0, s[72:73] offset:2048
v_mfma_f32_16x16x32_bf16 v[104:107], a[204:207], a[168:171], v[104:107]
ds_write_b128 v1, v[20:23] offset:5120
v_mfma_f32_16x16x32_bf16 v[136:139], a[204:207], a[164:167], v[136:139]
v_cvt_pk_bf16_f32 v16, v8, v9
v_cvt_pk_bf16_f32 v17, v10, v11
v_mfma_f32_16x16x32_bf16 v[136:139], a[228:231], a[160:163], v[136:139]
s_waitcnt lgkmcnt(5)
v_mfma_f32_16x16x32_bf16 v[168:171], a[228:231], a[156:159], v[168:171]
global_load_dwordx4 a[220:223], v0, s[74:75] offset:2048
v_mfma_f32_16x16x32_bf16 v[168:171], a[204:207], a[152:155], v[168:171]
ds_read_b128 a[52:55], v3 offset:5120
v_mfma_f32_16x16x32_bf16 v[200:203], a[204:207], a[148:151], v[200:203]
buffer_store_dwordx4 a[48:51], v4, s[20:23], s48 offen offset:64 sc1
v_mfma_f32_16x16x32_bf16 v[200:203], a[228:231], a[144:147], v[200:203]
v_mul_f32 v12, v12, v228
v_mul_f32 v13, v13, v229
s_waitcnt lgkmcnt(2)
v_mfma_f32_16x16x32_bf16 v[232:235], a[228:231], a[140:143], v[232:235]
v_mul_f32 v14, v14, v230
v_mul_f32 v15, v15, v231
v_mfma_f32_16x16x32_bf16 v[232:235], a[204:207], a[136:139], v[232:235]
v_mfma_f32_16x16x32_bf16 a[240:243], a[204:207], a[132:135], a[240:243]
global_load_dwordx4 a[204:207], v0, s[72:73] offset:3072
v_mfma_f32_16x16x32_bf16 a[240:243], a[228:231], a[128:131], a[240:243]
v_cvt_pk_bf16_f32 v18, v12, v13
v_cvt_pk_bf16_f32 v19, v14, v15
s_waitcnt vmcnt(10)
v_mfma_f32_16x16x32_bf16 a[244:247], a[224:227], a[128:131], a[244:247]
v_mfma_f32_16x16x32_bf16 a[244:247], a[196:199], a[132:135], a[244:247]
v_mfma_f32_4x4x4_16b_bf16 v[8:11], v[6:7], a[60:61], 0
v_mfma_f32_4x4x4_16b_bf16 v[12:15], v[6:7], a[62:63], 0
v_mfma_f32_16x16x32_bf16 v[236:239], a[196:199], a[136:139], v[236:239]
global_load_dwordx4 a[228:231], v0, s[74:75] offset:3072
v_mfma_f32_16x16x32_bf16 v[236:239], a[224:227], a[140:143], v[236:239]
s_add_u32 s72, s12, 610304
s_addc_u32 s73, s13, 0
v_mfma_f32_16x16x32_bf16 v[204:207], a[224:227], a[144:147], v[204:207]
ds_write_b128 v1, v[16:19] offset:6144
v_mfma_f32_16x16x32_bf16 v[204:207], a[196:199], a[148:151], v[204:207]
v_accvgpr_read_b32 v20, a232
v_accvgpr_read_b32 v21, a233
v_mfma_f32_16x16x32_bf16 v[172:175], a[196:199], a[152:155], v[172:175]
s_add_u32 s74, s12, 643072
s_addc_u32 s75, s13, 0
v_mfma_f32_16x16x32_bf16 v[172:175], a[224:227], a[156:159], v[172:175]
v_mul_f32 v8, v8, v20
v_mul_f32 v9, v9, v21
v_mfma_f32_16x16x32_bf16 v[140:143], a[224:227], a[160:163], v[140:143]
v_accvgpr_read_b32 v20, a234
v_accvgpr_read_b32 v21, a235
v_mfma_f32_16x16x32_bf16 v[140:143], a[196:199], a[164:167], v[140:143]
v_mul_f32 v10, v10, v20
v_mfma_f32_16x16x32_bf16 v[108:111], a[196:199], a[168:171], v[108:111]
v_mul_f32 v11, v11, v21
v_cvt_pk_bf16_f32 v20, v8, v9
v_mfma_f32_16x16x32_bf16 v[108:111], a[224:227], a[172:175], v[108:111]
v_cvt_pk_bf16_f32 v21, v10, v11
v_mfma_f32_16x16x32_bf16 v[76:79], a[224:227], a[176:179], v[76:79]
ds_read_b128 a[56:59], v3 offset:6144
s_waitcnt lgkmcnt(2)
v_mfma_f32_16x16x32_bf16 v[76:79], a[196:199], a[180:183], v[76:79]
buffer_store_dwordx4 a[52:55], v4, s[20:23], s49 offen offset:64 sc1
v_mfma_f32_16x16x32_bf16 v[44:47], a[196:199], a[184:187], v[44:47]
global_load_dwordx4 a[196:199], v0, s[72:73] offset:2048
v_mfma_f32_16x16x32_bf16 v[44:47], a[224:227], a[188:191], v[44:47]
s_waitcnt vmcnt(10)
v_mfma_f32_16x16x32_bf16 v[48:51], a[216:219], a[188:191], v[48:51]
v_accvgpr_read_b32 v22, a236
v_accvgpr_read_b32 v23, a237
v_mfma_f32_16x16x32_bf16 v[48:51], a[212:215], a[184:187], v[48:51]
v_mfma_f32_16x16x32_bf16 v[80:83], a[212:215], a[180:183], v[80:83]
global_load_dwordx4 a[224:227], v0, s[74:75] offset:2048
v_mfma_f32_16x16x32_bf16 v[80:83], a[216:219], a[176:179], v[80:83]
v_mul_f32 v12, v12, v22
v_mul_f32 v13, v13, v23
v_mfma_f32_16x16x32_bf16 v[112:115], a[216:219], a[172:175], v[112:115]
v_accvgpr_read_b32 v22, a238
v_accvgpr_read_b32 v23, a239
v_mfma_f32_16x16x32_bf16 v[112:115], a[212:215], a[168:171], v[112:115]
v_mul_f32 v14, v14, v22
v_mfma_f32_16x16x32_bf16 v[144:147], a[212:215], a[164:167], v[144:147]
v_mul_f32 v15, v15, v23
v_cvt_pk_bf16_f32 v22, v12, v13
v_mfma_f32_16x16x32_bf16 v[144:147], a[216:219], a[160:163], v[144:147]
v_cvt_pk_bf16_f32 v23, v14, v15
v_mfma_f32_16x16x32_bf16 v[176:179], a[216:219], a[156:159], v[176:179]
ds_write_b128 v1, v[20:23] offset:7168
v_mfma_f32_16x16x32_bf16 v[176:179], a[212:215], a[152:155], v[176:179]
v_mfma_f32_16x16x32_bf16 v[208:211], a[212:215], a[148:151], v[208:211]
ds_read_b128 a[60:63], v3 offset:7168
s_waitcnt lgkmcnt(2)
v_mfma_f32_16x16x32_bf16 v[208:211], a[216:219], a[144:147], v[208:211]
buffer_store_dwordx4 a[56:59], v4, s[20:23], s50 offen offset:64 sc1
v_mfma_f32_16x16x32_bf16 v[240:243], a[216:219], a[140:143], v[240:243]
v_mfma_f32_16x16x32_bf16 v[240:243], a[212:215], a[136:139], v[240:243]
v_mfma_f32_4x4x4_16b_bf16 v[8:11], v[6:7], a[64:65], 0
v_mfma_f32_4x4x4_16b_bf16 v[12:15], v[6:7], a[66:67], 0
v_mfma_f32_16x16x32_bf16 a[248:251], a[212:215], a[132:135], a[248:251]
global_load_dwordx4 a[212:215], v0, s[72:73] offset:3072
v_mfma_f32_16x16x32_bf16 a[248:251], a[216:219], a[128:131], a[248:251]
s_nop 0
v_mul_f32 v8, v8, v40
s_waitcnt vmcnt(10)
v_mfma_f32_16x16x32_bf16 a[252:255], a[208:211], a[128:131], a[252:255]
ds_read_b128 a[128:131], v2 offset:0
v_mul_f32 v9, v9, v41
v_mfma_f32_16x16x32_bf16 a[252:255], a[192:195], a[132:135], a[252:255]
ds_read_b128 a[132:135], v2 offset:8192
v_mul_f32 v10, v10, v42
v_mfma_f32_16x16x32_bf16 v[244:247], a[192:195], a[136:139], v[244:247]
ds_read_b128 a[136:139], v2 offset:9216
v_mul_f32 v11, v11, v43
v_mfma_f32_16x16x32_bf16 v[244:247], a[208:211], a[140:143], v[244:247]
ds_read_b128 a[140:143], v2 offset:1024
v_cvt_pk_bf16_f32 v16, v8, v9
v_mfma_f32_16x16x32_bf16 v[212:215], a[208:211], a[144:147], v[212:215]
ds_read_b128 a[144:147], v2 offset:2048
v_cvt_pk_bf16_f32 v17, v10, v11
v_mfma_f32_16x16x32_bf16 v[212:215], a[192:195], a[148:151], v[212:215]
ds_read_b128 a[148:151], v2 offset:10240
v_mul_f32 v12, v12, v44
v_mfma_f32_16x16x32_bf16 v[180:183], a[192:195], a[152:155], v[180:183]
ds_read_b128 a[152:155], v2 offset:11264
v_mul_f32 v13, v13, v45
v_mfma_f32_16x16x32_bf16 v[180:183], a[208:211], a[156:159], v[180:183]
ds_read_b128 a[156:159], v2 offset:3072
v_mul_f32 v14, v14, v46
v_mfma_f32_16x16x32_bf16 v[148:151], a[208:211], a[160:163], v[148:151]
ds_read_b128 a[160:163], v2 offset:4096
v_mul_f32 v15, v15, v47
v_mfma_f32_16x16x32_bf16 v[148:151], a[192:195], a[164:167], v[148:151]
ds_read_b128 a[164:167], v2 offset:12288
v_cvt_pk_bf16_f32 v18, v12, v13
v_mfma_f32_16x16x32_bf16 v[116:119], a[192:195], a[168:171], v[116:119]
ds_read_b128 a[168:171], v2 offset:13312
v_cvt_pk_bf16_f32 v19, v14, v15
v_mfma_f32_16x16x32_bf16 v[116:119], a[208:211], a[172:175], v[116:119]
ds_read_b128 a[172:175], v2 offset:5120
v_mfma_f32_4x4x4_16b_bf16 v[8:11], v[6:7], a[68:69], 0
v_mfma_f32_4x4x4_16b_bf16 v[12:15], v[6:7], a[70:71], 0
v_mfma_f32_16x16x32_bf16 v[84:87], a[208:211], a[176:179], v[84:87]
ds_read_b128 a[176:179], v2 offset:6144
v_mfma_f32_16x16x32_bf16 v[84:87], a[192:195], a[180:183], v[84:87]
ds_read_b128 a[180:183], v2 offset:14336
v_mfma_f32_16x16x32_bf16 v[52:55], a[192:195], a[184:187], v[52:55]
ds_read_b128 a[184:187], v2 offset:15360
v_mul_f32 v8, v8, v72
v_mfma_f32_16x16x32_bf16 v[52:55], a[208:211], a[188:191], v[52:55]
ds_read_b128 a[188:191], v2 offset:7168
s_waitcnt vmcnt(8) lgkmcnt(12)
v_mfma_f32_16x16x32_bf16 v[48:51], a[200:203], a[128:131], v[48:51]
global_load_dwordx4 a[216:219], v0, s[74:75] offset:3072
v_mfma_f32_16x16x32_bf16 v[48:51], a[220:223], a[132:135], v[48:51]
s_add_u32 s72, s12, 552960
s_addc_u32 s73, s13, 0
v_mfma_f32_16x16x32_bf16 v[80:83], a[220:223], a[136:139], v[80:83]
s_add_u32 s74, s12, 585728
s_addc_u32 s75, s13, 0
v_mfma_f32_16x16x32_bf16 v[80:83], a[200:203], a[140:143], v[80:83]
s_waitcnt lgkmcnt(8)
v_mfma_f32_16x16x32_bf16 v[112:115], a[200:203], a[144:147], v[112:115]
global_load_dwordx4 a[192:195], v0, s[72:73] offset:2048
v_mfma_f32_16x16x32_bf16 v[112:115], a[220:223], a[148:151], v[112:115]
ds_write_b128 v1, v[16:19] offset:0
v_mfma_f32_16x16x32_bf16 v[144:147], a[220:223], a[152:155], v[144:147]
v_mul_f32 v9, v9, v73
v_mul_f32 v10, v10, v74
v_mfma_f32_16x16x32_bf16 v[144:147], a[200:203], a[156:159], v[144:147]
v_mul_f32 v11, v11, v75
s_waitcnt lgkmcnt(5)
v_mfma_f32_16x16x32_bf16 v[176:179], a[200:203], a[160:163], v[176:179]
global_load_dwordx4 a[208:211], v0, s[74:75] offset:2048
v_mfma_f32_16x16x32_bf16 v[176:179], a[220:223], a[164:167], v[176:179]
v_cvt_pk_bf16_f32 v20, v8, v9
v_cvt_pk_bf16_f32 v21, v10, v11
v_mfma_f32_16x16x32_bf16 v[208:211], a[220:223], a[168:171], v[208:211]
ds_read_b128 a[64:67], v3 offset:0
v_mfma_f32_16x16x32_bf16 v[208:211], a[200:203], a[172:175], v[208:211]
s_waitcnt lgkmcnt(2)
v_mfma_f32_16x16x32_bf16 v[240:243], a[200:203], a[176:179], v[240:243]
v_mul_f32 v12, v12, v76
v_mfma_f32_16x16x32_bf16 v[240:243], a[220:223], a[180:183], v[240:243]
buffer_store_dwordx4 a[60:63], v4, s[20:23], s51 offen offset:64 sc1
v_mfma_f32_16x16x32_bf16 a[248:251], a[220:223], a[184:187], a[248:251]
global_load_dwordx4 a[220:223], v0, s[72:73] offset:3072
v_mfma_f32_16x16x32_bf16 a[248:251], a[200:203], a[188:191], a[248:251]
v_mul_f32 v13, v13, v77
v_mul_f32 v14, v14, v78
s_waitcnt vmcnt(10)
v_mfma_f32_16x16x32_bf16 a[252:255], a[204:207], a[188:191], a[252:255]
ds_read_b128 a[188:191], v2 offset:16384
v_mul_f32 v15, v15, v79
v_mfma_f32_16x16x32_bf16 a[252:255], a[228:231], a[184:187], a[252:255]
ds_read_b128 a[184:187], v2 offset:24576
v_cvt_pk_bf16_f32 v22, v12, v13
v_mfma_f32_16x16x32_bf16 v[244:247], a[228:231], a[180:183], v[244:247]
ds_read_b128 a[180:183], v2 offset:25600
v_cvt_pk_bf16_f32 v23, v14, v15
v_mfma_f32_16x16x32_bf16 v[244:247], a[204:207], a[176:179], v[244:247]
ds_read_b128 a[176:179], v2 offset:17408
v_mfma_f32_4x4x4_16b_bf16 v[8:11], v[6:7], a[72:73], 0
v_mfma_f32_4x4x4_16b_bf16 v[12:15], v[6:7], a[74:75], 0
v_mfma_f32_16x16x32_bf16 v[212:215], a[204:207], a[172:175], v[212:215]
ds_read_b128 a[172:175], v2 offset:18432
v_mfma_f32_16x16x32_bf16 v[212:215], a[228:231], a[168:171], v[212:215]
ds_read_b128 a[168:171], v2 offset:26624
v_mul_f32 v8, v8, v104
v_mfma_f32_16x16x32_bf16 v[180:183], a[228:231], a[164:167], v[180:183]
ds_read_b128 a[164:167], v2 offset:27648
v_mfma_f32_16x16x32_bf16 v[180:183], a[204:207], a[160:163], v[180:183]
ds_read_b128 a[160:163], v2 offset:19456
v_mul_f32 v9, v9, v105
v_mfma_f32_16x16x32_bf16 v[148:151], a[204:207], a[156:159], v[148:151]
ds_read_b128 a[156:159], v2 offset:20480
v_mul_f32 v10, v10, v106
v_mfma_f32_16x16x32_bf16 v[148:151], a[228:231], a[152:155], v[148:151]
ds_read_b128 a[152:155], v2 offset:28672
v_mul_f32 v11, v11, v107
v_mfma_f32_16x16x32_bf16 v[116:119], a[228:231], a[148:151], v[116:119]
ds_read_b128 a[148:151], v2 offset:29696
v_cvt_pk_bf16_f32 v16, v8, v9
v_mfma_f32_16x16x32_bf16 v[116:119], a[204:207], a[144:147], v[116:119]
ds_read_b128 a[144:147], v2 offset:21504
v_cvt_pk_bf16_f32 v17, v10, v11
v_mfma_f32_16x16x32_bf16 v[84:87], a[204:207], a[140:143], v[84:87]
ds_read_b128 a[140:143], v2 offset:22528
v_mfma_f32_16x16x32_bf16 v[84:87], a[228:231], a[136:139], v[84:87]
ds_read_b128 a[136:139], v2 offset:30720
v_mfma_f32_16x16x32_bf16 v[52:55], a[228:231], a[132:135], v[52:55]
ds_read_b128 a[132:135], v2 offset:31744
v_mfma_f32_16x16x32_bf16 v[52:55], a[204:207], a[128:131], v[52:55]
ds_read_b128 a[128:131], v2 offset:23552
s_waitcnt vmcnt(7) lgkmcnt(12)
v_mfma_f32_16x16x32_bf16 v[48:51], a[196:199], a[188:191], v[48:51]
global_load_dwordx4 a[200:203], v0, s[74:75] offset:3072
v_mfma_f32_16x16x32_bf16 v[48:51], a[224:227], a[184:187], v[48:51]
s_add_u32 s72, s12, 618496
s_addc_u32 s73, s13, 0
v_mfma_f32_16x16x32_bf16 v[80:83], a[224:227], a[180:183], v[80:83]
s_add_u32 s74, s12, 651264
s_addc_u32 s75, s13, 0
v_mfma_f32_16x16x32_bf16 v[80:83], a[196:199], a[176:179], v[80:83]
s_waitcnt lgkmcnt(8)
v_mfma_f32_16x16x32_bf16 v[112:115], a[196:199], a[172:175], v[112:115]
global_load_dwordx4 a[228:231], v0, s[72:73] offset:2048
v_mfma_f32_16x16x32_bf16 v[112:115], a[224:227], a[168:171], v[112:115]
ds_write_b128 v1, v[20:23] offset:1024
v_mfma_f32_16x16x32_bf16 v[144:147], a[224:227], a[164:167], v[144:147]
ds_read_b128 a[68:71], v3 offset:1024
v_mul_f32 v12, v12, v108
v_mfma_f32_16x16x32_bf16 v[144:147], a[196:199], a[160:163], v[144:147]
v_mul_f32 v13, v13, v109
s_waitcnt lgkmcnt(6)
v_mfma_f32_16x16x32_bf16 v[176:179], a[196:199], a[156:159], v[176:179]
global_load_dwordx4 a[204:207], v0, s[74:75] offset:2048
v_mfma_f32_16x16x32_bf16 v[176:179], a[224:227], a[152:155], v[176:179]
buffer_store_dwordx4 a[64:67], v4, s[20:23], s44 offen offset:128 sc1
v_mfma_f32_16x16x32_bf16 v[208:211], a[224:227], a[148:151], v[208:211]
v_mul_f32 v14, v14, v110
v_mul_f32 v15, v15, v111
v_mfma_f32_16x16x32_bf16 v[208:211], a[196:199], a[144:147], v[208:211]
v_cvt_pk_bf16_f32 v18, v12, v13
v_cvt_pk_bf16_f32 v19, v14, v15
v_mfma_f32_4x4x4_16b_bf16 v[8:11], v[6:7], a[76:77], 0
v_mfma_f32_4x4x4_16b_bf16 v[12:15], v[6:7], a[78:79], 0
s_waitcnt lgkmcnt(2)
v_mfma_f32_16x16x32_bf16 v[240:243], a[196:199], a[140:143], v[240:243]
s_nop 1
v_mul_f32 v8, v8, v136
v_mfma_f32_16x16x32_bf16 v[240:243], a[224:227], a[136:139], v[240:243]
ds_write_b128 v1, v[16:19] offset:2048
v_mfma_f32_16x16x32_bf16 a[248:251], a[224:227], a[132:135], a[248:251]
global_load_dwordx4 a[224:227], v0, s[72:73] offset:3072
v_mfma_f32_16x16x32_bf16 a[248:251], a[196:199], a[128:131], a[248:251]
v_add_u32 v2, 131072, v0
v_mul_f32 v9, v9, v137
s_waitcnt vmcnt(9)
v_mfma_f32_16x16x32_bf16 a[252:255], a[212:215], a[128:131], a[252:255]
ds_read_b128 a[128:131], v2 offset:0
v_mul_f32 v10, v10, v138
v_mfma_f32_16x16x32_bf16 a[252:255], a[216:219], a[132:135], a[252:255]
ds_read_b128 a[132:135], v2 offset:8192
v_mul_f32 v11, v11, v139
v_mfma_f32_16x16x32_bf16 v[244:247], a[216:219], a[136:139], v[244:247]
ds_read_b128 a[136:139], v2 offset:9216
v_cvt_pk_bf16_f32 v20, v8, v9
v_mfma_f32_16x16x32_bf16 v[244:247], a[212:215], a[140:143], v[244:247]
ds_read_b128 a[140:143], v2 offset:1024
v_mfma_f32_16x16x32_bf16 v[212:215], a[212:215], a[144:147], v[212:215]
ds_read_b128 a[144:147], v2 offset:2048
v_cvt_pk_bf16_f32 v21, v10, v11
v_mfma_f32_16x16x32_bf16 v[212:215], a[216:219], a[148:151], v[212:215]
ds_read_b128 a[148:151], v2 offset:10240
v_mfma_f32_16x16x32_bf16 v[180:183], a[216:219], a[152:155], v[180:183]
ds_read_b128 a[152:155], v2 offset:11264
v_mfma_f32_16x16x32_bf16 v[180:183], a[212:215], a[156:159], v[180:183]
ds_read_b128 a[156:159], v2 offset:3072
v_mfma_f32_16x16x32_bf16 v[148:151], a[212:215], a[160:163], v[148:151]
ds_read_b128 a[160:163], v2 offset:4096
v_mfma_f32_16x16x32_bf16 v[148:151], a[216:219], a[164:167], v[148:151]
ds_read_b128 a[164:167], v2 offset:12288
v_mul_f32 v12, v12, v140
v_mfma_f32_16x16x32_bf16 v[116:119], a[216:219], a[168:171], v[116:119]
ds_read_b128 a[168:171], v2 offset:13312
v_mul_f32 v13, v13, v141
v_mfma_f32_16x16x32_bf16 v[116:119], a[212:215], a[172:175], v[116:119]
ds_read_b128 a[172:175], v2 offset:5120
v_mul_f32 v14, v14, v142
v_mfma_f32_16x16x32_bf16 v[84:87], a[212:215], a[176:179], v[84:87]
ds_read_b128 a[176:179], v2 offset:6144
v_mul_f32 v15, v15, v143
v_mfma_f32_16x16x32_bf16 v[84:87], a[216:219], a[180:183], v[84:87]
ds_read_b128 a[180:183], v2 offset:14336
v_cvt_pk_bf16_f32 v22, v12, v13
v_mfma_f32_16x16x32_bf16 v[52:55], a[216:219], a[184:187], v[52:55]
ds_read_b128 a[184:187], v2 offset:15360
v_mfma_f32_16x16x32_bf16 v[52:55], a[212:215], a[188:191], v[52:55]
ds_read_b128 a[188:191], v2 offset:7168
s_waitcnt vmcnt(7) lgkmcnt(12)
v_mfma_f32_16x16x32_bf16 v[48:51], a[192:195], a[128:131], v[48:51]
global_load_dwordx4 a[196:199], v0, s[74:75] offset:3072
v_mfma_f32_16x16x32_bf16 v[48:51], a[208:211], a[132:135], v[48:51]
ds_read_b128 a[72:75], v3 offset:2048
v_mfma_f32_16x16x32_bf16 v[80:83], a[208:211], a[136:139], v[80:83]
buffer_store_dwordx4 a[68:71], v4, s[20:23], s45 offen offset:128 sc1
v_mfma_f32_16x16x32_bf16 v[80:83], a[192:195], a[140:143], v[80:83]
v_cvt_pk_bf16_f32 v23, v14, v15
v_mfma_f32_4x4x4_16b_bf16 v[8:11], v[6:7], a[80:81], 0
v_mfma_f32_4x4x4_16b_bf16 v[12:15], v[6:7], a[82:83], 0
s_waitcnt lgkmcnt(9)
v_mfma_f32_16x16x32_bf16 v[112:115], a[192:195], a[144:147], v[112:115]
ds_write_b128 v1, v[20:23] offset:3072
v_mfma_f32_16x16x32_bf16 v[112:115], a[208:211], a[148:151], v[112:115]
v_mul_f32 v8, v8, v168
v_mfma_f32_16x16x32_bf16 v[144:147], a[208:211], a[152:155], v[144:147]
v_mul_f32 v9, v9, v169
v_mul_f32 v10, v10, v170
v_mfma_f32_16x16x32_bf16 v[144:147], a[192:195], a[156:159], v[144:147]
v_mul_f32 v11, v11, v171
v_cvt_pk_bf16_f32 v16, v8, v9
s_waitcnt lgkmcnt(6)
v_mfma_f32_16x16x32_bf16 v[176:179], a[192:195], a[160:163], v[176:179]
v_cvt_pk_bf16_f32 v17, v10, v11
v_mfma_f32_16x16x32_bf16 v[176:179], a[208:211], a[164:167], v[176:179]
ds_read_b128 a[76:79], v3 offset:3072
s_waitcnt lgkmcnt(2)
v_mfma_f32_16x16x32_bf16 v[208:211], a[208:211], a[168:171], v[208:211]
buffer_store_dwordx4 a[72:75], v4, s[20:23], s46 offen offset:128 sc1
v_mfma_f32_16x16x32_bf16 v[208:211], a[192:195], a[172:175], v[208:211]
v_mul_f32 v12, v12, v172
v_mul_f32 v13, v13, v173
v_mfma_f32_16x16x32_bf16 v[240:243], a[192:195], a[176:179], v[240:243]
v_mul_f32 v14, v14, v174
v_mul_f32 v15, v15, v175
v_mfma_f32_16x16x32_bf16 v[240:243], a[208:211], a[180:183], v[240:243]
v_cvt_pk_bf16_f32 v18, v12, v13
v_cvt_pk_bf16_f32 v19, v14, v15
v_mfma_f32_4x4x4_16b_bf16 v[8:11], v[6:7], a[84:85], 0
v_mfma_f32_4x4x4_16b_bf16 v[12:15], v[6:7], a[86:87], 0
v_mfma_f32_16x16x32_bf16 a[248:251], a[208:211], a[184:187], a[248:251]
ds_write_b128 v1, v[16:19] offset:4096
v_mfma_f32_16x16x32_bf16 a[248:251], a[192:195], a[188:191], a[248:251]
s_nop 0
v_mul_f32 v8, v8, v200
s_waitcnt vmcnt(7)
v_mfma_f32_16x16x32_bf16 a[252:255], a[220:223], a[188:191], a[252:255]
ds_read_b128 a[188:191], v2 offset:16384
v_mul_f32 v9, v9, v201
v_mfma_f32_16x16x32_bf16 a[252:255], a[200:203], a[184:187], a[252:255]
ds_read_b128 a[184:187], v2 offset:24576
v_mul_f32 v10, v10, v202
v_mfma_f32_16x16x32_bf16 v[244:247], a[200:203], a[180:183], v[244:247]
ds_read_b128 a[180:183], v2 offset:25600
v_mul_f32 v11, v11, v203
v_mfma_f32_16x16x32_bf16 v[244:247], a[220:223], a[176:179], v[244:247]
ds_read_b128 a[176:179], v2 offset:17408
v_cvt_pk_bf16_f32 v20, v8, v9
v_mfma_f32_16x16x32_bf16 v[212:215], a[220:223], a[172:175], v[212:215]
ds_read_b128 a[172:175], v2 offset:18432
v_cvt_pk_bf16_f32 v21, v10, v11
v_mfma_f32_16x16x32_bf16 v[212:215], a[200:203], a[168:171], v[212:215]
ds_read_b128 a[168:171], v2 offset:26624
v_mfma_f32_16x16x32_bf16 v[180:183], a[200:203], a[164:167], v[180:183]
ds_read_b128 a[164:167], v2 offset:27648
v_mfma_f32_16x16x32_bf16 v[180:183], a[220:223], a[160:163], v[180:183]
ds_read_b128 a[160:163], v2 offset:19456
v_mfma_f32_16x16x32_bf16 v[148:151], a[220:223], a[156:159], v[148:151]
ds_read_b128 a[156:159], v2 offset:20480
v_mfma_f32_16x16x32_bf16 v[148:151], a[200:203], a[152:155], v[148:151]
ds_read_b128 a[152:155], v2 offset:28672
v_mfma_f32_16x16x32_bf16 v[116:119], a[200:203], a[148:151], v[116:119]
ds_read_b128 a[148:151], v2 offset:29696
v_mul_f32 v12, v12, v204
v_mfma_f32_16x16x32_bf16 v[116:119], a[220:223], a[144:147], v[116:119]
ds_read_b128 a[144:147], v2 offset:21504
v_mul_f32 v13, v13, v205
v_mfma_f32_16x16x32_bf16 v[84:87], a[220:223], a[140:143], v[84:87]
ds_read_b128 a[140:143], v2 offset:22528
v_mul_f32 v14, v14, v206
v_mfma_f32_16x16x32_bf16 v[84:87], a[200:203], a[136:139], v[84:87]
ds_read_b128 a[136:139], v2 offset:30720
v_mul_f32 v15, v15, v207
v_mfma_f32_16x16x32_bf16 v[52:55], a[200:203], a[132:135], v[52:55]
ds_read_b128 a[132:135], v2 offset:31744
v_cvt_pk_bf16_f32 v22, v12, v13
v_mfma_f32_16x16x32_bf16 v[52:55], a[220:223], a[128:131], v[52:55]
ds_read_b128 a[128:131], v2 offset:23552
s_waitcnt vmcnt(5) lgkmcnt(12)
v_mfma_f32_16x16x32_bf16 v[48:51], a[228:231], a[188:191], v[48:51]
ds_read_b128 a[80:83], v3 offset:4096
v_mfma_f32_16x16x32_bf16 v[48:51], a[204:207], a[184:187], v[48:51]
buffer_store_dwordx4 a[76:79], v4, s[20:23], s47 offen offset:128 sc1
v_mfma_f32_16x16x32_bf16 v[80:83], a[204:207], a[180:183], v[80:83]
v_cvt_pk_bf16_f32 v23, v14, v15
v_mfma_f32_16x16x32_bf16 v[80:83], a[228:231], a[176:179], v[80:83]
v_mfma_f32_4x4x4_16b_bf16 v[8:11], v[6:7], a[88:89], 0
v_mfma_f32_4x4x4_16b_bf16 v[12:15], v[6:7], a[90:91], 0
s_nop 3
v_mul_f32 v8, v8, v232
s_waitcnt lgkmcnt(9)
v_mfma_f32_16x16x32_bf16 v[112:115], a[228:231], a[172:175], v[112:115]
ds_write_b128 v1, v[20:23] offset:5120
v_mfma_f32_16x16x32_bf16 v[112:115], a[204:207], a[168:171], v[112:115]
v_mul_f32 v9, v9, v233
v_mul_f32 v10, v10, v234
v_mfma_f32_16x16x32_bf16 v[144:147], a[204:207], a[164:167], v[144:147]
v_mul_f32 v11, v11, v235
v_cvt_pk_bf16_f32 v16, v8, v9
v_mfma_f32_16x16x32_bf16 v[144:147], a[228:231], a[160:163], v[144:147]
v_cvt_pk_bf16_f32 v17, v10, v11
s_waitcnt lgkmcnt(6)
v_mfma_f32_16x16x32_bf16 v[176:179], a[228:231], a[156:159], v[176:179]
ds_read_b128 a[84:87], v3 offset:5120
s_waitcnt lgkmcnt(2)
v_mfma_f32_16x16x32_bf16 v[176:179], a[204:207], a[152:155], v[176:179]
buffer_store_dwordx4 a[80:83], v4, s[20:23], s48 offen offset:128 sc1
v_mfma_f32_16x16x32_bf16 v[208:211], a[204:207], a[148:151], v[208:211]
v_mul_f32 v12, v12, v236
v_mul_f32 v13, v13, v237
v_mfma_f32_16x16x32_bf16 v[208:211], a[228:231], a[144:147], v[208:211]
v_mul_f32 v14, v14, v238
v_mul_f32 v15, v15, v239
v_mfma_f32_16x16x32_bf16 v[240:243], a[228:231], a[140:143], v[240:243]
L_pad22:
s_cbranch_execz L_tret1
v_cvt_pk_bf16_f32 v18, v12, v13
v_cvt_pk_bf16_f32 v19, v14, v15
v_mfma_f32_16x16x32_bf16 v[240:243], a[204:207], a[136:139], v[240:243]
v_mfma_f32_4x4x4_16b_bf16 v[8:11], v[6:7], a[92:93], 0
v_mfma_f32_4x4x4_16b_bf16 v[12:15], v[6:7], a[94:95], 0
v_mfma_f32_16x16x32_bf16 a[248:251], a[204:207], a[132:135], a[248:251]
ds_write_b128 v1, v[16:19] offset:6144
v_mfma_f32_16x16x32_bf16 a[248:251], a[228:231], a[128:131], a[248:251]
v_accvgpr_read_b32 v20, a240
v_accvgpr_read_b32 v21, a241
s_waitcnt vmcnt(4)
v_mfma_f32_16x16x32_bf16 a[252:255], a[224:227], a[128:131], a[252:255]
v_mul_f32 v8, v8, v20
v_mul_f32 v9, v9, v21
v_mfma_f32_16x16x32_bf16 a[252:255], a[196:199], a[132:135], a[252:255]
v_accvgpr_read_b32 v20, a242
v_accvgpr_read_b32 v21, a243
v_mfma_f32_16x16x32_bf16 v[244:247], a[196:199], a[136:139], v[244:247]
v_mul_f32 v10, v10, v20
v_mul_f32 v11, v11, v21
v_mfma_f32_16x16x32_bf16 v[244:247], a[224:227], a[140:143], v[244:247]
v_cvt_pk_bf16_f32 v20, v8, v9
v_cvt_pk_bf16_f32 v21, v10, v11
v_mfma_f32_16x16x32_bf16 v[212:215], a[224:227], a[144:147], v[212:215]
ds_read_b128 a[88:91], v3 offset:6144
v_mfma_f32_16x16x32_bf16 v[212:215], a[196:199], a[148:151], v[212:215]
s_waitcnt lgkmcnt(2)
v_mfma_f32_16x16x32_bf16 v[180:183], a[196:199], a[152:155], v[180:183]
buffer_store_dwordx4 a[84:87], v4, s[20:23], s49 offen offset:128 sc1
v_mfma_f32_16x16x32_bf16 v[180:183], a[224:227], a[156:159], v[180:183]
v_accvgpr_read_b32 v22, a244
v_accvgpr_read_b32 v23, a245
v_mfma_f32_16x16x32_bf16 v[148:151], a[224:227], a[160:163], v[148:151]
v_mul_f32 v12, v12, v22
v_mul_f32 v13, v13, v23
v_mfma_f32_16x16x32_bf16 v[148:151], a[196:199], a[164:167], v[148:151]
v_accvgpr_read_b32 v22, a246
v_accvgpr_read_b32 v23, a247
v_mfma_f32_16x16x32_bf16 v[116:119], a[196:199], a[168:171], v[116:119]
v_mul_f32 v14, v14, v22
v_mul_f32 v15, v15, v23
v_mfma_f32_16x16x32_bf16 v[116:119], a[224:227], a[172:175], v[116:119]
v_cvt_pk_bf16_f32 v22, v12, v13
v_cvt_pk_bf16_f32 v23, v14, v15
v_mfma_f32_16x16x32_bf16 v[84:87], a[224:227], a[176:179], v[84:87]
ds_write_b128 v1, v[20:23] offset:7168
v_mfma_f32_16x16x32_bf16 v[84:87], a[196:199], a[180:183], v[84:87]
v_mfma_f32_16x16x32_bf16 v[52:55], a[196:199], a[184:187], v[52:55]
ds_read_b128 a[92:95], v3 offset:7168
s_waitcnt lgkmcnt(2)
v_mfma_f32_16x16x32_bf16 v[52:55], a[224:227], a[188:191], v[52:55]
buffer_store_dwordx4 a[88:91], v4, s[20:23], s50 offen offset:128 sc1
v_mfma_f32_4x4x4_16b_bf16 v[8:11], v[6:7], a[124:125], 0
v_mfma_f32_4x4x4_16b_bf16 v[12:15], v[6:7], a[126:127], 0
v_accvgpr_read_b32 v16, a248
v_accvgpr_read_b32 v17, a249
s_nop 1
v_mul_f32 v8, v8, v16
v_mul_f32 v9, v9, v17
v_accvgpr_read_b32 v16, a250
v_accvgpr_read_b32 v17, a251
v_mul_f32 v10, v10, v16
v_mul_f32 v11, v11, v17
v_cvt_pk_bf16_f32 v16, v8, v9
v_cvt_pk_bf16_f32 v17, v10, v11
v_mfma_f32_4x4x4_16b_bf16 v[8:11], v[6:7], a[120:121], 0
v_accvgpr_read_b32 v18, a252
v_accvgpr_read_b32 v19, a253
v_mul_f32 v12, v12, v18
v_mul_f32 v13, v13, v19
v_accvgpr_read_b32 v18, a254
v_accvgpr_read_b32 v19, a255
v_mul_f32 v14, v14, v18
v_mul_f32 v15, v15, v19
v_cvt_pk_bf16_f32 v18, v12, v13
v_cvt_pk_bf16_f32 v19, v14, v15
v_mfma_f32_4x4x4_16b_bf16 v[12:15], v[6:7], a[122:123], 0
ds_write_b128 v1, v[16:19] offset:7168
v_pk_mul_f32 v[8:9], v[8:9], v[240:241]
v_pk_mul_f32 v[10:11], v[10:11], v[242:243]
v_cvt_pk_bf16_f32 v20, v8, v9
v_cvt_pk_bf16_f32 v21, v10, v11
v_mfma_f32_4x4x4_16b_bf16 v[8:11], v[6:7], a[116:117], 0
ds_read_b128 a[124:127], v3 offset:7168
s_waitcnt lgkmcnt(2)
buffer_store_dwordx4 a[92:95], v4, s[20:23], s51 offen offset:128 sc1
v_pk_mul_f32 v[12:13], v[12:13], v[244:245]
v_pk_mul_f32 v[14:15], v[14:15], v[246:247]
v_cvt_pk_bf16_f32 v22, v12, v13
v_cvt_pk_bf16_f32 v23, v14, v15
v_mfma_f32_4x4x4_16b_bf16 v[12:15], v[6:7], a[118:119], 0
ds_write_b128 v1, v[20:23] offset:6144
v_pk_mul_f32 v[8:9], v[8:9], v[208:209]
v_pk_mul_f32 v[10:11], v[10:11], v[210:211]
v_cvt_pk_bf16_f32 v16, v8, v9
v_cvt_pk_bf16_f32 v17, v10, v11
v_mfma_f32_4x4x4_16b_bf16 v[8:11], v[6:7], a[112:113], 0
ds_read_b128 a[120:123], v3 offset:6144
s_waitcnt lgkmcnt(2)
buffer_store_dwordx4 a[124:127], v4, s[20:23], s51 offen offset:192 sc1
v_pk_mul_f32 v[12:13], v[12:13], v[212:213]
v_pk_mul_f32 v[14:15], v[14:15], v[214:215]
v_cvt_pk_bf16_f32 v18, v12, v13
v_cvt_pk_bf16_f32 v19, v14, v15
v_mfma_f32_4x4x4_16b_bf16 v[12:15], v[6:7], a[114:115], 0
ds_write_b128 v1, v[16:19] offset:5120
v_pk_mul_f32 v[8:9], v[8:9], v[176:177]
v_pk_mul_f32 v[10:11], v[10:11], v[178:179]
v_cvt_pk_bf16_f32 v20, v8, v9
v_cvt_pk_bf16_f32 v21, v10, v11
v_mfma_f32_4x4x4_16b_bf16 v[8:11], v[6:7], a[108:109], 0
ds_read_b128 a[116:119], v3 offset:5120
s_waitcnt lgkmcnt(2)
buffer_store_dwordx4 a[120:123], v4, s[20:23], s50 offen offset:192 sc1
v_pk_mul_f32 v[12:13], v[12:13], v[180:181]
v_pk_mul_f32 v[14:15], v[14:15], v[182:183]
v_cvt_pk_bf16_f32 v22, v12, v13
v_cvt_pk_bf16_f32 v23, v14, v15
v_mfma_f32_4x4x4_16b_bf16 v[12:15], v[6:7], a[110:111], 0
ds_write_b128 v1, v[20:23] offset:4096
v_pk_mul_f32 v[8:9], v[8:9], v[144:145]
v_pk_mul_f32 v[10:11], v[10:11], v[146:147]
v_cvt_pk_bf16_f32 v16, v8, v9
v_cvt_pk_bf16_f32 v17, v10, v11
v_mfma_f32_4x4x4_16b_bf16 v[8:11], v[6:7], a[104:105], 0
ds_read_b128 a[112:115], v3 offset:4096
s_waitcnt lgkmcnt(2)
buffer_store_dwordx4 a[116:119], v4, s[20:23], s49 offen offset:192 sc1
v_pk_mul_f32 v[12:13], v[12:13], v[148:149]
v_pk_mul_f32 v[14:15], v[14:15], v[150:151]
v_cvt_pk_bf16_f32 v18, v12, v13
v_cvt_pk_bf16_f32 v19, v14, v15
v_mfma_f32_4x4x4_16b_bf16 v[12:15], v[6:7], a[106:107], 0
ds_write_b128 v1, v[16:19] offset:3072
v_pk_mul_f32 v[8:9], v[8:9], v[112:113]
v_pk_mul_f32 v[10:11], v[10:11], v[114:115]
v_cvt_pk_bf16_f32 v20, v8, v9
v_cvt_pk_bf16_f32 v21, v10, v11
v_mfma_f32_4x4x4_16b_bf16 v[8:11], v[6:7], a[100:101], 0
ds_read_b128 a[108:111], v3 offset:3072
s_waitcnt lgkmcnt(2)
buffer_store_dwordx4 a[112:115], v4, s[20:23], s48 offen offset:192 sc1
v_pk_mul_f32 v[12:13], v[12:13], v[116:117]
v_pk_mul_f32 v[14:15], v[14:15], v[118:119]
v_cvt_pk_bf16_f32 v22, v12, v13
v_cvt_pk_bf16_f32 v23, v14, v15
v_mfma_f32_4x4x4_16b_bf16 v[12:15], v[6:7], a[102:103], 0
ds_write_b128 v1, v[20:23] offset:2048
v_pk_mul_f32 v[8:9], v[8:9], v[80:81]
v_pk_mul_f32 v[10:11], v[10:11], v[82:83]
v_cvt_pk_bf16_f32 v16, v8, v9
v_cvt_pk_bf16_f32 v17, v10, v11
v_mfma_f32_4x4x4_16b_bf16 v[8:11], v[6:7], a[96:97], 0
ds_read_b128 a[104:107], v3 offset:2048
s_waitcnt lgkmcnt(2)
buffer_store_dwordx4 a[108:111], v4, s[20:23], s47 offen offset:192 sc1
v_pk_mul_f32 v[12:13], v[12:13], v[84:85]
v_pk_mul_f32 v[14:15], v[14:15], v[86:87]
v_cvt_pk_bf16_f32 v18, v12, v13
v_cvt_pk_bf16_f32 v19, v14, v15
v_mfma_f32_4x4x4_16b_bf16 v[12:15], v[6:7], a[98:99], 0
ds_write_b128 v1, v[16:19] offset:1024
v_pk_mul_f32 v[8:9], v[8:9], v[48:49]
v_pk_mul_f32 v[10:11], v[10:11], v[50:51]
v_cvt_pk_bf16_f32 v20, v8, v9
v_cvt_pk_bf16_f32 v21, v10, v11
ds_read_b128 a[100:103], v3 offset:1024
s_waitcnt lgkmcnt(2)
buffer_store_dwordx4 a[104:107], v4, s[20:23], s46 offen offset:192 sc1
v_pk_mul_f32 v[12:13], v[12:13], v[52:53]
v_pk_mul_f32 v[14:15], v[14:15], v[54:55]
v_cvt_pk_bf16_f32 v22, v12, v13
v_cvt_pk_bf16_f32 v23, v14, v15
ds_write_b128 v1, v[20:23] offset:0
ds_read_b128 a[96:99], v3 offset:0
s_waitcnt lgkmcnt(2)
buffer_store_dwordx4 a[100:103], v4, s[20:23], s45 offen offset:192 sc1
s_waitcnt lgkmcnt(0)
buffer_store_dwordx4 a[96:99], v4, s[20:23], s44 offen offset:192 sc1
s_endpgm
L_slow0:
s_mov_b32 s62, 0x40000
L_spin0:
s_sleep 24
buffer_load_dword v8, v0, s[84:87], 0 offen offset:0 sc1
s_sub_u32 s62, s62, 1
s_waitcnt vmcnt(0)
s_cbranch_scc1 L_back0
v_cmp_gt_u32 vcc, 128, v8
s_nop 1
s_and_b32 s3, vcc_lo, 257
s_cbranch_scc1 L_spin0
s_branch L_back0
L_slow1:
s_mov_b32 s62, 0x40000
L_spin1:
s_sleep 24
buffer_load_dword v5, v0, s[84:87], 0 offen offset:0 sc1
s_sub_u32 s62, s62, 1
s_waitcnt vmcnt(0)
s_cbranch_scc1 L_back1
v_cmp_gt_u32 vcc, 128, v5
s_nop 1
s_and_b32 s3, vcc_lo, 514
s_cbranch_scc1 L_spin1
s_branch L_back1
L_slow2:
s_mov_b32 s62, 0x40000
L_spin2:
s_sleep 8
buffer_load_dword v5, v0, s[32:35], 0 offen offset:0 sc1
s_sub_u32 s62, s62, 1
s_waitcnt vmcnt(0)
s_cbranch_scc1 L_back2
v_cmp_ne_u32 vcc, 16256, v5
s_nop 1
s_and_b32 s3, vcc_lo, 15
s_cbranch_scc1 L_spin2
s_branch L_back2
L_slow3:
s_mov_b32 s62, 0x40000
L_spin3:
s_sleep 8
buffer_load_dword v5, v0, s[32:35], 0 offen offset:128 sc1
s_sub_u32 s62, s62, 1
s_waitcnt vmcnt(0)
s_cbranch_scc1 L_back3
v_cmp_ne_u32 vcc, 16256, v5
s_nop 1
s_and_b32 s3, vcc_lo, 15
s_cbranch_scc1 L_spin3
s_branch L_back3
L_slow4:
s_mov_b32 s62, 0x40000
L_spin4:
s_sleep 8
buffer_load_dword v5, v0, s[32:35], 0 offen offset:256 sc1
s_sub_u32 s62, s62, 1
s_waitcnt vmcnt(0)
s_cbranch_scc1 L_back4
v_cmp_ne_u32 vcc, 16256, v5
s_nop 1
s_and_b32 s3, vcc_lo, 15
s_cbranch_scc1 L_spin4
s_branch L_back4
L_slow5:
s_mov_b32 s62, 0x40000
L_spin5:
s_sleep 8
buffer_load_dword v5, v0, s[32:35], 0 offen offset:384 sc1
s_sub_u32 s62, s62, 1
s_waitcnt vmcnt(0)
s_cbranch_scc1 L_back5
v_cmp_ne_u32 vcc, 16256, v5
s_nop 1
s_and_b32 s3, vcc_lo, 15
s_cbranch_scc1 L_spin5
s_branch L_back5
L_slow6:
s_mov_b32 s62, 0x40000
L_spin6:
s_sleep 8
buffer_load_dword v5, v0, s[32:35], 0 offen offset:512 sc1
s_sub_u32 s62, s62, 1
s_waitcnt vmcnt(0)
s_cbranch_scc1 L_back6
v_cmp_ne_u32 vcc, 16256, v5
s_nop 1
s_and_b32 s3, vcc_lo, 15
s_cbranch_scc1 L_spin6
s_branch L_back6
L_slow7:
s_mov_b32 s62, 0x40000
L_spin7:
s_sleep 8
buffer_load_dword v5, v0, s[32:35], 0 offen offset:640 sc1
s_sub_u32 s62, s62, 1
s_waitcnt vmcnt(0)
s_cbranch_scc1 L_back7
v_cmp_ne_u32 vcc, 16256, v5
s_nop 1
s_and_b32 s3, vcc_lo, 15
s_cbranch_scc1 L_spin7
s_branch L_back7
L_slow8:
s_mov_b32 s62, 0x40000
L_spin8:
s_sleep 8
buffer_load_dword v5, v0, s[32:35], 0 offen offset:768 sc1
s_sub_u32 s62, s62, 1
s_waitcnt vmcnt(0)
s_cbranch_scc1 L_back8
v_cmp_ne_u32 vcc, 16256, v5
s_nop 1
s_and_b32 s3, vcc_lo, 15
s_cbranch_scc1 L_spin8
s_branch L_back8
L_slow9:
s_mov_b32 s62, 0x40000
L_spin9:
s_sleep 8
buffer_load_dword v5, v0, s[32:35], 0 offen offset:896 sc1
s_sub_u32 s62, s62, 1
s_waitcnt vmcnt(0)
s_cbranch_scc1 L_back9
v_cmp_ne_u32 vcc, 16256, v5
s_nop 1
s_and_b32 s3, vcc_lo, 15
s_cbranch_scc1 L_spin9
s_branch L_back9
L_end:
.section .rodata,"a"
.p2align 6
.amdhsa_kernel standalone__dcn_v2_cross__recsys_kernel
  .amdhsa_next_free_vgpr 512
  .amdhsa_next_free_sgpr 102
  .amdhsa_accum_offset 256
  .amdhsa_group_segment_fixed_size 0
  .amdhsa_kernarg_size 48
  .amdhsa_user_sgpr_count 2
  .amdhsa_user_sgpr_kernarg_segment_ptr 1
  .amdhsa_system_sgpr_workgroup_id_x 1
  .amdhsa_float_denorm_mode_32 3
.end_amdhsa_kernel
```
